```python
import torch

def _softmax(x, axis=-1):
    return torch.softmax(x, dim=axis)
def _gelu(x):
    return torch.nn.functional.gelu(x, approximate="tanh")
def _silu(x):
    return torch.nn.functional.silu(x)
def _sigmoid(x):
    return torch.sigmoid(x)
def _layernorm(x, axis=-1, eps=1e-5):
    m = x.mean(dim=axis, keepdim=True)
    v = x.var(dim=axis, keepdim=True, unbiased=False)
    return (x - m) / torch.sqrt(v + eps)
def _scatter_add(tgt, idx, src, axis=0):
    return tgt.clone().index_add_(axis, idx, src)
def _segment_sum(src, seg, n):
    out = torch.zeros((n,) + src.shape[1:], dtype=src.dtype)
    return out.index_add_(0, seg, src)
def _pad(x, pw):
    flat = tuple(v for pair in reversed(pw) for v in pair)
    return torch.nn.functional.pad(x, flat)

kernel_name = 'concat_heads__mha_block_cached__mha_block_cached__near_ridge'

def setup_inputs():

    _w = (lambda a: (lambda t: t.to(torch.bfloat16) if t.is_floating_point() else t)(torch.as_tensor(a)))
    def _A_setup():
        B, Sq, D = 16, 144, 512
        H, Sk, Dh = 32, 512, 128
        return {
            "x": _w((lambda *s: torch.randn(*s, dtype=torch.bfloat16) * 0.8)(B, Sq, D)),
            "k_cache": _w((lambda *s: torch.randn(*s, dtype=torch.bfloat16) * 0.8)(B, H, Sk, Dh)),
            "v_cache": _w((lambda *s: torch.randn(*s, dtype=torch.bfloat16) * 0.05)(B, H, Sk, Dh)),
            "wq": _w((lambda *s: torch.randn(*s, dtype=torch.bfloat16) * 0.8)(D, H * Dh) * (D ** -0.5)),
            "wo": _w((lambda *s: torch.randn(*s, dtype=torch.bfloat16) * 0.05)(H * Dh, D) * ((H * Dh) ** -0.5)),
        }
    _A_in = _A_setup()

    def _B_setup():
        B, Sq, D = 16, 144, 512
        H, Sk, Dh = 32, 512, 128
        return {
            "x": _w((lambda *s: torch.randn(*s, dtype=torch.bfloat16) * 0.8)(B, Sq, D)),
            "k_cache": _w((lambda *s: torch.randn(*s, dtype=torch.bfloat16) * 0.8)(B, H, Sk, Dh)),
            "v_cache": _w((lambda *s: torch.randn(*s, dtype=torch.bfloat16) * 0.05)(B, H, Sk, Dh)),
            "wq": _w((lambda *s: torch.randn(*s, dtype=torch.bfloat16) * 0.8)(D, H * Dh) * (D ** -0.5)),
            "wo": _w((lambda *s: torch.randn(*s, dtype=torch.bfloat16) * 0.05)(H * Dh, D) * ((H * Dh) ** -0.5)),
        }
    _B_in = _B_setup()

    return {
        "A_x": _A_in["x"],
        "A_k_cache": _A_in["k_cache"],
        "A_v_cache": _A_in["v_cache"],
        "A_wq": _A_in["wq"],
        "A_wo": _A_in["wo"],
        "B_x": _B_in["x"],
        "B_k_cache": _B_in["k_cache"],
        "B_v_cache": _B_in["v_cache"],
        "B_wq": _B_in["wq"],
        "B_wo": _B_in["wo"],
    }

def reference(A_x, A_k_cache, A_v_cache, A_wq, A_wo, B_x, B_k_cache, B_v_cache, B_wq, B_wo):
    def _A_ref(x, k_cache, v_cache, wq, wo):
        B, Sq, D = x.shape
        H, Dh = 32, 128
        q = (lambda x, *d: x.permute(*d))((x @ wq).reshape(B, Sq, H, Dh), 0, 2, 1, 3)
        scores = torch.einsum("bhqd,bhkd->bhqk", q, k_cache) * (Dh ** -0.5)
        p = _softmax(scores, axis=-1)
        o = torch.einsum("bhqk,bhkd->bhqd", p, v_cache)
        return (lambda x, *d: x.permute(*d))(o, 0, 2, 1, 3).reshape(B, Sq, H * Dh) @ wo

    def _B_ref(x, k_cache, v_cache, wq, wo):
        B, Sq, D = x.shape
        H, Dh = 32, 128
        q = (lambda x, *d: x.permute(*d))((x @ wq).reshape(B, Sq, H, Dh), 0, 2, 1, 3)
        scores = torch.einsum("bhqd,bhkd->bhqk", q, k_cache) * (Dh ** -0.5)
        p = _softmax(scores, axis=-1)
        o = torch.einsum("bhqk,bhkd->bhqd", p, v_cache)
        return (lambda x, *d: x.permute(*d))(o, 0, 2, 1, 3).reshape(B, Sq, H * Dh) @ wo

    a = _A_ref(A_x, A_k_cache, A_v_cache, A_wq, A_wo)
    b = _B_ref(B_x, B_k_cache, B_v_cache, B_wq, B_wo)
    return torch.concatenate([a, b], axis=-1)
```

```asm
; @launch grid=(256,1,1) block=(256,1,1) lds=161600
.amdgcn_target "amdgcn-amd-amdhsa--gfx950"
.text
.globl concat_heads__mha_block_cached__mha_block_cached__near_ridge_kernel
.p2align 8
.type concat_heads__mha_block_cached__mha_block_cached__near_ridge_kernel,@function
concat_heads__mha_block_cached__mha_block_cached__near_ridge_kernel:
s_cmp_ge_u32 s2, 256
s_cbranch_scc1 L_end
s_mov_b32 s97, 0
L_restart:
s_load_dwordx8 s[44:51], s[0:1], 0
s_load_dwordx4 s[52:55], s[0:1], 32
s_load_dwordx8 s[76:83], s[0:1], 48
s_load_dwordx2 s[84:85], s[0:1], 80
s_load_dwordx2 s[88:89], s[0:1], 96
v_lshrrev_b32 v15, 6, v0
v_and_b32 v74, 63, v0
v_readfirstlane_b32 s40, v15
v_lshlrev_b32 v253, 4, v74
s_and_b32 s3, s2, 7
s_lshr_b32 s4, s2, 3
s_lshr_b32 s60, s3, 2
s_and_b32 s3, s3, 3
s_and_b32 s5, s3, 3
s_lshl_b32 s5, s5, 1
s_and_b32 s6, s4, 1
s_add_u32 s58, s5, s6
s_lshr_b32 s3, s3, 2
s_lshl_b32 s3, s3, 4
s_lshr_b32 s6, s4, 1
s_add_u32 s59, s3, s6
s_getpc_b64 s[92:93]
L_pc:
s_sub_u32 s92, s92, L_pc-concat_heads__mha_block_cached__mha_block_cached__near_ridge_kernel
s_subb_u32 s93, s93, 0
s_mov_b32 s94, L_end-concat_heads__mha_block_cached__mha_block_cached__near_ridge_kernel+4
s_mov_b32 s95, 0x20000
s_lshl_b32 s4, s4, 2
s_add_u32 s4, s4, s40
s_and_b32 s4, s4, 127
s_lshl_b32 s64, s4, 10
s_mov_b32 m0, 148224
s_nop 0
buffer_load_dwordx4 v253, s[92:95], s64 offen  lds
v_lshrrev_b32 v75, 3, v74
v_and_b32 v76, 7, v74
v_bfe_u32 v77, v75, 1, 1
v_lshlrev_b32 v78, 2, v77
v_xor_b32 v78, v78, v76
v_lshlrev_b32 v78, 4, v78
s_lshl_b32 s3, s40, 3
v_add_u32 v79, s3, v75
v_lshl_add_u32 v14, v79, 13, v78
v_lshl_add_u32 v13, v79, 8, v78
s_and_b32 s3, s58, 1
s_lshl_b32 s3, s3, 2
s_add_u32 s3, s3, s59
s_and_b32 s3, s3, 0
s_lshl_b32 s69, s3, 7
s_lshl_b32 s62, s3, 19
s_mov_b32 s61, 0xffc40000
s_lshl_b32 s3, s58, 10
s_add_u32 s3, s3, s62
v_add_u32 v14, s3, v14
s_lshl_b32 s3, s40, 1
v_or_b32 v77, s3, v77
v_xor_b32 v77, v77, v76
v_lshlrev_b32 v77, 4, v77
v_lshl_add_u32 v12, v79, 8, v77
v_lshrrev_b32 v77, 1, v75
v_xor_b32 v77, v77, v76
v_lshlrev_b32 v77, 4, v77
s_lshl_b32 s3, s40, 5
v_add_u32 v80, s3, v75
v_lshl_add_u32 v80, v80, 10, v77
v_xor_b32 v81, 64, v80
v_add_u32 v81, 0x2000, v81
v_add_u32 v82, 0x4000, v80
v_add_u32 v83, 0x4000, v81
v_lshl_add_u32 v89, v75, 10, v77
s_and_b32 s4, s40, 1
s_lshl_b32 s3, s4, 6
v_xor_b32 v89, s3, v89
s_lshl_b32 s3, s4, 13
s_lshr_b32 s4, s40, 1
s_lshl_b32 s4, s4, 7
s_add_u32 s68, s69, s4
s_add_u32 s3, s3, 0x20000
v_add_u32 v89, s3, v89
v_and_b32 v94, 15, v74
v_lshrrev_b32 v84, 4, v74
s_lshl_b32 s41, s40, 10
s_mov_b32 s56, s41
s_lshr_b32 s3, s40, 1
s_and_b32 s4, s40, 1
s_mul_i32 s5, s3, 2064
s_add_u32 s5, s5, 32768
s_mul_i32 s6, s4, 1032
s_add_u32 s42, s5, s6
s_mul_i32 s6, s4, 1040
s_add_u32 s71, s5, s6
s_lshl_b32 s70, s40, 13
s_add_u32 s70, s70, 115456
s_mov_b32 s18, 4194304
s_mov_b32 s19, 0x20000
s_mov_b32 s22, 147456
s_mov_b32 s23, 0x20000
s_mul_i32 s4, s59, 147456
s_cmp_eq_u32 s60, 0
s_waitcnt lgkmcnt(0)
s_cselect_b64 s[44:45], s[44:45], s[54:55]
s_cselect_b64 s[46:47], s[46:47], s[76:77]
s_cselect_b64 s[48:49], s[48:49], s[78:79]
s_cselect_b64 s[16:17], s[50:51], s[80:81]
s_cselect_b64 s[52:53], s[52:53], s[82:83]
s_add_u32 s20, s44, s4
s_addc_u32 s21, s45, 0
s_add_u32 m0, s42, 33024
s_nop 0
buffer_load_dwordx4 v14, s[16:19], 0 offen lds
s_add_u32 m0, s42, 37024
s_nop 0
buffer_load_dwordx4 v14, s[16:19], 0 offen offset:128 lds
v_add_u32 v14, 0x40000, v14
s_add_u32 s63, s69, 0
s_and_b32 s63, s63, 0x3ff
s_add_u32 m0, s41, 0
s_nop 0
buffer_load_dwordx4 v80, s[20:23], s63 offen lds
s_add_u32 m0, s41, 4096
s_nop 0
buffer_load_dwordx4 v81, s[20:23], s63 offen lds
s_add_u32 m0, s41, 8192
s_nop 0
buffer_load_dwordx4 v82, s[20:23], s63 offen lds
s_add_u32 m0, s41, 12288
s_nop 0
buffer_load_dwordx4 v83, s[20:23], s63 offen lds
s_add_u32 s63, s68, 0
s_and_b32 s63, s63, 0x3ff
s_add_u32 m0, s41, 98816
s_nop 0
buffer_load_dwordx4 v89, s[20:23], s63 offen lds
s_add_u32 m0, s42, 41280
s_nop 0
buffer_load_dwordx4 v14, s[16:19], 0 offen lds
s_add_u32 m0, s42, 45280
s_nop 0
buffer_load_dwordx4 v14, s[16:19], 0 offen offset:128 lds
s_add_u32 s62, s62, 0x80000
s_and_b32 s62, s62, 0x3fffff
s_cselect_b32 s67, 0x40000, s61
v_add_u32 v14, s67, v14
s_add_u32 s63, s69, 128
s_and_b32 s63, s63, 0x3ff
s_add_u32 m0, s41, 16384
s_nop 0
buffer_load_dwordx4 v80, s[20:23], s63 offen lds
s_add_u32 m0, s41, 20480
s_nop 0
buffer_load_dwordx4 v81, s[20:23], s63 offen lds
s_add_u32 m0, s41, 24576
s_nop 0
buffer_load_dwordx4 v82, s[20:23], s63 offen lds
s_add_u32 m0, s41, 28672
s_nop 0
buffer_load_dwordx4 v83, s[20:23], s63 offen lds
s_mov_b32 s10, 524288
s_mov_b32 s11, 0x20000
s_mov_b32 s14, 524288
s_mov_b32 s15, 0x20000
s_mov_b32 s26, 1179648
s_mov_b32 s27, 0x20000
s_mov_b32 s30, 2048
s_mov_b32 s31, 0x20000
s_mov_b32 s34, 294912
s_mov_b32 s35, 0x20000
s_mov_b32 s38, 524288
s_mov_b32 s39, 0x20000
s_lshl_b32 s3, s59, 3
s_add_u32 s3, s3, s58
s_lshl_b32 s3, s3, 19
s_add_u32 s8, s46, s3
s_addc_u32 s9, s47, 0
s_add_u32 s12, s48, s3
s_addc_u32 s13, s49, 0
s_lshl_b32 s5, s58, 19
s_add_u32 s36, s52, s5
s_addc_u32 s37, s53, 0
s_mul_i32 s5, s59, 294912
s_add_u32 s32, s84, s5
s_addc_u32 s33, s85, 0
s_lshl_b32 s6, s60, 4
s_add_u32 s6, s6, s59
s_mul_i32 s7, s6, 1179648
s_add_u32 s24, s88, s7
s_addc_u32 s25, s89, 0
s_lshl_b32 s6, s6, 11
s_add_u32 s6, s6, 0x2400000
s_add_u32 s28, s88, s6
s_addc_u32 s29, s89, 0
s_add_u32 s100, s88, 0x2500000
s_addc_u32 s101, s89, 0
s_load_dword s57, s[28:29], 1024
s_lshr_b32 s3, s40, 1
s_lshl_b32 s3, s3, 13
s_and_b32 s4, s40, 1
s_lshl_b32 s4, s4, 9
s_add_u32 s55, s3, s4
s_mov_b32 s45, 0x40100
s_add_u32 s44, s61, 256
s_mov_b32 s75, 0x40000000
v_lshrrev_b32 v75, 2, v94
v_and_b32 v76, 3, v94
v_lshlrev_b32 v77, 10, v75
v_lshl_add_u32 v77, v76, 7, v77
v_lshlrev_b32 v78, 1, v75
v_bfe_u32 v79, v94, 1, 1
v_or_b32 v78, v78, v79
v_xor_b32 v78, v78, v84
v_lshl_add_u32 v77, v78, 4, v77
v_add_u32 v4, s55, v77
v_xor_b32 v5, 64, v4
s_xor_b32 s3, s40, 0
s_lshr_b32 s4, s3, 1
s_lshl_b32 s4, s4, 12
s_and_b32 s3, s3, 1
s_lshl_b32 s3, s3, 6
v_xor_b32 v79, s3, v77
v_add_u32 v90, s4, v79
s_xor_b32 s3, s40, 1
s_lshr_b32 s4, s3, 1
s_lshl_b32 s4, s4, 12
s_and_b32 s3, s3, 1
s_lshl_b32 s3, s3, 6
v_xor_b32 v79, s3, v77
v_add_u32 v91, s4, v79
s_xor_b32 s3, s40, 2
s_lshr_b32 s4, s3, 1
s_lshl_b32 s4, s4, 12
s_and_b32 s3, s3, 1
s_lshl_b32 s3, s3, 6
v_xor_b32 v79, s3, v77
v_add_u32 v92, s4, v79
s_xor_b32 s3, s40, 3
s_lshr_b32 s4, s3, 1
s_lshl_b32 s4, s4, 12
s_and_b32 s3, s3, 1
s_lshl_b32 s3, s3, 6
v_xor_b32 v79, s3, v77
v_add_u32 v93, s4, v79
v_lshrrev_b32 v78, 1, v84
v_mul_u32_u24 v77, 2064, v78
v_and_b32 v78, 1, v84
v_mul_u32_u24 v78, 1032, v78
v_add_u32 v77, v77, v78
v_add_u32 v98, 32768, v77
v_lshrrev_b32 v78, 1, v75
v_lshlrev_b32 v78, 2, v78
v_xor_b32 v78, v78, v76
v_lshlrev_b32 v78, 4, v78
v_lshl_add_u32 v99, v75, 7, v78
s_xor_b32 s3, s40, 0
s_lshr_b32 s4, s3, 1
s_mul_i32 s4, s4, 4128
s_and_b32 s3, s3, 1
s_lshl_b32 s3, s3, 6
v_xor_b32 v79, s3, v99
v_add3_u32 v6, v79, v98, s4
s_xor_b32 s3, s40, 1
s_lshr_b32 s4, s3, 1
s_mul_i32 s4, s4, 4128
s_and_b32 s3, s3, 1
s_lshl_b32 s3, s3, 6
v_xor_b32 v79, s3, v99
v_add3_u32 v7, v79, v98, s4
s_xor_b32 s3, s40, 2
s_lshr_b32 s4, s3, 1
s_mul_i32 s4, s4, 4128
s_and_b32 s3, s3, 1
s_lshl_b32 s3, s3, 6
v_xor_b32 v79, s3, v99
v_add3_u32 v8, v79, v98, s4
s_xor_b32 s3, s40, 3
s_lshr_b32 s4, s3, 1
s_mul_i32 s4, s4, 4128
s_and_b32 s3, s3, 1
s_lshl_b32 s3, s3, 6
v_xor_b32 v79, s3, v99
v_add3_u32 v9, v79, v98, s4
v_add_u32 v10, 98816, v253
s_lshr_b32 s3, s40, 1
s_lshl_b32 s3, s3, 10
s_and_b32 s4, s40, 1
s_lshl_b32 s4, s4, 3
s_add_u32 s3, s3, s4
v_add_u32 v11, s3, v10
v_and_b32 v75, 7, v94
v_lshrrev_b32 v76, 1, v94
v_xor_b32 v76, v76, v84
v_lshlrev_b32 v76, 4, v76
v_lshl_add_u32 v76, v75, 7, v76
v_lshrrev_b32 v75, 3, v94
v_xor_b32 v77, 64, v76
v_lshlrev_b32 v78, 12, v75
v_add3_u32 v85, v76, v78, s41
v_add3_u32 v86, v77, v78, s41
v_mul_u32_u24 v78, 4128, v75
v_add3_u32 v87, v76, v78, s71
v_add3_u32 v88, v77, v78, s71
v_lshlrev_b32 v78, 10, v75
v_add3_u32 v96, v76, v78, s70
v_add3_u32 v97, v77, v78, s70
v_add_u32 v78, 98816, v78
v_add_u32 v251, v76, v78
v_add_u32 v252, v77, v78
v_mov_b32 v0, v90
v_mov_b32 v1, v91
v_mov_b32 v2, v92
v_mov_b32 v3, v93
v_mov_b32 v16, 0x3f803f80
v_mov_b32 v17, 0x3f803f80
v_mov_b32 v18, 0x3f803f80
v_mov_b32 v19, 0x3f803f80
s_mov_b32 s48, 0x3e0293ee
s_mov_b32 s49, 0x4f800000
s_mov_b64 s[50:51], 0
s_mov_b64 s[52:53], 0
s_mov_b32 s47, 0
s_mov_b32 s96, 0
s_and_b32 s3, s59, 15
s_lshl_b32 s3, s3, 2
s_add_u32 s3, s3, s40
s_lshl_b32 s4, s3, 13
v_lshl_add_u32 v254, v74, 7, s4
s_lshl_b32 s3, s3, 16
s_lshl_b32 s4, s58, 10
s_add_u32 s3, s3, s4
s_add_u32 s3, s3, 256
v_and_b32 v75, 7, v74
v_lshrrev_b32 v76, 3, v74
v_min_u32 v76, 5, v76
v_lshlrev_b32 v76, 7, v76
v_lshl_add_u32 v75, v75, 13, v76
v_add_u32 v255, s3, v75
s_add_u32 s54, s56, 28928
s_mul_i32 s43, s59, 8192
s_and_b32 s43, s43, 0x1ffff
v_add_u32 v12, s43, v12
v_add_u32 v13, s43, v13
s_mov_b32 s4, 8192
s_mov_b32 s5, 0xfffe2000
s_add_u32 m0, s42, 49536
s_nop 0
buffer_load_dwordx4 v14, s[16:19], 0 offen lds
s_add_u32 m0, s42, 53536
s_nop 0
buffer_load_dwordx4 v14, s[16:19], 0 offen offset:128 lds
v_add_u32 v14, 0x40000, v14
s_add_u32 s63, s69, 256
s_and_b32 s63, s63, 0x3ff
s_add_u32 m0, s71, 0
s_nop 0
buffer_load_dwordx4 v80, s[20:23], s63 offen lds
s_add_u32 m0, s71, 4128
s_nop 0
buffer_load_dwordx4 v81, s[20:23], s63 offen lds
s_add_u32 m0, s71, 8256
s_nop 0
buffer_load_dwordx4 v82, s[20:23], s63 offen lds
s_add_u32 m0, s71, 12384
s_nop 0
buffer_load_dwordx4 v83, s[20:23], s63 offen lds
s_waitcnt vmcnt(12) lgkmcnt(0)
s_mul_i32 s57, s57, 1664525
s_add_u32 s57, s57, 1013904223
ds_read_b128 a[0:3], v85 offset:0
ds_read_b128 a[64:67], v85 offset:8192
ds_read_b128 a[4:7], v86 offset:0
ds_read_b128 a[68:71], v86 offset:8192
s_waitcnt lgkmcnt(0)
s_barrier
ds_read_b64_tr_b16 a[224:225], v6 offset:33024
ds_read_b64_tr_b16 a[226:227], v6 offset:33536
s_waitcnt lgkmcnt(0)
v_mfma_f32_16x16x32_bf16 v[100:103], a[224:227], a[0:3], 0
s_add_u32 m0, s42, 57792
ds_read_b128 v[76:79], v251 offset:0
ds_read_b64_tr_b16 a[228:229], v6 offset:33032
ds_read_b64_tr_b16 a[230:231], v6 offset:33544
v_mfma_f32_16x16x32_bf16 v[104:107], a[224:227], a[64:67], 0
s_waitcnt lgkmcnt(2)
ds_read_b64_tr_b16 a[232:233], v7 offset:33024
ds_read_b64_tr_b16 a[234:235], v7 offset:33536
v_mfma_f32_16x16x32_bf16 v[164:167], a[224:227], v[76:79], 0
s_waitcnt lgkmcnt(2)
ds_read_b64_tr_b16 a[238:239], v7 offset:33544
buffer_load_dwordx4 v14, s[16:19], 0 offen lds
ds_read_b64_tr_b16 a[236:237], v7 offset:33032
v_mfma_f32_16x16x32_bf16 v[108:111], a[228:231], a[0:3], 0
s_add_u32 m0, s42, 61792
ds_read_b64_tr_b16 a[242:243], v8 offset:33536
ds_read_b64_tr_b16 a[240:241], v8 offset:33024
v_mfma_f32_16x16x32_bf16 v[112:115], a[228:231], a[64:67], 0
s_add_u32 s63, s68, 256
ds_read_b64_tr_b16 a[246:247], v8 offset:33544
ds_read_b64_tr_b16 a[244:245], v8 offset:33032
v_mfma_f32_16x16x32_bf16 v[168:171], a[228:231], v[76:79], 0
s_waitcnt lgkmcnt(6)
ds_read_b64_tr_b16 a[250:251], v9 offset:33536
buffer_load_dwordx4 v14, s[16:19], 0 offen offset:128 lds
ds_read_b64_tr_b16 a[248:249], v9 offset:33024
v_mfma_f32_16x16x32_bf16 v[116:119], a[232:235], a[0:3], 0
s_and_b32 s63, s63, 0x3ff
ds_read_b64_tr_b16 a[254:255], v9 offset:33544
ds_read_b64_tr_b16 a[252:253], v9 offset:33032
v_mfma_f32_16x16x32_bf16 v[120:123], a[232:235], a[64:67], 0
s_waitcnt lgkmcnt(8)
s_add_u32 m0, s41, 102912
s_add_u32 s62, s62, 0x80000
buffer_load_dwordx4 v89, s[20:23], s63 offen lds
v_mfma_f32_16x16x32_bf16 v[124:127], a[236:239], a[0:3], 0
s_add_u32 s63, s69, 384
s_add_u32 m0, s71, 16512
s_and_b32 s63, s63, 0x3ff
buffer_load_dwordx4 v80, s[20:23], s63 offen lds
v_mfma_f32_16x16x32_bf16 v[128:131], a[236:239], a[64:67], 0
s_waitcnt lgkmcnt(6)
s_add_u32 m0, s71, 20640
s_nop 0
buffer_load_dwordx4 v81, s[20:23], s63 offen lds
s_add_u32 m0, s71, 24768
s_nop 0
buffer_load_dwordx4 v82, s[20:23], s63 offen lds
s_add_u32 m0, s71, 28896
s_nop 0
buffer_load_dwordx4 v83, s[20:23], s63 offen lds
s_waitcnt lgkmcnt(0) vmcnt(13)
s_barrier
ds_read_b64_tr_b16 a[226:227], v6 offset:41792
s_add_u32 m0, s42, 33024
v_mfma_f32_16x16x32_bf16 v[132:135], a[240:243], a[0:3], 0
s_and_b32 s62, s62, 0x3fffff
s_cselect_b32 s67, 0x40000, s61
ds_read_b64_tr_b16 a[224:225], v6 offset:41280
ds_read_b128 v[76:79], v252 offset:0
v_mfma_f32_16x16x32_bf16 v[136:139], a[240:243], a[64:67], 0
s_add_u32 s63, s69, 512
ds_read_b64_tr_b16 a[230:231], v6 offset:41800
v_add_u32 v14, s67, v14
buffer_load_dwordx4 v14, s[16:19], 0 offen lds
v_mfma_f32_16x16x32_bf16 v[140:143], a[244:247], a[0:3], 0
s_add_u32 m0, s42, 37024
ds_read_b64_tr_b16 a[228:229], v6 offset:41288
ds_read_b64_tr_b16 a[234:235], v7 offset:41792
v_mfma_f32_16x16x32_bf16 v[144:147], a[244:247], a[64:67], 0
s_and_b32 s63, s63, 0x3ff
ds_read_b64_tr_b16 a[232:233], v7 offset:41280
buffer_load_dwordx4 v14, s[16:19], 0 offen offset:128 lds
v_mfma_f32_16x16x32_bf16 v[148:151], a[248:251], a[0:3], 0
s_add_u32 m0, s70, 0
ds_read_b64_tr_b16 a[238:239], v7 offset:41800
ds_read_b64_tr_b16 a[236:237], v7 offset:41288
v_mfma_f32_16x16x32_bf16 v[152:155], a[248:251], a[64:67], 0
s_add_u32 s62, s62, 0x80000
ds_read_b64_tr_b16 a[242:243], v8 offset:41792
buffer_load_dwordx4 v80, s[20:23], s63 offen lds
v_mfma_f32_16x16x32_bf16 v[156:159], a[252:255], a[0:3], 0
s_add_u32 m0, s70, 1024
ds_read_b64_tr_b16 a[240:241], v8 offset:41280
ds_read_b64_tr_b16 a[246:247], v8 offset:41800
v_mfma_f32_16x16x32_bf16 v[160:163], a[252:255], a[64:67], 0
s_waitcnt lgkmcnt(10)
ds_read_b64_tr_b16 a[244:245], v8 offset:41288
buffer_load_dwordx4 v81, s[20:23], s63 offen lds
v_mfma_f32_16x16x32_bf16 v[100:103], a[224:227], a[4:7], v[100:103]
s_add_u32 m0, s70, 2048
ds_read_b64_tr_b16 a[250:251], v9 offset:41792
ds_read_b64_tr_b16 a[248:249], v9 offset:41280
v_mfma_f32_16x16x32_bf16 v[104:107], a[224:227], a[68:71], v[104:107]
s_waitcnt lgkmcnt(12)
ds_read_b64_tr_b16 a[254:255], v9 offset:41800
ds_read_b64_tr_b16 a[252:253], v9 offset:41288
v_mfma_f32_16x16x32_bf16 v[164:167], a[224:227], v[76:79], v[164:167]
s_waitcnt lgkmcnt(12)
ds_read_b128 a[76:79], v86 offset:24576
buffer_load_dwordx4 v82, s[20:23], s63 offen lds
v_mfma_f32_16x16x32_bf16 v[108:111], a[228:231], a[4:7], v[108:111]
s_add_u32 m0, s70, 3072
ds_read_b128 a[12:15], v86 offset:16384
ds_read_b128 a[72:75], v85 offset:24576
v_mfma_f32_16x16x32_bf16 v[112:115], a[228:231], a[68:71], v[112:115]
s_and_b32 s62, s62, 0x3fffff
s_cselect_b32 s67, 0x40000, s61
ds_read_b128 a[8:11], v85 offset:16384
buffer_load_dwordx4 v83, s[20:23], s63 offen lds
v_mfma_f32_16x16x32_bf16 v[168:171], a[228:231], v[76:79], v[168:171]
s_waitcnt lgkmcnt(14)
v_add_u32 v14, 0x40000, v14
s_add_u32 m0, s42, 41280
v_mfma_f32_16x16x32_bf16 v[116:119], a[232:235], a[4:7], v[116:119]
s_add_u32 s63, s68, 512
s_and_b32 s63, s63, 0x3ff
s_add_u32 s62, s62, 0x80000
v_mfma_f32_16x16x32_bf16 v[120:123], a[232:235], a[68:71], v[120:123]
s_waitcnt lgkmcnt(12)
s_add_u32 s43, s43, 8192
v_add_u32 v15, s56, v10
v_mfma_f32_16x16x32_bf16 v[124:127], a[236:239], a[4:7], v[124:127]
s_and_b32 s43, s43, 0x1ffff
s_cselect_b32 s7, s4, s5
s_add_u32 s43, s43, 8192
v_mfma_f32_16x16x32_bf16 v[128:131], a[236:239], a[68:71], v[128:131]
s_waitcnt lgkmcnt(10)
s_waitcnt lgkmcnt(0) vmcnt(17)
s_barrier
ds_read_b64_tr_b16 a[226:227], v6 offset:50048
buffer_load_dwordx4 v14, s[16:19], 0 offen lds
v_mfma_f32_16x16x32_bf16 v[132:135], a[240:243], a[4:7], v[132:135]
s_add_u32 m0, s42, 45280
ds_read_b64_tr_b16 a[224:225], v6 offset:49536
v_mfma_f32_16x16x32_bf16 v[136:139], a[240:243], a[68:71], v[136:139]
s_and_b32 s43, s43, 0x1ffff
s_cselect_b32 s6, s4, s5
ds_read_b128 v[76:79], v251 offset:2048
s_add_u32 s43, s43, 8192
v_mfma_f32_16x16x32_bf16 v[140:143], a[244:247], a[4:7], v[140:143]
ds_read_b64_tr_b16 a[230:231], v6 offset:50056
ds_read_b64_tr_b16 a[228:229], v6 offset:49544
v_mfma_f32_16x16x32_bf16 v[144:147], a[244:247], a[68:71], v[144:147]
ds_read_b64_tr_b16 a[234:235], v7 offset:50048
buffer_load_dwordx4 v14, s[16:19], 0 offen offset:128 lds
v_mfma_f32_16x16x32_bf16 v[148:151], a[248:251], a[4:7], v[148:151]
s_add_u32 m0, s41, 107008
ds_read_b64_tr_b16 a[232:233], v7 offset:49536
buffer_load_dwordx4 v89, s[20:23], s63 offen lds
v_mfma_f32_16x16x32_bf16 v[152:155], a[248:251], a[68:71], v[152:155]
s_add_u32 s63, s69, 640
ds_read_b64_tr_b16 a[238:239], v7 offset:50056
s_add_u32 m0, s70, 4096
v_mfma_f32_16x16x32_bf16 v[156:159], a[252:255], a[4:7], v[156:159]
s_and_b32 s63, s63, 0x3ff
ds_read_b64_tr_b16 a[236:237], v7 offset:49544
ds_read_b64_tr_b16 a[242:243], v8 offset:50048
v_mfma_f32_16x16x32_bf16 v[160:163], a[252:255], a[68:71], v[160:163]
s_waitcnt lgkmcnt(8)
ds_read_b64_tr_b16 a[240:241], v8 offset:49536
buffer_load_dwordx4 v80, s[20:23], s63 offen lds
v_mfma_f32_16x16x32_bf16 v[100:103], a[224:227], a[8:11], v[100:103]
s_add_u32 m0, s70, 5120
ds_read_b64_tr_b16 a[246:247], v8 offset:50056
buffer_load_dwordx4 v81, s[20:23], s63 offen lds
v_mfma_f32_16x16x32_bf16 v[104:107], a[224:227], a[72:75], v[104:107]
s_waitcnt lgkmcnt(9)
ds_read_b64_tr_b16 a[244:245], v8 offset:49544
s_add_u32 m0, s70, 6144
v_mfma_f32_16x16x32_bf16 v[164:167], a[224:227], v[76:79], v[164:167]
s_waitcnt lgkmcnt(8)
ds_read_b64_tr_b16 a[250:251], v9 offset:50048
ds_read_b64_tr_b16 a[248:249], v9 offset:49536
v_mfma_f32_16x16x32_bf16 v[108:111], a[228:231], a[8:11], v[108:111]
ds_read_b64_tr_b16 a[254:255], v9 offset:50056
buffer_load_dwordx4 v82, s[20:23], s63 offen lds
v_mfma_f32_16x16x32_bf16 v[112:115], a[228:231], a[72:75], v[112:115]
s_add_u32 m0, s70, 7168
ds_read_b64_tr_b16 a[252:253], v9 offset:49544
buffer_load_dwordx4 v83, s[20:23], s63 offen lds
v_mfma_f32_16x16x32_bf16 v[168:171], a[228:231], v[76:79], v[168:171]
s_waitcnt lgkmcnt(10)
v_add_u32 v14, s67, v14
s_add_u32 m0, s42, 49536
v_mfma_f32_16x16x32_bf16 v[116:119], a[232:235], a[8:11], v[116:119]
s_add_u32 s63, s68, 768
s_and_b32 s63, s63, 0x3ff
v_mfma_f32_16x16x32_bf16 v[120:123], a[232:235], a[72:75], v[120:123]
s_waitcnt lgkmcnt(8)
s_and_b32 s62, s62, 0x3fffff
s_cselect_b32 s67, 0x40000, s61
v_mfma_f32_16x16x32_bf16 v[124:127], a[236:239], a[8:11], v[124:127]
s_add_u32 s62, s62, 0x80000
v_mfma_f32_16x16x32_bf16 v[128:131], a[236:239], a[72:75], v[128:131]
s_waitcnt lgkmcnt(6)
s_waitcnt lgkmcnt(0) vmcnt(18)
s_barrier
ds_read_b64_tr_b16 a[226:227], v6 offset:58304
buffer_load_dwordx4 v14, s[16:19], 0 offen lds
v_mfma_f32_16x16x32_bf16 v[132:135], a[240:243], a[8:11], v[132:135]
s_add_u32 m0, s42, 53536
ds_read_b64_tr_b16 a[224:225], v6 offset:57792
ds_read_b128 v[76:79], v252 offset:2048
v_mfma_f32_16x16x32_bf16 v[136:139], a[240:243], a[72:75], v[136:139]
ds_read_b64_tr_b16 a[230:231], v6 offset:58312
v_mfma_f32_16x16x32_bf16 v[140:143], a[244:247], a[8:11], v[140:143]
ds_read_b64_tr_b16 a[228:229], v6 offset:57800
ds_read_b64_tr_b16 a[234:235], v7 offset:58304
v_mfma_f32_16x16x32_bf16 v[144:147], a[244:247], a[72:75], v[144:147]
ds_read_b64_tr_b16 a[232:233], v7 offset:57792
buffer_load_dwordx4 v14, s[16:19], 0 offen offset:128 lds
v_mfma_f32_16x16x32_bf16 v[148:151], a[248:251], a[8:11], v[148:151]
s_add_u32 m0, s42, 57792
ds_read_b64_tr_b16 a[238:239], v7 offset:58312
ds_read_b64_tr_b16 a[236:237], v7 offset:57800
v_mfma_f32_16x16x32_bf16 v[152:155], a[248:251], a[72:75], v[152:155]
ds_read_b64_tr_b16 a[242:243], v8 offset:58304
v_add_u32 v14, 0x40000, v14
v_mfma_f32_16x16x32_bf16 v[156:159], a[252:255], a[8:11], v[156:159]
ds_read_b64_tr_b16 a[240:241], v8 offset:57792
ds_read_b64_tr_b16 a[246:247], v8 offset:58312
v_mfma_f32_16x16x32_bf16 v[160:163], a[252:255], a[72:75], v[160:163]
s_waitcnt lgkmcnt(10)
ds_read_b64_tr_b16 a[244:245], v8 offset:57800
ds_read_b64_tr_b16 a[250:251], v9 offset:58304
v_mfma_f32_16x16x32_bf16 v[100:103], a[224:227], a[12:15], v[100:103]
ds_read_b64_tr_b16 a[248:249], v9 offset:57792
v_mfma_f32_16x16x32_bf16 v[104:107], a[224:227], a[76:79], v[104:107]
s_waitcnt lgkmcnt(12)
ds_read_b64_tr_b16 a[254:255], v9 offset:58312
ds_read_b64_tr_b16 a[252:253], v9 offset:57800
v_mfma_f32_16x16x32_bf16 v[164:167], a[224:227], v[76:79], v[164:167]
s_waitcnt lgkmcnt(12)
ds_read_b128 a[84:87], v88 offset:8256
v_mfma_f32_16x16x32_bf16 v[108:111], a[228:231], a[12:15], v[108:111]
ds_read_b128 a[20:23], v88 offset:0
ds_read_b128 a[80:83], v87 offset:8256
v_mfma_f32_16x16x32_bf16 v[112:115], a[228:231], a[76:79], v[112:115]
ds_read_b128 a[16:19], v87 offset:0
v_mfma_f32_16x16x32_bf16 v[168:171], a[228:231], v[76:79], v[168:171]
s_waitcnt lgkmcnt(14)
v_mfma_f32_16x16x32_bf16 v[116:119], a[232:235], a[12:15], v[116:119]
v_mfma_f32_16x16x32_bf16 v[120:123], a[232:235], a[76:79], v[120:123]
s_waitcnt lgkmcnt(12)
v_mfma_f32_16x16x32_bf16 v[124:127], a[236:239], a[12:15], v[124:127]
v_mfma_f32_16x16x32_bf16 v[128:131], a[236:239], a[76:79], v[128:131]
s_waitcnt lgkmcnt(10)
s_waitcnt lgkmcnt(0) vmcnt(13)
s_barrier
ds_read_b64_tr_b16 a[226:227], v6 offset:33536
buffer_load_dwordx4 v14, s[16:19], 0 offen lds
v_mfma_f32_16x16x32_bf16 v[132:135], a[240:243], a[12:15], v[132:135]
s_add_u32 m0, s42, 61792
ds_read_b64_tr_b16 a[224:225], v6 offset:33024
v_mfma_f32_16x16x32_bf16 v[136:139], a[240:243], a[76:79], v[136:139]
ds_read_b128 v[76:79], v251 offset:4096
v_mfma_f32_16x16x32_bf16 v[140:143], a[244:247], a[12:15], v[140:143]
ds_read_b64_tr_b16 a[230:231], v6 offset:33544
ds_read_b64_tr_b16 a[228:229], v6 offset:33032
v_mfma_f32_16x16x32_bf16 v[144:147], a[244:247], a[76:79], v[144:147]
ds_read_b64_tr_b16 a[234:235], v7 offset:33536
buffer_load_dwordx4 v14, s[16:19], 0 offen offset:128 lds
v_mfma_f32_16x16x32_bf16 v[148:151], a[248:251], a[12:15], v[148:151]
s_add_u32 m0, s41, 111104
ds_read_b64_tr_b16 a[232:233], v7 offset:33024
buffer_load_dwordx4 v89, s[20:23], s63 offen lds
v_mfma_f32_16x16x32_bf16 v[152:155], a[248:251], a[76:79], v[152:155]
s_add_u32 s63, s69, 768
ds_read_b64_tr_b16 a[238:239], v7 offset:33544
s_add_u32 m0, s71, 0
v_mfma_f32_16x16x32_bf16 v[156:159], a[252:255], a[12:15], v[156:159]
s_and_b32 s63, s63, 0x3ff
ds_read_b64_tr_b16 a[236:237], v7 offset:33032
ds_read_b64_tr_b16 a[242:243], v8 offset:33536
v_mfma_f32_16x16x32_bf16 v[160:163], a[252:255], a[76:79], v[160:163]
s_waitcnt lgkmcnt(8)
ds_read_b64_tr_b16 a[240:241], v8 offset:33024
buffer_load_dwordx4 v80, s[20:23], s63 offen lds
v_mfma_f32_16x16x32_bf16 v[100:103], a[224:227], a[16:19], v[100:103]
s_add_u32 m0, s71, 4128
ds_read_b64_tr_b16 a[246:247], v8 offset:33544
buffer_load_dwordx4 v81, s[20:23], s63 offen lds
v_mfma_f32_16x16x32_bf16 v[104:107], a[224:227], a[80:83], v[104:107]
s_waitcnt lgkmcnt(9)
ds_read_b64_tr_b16 a[244:245], v8 offset:33032
s_add_u32 m0, s71, 8256
v_mfma_f32_16x16x32_bf16 v[164:167], a[224:227], v[76:79], v[164:167]
s_waitcnt lgkmcnt(8)
ds_read_b64_tr_b16 a[250:251], v9 offset:33536
ds_read_b64_tr_b16 a[248:249], v9 offset:33024
v_mfma_f32_16x16x32_bf16 v[108:111], a[228:231], a[16:19], v[108:111]
ds_read_b64_tr_b16 a[254:255], v9 offset:33544
buffer_load_dwordx4 v82, s[20:23], s63 offen lds
v_mfma_f32_16x16x32_bf16 v[112:115], a[228:231], a[80:83], v[112:115]
s_add_u32 m0, s71, 12384
ds_read_b64_tr_b16 a[252:253], v9 offset:33032
buffer_load_dwordx4 v83, s[20:23], s63 offen lds
v_mfma_f32_16x16x32_bf16 v[168:171], a[228:231], v[76:79], v[168:171]
s_waitcnt lgkmcnt(10)
v_add_u32 v14, s67, v14
s_add_u32 m0, s42, 33024
v_mfma_f32_16x16x32_bf16 v[116:119], a[232:235], a[16:19], v[116:119]
s_add_u32 s63, s69, 896
s_and_b32 s63, s63, 0x3ff
v_mfma_f32_16x16x32_bf16 v[120:123], a[232:235], a[80:83], v[120:123]
s_waitcnt lgkmcnt(8)
s_and_b32 s62, s62, 0x3fffff
s_cselect_b32 s67, 0x40000, s61
v_mfma_f32_16x16x32_bf16 v[124:127], a[236:239], a[16:19], v[124:127]
s_add_u32 s62, s62, 0x80000
v_mfma_f32_16x16x32_bf16 v[128:131], a[236:239], a[80:83], v[128:131]
s_waitcnt lgkmcnt(6)
s_waitcnt lgkmcnt(0) vmcnt(14)
s_barrier
ds_read_b64_tr_b16 a[226:227], v6 offset:41792
buffer_load_dwordx4 v14, s[16:19], 0 offen lds
v_mfma_f32_16x16x32_bf16 v[132:135], a[240:243], a[16:19], v[132:135]
s_add_u32 m0, s42, 37024
ds_read_b64_tr_b16 a[224:225], v6 offset:41280
ds_read_b128 v[76:79], v252 offset:4096
v_mfma_f32_16x16x32_bf16 v[136:139], a[240:243], a[80:83], v[136:139]
ds_read_b64_tr_b16 a[230:231], v6 offset:41800
v_mfma_f32_16x16x32_bf16 v[140:143], a[244:247], a[16:19], v[140:143]
ds_read_b64_tr_b16 a[228:229], v6 offset:41288
ds_read_b64_tr_b16 a[234:235], v7 offset:41792
v_mfma_f32_16x16x32_bf16 v[144:147], a[244:247], a[80:83], v[144:147]
ds_read_b64_tr_b16 a[232:233], v7 offset:41280
buffer_load_dwordx4 v14, s[16:19], 0 offen offset:128 lds
v_mfma_f32_16x16x32_bf16 v[148:151], a[248:251], a[16:19], v[148:151]
s_add_u32 m0, s42, 41280
ds_read_b64_tr_b16 a[238:239], v7 offset:41800
ds_read_b64_tr_b16 a[236:237], v7 offset:41288
v_mfma_f32_16x16x32_bf16 v[152:155], a[248:251], a[80:83], v[152:155]
ds_read_b64_tr_b16 a[242:243], v8 offset:41792
v_add_u32 v14, 0x40000, v14
v_mfma_f32_16x16x32_bf16 v[156:159], a[252:255], a[16:19], v[156:159]
ds_read_b64_tr_b16 a[240:241], v8 offset:41280
ds_read_b64_tr_b16 a[246:247], v8 offset:41800
v_mfma_f32_16x16x32_bf16 v[160:163], a[252:255], a[80:83], v[160:163]
s_waitcnt lgkmcnt(10)
ds_read_b64_tr_b16 a[244:245], v8 offset:41288
v_mfma_f32_16x16x32_bf16 v[100:103], a[224:227], a[20:23], v[100:103]
ds_read_b64_tr_b16 a[250:251], v9 offset:41792
ds_read_b64_tr_b16 a[248:249], v9 offset:41280
v_mfma_f32_16x16x32_bf16 v[104:107], a[224:227], a[84:87], v[104:107]
s_waitcnt lgkmcnt(12)
ds_read_b64_tr_b16 a[254:255], v9 offset:41800
ds_read_b64_tr_b16 a[252:253], v9 offset:41288
v_mfma_f32_16x16x32_bf16 v[164:167], a[224:227], v[76:79], v[164:167]
s_waitcnt lgkmcnt(12)
ds_read_b128 a[92:95], v88 offset:24768
v_mfma_f32_16x16x32_bf16 v[108:111], a[228:231], a[20:23], v[108:111]
ds_read_b128 a[28:31], v88 offset:16512
ds_read_b128 a[88:91], v87 offset:24768
v_mfma_f32_16x16x32_bf16 v[112:115], a[228:231], a[84:87], v[112:115]
ds_read_b128 a[24:27], v87 offset:16512
v_mfma_f32_16x16x32_bf16 v[168:171], a[228:231], v[76:79], v[168:171]
s_waitcnt lgkmcnt(14)
v_mfma_f32_16x16x32_bf16 v[116:119], a[232:235], a[20:23], v[116:119]
v_mfma_f32_16x16x32_bf16 v[120:123], a[232:235], a[84:87], v[120:123]
s_waitcnt lgkmcnt(12)
v_mfma_f32_16x16x32_bf16 v[124:127], a[236:239], a[20:23], v[124:127]
v_mfma_f32_16x16x32_bf16 v[128:131], a[236:239], a[84:87], v[128:131]
s_waitcnt lgkmcnt(10)
s_waitcnt lgkmcnt(0) vmcnt(9)
s_barrier
ds_read_b64_tr_b16 a[226:227], v6 offset:50048
buffer_load_dwordx4 v14, s[16:19], 0 offen lds
v_mfma_f32_16x16x32_bf16 v[132:135], a[240:243], a[20:23], v[132:135]
s_add_u32 m0, s42, 45280
ds_read_b64_tr_b16 a[224:225], v6 offset:49536
v_mfma_f32_16x16x32_bf16 v[136:139], a[240:243], a[84:87], v[136:139]
ds_read_b128 v[76:79], v251 offset:6144
v_mfma_f32_16x16x32_bf16 v[140:143], a[244:247], a[20:23], v[140:143]
ds_read_b64_tr_b16 a[230:231], v6 offset:50056
ds_read_b64_tr_b16 a[228:229], v6 offset:49544
v_mfma_f32_16x16x32_bf16 v[144:147], a[244:247], a[84:87], v[144:147]
ds_read_b64_tr_b16 a[234:235], v7 offset:50048
buffer_load_dwordx4 v14, s[16:19], 0 offen offset:128 lds
v_mfma_f32_16x16x32_bf16 v[148:151], a[248:251], a[20:23], v[148:151]
s_add_u32 m0, s71, 16512
ds_read_b64_tr_b16 a[232:233], v7 offset:49536
buffer_load_dwordx4 v80, s[20:23], s63 offen lds
v_mfma_f32_16x16x32_bf16 v[152:155], a[248:251], a[84:87], v[152:155]
s_add_u32 m0, s71, 20640
ds_read_b64_tr_b16 a[238:239], v7 offset:50056
buffer_load_dwordx4 v81, s[20:23], s63 offen lds
v_mfma_f32_16x16x32_bf16 v[156:159], a[252:255], a[20:23], v[156:159]
s_add_u32 m0, s71, 24768
ds_read_b64_tr_b16 a[236:237], v7 offset:49544
ds_read_b64_tr_b16 a[242:243], v8 offset:50048
v_mfma_f32_16x16x32_bf16 v[160:163], a[252:255], a[84:87], v[160:163]
s_waitcnt lgkmcnt(8)
ds_read_b64_tr_b16 a[240:241], v8 offset:49536
buffer_load_dwordx4 v82, s[20:23], s63 offen lds
v_mfma_f32_16x16x32_bf16 v[100:103], a[224:227], a[24:27], v[100:103]
s_add_u32 m0, s71, 28896
ds_read_b64_tr_b16 a[246:247], v8 offset:50056
buffer_load_dwordx4 v83, s[20:23], s63 offen lds
v_mfma_f32_16x16x32_bf16 v[104:107], a[224:227], a[88:91], v[104:107]
s_waitcnt lgkmcnt(9)
ds_read_b64_tr_b16 a[244:245], v8 offset:49544
s_mov_b32 m0, s41
v_mfma_f32_16x16x32_bf16 v[164:167], a[224:227], v[76:79], v[164:167]
s_waitcnt lgkmcnt(8)
ds_read_b64_tr_b16 a[250:251], v9 offset:50048
ds_read_b64_tr_b16 a[248:249], v9 offset:49536
v_mfma_f32_16x16x32_bf16 v[108:111], a[228:231], a[24:27], v[108:111]
ds_read_b64_tr_b16 a[254:255], v9 offset:50056
v_add_u32 v14, s67, v14
v_mfma_f32_16x16x32_bf16 v[112:115], a[228:231], a[88:91], v[112:115]
s_and_b32 s62, s62, 0x3fffff
s_cselect_b32 s67, 0x40000, s61
ds_read_b64_tr_b16 a[252:253], v9 offset:49544
s_add_u32 s62, s62, 0x80000
v_mfma_f32_16x16x32_bf16 v[168:171], a[228:231], v[76:79], v[168:171]
s_waitcnt lgkmcnt(10)
v_mfma_f32_16x16x32_bf16 v[116:119], a[232:235], a[24:27], v[116:119]
v_mfma_f32_16x16x32_bf16 v[120:123], a[232:235], a[88:91], v[120:123]
s_waitcnt lgkmcnt(8)
v_mfma_f32_16x16x32_bf16 v[124:127], a[236:239], a[24:27], v[124:127]
v_mfma_f32_16x16x32_bf16 v[128:131], a[236:239], a[88:91], v[128:131]
s_waitcnt lgkmcnt(6)
s_waitcnt lgkmcnt(0) vmcnt(13)
s_barrier
ds_read_b64_tr_b16 a[226:227], v6 offset:58304
v_mfma_f32_16x16x32_bf16 v[132:135], a[240:243], a[24:27], v[132:135]
ds_read_b64_tr_b16 a[224:225], v6 offset:57792
ds_read_b128 v[76:79], v252 offset:6144
v_mfma_f32_16x16x32_bf16 v[136:139], a[240:243], a[88:91], v[136:139]
ds_read_b64_tr_b16 a[230:231], v6 offset:58312
buffer_load_dwordx4 v12, s[8:11], 0 offen nt lds
v_mfma_f32_16x16x32_bf16 v[140:143], a[244:247], a[24:27], v[140:143]
s_add_u32 m0, s41, 3968
ds_read_b64_tr_b16 a[228:229], v6 offset:57800
ds_read_b64_tr_b16 a[234:235], v7 offset:58304
v_mfma_f32_16x16x32_bf16 v[144:147], a[244:247], a[88:91], v[144:147]
ds_read_b64_tr_b16 a[232:233], v7 offset:57792
v_mfma_f32_16x16x32_bf16 v[148:151], a[248:251], a[24:27], v[148:151]
ds_read_b64_tr_b16 a[238:239], v7 offset:58312
ds_read_b64_tr_b16 a[236:237], v7 offset:57800
v_mfma_f32_16x16x32_bf16 v[152:155], a[248:251], a[88:91], v[152:155]
ds_read_b64_tr_b16 a[242:243], v8 offset:58304
buffer_load_dwordx4 v12, s[8:11], 0 offen offset:128 nt lds
v_mfma_f32_16x16x32_bf16 v[156:159], a[252:255], a[24:27], v[156:159]
s_add_u32 m0, s42, 49536
ds_read_b64_tr_b16 a[240:241], v8 offset:57792
ds_read_b64_tr_b16 a[246:247], v8 offset:58312
v_mfma_f32_16x16x32_bf16 v[160:163], a[252:255], a[88:91], v[160:163]
s_waitcnt lgkmcnt(10)
ds_read_b64_tr_b16 a[244:245], v8 offset:57800
v_add_u32 v12, s7, v12
v_mfma_f32_16x16x32_bf16 v[100:103], a[224:227], a[28:31], v[100:103]
ds_read_b64_tr_b16 a[250:251], v9 offset:58304
ds_read_b64_tr_b16 a[248:249], v9 offset:57792
v_mfma_f32_16x16x32_bf16 v[104:107], a[224:227], a[92:95], v[104:107]
s_waitcnt lgkmcnt(12)
ds_read_b64_tr_b16 a[254:255], v9 offset:58312
ds_read_b64_tr_b16 a[252:253], v9 offset:57800
v_mfma_f32_16x16x32_bf16 v[164:167], a[224:227], v[76:79], v[164:167]
s_waitcnt lgkmcnt(12)
ds_read_b128 a[100:103], v97 offset:2048
buffer_load_dwordx4 v14, s[16:19], 0 offen lds
v_mfma_f32_16x16x32_bf16 v[108:111], a[228:231], a[28:31], v[108:111]
s_add_u32 m0, s42, 53536
ds_read_b128 a[36:39], v97 offset:0
ds_read_b128 a[96:99], v96 offset:2048
v_mfma_f32_16x16x32_bf16 v[112:115], a[228:231], a[92:95], v[112:115]
ds_read_b128 a[32:35], v96 offset:0
buffer_load_dwordx4 v14, s[16:19], 0 offen offset:128 lds
v_mfma_f32_16x16x32_bf16 v[168:171], a[228:231], v[76:79], v[168:171]
s_waitcnt lgkmcnt(14)
s_add_u32 m0, s41, 8192
v_add_u32 v14, 0x40000, v14
v_mfma_f32_16x16x32_bf16 v[116:119], a[232:235], a[28:31], v[116:119]
v_mfma_f32_16x16x32_bf16 v[120:123], a[232:235], a[92:95], v[120:123]
s_waitcnt lgkmcnt(12)
v_mfma_f32_16x16x32_bf16 v[124:127], a[236:239], a[28:31], v[124:127]
v_mfma_f32_16x16x32_bf16 v[128:131], a[236:239], a[92:95], v[128:131]
s_waitcnt lgkmcnt(10)
s_waitcnt lgkmcnt(0) vmcnt(10)
s_barrier
ds_read_b64_tr_b16 a[226:227], v6 offset:33536
v_mfma_f32_16x16x32_bf16 v[132:135], a[240:243], a[28:31], v[132:135]
ds_read_b64_tr_b16 a[224:225], v6 offset:33024
buffer_load_dwordx4 v12, s[8:11], 0 offen nt lds
v_mfma_f32_16x16x32_bf16 v[136:139], a[240:243], a[92:95], v[136:139]
s_add_u32 m0, s41, 12160
ds_read_b128 v[76:79], v251 offset:8192
v_mfma_f32_16x16x32_bf16 v[140:143], a[244:247], a[28:31], v[140:143]
ds_read_b64_tr_b16 a[230:231], v6 offset:33544
ds_read_b64_tr_b16 a[228:229], v6 offset:33032
v_mfma_f32_16x16x32_bf16 v[144:147], a[244:247], a[92:95], v[144:147]
ds_read_b64_tr_b16 a[234:235], v7 offset:33536
v_mfma_f32_16x16x32_bf16 v[148:151], a[248:251], a[28:31], v[148:151]
ds_read_b64_tr_b16 a[232:233], v7 offset:33024
buffer_load_dwordx4 v12, s[8:11], 0 offen offset:128 nt lds
v_mfma_f32_16x16x32_bf16 v[152:155], a[248:251], a[92:95], v[152:155]
s_add_u32 m0, s42, 57792
ds_read_b64_tr_b16 a[238:239], v7 offset:33544
v_add_u32 v12, s6, v12
v_mfma_f32_16x16x32_bf16 v[156:159], a[252:255], a[28:31], v[156:159]
ds_read_b64_tr_b16 a[236:237], v7 offset:33032
ds_read_b64_tr_b16 a[242:243], v8 offset:33536
v_mfma_f32_16x16x32_bf16 v[160:163], a[252:255], a[92:95], v[160:163]
s_waitcnt lgkmcnt(8)
ds_read_b64_tr_b16 a[240:241], v8 offset:33024
v_mfma_f32_16x16x32_bf16 v[100:103], a[224:227], a[32:35], v[100:103]
ds_read_b64_tr_b16 a[246:247], v8 offset:33544
buffer_load_dwordx4 v14, s[16:19], 0 offen lds
v_mfma_f32_16x16x32_bf16 v[104:107], a[224:227], a[96:99], v[104:107]
s_waitcnt lgkmcnt(9)
ds_read_b64_tr_b16 a[244:245], v8 offset:33032
s_add_u32 m0, s42, 61792
v_mfma_f32_16x16x32_bf16 v[164:167], a[224:227], v[76:79], v[164:167]
s_waitcnt lgkmcnt(8)
ds_read_b64_tr_b16 a[250:251], v9 offset:33536
ds_read_b64_tr_b16 a[248:249], v9 offset:33024
v_mfma_f32_16x16x32_bf16 v[108:111], a[228:231], a[32:35], v[108:111]
ds_read_b64_tr_b16 a[254:255], v9 offset:33544
v_mfma_f32_16x16x32_bf16 v[112:115], a[228:231], a[96:99], v[112:115]
ds_read_b64_tr_b16 a[252:253], v9 offset:33032
buffer_load_dwordx4 v14, s[16:19], 0 offen offset:128 lds
v_mfma_f32_16x16x32_bf16 v[168:171], a[228:231], v[76:79], v[168:171]
s_waitcnt lgkmcnt(10)
s_mov_b32 m0, 148224
v_add_u32 v14, s67, v14
v_mfma_f32_16x16x32_bf16 v[116:119], a[232:235], a[32:35], v[116:119]
s_and_b32 s62, s62, 0x3fffff
s_cselect_b32 s67, 0x40000, s61
s_add_u32 s62, s62, 0x80000
v_mfma_f32_16x16x32_bf16 v[120:123], a[232:235], a[96:99], v[120:123]
s_waitcnt lgkmcnt(8)
v_mfma_f32_16x16x32_bf16 v[124:127], a[236:239], a[32:35], v[124:127]
v_mfma_f32_16x16x32_bf16 v[128:131], a[236:239], a[96:99], v[128:131]
s_waitcnt lgkmcnt(6)
s_waitcnt lgkmcnt(0) vmcnt(12)
s_barrier
ds_read_b64_tr_b16 a[226:227], v6 offset:41792
buffer_load_dwordx4 v253, s[92:95], s64 offen lds
v_mfma_f32_16x16x32_bf16 v[132:135], a[240:243], a[32:35], v[132:135]
s_add_u32 m0, s42, 33024
ds_read_b64_tr_b16 a[224:225], v6 offset:41280
ds_read_b128 v[76:79], v252 offset:8192
v_mfma_f32_16x16x32_bf16 v[136:139], a[240:243], a[96:99], v[136:139]
ds_read_b64_tr_b16 a[230:231], v6 offset:41800
buffer_load_dwordx4 v14, s[16:19], 0 offen lds
v_mfma_f32_16x16x32_bf16 v[140:143], a[244:247], a[32:35], v[140:143]
s_add_u32 m0, s42, 37024
ds_read_b64_tr_b16 a[228:229], v6 offset:41288
ds_read_b64_tr_b16 a[234:235], v7 offset:41792
v_mfma_f32_16x16x32_bf16 v[144:147], a[244:247], a[96:99], v[144:147]
ds_read_b64_tr_b16 a[232:233], v7 offset:41280
buffer_load_dwordx4 v14, s[16:19], 0 offen offset:128 lds
v_mfma_f32_16x16x32_bf16 v[148:151], a[248:251], a[32:35], v[148:151]
s_add_u32 m0, s42, 41280
ds_read_b64_tr_b16 a[238:239], v7 offset:41800
ds_read_b64_tr_b16 a[236:237], v7 offset:41288
v_mfma_f32_16x16x32_bf16 v[152:155], a[248:251], a[96:99], v[152:155]
ds_read_b64_tr_b16 a[242:243], v8 offset:41792
v_add_u32 v14, 0x40000, v14
v_mfma_f32_16x16x32_bf16 v[156:159], a[252:255], a[32:35], v[156:159]
ds_read_b64_tr_b16 a[240:241], v8 offset:41280
ds_read_b64_tr_b16 a[246:247], v8 offset:41800
v_mfma_f32_16x16x32_bf16 v[160:163], a[252:255], a[96:99], v[160:163]
s_waitcnt lgkmcnt(10)
ds_read_b64_tr_b16 a[244:245], v8 offset:41288
v_mfma_f32_16x16x32_bf16 v[100:103], a[224:227], a[36:39], v[100:103]
ds_read_b64_tr_b16 a[250:251], v9 offset:41792
ds_read_b64_tr_b16 a[248:249], v9 offset:41280
v_mfma_f32_16x16x32_bf16 v[104:107], a[224:227], a[100:103], v[104:107]
s_waitcnt lgkmcnt(12)
ds_read_b64_tr_b16 a[254:255], v9 offset:41800
ds_read_b64_tr_b16 a[252:253], v9 offset:41288
v_mfma_f32_16x16x32_bf16 v[164:167], a[224:227], v[76:79], v[164:167]
s_waitcnt lgkmcnt(12)
ds_read_b128 a[108:111], v97 offset:6144
v_mfma_f32_16x16x32_bf16 v[108:111], a[228:231], a[36:39], v[108:111]
ds_read_b128 a[44:47], v97 offset:4096
ds_read_b128 a[104:107], v96 offset:6144
v_mfma_f32_16x16x32_bf16 v[112:115], a[228:231], a[100:103], v[112:115]
ds_read_b128 a[40:43], v96 offset:4096
v_mfma_f32_16x16x32_bf16 v[168:171], a[228:231], v[76:79], v[168:171]
s_waitcnt lgkmcnt(14)
v_mfma_f32_16x16x32_bf16 v[116:119], a[232:235], a[36:39], v[116:119]
v_mfma_f32_16x16x32_bf16 v[120:123], a[232:235], a[100:103], v[120:123]
s_waitcnt lgkmcnt(12)
v_mfma_f32_16x16x32_bf16 v[124:127], a[236:239], a[36:39], v[124:127]
v_mfma_f32_16x16x32_bf16 v[128:131], a[236:239], a[100:103], v[128:131]
s_waitcnt lgkmcnt(10)
s_waitcnt lgkmcnt(0) vmcnt(7)
s_barrier
ds_read_b64_tr_b16 a[226:227], v6 offset:50048
buffer_load_dwordx4 v14, s[16:19], 0 offen lds
v_mfma_f32_16x16x32_bf16 v[132:135], a[240:243], a[36:39], v[132:135]
s_add_u32 m0, s42, 45280
ds_read_b64_tr_b16 a[224:225], v6 offset:49536
v_mfma_f32_16x16x32_bf16 v[136:139], a[240:243], a[100:103], v[136:139]
ds_read_b128 v[76:79], v251 offset:10240
v_mfma_f32_16x16x32_bf16 v[140:143], a[244:247], a[36:39], v[140:143]
ds_read_b64_tr_b16 a[230:231], v6 offset:50056
ds_read_b64_tr_b16 a[228:229], v6 offset:49544
v_mfma_f32_16x16x32_bf16 v[144:147], a[244:247], a[100:103], v[144:147]
ds_read_b64_tr_b16 a[234:235], v7 offset:50048
buffer_load_dwordx4 v14, s[16:19], 0 offen offset:128 lds
v_mfma_f32_16x16x32_bf16 v[148:151], a[248:251], a[36:39], v[148:151]
s_add_u32 m0, s42, 49536
ds_read_b64_tr_b16 a[232:233], v7 offset:49536
v_add_u32 v14, s67, v14
v_mfma_f32_16x16x32_bf16 v[152:155], a[248:251], a[100:103], v[152:155]
s_and_b32 s62, s62, 0x3fffff
s_cselect_b32 s67, s45, s44
ds_read_b64_tr_b16 a[238:239], v7 offset:50056
s_add_u32 s62, s62, 0x80000
v_mfma_f32_16x16x32_bf16 v[156:159], a[252:255], a[36:39], v[156:159]
ds_read_b64_tr_b16 a[236:237], v7 offset:49544
ds_read_b64_tr_b16 a[242:243], v8 offset:50048
v_mfma_f32_16x16x32_bf16 v[160:163], a[252:255], a[100:103], v[160:163]
s_waitcnt lgkmcnt(8)
ds_read_b64_tr_b16 a[240:241], v8 offset:49536
v_mfma_f32_16x16x32_bf16 v[100:103], a[224:227], a[40:43], v[100:103]
ds_read_b64_tr_b16 a[246:247], v8 offset:50056
v_mfma_f32_16x16x32_bf16 v[104:107], a[224:227], a[104:107], v[104:107]
s_waitcnt lgkmcnt(9)
ds_read_b64_tr_b16 a[244:245], v8 offset:49544
v_mfma_f32_16x16x32_bf16 v[164:167], a[224:227], v[76:79], v[164:167]
s_waitcnt lgkmcnt(8)
ds_read_b64_tr_b16 a[250:251], v9 offset:50048
ds_read_b64_tr_b16 a[248:249], v9 offset:49536
v_mfma_f32_16x16x32_bf16 v[108:111], a[228:231], a[40:43], v[108:111]
ds_read_b64_tr_b16 a[254:255], v9 offset:50056
v_mfma_f32_16x16x32_bf16 v[112:115], a[228:231], a[104:107], v[112:115]
ds_read_b64_tr_b16 a[252:253], v9 offset:49544
v_mfma_f32_16x16x32_bf16 v[168:171], a[228:231], v[76:79], v[168:171]
s_waitcnt lgkmcnt(10)
v_mfma_f32_16x16x32_bf16 v[116:119], a[232:235], a[40:43], v[116:119]
v_mfma_f32_16x16x32_bf16 v[120:123], a[232:235], a[104:107], v[120:123]
s_waitcnt lgkmcnt(8)
v_mfma_f32_16x16x32_bf16 v[124:127], a[236:239], a[40:43], v[124:127]
v_mfma_f32_16x16x32_bf16 v[128:131], a[236:239], a[104:107], v[128:131]
s_waitcnt lgkmcnt(6)
s_waitcnt lgkmcnt(0) vmcnt(5)
s_barrier
ds_read_b64_tr_b16 a[226:227], v6 offset:58304
buffer_load_dwordx4 v14, s[16:19], 0 offen lds
v_mfma_f32_16x16x32_bf16 v[132:135], a[240:243], a[40:43], v[132:135]
s_add_u32 m0, s42, 53536
ds_read_b64_tr_b16 a[224:225], v6 offset:57792
ds_read_b128 v[76:79], v252 offset:10240
v_mfma_f32_16x16x32_bf16 v[136:139], a[240:243], a[104:107], v[136:139]
ds_read_b64_tr_b16 a[230:231], v6 offset:58312
v_mfma_f32_16x16x32_bf16 v[140:143], a[244:247], a[40:43], v[140:143]
ds_read_b64_tr_b16 a[228:229], v6 offset:57800
ds_read_b64_tr_b16 a[234:235], v7 offset:58304
v_mfma_f32_16x16x32_bf16 v[144:147], a[244:247], a[104:107], v[144:147]
ds_read_b64_tr_b16 a[232:233], v7 offset:57792
buffer_load_dwordx4 v14, s[16:19], 0 offen offset:128 lds
v_mfma_f32_16x16x32_bf16 v[148:151], a[248:251], a[40:43], v[148:151]
s_mov_b32 m0, s42
ds_read_b64_tr_b16 a[238:239], v7 offset:58312
ds_read_b64_tr_b16 a[236:237], v7 offset:57800
v_mfma_f32_16x16x32_bf16 v[152:155], a[248:251], a[104:107], v[152:155]
ds_read_b64_tr_b16 a[242:243], v8 offset:58304
v_add_u32 v14, 0x40000, v14
v_mfma_f32_16x16x32_bf16 v[156:159], a[252:255], a[40:43], v[156:159]
ds_read_b64_tr_b16 a[240:241], v8 offset:57792
ds_read_b64_tr_b16 a[246:247], v8 offset:58312
v_mfma_f32_16x16x32_bf16 v[160:163], a[252:255], a[104:107], v[160:163]
s_waitcnt lgkmcnt(10)
ds_read_b64_tr_b16 a[244:245], v8 offset:57800
v_mfma_f32_16x16x32_bf16 v[100:103], a[224:227], a[44:47], v[100:103]
ds_read_b64_tr_b16 a[250:251], v9 offset:58304
ds_read_b64_tr_b16 a[248:249], v9 offset:57792
v_mfma_f32_16x16x32_bf16 v[104:107], a[224:227], a[108:111], v[104:107]
s_waitcnt lgkmcnt(12)
ds_read_b64_tr_b16 a[254:255], v9 offset:58312
ds_read_b64_tr_b16 a[252:253], v9 offset:57800
v_mfma_f32_16x16x32_bf16 v[164:167], a[224:227], v[76:79], v[164:167]
s_waitcnt lgkmcnt(12)
ds_read_b128 a[116:119], v88 offset:8256
v_mfma_f32_16x16x32_bf16 v[108:111], a[228:231], a[44:47], v[108:111]
ds_read_b128 a[52:55], v88 offset:0
ds_read_b128 a[112:115], v87 offset:8256
v_mfma_f32_16x16x32_bf16 v[112:115], a[228:231], a[108:111], v[112:115]
ds_read_b128 a[48:51], v87 offset:0
v_mfma_f32_16x16x32_bf16 v[168:171], a[228:231], v[76:79], v[168:171]
s_waitcnt lgkmcnt(14)
v_mfma_f32_16x16x32_bf16 v[116:119], a[232:235], a[44:47], v[116:119]
v_mfma_f32_16x16x32_bf16 v[120:123], a[232:235], a[108:111], v[120:123]
s_waitcnt lgkmcnt(12)
v_mfma_f32_16x16x32_bf16 v[124:127], a[236:239], a[44:47], v[124:127]
v_mfma_f32_16x16x32_bf16 v[128:131], a[236:239], a[108:111], v[128:131]
s_waitcnt lgkmcnt(10)
s_waitcnt lgkmcnt(0) vmcnt(4)
s_barrier
ds_read_b64_tr_b16 a[226:227], v6 offset:33536
v_mfma_f32_16x16x32_bf16 v[132:135], a[240:243], a[44:47], v[132:135]
ds_read_b64_tr_b16 a[224:225], v6 offset:33024
v_mfma_f32_16x16x32_bf16 v[136:139], a[240:243], a[108:111], v[136:139]
ds_read_b128 v[76:79], v251 offset:12288
buffer_load_dwordx4 v13, s[12:15], 0 offen nt lds
v_mfma_f32_16x16x32_bf16 v[140:143], a[244:247], a[44:47], v[140:143]
s_add_u32 m0, s42, 4000
ds_read_b64_tr_b16 a[230:231], v6 offset:33544
ds_read_b64_tr_b16 a[228:229], v6 offset:33032
v_mfma_f32_16x16x32_bf16 v[144:147], a[244:247], a[108:111], v[144:147]
ds_read_b64_tr_b16 a[234:235], v7 offset:33536
v_mfma_f32_16x16x32_bf16 v[148:151], a[248:251], a[44:47], v[148:151]
ds_read_b64_tr_b16 a[232:233], v7 offset:33024
v_mfma_f32_16x16x32_bf16 v[152:155], a[248:251], a[108:111], v[152:155]
ds_read_b64_tr_b16 a[238:239], v7 offset:33544
buffer_load_dwordx4 v13, s[12:15], 0 offen offset:128 nt lds
v_mfma_f32_16x16x32_bf16 v[156:159], a[252:255], a[44:47], v[156:159]
s_add_u32 m0, s42, 57792
ds_read_b64_tr_b16 a[236:237], v7 offset:33032
ds_read_b64_tr_b16 a[242:243], v8 offset:33536
v_mfma_f32_16x16x32_bf16 v[160:163], a[252:255], a[108:111], v[160:163]
s_waitcnt lgkmcnt(8)
ds_read_b64_tr_b16 a[240:241], v8 offset:33024
v_add_u32 v13, s7, v13
v_mfma_f32_16x16x32_bf16 v[100:103], a[224:227], a[48:51], v[100:103]
s_and_b32 s43, s43, 0x1ffff
s_cselect_b32 s7, s4, s5
ds_read_b64_tr_b16 a[246:247], v8 offset:33544
buffer_load_dwordx4 v14, s[16:19], 0 offen lds
v_mfma_f32_16x16x32_bf16 v[104:107], a[224:227], a[112:115], v[104:107]
s_waitcnt lgkmcnt(9)
ds_read_b64_tr_b16 a[244:245], v8 offset:33032
s_add_u32 m0, s42, 61792
v_mfma_f32_16x16x32_bf16 v[164:167], a[224:227], v[76:79], v[164:167]
s_waitcnt lgkmcnt(8)
ds_read_b64_tr_b16 a[250:251], v9 offset:33536
ds_read_b64_tr_b16 a[248:249], v9 offset:33024
v_mfma_f32_16x16x32_bf16 v[108:111], a[228:231], a[48:51], v[108:111]
ds_read_b64_tr_b16 a[254:255], v9 offset:33544
v_mfma_f32_16x16x32_bf16 v[112:115], a[228:231], a[112:115], v[112:115]
ds_read_b64_tr_b16 a[252:253], v9 offset:33032
buffer_load_dwordx4 v14, s[16:19], 0 offen offset:128 lds
v_mfma_f32_16x16x32_bf16 v[168:171], a[228:231], v[76:79], v[168:171]
s_waitcnt lgkmcnt(10)
v_add_u32 v14, s67, v14
s_add_u32 m0, s42, 33024
v_mfma_f32_16x16x32_bf16 v[116:119], a[232:235], a[48:51], v[116:119]
s_and_b32 s62, s62, 0x3fffff
s_cselect_b32 s67, 0x40000, s61
v_mfma_f32_16x16x32_bf16 v[120:123], a[232:235], a[112:115], v[120:123]
s_waitcnt lgkmcnt(8)
v_mfma_f32_16x16x32_bf16 v[124:127], a[236:239], a[48:51], v[124:127]
v_mfma_f32_16x16x32_bf16 v[128:131], a[236:239], a[112:115], v[128:131]
s_waitcnt lgkmcnt(6)
s_waitcnt lgkmcnt(0) vmcnt(6)
s_barrier
ds_read_b64_tr_b16 a[226:227], v6 offset:41792
buffer_load_dwordx4 v14, s[16:19], 0 offen lds
v_mfma_f32_16x16x32_bf16 v[132:135], a[240:243], a[48:51], v[132:135]
s_add_u32 m0, s42, 37024
ds_read_b64_tr_b16 a[224:225], v6 offset:41280
ds_read_b128 v[76:79], v252 offset:12288
v_mfma_f32_16x16x32_bf16 v[136:139], a[240:243], a[112:115], v[136:139]
ds_read_b64_tr_b16 a[230:231], v6 offset:41800
v_mfma_f32_16x16x32_bf16 v[140:143], a[244:247], a[48:51], v[140:143]
ds_read_b64_tr_b16 a[228:229], v6 offset:41288
ds_read_b64_tr_b16 a[234:235], v7 offset:41792
v_mfma_f32_16x16x32_bf16 v[144:147], a[244:247], a[112:115], v[144:147]
ds_read_b64_tr_b16 a[232:233], v7 offset:41280
buffer_load_dwordx4 v14, s[16:19], 0 offen offset:128 lds
v_mfma_f32_16x16x32_bf16 v[148:151], a[248:251], a[48:51], v[148:151]
s_mov_b32 m0, 148224
ds_read_b64_tr_b16 a[238:239], v7 offset:41800
ds_read_b64_tr_b16 a[236:237], v7 offset:41288
v_mfma_f32_16x16x32_bf16 v[152:155], a[248:251], a[112:115], v[152:155]
ds_read_b64_tr_b16 a[242:243], v8 offset:41792
v_add_u32 v14, 0x40000, v14
v_mfma_f32_16x16x32_bf16 v[156:159], a[252:255], a[48:51], v[156:159]
ds_read_b64_tr_b16 a[240:241], v8 offset:41280
ds_read_b64_tr_b16 a[246:247], v8 offset:41800
v_mfma_f32_16x16x32_bf16 v[160:163], a[252:255], a[112:115], v[160:163]
s_waitcnt lgkmcnt(10)
ds_read_b64_tr_b16 a[244:245], v8 offset:41288
v_mfma_f32_16x16x32_bf16 v[100:103], a[224:227], a[52:55], v[100:103]
ds_read_b64_tr_b16 a[250:251], v9 offset:41792
ds_read_b64_tr_b16 a[248:249], v9 offset:41280
v_mfma_f32_16x16x32_bf16 v[104:107], a[224:227], a[116:119], v[104:107]
s_waitcnt lgkmcnt(12)
ds_read_b64_tr_b16 a[254:255], v9 offset:41800
ds_read_b64_tr_b16 a[252:253], v9 offset:41288
v_mfma_f32_16x16x32_bf16 v[164:167], a[224:227], v[76:79], v[164:167]
s_waitcnt lgkmcnt(12)
ds_read_b128 a[124:127], v88 offset:24768
v_mfma_f32_16x16x32_bf16 v[108:111], a[228:231], a[52:55], v[108:111]
ds_read_b128 a[60:63], v88 offset:16512
ds_read_b128 a[120:123], v87 offset:24768
v_mfma_f32_16x16x32_bf16 v[112:115], a[228:231], a[116:119], v[112:115]
ds_read_b128 a[56:59], v87 offset:16512
v_mfma_f32_16x16x32_bf16 v[168:171], a[228:231], v[76:79], v[168:171]
s_waitcnt lgkmcnt(14)
v_mfma_f32_16x16x32_bf16 v[116:119], a[232:235], a[52:55], v[116:119]
v_mfma_f32_16x16x32_bf16 v[120:123], a[232:235], a[116:119], v[120:123]
s_waitcnt lgkmcnt(12)
v_mfma_f32_16x16x32_bf16 v[124:127], a[236:239], a[52:55], v[124:127]
v_mfma_f32_16x16x32_bf16 v[128:131], a[236:239], a[116:119], v[128:131]
s_waitcnt lgkmcnt(10)
s_waitcnt lgkmcnt(0) vmcnt(6)
s_barrier
ds_read_b64_tr_b16 a[226:227], v6 offset:50048
buffer_load_dwordx4 v13, s[12:15], s75 offen lds
s_mov_b32 m0, 148224
v_mfma_f32_16x16x32_bf16 v[132:135], a[240:243], a[52:55], v[132:135]
ds_read_b64_tr_b16 a[224:225], v6 offset:49536
buffer_load_dwordx4 v13, s[12:15], s75 offen lds
s_mov_b32 m0, 148224
v_mfma_f32_16x16x32_bf16 v[136:139], a[240:243], a[116:119], v[136:139]
ds_read_b128 v[76:79], v251 offset:14336
buffer_load_dwordx4 v13, s[12:15], s75 offen lds
s_mov_b32 m0, 148224
v_mfma_f32_16x16x32_bf16 v[140:143], a[244:247], a[52:55], v[140:143]
ds_read_b64_tr_b16 a[230:231], v6 offset:50056
buffer_load_dwordx4 v13, s[12:15], s75 offen lds
s_add_u32 m0, s42, 41280
v_mfma_f32_16x16x32_bf16 v[144:147], a[244:247], a[116:119], v[144:147]
ds_read_b64_tr_b16 a[228:229], v6 offset:49544
buffer_load_dwordx4 v14, s[16:19], 0 offen lds
ds_read_b64_tr_b16 a[234:235], v7 offset:50048
v_mfma_f32_16x16x32_bf16 v[148:151], a[248:251], a[52:55], v[148:151]
s_add_u32 m0, s42, 45280
ds_read_b64_tr_b16 a[232:233], v7 offset:49536
buffer_load_dwordx4 v14, s[16:19], 0 offen offset:128 lds
v_mfma_f32_16x16x32_bf16 v[152:155], a[248:251], a[116:119], v[152:155]
s_add_u32 m0, s41, 16384
ds_read_b64_tr_b16 a[238:239], v7 offset:50056
v_add_u32 v14, s67, v14
v_mfma_f32_16x16x32_bf16 v[156:159], a[252:255], a[52:55], v[156:159]
ds_read_b64_tr_b16 a[236:237], v7 offset:49544
ds_read_b64_tr_b16 a[242:243], v8 offset:50048
v_mfma_f32_16x16x32_bf16 v[160:163], a[252:255], a[116:119], v[160:163]
s_waitcnt lgkmcnt(8)
ds_read_b64_tr_b16 a[240:241], v8 offset:49536
v_mfma_f32_16x16x32_bf16 v[100:103], a[224:227], a[56:59], v[100:103]
ds_read_b64_tr_b16 a[246:247], v8 offset:50056
v_mfma_f32_16x16x32_bf16 v[104:107], a[224:227], a[120:123], v[104:107]
s_waitcnt lgkmcnt(9)
ds_read_b64_tr_b16 a[244:245], v8 offset:49544
v_mfma_f32_16x16x32_bf16 v[164:167], a[224:227], v[76:79], v[164:167]
s_waitcnt lgkmcnt(8)
ds_read_b64_tr_b16 a[250:251], v9 offset:50048
ds_read_b64_tr_b16 a[248:249], v9 offset:49536
v_mfma_f32_16x16x32_bf16 v[108:111], a[228:231], a[56:59], v[108:111]
ds_read_b64_tr_b16 a[254:255], v9 offset:50056
v_mfma_f32_16x16x32_bf16 v[112:115], a[228:231], a[120:123], v[112:115]
ds_read_b64_tr_b16 a[252:253], v9 offset:49544
v_mfma_f32_16x16x32_bf16 v[168:171], a[228:231], v[76:79], v[168:171]
s_waitcnt lgkmcnt(10)
v_mfma_f32_16x16x32_bf16 v[116:119], a[232:235], a[56:59], v[116:119]
v_mfma_f32_16x16x32_bf16 v[120:123], a[232:235], a[120:123], v[120:123]
s_waitcnt lgkmcnt(8)
v_mfma_f32_16x16x32_bf16 v[124:127], a[236:239], a[56:59], v[124:127]
v_mfma_f32_16x16x32_bf16 v[128:131], a[236:239], a[120:123], v[128:131]
s_waitcnt lgkmcnt(6)
s_waitcnt lgkmcnt(0) vmcnt(8)
s_barrier
ds_read_b64_tr_b16 a[226:227], v6 offset:58304
v_mfma_f32_16x16x32_bf16 v[132:135], a[240:243], a[56:59], v[132:135]
ds_read_b64_tr_b16 a[224:225], v6 offset:57792
buffer_load_dwordx4 v12, s[8:11], 0 offen nt lds
v_mfma_f32_16x16x32_bf16 v[136:139], a[240:243], a[120:123], v[136:139]
s_add_u32 m0, s41, 20352
ds_read_b128 v[76:79], v252 offset:14336
v_mfma_f32_16x16x32_bf16 v[140:143], a[244:247], a[56:59], v[140:143]
ds_read_b64_tr_b16 a[230:231], v6 offset:58312
v_mfma_f32_16x16x32_bf16 v[144:147], a[244:247], a[120:123], v[144:147]
ds_read_b64_tr_b16 a[228:229], v6 offset:57800
v_mfma_f32_16x16x32_bf16 v[148:151], a[248:251], a[56:59], v[148:151]
ds_read_b64_tr_b16 a[234:235], v7 offset:58304
buffer_load_dwordx4 v12, s[8:11], 0 offen offset:128 nt lds
v_mfma_f32_16x16x32_bf16 v[152:155], a[248:251], a[120:123], v[152:155]
s_add_u32 m0, s42, 8256
ds_read_b64_tr_b16 a[232:233], v7 offset:57792
v_add_u32 v12, s7, v12
v_mfma_f32_16x16x32_bf16 v[156:159], a[252:255], a[56:59], v[156:159]
ds_read_b64_tr_b16 a[238:239], v7 offset:58312
v_mfma_f32_16x16x32_bf16 v[160:163], a[252:255], a[120:123], v[160:163]
s_waitcnt lgkmcnt(6)
ds_read_b64_tr_b16 a[236:237], v7 offset:57800
v_mfma_f32_16x16x32_bf16 v[100:103], a[224:227], a[60:63], v[100:103]
ds_read_b64_tr_b16 a[242:243], v8 offset:58304
buffer_load_dwordx4 v13, s[12:15], 0 offen nt lds
v_mfma_f32_16x16x32_bf16 v[104:107], a[224:227], a[124:127], v[104:107]
s_waitcnt lgkmcnt(7)
ds_read_b64_tr_b16 a[240:241], v8 offset:57792
s_add_u32 m0, s42, 12256
v_mfma_f32_16x16x32_bf16 v[164:167], a[224:227], v[76:79], v[164:167]
s_waitcnt lgkmcnt(6)
ds_read_b64_tr_b16 a[246:247], v8 offset:58312
v_mfma_f32_16x16x32_bf16 v[108:111], a[228:231], a[60:63], v[108:111]
ds_read_b64_tr_b16 a[244:245], v8 offset:57800
v_mfma_f32_16x16x32_bf16 v[112:115], a[228:231], a[124:127], v[112:115]
ds_read_b64_tr_b16 a[250:251], v9 offset:58304
buffer_load_dwordx4 v13, s[12:15], 0 offen offset:128 nt lds
v_mfma_f32_16x16x32_bf16 v[168:171], a[228:231], v[76:79], v[168:171]
s_waitcnt lgkmcnt(7)
ds_read_b64_tr_b16 a[248:249], v9 offset:57792
s_add_u32 m0, s42, 49536
v_mfma_f32_16x16x32_bf16 v[116:119], a[232:235], a[60:63], v[116:119]
ds_read_b64_tr_b16 a[254:255], v9 offset:58312
buffer_load_dwordx4 v14, s[16:19], 0 offen lds
v_mfma_f32_16x16x32_bf16 v[120:123], a[232:235], a[124:127], v[120:123]
s_waitcnt lgkmcnt(7)
ds_read_b64_tr_b16 a[252:253], v9 offset:57800
v_mul_f32 v165, s48, v165
v_mfma_f32_16x16x32_bf16 v[124:127], a[236:239], a[60:63], v[124:127]
s_add_u32 m0, s42, 53536
v_mul_f32 v164, s48, v164
v_cvt_pk_bf16_f32 v164, v164, v165
v_mfma_f32_16x16x32_bf16 v[128:131], a[236:239], a[124:127], v[128:131]
s_waitcnt lgkmcnt(6)
buffer_load_dwordx4 v14, s[16:19], 0 offen offset:128 lds
v_mul_f32 v167, s48, v167
v_mfma_f32_16x16x32_bf16 v[132:135], a[240:243], a[60:63], v[132:135]
v_mul_f32 v166, s48, v166
v_cvt_pk_bf16_f32 v165, v166, v167
v_mfma_f32_16x16x32_bf16 v[136:139], a[240:243], a[124:127], v[136:139]
s_waitcnt lgkmcnt(4)
v_mul_f32 v171, s48, v171
v_mul_f32 v170, s48, v170
v_mfma_f32_16x16x32_bf16 v[140:143], a[244:247], a[60:63], v[140:143]
v_mul_f32 v169, s48, v169
v_mul_f32 v168, s48, v168
v_mfma_f32_16x16x32_bf16 v[144:147], a[244:247], a[124:127], v[144:147]
s_waitcnt lgkmcnt(2)
v_cvt_pk_bf16_f32 v167, v170, v171
v_cvt_pk_bf16_f32 v166, v168, v169
v_mfma_f32_16x16x32_bf16 v[148:151], a[248:251], a[60:63], v[148:151]
v_add_u32 v14, 0x40000, v14
v_add_u32 v13, s6, v13
v_mfma_f32_16x16x32_bf16 v[152:155], a[248:251], a[124:127], v[152:155]
s_waitcnt lgkmcnt(0)
v_mfma_f32_16x16x32_bf16 v[156:159], a[252:255], a[60:63], v[156:159]
v_mfma_f32_16x16x32_bf16 v[160:163], a[252:255], a[124:127], v[160:163]
ds_write_b128 v15, v[164:167] offset:33024
s_cmp_eq_u32 s97, 1
s_cbranch_scc1 L_collect
L_round:
s_waitcnt lgkmcnt(0) vmcnt(10)
s_barrier
v_mfma_f32_16x16x32_bf16 v[32:35], v[16:19], v[64:67], v[32:35]
s_add_u32 m0, s41, 24576
ds_read_b128 v[80:83], v10 offset:40192
ds_read_b64_tr_b16 a[224:225], v6 offset:24768
ds_read_b64_tr_b16 a[226:227], v6 offset:25280
v_mul_f32 v100, s48, v100
v_mul_f32 v101, s48, v101
v_mul_f32 v108, s48, v108
v_mul_f32 v109, s48, v109
v_mul_f32 v104, s48, v104
v_mul_f32 v105, s48, v105
v_mul_f32 v112, s48, v112
v_mul_f32 v113, s48, v113
v_mul_f32 v116, s48, v116
v_mul_f32 v117, s48, v117
v_mul_f32 v124, s48, v124
v_mul_f32 v125, s48, v125
v_mul_f32 v120, s48, v120
v_mul_f32 v121, s48, v121
v_mul_f32 v128, s48, v128
v_mul_f32 v129, s48, v129
v_mul_f32 v132, s48, v132
v_mul_f32 v133, s48, v133
v_mul_f32 v140, s48, v140
v_mul_f32 v141, s48, v141
v_mfma_f32_16x16x32_bf16 v[36:39], v[16:19], v[68:71], v[36:39]
s_waitcnt lgkmcnt(2)
ds_read_b64_tr_b16 a[228:229], v6 offset:24776
v_mul_f32 v102, s48, v102
v_mul_f32 v103, s48, v103
v_mul_f32 v110, s48, v110
v_mul_f32 v111, s48, v111
v_mul_f32 v106, s48, v106
v_mul_f32 v107, s48, v107
v_mul_f32 v114, s48, v114
v_mul_f32 v115, s48, v115
v_mul_f32 v118, s48, v118
v_mul_f32 v119, s48, v119
v_mul_f32 v126, s48, v126
v_mul_f32 v127, s48, v127
v_mul_f32 v122, s48, v122
v_mul_f32 v123, s48, v123
v_mul_f32 v130, s48, v130
v_mul_f32 v131, s48, v131
v_mul_f32 v134, s48, v134
v_mul_f32 v135, s48, v135
v_mul_f32 v142, s48, v142
v_mul_f32 v143, s48, v143
v_mul_f32 v136, s48, v136
v_mul_f32 v137, s48, v137
v_mul_f32 v144, s48, v144
v_mul_f32 v145, s48, v145
v_mul_f32 v148, s48, v148
v_mul_f32 v149, s48, v149
v_mul_f32 v156, s48, v156
v_mul_f32 v157, s48, v157
v_cvt_pk_bf16_f32 v100, v100, v101
v_cvt_pk_bf16_f32 v108, v108, v109
v_cvt_pk_bf16_f32 v104, v104, v105
v_cvt_pk_bf16_f32 v112, v112, v113
v_cvt_pk_bf16_f32 v116, v116, v117
v_cvt_pk_bf16_f32 v124, v124, v125
v_cvt_pk_bf16_f32 v120, v120, v121
v_cvt_pk_bf16_f32 v128, v128, v129
v_cvt_pk_bf16_f32 v132, v132, v133
v_cvt_pk_bf16_f32 v140, v140, v141
v_mul_f32 v138, s48, v138
v_mul_f32 v139, s48, v139
v_mul_f32 v146, s48, v146
v_mul_f32 v147, s48, v147
v_mul_f32 v150, s48, v150
v_mul_f32 v151, s48, v151
v_mul_f32 v158, s48, v158
v_mul_f32 v159, s48, v159
v_mul_f32 v160, s48, v160
v_mul_f32 v161, s48, v161
ds_read_b64_tr_b16 a[230:231], v6 offset:25288
v_cvt_pk_bf16_f32 v136, v136, v137
v_cvt_pk_bf16_f32 v144, v144, v145
v_cvt_pk_bf16_f32 v148, v148, v149
v_cvt_pk_bf16_f32 v156, v156, v157
v_cvt_pk_bf16_f32 v101, v102, v103
v_cvt_pk_bf16_f32 v109, v110, v111
v_cvt_pk_bf16_f32 v105, v106, v107
v_cvt_pk_bf16_f32 v113, v114, v115
v_cvt_pk_bf16_f32 v117, v118, v119
v_cvt_pk_bf16_f32 v125, v126, v127
v_cvt_pk_bf16_f32 v121, v122, v123
v_cvt_pk_bf16_f32 v129, v130, v131
v_cvt_pk_bf16_f32 v133, v134, v135
v_cvt_pk_bf16_f32 v141, v142, v143
v_mul_f32 v153, s48, v153
v_mfma_f32_16x16x32_bf16 v[40:43], v[16:19], v[80:83], v[40:43]
s_waitcnt lgkmcnt(2)
ds_read_b64_tr_b16 a[234:235], v7 offset:25280
buffer_load_dwordx4 v12, s[8:11], 0 offen nt lds
v_mul_f32 v152, s48, v152
v_cvt_pk_bf16_f32 v160, v160, v161
v_mfma_f32_16x16x32_bf16 v[172:175], a[224:227], v[64:67], v[172:175]
s_add_u32 m0, s41, 28544
ds_read_b64_tr_b16 a[232:233], v7 offset:24768
v_mul_f32 v163, s48, v163
v_mul_f32 v162, s48, v162
v_mfma_f32_16x16x32_bf16 v[176:179], a[224:227], v[68:71], v[176:179]
s_add_u32 s43, s43, 8192
ds_read_b64_tr_b16 a[238:239], v7 offset:25288
v_cvt_pk_bf16_f32 v145, v146, v147
v_accvgpr_write_b32 a131, v109
v_mfma_f32_16x16x32_bf16 v[236:239], a[224:227], v[80:83], v[236:239]
s_waitcnt lgkmcnt(3)
ds_read_b64_tr_b16 a[236:237], v7 offset:24776
v_accvgpr_write_b32 a130, v108
v_accvgpr_write_b32 a129, v101
v_mfma_f32_16x16x32_bf16 v[180:183], a[228:231], v[64:67], v[180:183]
s_and_b32 s43, s43, 0x1ffff
s_cselect_b32 s6, s4, s5
ds_read_b64_tr_b16 a[242:243], v8 offset:25280
buffer_load_dwordx4 v12, s[8:11], 0 offen offset:128 nt lds
v_accvgpr_write_b32 a128, v100
v_mfma_f32_16x16x32_bf16 v[184:187], a[228:231], v[68:71], v[184:187]
s_add_u32 m0, s42, 16512
ds_read_b64_tr_b16 a[240:241], v8 offset:24768
v_cvt_pk_bf16_f32 v137, v138, v139
v_accvgpr_write_b32 a147, v113
v_mfma_f32_16x16x32_bf16 v[240:243], a[228:231], v[80:83], v[240:243]
s_waitcnt lgkmcnt(4)
ds_read_b64_tr_b16 a[246:247], v8 offset:25288
v_accvgpr_write_b32 a146, v112
v_accvgpr_write_b32 a145, v105
v_mfma_f32_16x16x32_bf16 v[188:191], a[232:235], v[64:67], v[188:191]
s_add_u32 s62, s62, 0x80000
ds_read_b64_tr_b16 a[244:245], v8 offset:24776
v_accvgpr_write_b32 a144, v104
v_cvt_pk_bf16_f32 v157, v158, v159
v_mfma_f32_16x16x32_bf16 v[192:195], a[232:235], v[68:71], v[192:195]
s_waitcnt lgkmcnt(4)
ds_read_b64_tr_b16 a[250:251], v9 offset:25280
buffer_load_dwordx4 v13, s[12:15], 0 offen nt lds
v_accvgpr_write_b32 a135, v125
v_mfma_f32_16x16x32_bf16 v[196:199], a[236:239], v[64:67], v[196:199]
s_add_u32 m0, s42, 20512
ds_read_b64_tr_b16 a[248:249], v9 offset:24768
v_accvgpr_write_b32 a134, v124
v_accvgpr_write_b32 a133, v117
v_mfma_f32_16x16x32_bf16 v[200:203], a[236:239], v[68:71], v[200:203]
s_waitcnt lgkmcnt(4)
ds_read_b64_tr_b16 a[254:255], v9 offset:25288
v_accvgpr_write_b32 a132, v116
v_accvgpr_write_b32 a151, v129
v_mfma_f32_16x16x32_bf16 v[204:207], a[240:243], v[64:67], v[204:207]
s_and_b32 s62, s62, 0x3fffff
s_cselect_b32 s67, 0x40000, s61
ds_read_b64_tr_b16 a[252:253], v9 offset:24776
v_accvgpr_write_b32 a150, v128
v_accvgpr_write_b32 a149, v121
v_mfma_f32_16x16x32_bf16 v[208:211], a[240:243], v[68:71], v[208:211]
s_waitcnt lgkmcnt(4)
ds_read_b128 a[224:227], v0 offset:0
buffer_load_dwordx4 v13, s[12:15], 0 offen offset:128 nt lds
v_accvgpr_write_b32 a148, v120
v_mfma_f32_16x16x32_bf16 v[212:215], a[244:247], v[64:67], v[212:215]
s_add_u32 m0, s42, 57792
ds_read_b128 a[228:231], v1 offset:0
v_cvt_pk_bf16_f32 v149, v150, v151
v_accvgpr_write_b32 a139, v141
v_mfma_f32_16x16x32_bf16 v[216:219], a[244:247], v[68:71], v[216:219]
s_waitcnt lgkmcnt(4)
ds_read_b128 a[232:235], v2 offset:0
v_accvgpr_write_b32 a138, v140
v_accvgpr_write_b32 a137, v133
v_mfma_f32_16x16x32_bf16 v[220:223], a[248:251], v[64:67], v[220:223]
s_add_u32 s43, s43, 8192
ds_read_b128 a[236:239], v3 offset:0
v_accvgpr_write_b32 a136, v132
v_cvt_pk_bf16_f32 v152, v152, v153
v_mfma_f32_16x16x32_bf16 v[224:227], a[248:251], v[68:71], v[224:227]
s_waitcnt lgkmcnt(4)
ds_read_b128 a[240:243], v0 offset:512
buffer_load_dwordx4 v14, s[16:19], 0 offen lds
v_mul_f32 v155, s48, v155
v_mfma_f32_16x16x32_bf16 v[228:231], a[252:255], v[64:67], v[228:231]
s_add_u32 m0, s42, 61792
ds_read_b128 a[244:247], v1 offset:512
v_mul_f32 v154, s48, v154
v_cvt_pk_bf16_f32 v161, v162, v163
v_mfma_f32_16x16x32_bf16 v[232:235], a[252:255], v[68:71], v[232:235]
s_waitcnt lgkmcnt(5)
ds_read_b128 a[248:251], v2 offset:512
v_accvgpr_write_b32 a155, v145
v_accvgpr_write_b32 a154, v144
v_mfma_f32_16x16x32_bf16 v[44:47], a[224:227], a[128:131], 0
s_add_u32 s62, s62, 0x80000
ds_read_b128 a[252:255], v3 offset:512
v_accvgpr_write_b32 a153, v137
v_accvgpr_write_b32 a152, v136
v_mfma_f32_16x16x32_bf16 v[48:51], a[224:227], a[144:147], 0
s_waitcnt lgkmcnt(6)
ds_read_b128 v[84:87], v10 offset:33024
buffer_load_dwordx4 v14, s[16:19], 0 offen offset:128 lds
v_subrev_u32 v74, s55, v4
v_mfma_f32_16x16x32_bf16 v[44:47], a[228:231], a[132:135], v[44:47]
s_mov_b32 m0, s41
ds_read_b128 a[224:227], v74 offset:0
v_accvgpr_write_b32 a143, v157
v_accvgpr_write_b32 a142, v156
v_mfma_f32_16x16x32_bf16 v[48:51], a[228:231], a[148:151], v[48:51]
s_waitcnt lgkmcnt(7)
ds_read_b128 v[88:91], v10 offset:34048
v_accvgpr_write_b32 a141, v149
v_accvgpr_write_b32 a140, v148
v_mfma_f32_16x16x32_bf16 v[44:47], a[232:235], a[136:139], v[44:47]
ds_read_b128 v[92:95], v10 offset:35072
v_cvt_pk_bf16_f32 v153, v154, v155
v_accvgpr_write_b32 a159, v161
v_mfma_f32_16x16x32_bf16 v[48:51], a[232:235], a[152:155], v[48:51]
s_waitcnt lgkmcnt(8)
ds_read_b128 a[232:235], v74 offset:4096
v_accvgpr_write_b32 a158, v160
v_accvgpr_write_b32 a157, v153
v_mfma_f32_16x16x32_bf16 v[44:47], a[236:239], a[140:143], v[44:47]
ds_read_b128 v[96:99], v10 offset:36096
v_accvgpr_write_b32 a156, v152
s_nop 1
v_mfma_f32_16x16x32_bf16 v[48:51], a[236:239], a[156:159], v[48:51]
s_waitcnt lgkmcnt(9)
ds_read_b128 v[76:79], v251 offset:0
v_subrev_u32 v75, s55, v5
ds_read_b128 a[228:231], v75 offset:0
v_mfma_f32_16x16x32_bf16 v[52:55], a[240:243], a[128:131], 0
v_rcp_f32 v249, v36
v_mfma_f32_16x16x32_bf16 v[56:59], a[240:243], a[144:147], 0
s_waitcnt lgkmcnt(10)
ds_read_b128 a[236:239], v75 offset:4096
v_mul_f32 v225, v249, v225
v_mfma_f32_16x16x32_bf16 v[52:55], a[244:247], a[132:135], v[52:55]
v_rcp_f32 v248, v32
v_mfma_f32_16x16x32_bf16 v[56:59], a[244:247], a[148:151], v[56:59]
s_waitcnt lgkmcnt(10)
ds_read_b128 a[240:243], v4 offset:0
v_mul_f32 v224, v249, v224
v_mfma_f32_16x16x32_bf16 v[52:55], a[248:251], a[136:139], v[52:55]
ds_read_b128 a[244:247], v5 offset:0
v_mul_f32 v173, v248, v173
v_rcp_f32 v250, v40
v_mfma_f32_16x16x32_bf16 v[56:59], a[248:251], a[152:155], v[56:59]
s_waitcnt lgkmcnt(11)
ds_read_b128 a[248:251], v4 offset:4096
v_mul_f32 v172, v248, v172
v_mul_f32 v237, v250, v237
v_mfma_f32_16x16x32_bf16 v[52:55], a[252:255], a[140:143], v[52:55]
v_mul_f32 v233, v249, v233
v_mul_f32 v236, v250, v236
v_cvt_pk_bf16_f32 v236, v236, v237
v_mfma_f32_16x16x32_bf16 v[56:59], a[252:255], a[156:159], v[56:59]
s_waitcnt lgkmcnt(10)
ds_read_b128 a[252:255], v5 offset:4096
v_mul_f32 v232, v249, v232
v_mul_f32 v239, v250, v239
v_mfma_f32_16x16x32_bf16 v[60:63], a[224:227], v[84:87], 0
s_waitcnt lgkmcnt(5)
ds_read_b64_tr_b16 a[224:225], v6 offset:33024
v_max3_f32 v244, v44, v45, v46
v_mul_f32 v205, v248, v205
v_mfma_f32_16x16x32_bf16 v[60:63], a[228:231], v[88:91], v[60:63]
ds_read_b64_tr_b16 a[226:227], v6 offset:33536
v_mul_f32 v238, v250, v238
v_max3_f32 v246, v48, v49, v50
v_max3_f32 v244, v244, v47, v52
v_mul_f32 v204, v248, v204
v_max3_f32 v244, v244, v53, v54
v_cmp_nge_f32 vcc, s49, v40
v_max_f32 v244, v244, v55
v_mfma_f32_16x16x32_bf16 v[60:63], a[232:235], v[92:95], v[60:63]
s_waitcnt lgkmcnt(6)
ds_read_b64_tr_b16 a[230:231], v6 offset:33544
v_add_u32 v12, s6, v12
v_mul_f32 v213, v248, v213
v_max3_f32 v246, v246, v51, v56
v_mov_b32 v245, v244
v_max3_f32 v246, v246, v57, v58
v_mul_f32 v212, v248, v212
v_permlane32_swap_b32 v244, v245
v_cvt_pk_bf16_f32 v237, v238, v239
s_and_b64 vcc, vcc, s[52:53]
v_max_f32 v246, v246, v59
v_max_f32 v244, v244, v245
v_mfma_f32_16x16x32_bf16 v[60:63], a[236:239], v[96:99], v[60:63]
s_waitcnt lgkmcnt(6)
ds_read_b64_tr_b16 a[228:229], v6 offset:33032
s_or_b64 s[50:51], s[50:51], vcc
ds_read_b64_tr_b16 a[234:235], v7 offset:33536
v_mov_b32 v247, v246
v_mov_b32 v245, v244
v_mul_f32 v243, v250, v243
v_cmp_nge_f32 vcc, s49, v32
v_max3_f32 v74, v60, v61, v62
v_max_f32 v74, v74, v63
v_mov_b32 v75, v74
v_permlane32_swap_b32 v246, v247
v_max_f32 v246, v246, v247
v_permlane32_swap_b32 v74, v75
v_max_f32 v74, v74, v75
v_add_u32 v13, s7, v13
v_mul_f32 v242, v250, v242
v_mov_b32 v247, v246
v_mul_f32 v193, v249, v193
v_mov_b32 v75, v74
s_nop 1
v_permlane16_swap_b32 v74, v75
v_max_f32 v74, v74, v75
s_cmp_eq_u32 s97, 2
s_cbranch_scc1 L_tm1
L_tr1:
v_sub_f32 v28, 0, v74
v_sub_f32 v29, 0, v74
v_sub_f32 v30, 0, v74
v_sub_f32 v31, 0, v74
s_nop 1
v_mfma_f32_16x16x32_bf16 v[60:63], a[240:243], v[84:87], v[28:31]
s_waitcnt lgkmcnt(7)
ds_read_b64_tr_b16 a[232:233], v7 offset:33024
v_permlane16_swap_b32 v244, v245
v_permlane16_swap_b32 v246, v247
v_mul_f32 v185, v249, v185
v_mul_f32 v241, v250, v241
v_mul_f32 v192, v249, v192
v_max_f32 v244, v244, v245
v_mfma_f32_16x16x32_bf16 v[60:63], a[244:247], v[88:91], v[60:63]
s_waitcnt lgkmcnt(7)
ds_read_b64_tr_b16 a[238:239], v7 offset:33544
v_cvt_pk_bf16_f32 v192, v192, v193
v_mul_f32 v184, v249, v184
v_mul_f32 v240, v250, v240
v_mul_f32 v181, v248, v181
v_mul_f32 v195, v249, v195
v_mul_f32 v217, v249, v217
v_mul_f32 v229, v248, v229
v_mfma_f32_16x16x32_bf16 v[60:63], a[248:251], v[92:95], v[60:63]
s_waitcnt lgkmcnt(7)
ds_read_b64_tr_b16 a[236:237], v7 offset:33032
v_mul_f32 v180, v248, v180
v_mul_f32 v194, v249, v194
v_mul_f32 v216, v249, v216
v_mul_f32 v228, v248, v228
v_max_f32 v246, v246, v247
s_cmp_eq_u32 s97, 2
s_cbranch_scc1 L_tm2
L_tr2:
v_cvt_pk_bf16_f32 v180, v180, v181
v_mul_f32 v201, v249, v201
v_mul_f32 v197, v248, v197
s_cmp_eq_u32 s97, 2
s_cbranch_scc1 L_tm3
L_tr3:
v_mfma_f32_16x16x32_bf16 v[60:63], a[252:255], v[96:99], v[60:63]
s_waitcnt lgkmcnt(6)
ds_read_b64_tr_b16 a[242:243], v8 offset:33536
v_sub_f32 v44, v44, v244
v_sub_f32 v45, v45, v244
v_sub_f32 v46, v46, v244
v_sub_f32 v47, v47, v244
v_sub_f32 v52, v52, v244
v_sub_f32 v53, v53, v244
v_sub_f32 v54, v54, v244
v_sub_f32 v55, v55, v244
v_sub_f32 v48, v48, v246
v_sub_f32 v49, v49, v246
v_sub_f32 v50, v50, v246
v_sub_f32 v51, v51, v246
v_sub_f32 v56, v56, v246
v_sub_f32 v57, v57, v246
v_sub_f32 v58, v58, v246
v_sub_f32 v59, v59, v246
v_mul_f32 v189, v248, v189
v_mul_f32 v183, v248, v183
v_mul_f32 v200, v249, v200
v_mul_f32 v196, v248, v196
v_exp_f32 v44, v44
v_exp_f32 v45, v45
v_exp_f32 v46, v46
v_exp_f32 v47, v47
v_exp_f32 v52, v52
v_exp_f32 v53, v53
v_exp_f32 v54, v54
v_exp_f32 v55, v55
v_exp_f32 v48, v48
v_exp_f32 v49, v49
v_exp_f32 v50, v50
v_exp_f32 v51, v51
v_exp_f32 v56, v56
v_exp_f32 v57, v57
v_exp_f32 v58, v58
v_exp_f32 v59, v59
v_mul_f32 v188, v248, v188
v_mfma_f32_16x16x32_bf16 v[100:103], a[224:227], a[0:3], 0
s_and_b64 vcc, vcc, s[52:53]
ds_read_b64_tr_b16 a[240:241], v8 offset:33024
v_mul_f32 v182, v248, v182
v_sub_f32 v20, 0, v244
v_sub_f32 v21, 0, v244
v_sub_f32 v22, 0, v244
v_sub_f32 v23, 0, v244
v_sub_f32 v24, 0, v246
v_sub_f32 v25, 0, v246
v_sub_f32 v26, 0, v246
v_sub_f32 v27, 0, v246
v_cvt_pk_bf16_f32 v64, v44, v45
v_cvt_pk_bf16_f32 v65, v46, v47
v_cvt_pk_bf16_f32 v66, v52, v53
v_cvt_pk_bf16_f32 v67, v54, v55
v_cvt_pk_bf16_f32 v68, v48, v49
v_cvt_pk_bf16_f32 v69, v50, v51
v_cvt_pk_bf16_f32 v70, v56, v57
v_cvt_pk_bf16_f32 v71, v58, v59
v_mul_f32 v177, v249, v177
v_cvt_pk_bf16_f32 v188, v188, v189
v_mfma_f32_16x16x32_bf16 v[104:107], a[224:227], a[64:67], 0
s_or_b64 s[50:51], s[50:51], vcc
ds_read_b64_tr_b16 a[246:247], v8 offset:33544
v_mul_f32 v176, v249, v176
v_mul_f32 v191, v248, v191
v_mul_f32 v209, v249, v209
v_mul_f32 v190, v248, v190
v_mfma_f32_16x16x32_bf16 v[164:167], a[224:227], v[76:79], 0
s_waitcnt lgkmcnt(7)
ds_read_b64_tr_b16 a[244:245], v8 offset:33032
v_mul_f32 v208, v249, v208
v_add_u32 v14, s67, v14
v_mul_f32 v221, v248, v221
v_mfma_f32_16x16x32_bf16 v[108:111], a[228:231], a[0:3], 0
s_and_b32 s43, s43, 0x1ffff
s_cselect_b32 s7, s4, s5
ds_read_b64_tr_b16 a[250:251], v9 offset:33536
v_cvt_pk_bf16_f32 v176, v176, v177
v_mul_f32 v220, v248, v220
v_exp_f32 v60, v60
v_exp_f32 v61, v61
v_exp_f32 v62, v62
v_exp_f32 v63, v63
v_mul_f32 v179, v249, v179
v_mfma_f32_16x16x32_bf16 v[112:115], a[228:231], a[64:67], 0
s_add_u32 s43, s43, 8192
ds_read_b64_tr_b16 a[248:249], v9 offset:33024
v_cvt_pk_bf16_f32 v72, v60, v61
v_cvt_pk_bf16_f32 v73, v62, v63
v_mul_f32 v178, v249, v178
v_cvt_pk_bf16_f32 v208, v208, v209
v_mfma_f32_16x16x32_bf16 v[168:171], a[228:231], v[76:79], 0
s_waitcnt lgkmcnt(8)
ds_read_b64_tr_b16 a[254:255], v9 offset:33544
v_mul_f32 v211, v249, v211
v_mul_f32 v210, v249, v210
v_mfma_f32_16x16x32_bf16 v[116:119], a[232:235], a[0:3], 0
s_and_b32 s62, s62, 0x3fffff
s_cselect_b32 s67, 0x40000, s61
ds_read_b64_tr_b16 a[252:253], v9 offset:33032
v_cvt_pk_bf16_f32 v220, v220, v221
v_mul_f32 v223, v248, v223
v_mfma_f32_16x16x32_bf16 v[120:123], a[232:235], a[64:67], 0
s_waitcnt lgkmcnt(8)
ds_write_b64 v11, v[72:73] offset:37120
v_mul_f32 v222, v248, v222
v_mfma_f32_16x16x32_bf16 v[124:127], a[236:239], a[0:3], 0
s_add_u32 s62, s62, 0x80000
v_cvt_pk_bf16_f32 v224, v224, v225
v_mul_f32 v227, v249, v227
v_mul_f32 v226, v249, v226
v_mfma_f32_16x16x32_bf16 v[128:131], a[236:239], a[64:67], 0
s_waitcnt lgkmcnt(7)
s_waitcnt lgkmcnt(0) vmcnt(12)
s_barrier
ds_read_b128 a[224:227], v0 offset:8192
v_cvt_pk_bf16_f32 v172, v172, v173
v_mul_f32 v175, v248, v175
v_mfma_f32_16x16x32_bf16 v[132:135], a[240:243], a[0:3], 0
ds_read_b128 a[228:231], v1 offset:8192
v_mul_f32 v174, v248, v174
v_cvt_pk_bf16_f32 v232, v232, v233
v_mfma_f32_16x16x32_bf16 v[136:139], a[240:243], a[64:67], 0
ds_read_b128 a[232:235], v2 offset:8192
v_mul_f32 v235, v249, v235
v_mul_f32 v234, v249, v234
v_mfma_f32_16x16x32_bf16 v[140:143], a[244:247], a[0:3], 0
ds_read_b128 a[236:239], v3 offset:8192
buffer_load_dwordx4 v12, s[8:11], 0 offen nt lds
v_cvt_pk_bf16_f32 v204, v204, v205
v_mfma_f32_16x16x32_bf16 v[144:147], a[244:247], a[64:67], 0
s_add_u32 m0, s41, 3968
ds_read_b128 a[240:243], v0 offset:8704
v_mul_f32 v207, v248, v207
v_mul_f32 v206, v248, v206
v_mfma_f32_16x16x32_bf16 v[148:151], a[248:251], a[0:3], 0
ds_read_b128 a[244:247], v1 offset:8704
v_cvt_pk_bf16_f32 v239, v242, v243
v_cvt_pk_bf16_f32 v238, v240, v241
v_mfma_f32_16x16x32_bf16 v[152:155], a[248:251], a[64:67], 0
ds_read_b128 a[248:251], v2 offset:8704
v_add_u32 v15, s54, v10
v_cvt_pk_bf16_f32 v228, v228, v229
v_mfma_f32_16x16x32_bf16 v[156:159], a[252:255], a[0:3], 0
ds_read_b128 v[80:83], v10 offset:37120
buffer_load_dwordx4 v12, s[8:11], 0 offen offset:128 nt lds
v_mul_f32 v231, v248, v231
v_mfma_f32_16x16x32_bf16 v[160:163], a[252:255], a[64:67], 0
s_waitcnt lgkmcnt(7)
ds_read_b128 a[252:255], v3 offset:8704
v_mul_f32 v230, v248, v230
v_cvt_pk_bf16_f32 v196, v196, v197
v_mfma_f32_16x16x32_bf16 v[44:47], a[224:227], a[128:131], v[20:23]
s_add_u32 m0, s42, 24768
ds_read_b128 v[76:79], v252 offset:0
v_mul_f32 v199, v248, v199
v_mul_f32 v198, v248, v198
v_mfma_f32_16x16x32_bf16 v[48:51], a[224:227], a[144:147], v[24:27]
s_waitcnt lgkmcnt(8)
ds_read_b64_tr_b16 a[226:227], v6 offset:512
v_cvt_pk_bf16_f32 v212, v212, v213
v_mul_f32 v215, v248, v215
v_mfma_f32_16x16x32_bf16 v[44:47], a[228:231], a[132:135], v[44:47]
ds_read_b64_tr_b16 a[224:225], v6 offset:0
buffer_load_dwordx4 v13, s[12:15], 0 offen nt lds
v_mul_f32 v214, v248, v214
v_mfma_f32_16x16x32_bf16 v[48:51], a[228:231], a[148:151], v[48:51]
s_waitcnt lgkmcnt(9)
ds_read_b64_tr_b16 a[230:231], v6 offset:520
v_cmp_nge_f32 vcc, s49, v36
v_cvt_pk_bf16_f32 v184, v184, v185
v_mfma_f32_16x16x32_bf16 v[44:47], a[232:235], a[136:139], v[44:47]
s_add_u32 m0, s42, 28768
ds_read_b64_tr_b16 a[228:229], v6 offset:8
v_mul_f32 v187, v249, v187
v_mul_f32 v186, v249, v186
v_mfma_f32_16x16x32_bf16 v[48:51], a[232:235], a[152:155], v[48:51]
s_waitcnt lgkmcnt(10)
ds_read_b64_tr_b16 a[234:235], v7 offset:512
v_cvt_pk_bf16_f32 v216, v216, v217
v_mul_f32 v219, v249, v219
v_mfma_f32_16x16x32_bf16 v[44:47], a[236:239], a[140:143], v[44:47]
s_and_b64 vcc, vcc, s[52:53]
ds_read_b64_tr_b16 a[232:233], v7 offset:0
buffer_load_dwordx4 v13, s[12:15], 0 offen offset:128 nt lds
v_mul_f32 v218, v249, v218
v_mfma_f32_16x16x32_bf16 v[48:51], a[236:239], a[156:159], v[48:51]
s_waitcnt lgkmcnt(11)
ds_read_b64_tr_b16 a[238:239], v7 offset:520
v_cvt_pk_bf16_f32 v200, v200, v201
v_mul_f32 v203, v249, v203
v_mfma_f32_16x16x32_bf16 v[52:55], a[240:243], a[128:131], v[20:23]
s_add_u32 m0, s42, 33024
ds_read_b64_tr_b16 a[236:237], v7 offset:8
v_mul_f32 v202, v249, v202
v_cvt_pk_bf16_f32 v193, v194, v195
v_mfma_f32_16x16x32_bf16 v[56:59], a[240:243], a[144:147], v[24:27]
s_waitcnt lgkmcnt(12)
ds_read_b64_tr_b16 a[242:243], v8 offset:512
v_cvt_pk_bf16_f32 v181, v182, v183
v_mfma_f32_16x16x32_bf16 v[52:55], a[244:247], a[132:135], v[52:55]
s_or_b64 s[50:51], s[50:51], vcc
ds_read_b64_tr_b16 a[240:241], v8 offset:0
buffer_load_dwordx4 v14, s[16:19], 0 offen lds
v_cvt_pk_bf16_f32 v189, v190, v191
v_mfma_f32_16x16x32_bf16 v[56:59], a[244:247], a[148:151], v[56:59]
s_waitcnt lgkmcnt(13)
ds_read_b64_tr_b16 a[246:247], v8 offset:520
v_cvt_pk_bf16_f32 v177, v178, v179
v_cvt_pk_bf16_f32 v209, v210, v211
v_mfma_f32_16x16x32_bf16 v[52:55], a[248:251], a[136:139], v[52:55]
s_add_u32 m0, s42, 37024
ds_read_b64_tr_b16 a[244:245], v8 offset:8
v_cvt_pk_bf16_f32 v221, v222, v223
v_cvt_pk_bf16_f32 v225, v226, v227
v_mfma_f32_16x16x32_bf16 v[56:59], a[248:251], a[152:155], v[56:59]
s_waitcnt lgkmcnt(13)
ds_read_b64_tr_b16 a[250:251], v9 offset:512
v_cvt_pk_bf16_f32 v173, v174, v175
v_cvt_pk_bf16_f32 v233, v234, v235
v_mfma_f32_16x16x32_bf16 v[52:55], a[252:255], a[140:143], v[52:55]
ds_read_b64_tr_b16 a[248:249], v9 offset:0
buffer_load_dwordx4 v14, s[16:19], 0 offen offset:128 lds
v_cvt_pk_bf16_f32 v205, v206, v207
v_mfma_f32_16x16x32_bf16 v[56:59], a[252:255], a[156:159], v[56:59]
s_add_u32 m0, s41, 8192
ds_write_b128 v15, v[236:239] offset:0
v_mfma_f32_16x16x32_bf16 v[32:35], v[16:19], v[64:67], 0
ds_read_b64_tr_b16 a[254:255], v9 offset:520
v_cvt_pk_bf16_f32 v229, v230, v231
v_cvt_pk_bf16_f32 v197, v198, v199
v_mfma_f32_16x16x32_bf16 v[36:39], v[16:19], v[68:71], 0
ds_read_b64_tr_b16 a[252:253], v9 offset:8
v_cvt_pk_bf16_f32 v213, v214, v215
v_cvt_pk_bf16_f32 v185, v186, v187
v_mfma_f32_16x16x32_bf16 v[40:43], v[16:19], v[80:83], 0
s_waitcnt lgkmcnt(15)
v_cvt_pk_bf16_f32 v217, v218, v219
v_cvt_pk_bf16_f32 v201, v202, v203
s_cmp_eq_u32 s47, 2
s_cbranch_scc1 L_ob4
v_accvgpr_write_b32 a160, v172
v_accvgpr_write_b32 a161, v173
v_accvgpr_write_b32 a162, v180
v_accvgpr_write_b32 a163, v181
v_accvgpr_write_b32 a176, v176
v_accvgpr_write_b32 a177, v177
v_accvgpr_write_b32 a178, v184
v_accvgpr_write_b32 a179, v185
v_accvgpr_write_b32 a164, v188
v_accvgpr_write_b32 a165, v189
v_accvgpr_write_b32 a166, v196
v_accvgpr_write_b32 a167, v197
v_accvgpr_write_b32 a180, v192
v_accvgpr_write_b32 a181, v193
v_accvgpr_write_b32 a182, v200
v_accvgpr_write_b32 a183, v201
v_accvgpr_write_b32 a168, v204
v_accvgpr_write_b32 a169, v205
v_accvgpr_write_b32 a170, v212
v_accvgpr_write_b32 a171, v213
v_accvgpr_write_b32 a184, v208
v_accvgpr_write_b32 a185, v209
v_accvgpr_write_b32 a186, v216
v_accvgpr_write_b32 a187, v217
v_accvgpr_write_b32 a172, v220
v_accvgpr_write_b32 a173, v221
v_accvgpr_write_b32 a174, v228
v_accvgpr_write_b32 a175, v229
v_accvgpr_write_b32 a188, v224
v_accvgpr_write_b32 a189, v225
v_accvgpr_write_b32 a190, v232
v_accvgpr_write_b32 a191, v233
s_branch L_oj4
L_ob4:
v_accvgpr_write_b32 a192, v172
v_accvgpr_write_b32 a193, v173
v_accvgpr_write_b32 a194, v180
v_accvgpr_write_b32 a195, v181
v_accvgpr_write_b32 a208, v176
v_accvgpr_write_b32 a209, v177
v_accvgpr_write_b32 a210, v184
v_accvgpr_write_b32 a211, v185
v_accvgpr_write_b32 a196, v188
v_accvgpr_write_b32 a197, v189
v_accvgpr_write_b32 a198, v196
v_accvgpr_write_b32 a199, v197
v_accvgpr_write_b32 a212, v192
v_accvgpr_write_b32 a213, v193
v_accvgpr_write_b32 a214, v200
v_accvgpr_write_b32 a215, v201
v_accvgpr_write_b32 a200, v204
v_accvgpr_write_b32 a201, v205
v_accvgpr_write_b32 a202, v212
v_accvgpr_write_b32 a203, v213
v_accvgpr_write_b32 a216, v208
v_accvgpr_write_b32 a217, v209
v_accvgpr_write_b32 a218, v216
v_accvgpr_write_b32 a219, v217
v_accvgpr_write_b32 a204, v220
v_accvgpr_write_b32 a205, v221
v_accvgpr_write_b32 a206, v228
v_accvgpr_write_b32 a207, v229
v_accvgpr_write_b32 a220, v224
v_accvgpr_write_b32 a221, v225
v_accvgpr_write_b32 a222, v232
v_accvgpr_write_b32 a223, v233
L_oj4:
v_mfma_f32_16x16x32_bf16 v[172:175], a[224:227], v[64:67], 0
v_exp_f32 v47, v47
v_mfma_f32_16x16x32_bf16 v[176:179], a[224:227], v[68:71], 0
v_exp_f32 v46, v46
v_mfma_f32_16x16x32_bf16 v[236:239], a[224:227], v[80:83], 0
s_waitcnt lgkmcnt(13)
ds_read_b64_tr_b16 a[226:227], v6 offset:41792
v_add_u32 v12, s7, v12
v_mfma_f32_16x16x32_bf16 v[180:183], a[228:231], v[64:67], 0
ds_read_b64_tr_b16 a[224:225], v6 offset:41280
v_add_u32 v13, s6, v13
v_mfma_f32_16x16x32_bf16 v[184:187], a[228:231], v[68:71], 0
s_and_b32 s43, s43, 0x1ffff
s_cselect_b32 s6, s4, s5
v_exp_f32 v45, v45
v_mfma_f32_16x16x32_bf16 v[240:243], a[228:231], v[80:83], 0
s_waitcnt lgkmcnt(13)
ds_read_b64_tr_b16 a[230:231], v6 offset:41800
v_add_u32 v14, 0x40000, v14
v_mfma_f32_16x16x32_bf16 v[188:191], a[232:235], v[64:67], 0
s_add_u32 s43, s43, 8192
ds_read_b64_tr_b16 a[228:229], v6 offset:41288
v_add_u32 v15, s56, v10
v_mfma_f32_16x16x32_bf16 v[192:195], a[232:235], v[68:71], 0
s_waitcnt lgkmcnt(13)
ds_read_b64_tr_b16 a[234:235], v7 offset:41792
v_mfma_f32_16x16x32_bf16 v[196:199], a[236:239], v[64:67], 0
ds_read_b64_tr_b16 a[232:233], v7 offset:41280
v_mfma_f32_16x16x32_bf16 v[200:203], a[236:239], v[68:71], 0
s_waitcnt lgkmcnt(13)
ds_read_b64_tr_b16 a[238:239], v7 offset:41800
v_mfma_f32_16x16x32_bf16 v[204:207], a[240:243], v[64:67], 0
ds_read_b64_tr_b16 a[236:237], v7 offset:41288
v_mfma_f32_16x16x32_bf16 v[208:211], a[240:243], v[68:71], 0
s_waitcnt lgkmcnt(13)
ds_read_b64_tr_b16 a[242:243], v8 offset:41792
v_mfma_f32_16x16x32_bf16 v[212:215], a[244:247], v[64:67], 0
ds_read_b64_tr_b16 a[240:241], v8 offset:41280
v_mfma_f32_16x16x32_bf16 v[216:219], a[244:247], v[68:71], 0
s_waitcnt lgkmcnt(13)
ds_read_b64_tr_b16 a[246:247], v8 offset:41800
v_mfma_f32_16x16x32_bf16 v[220:223], a[248:251], v[64:67], 0
ds_read_b64_tr_b16 a[244:245], v8 offset:41288
v_mfma_f32_16x16x32_bf16 v[224:227], a[248:251], v[68:71], 0
s_waitcnt lgkmcnt(12)
ds_read_b64_tr_b16 a[250:251], v9 offset:41792
v_mfma_f32_16x16x32_bf16 v[228:231], a[252:255], v[64:67], 0
ds_read_b64_tr_b16 a[248:249], v9 offset:41280
v_cvt_pk_bf16_f32 v65, v46, v47
v_mfma_f32_16x16x32_bf16 v[232:235], a[252:255], v[68:71], 0
s_waitcnt lgkmcnt(12)
ds_read_b64_tr_b16 a[254:255], v9 offset:41800
v_mfma_f32_16x16x32_bf16 v[100:103], a[224:227], a[4:7], v[100:103]
ds_read_b64_tr_b16 a[252:253], v9 offset:41288
v_mfma_f32_16x16x32_bf16 v[104:107], a[224:227], a[68:71], v[104:107]
v_exp_f32 v44, v44
v_mfma_f32_16x16x32_bf16 v[164:167], a[224:227], v[76:79], v[164:167]
s_waitcnt lgkmcnt(12)
v_exp_f32 v51, v51
v_mfma_f32_16x16x32_bf16 v[108:111], a[228:231], a[4:7], v[108:111]
v_exp_f32 v50, v50
v_mfma_f32_16x16x32_bf16 v[112:115], a[228:231], a[68:71], v[112:115]
v_exp_f32 v49, v49
v_mfma_f32_16x16x32_bf16 v[168:171], a[228:231], v[76:79], v[168:171]
s_waitcnt lgkmcnt(10)
v_cvt_pk_bf16_f32 v64, v44, v45
v_cvt_pk_bf16_f32 v69, v50, v51
v_mfma_f32_16x16x32_bf16 v[116:119], a[232:235], a[4:7], v[116:119]
v_exp_f32 v48, v48
v_mfma_f32_16x16x32_bf16 v[120:123], a[232:235], a[68:71], v[120:123]
s_waitcnt lgkmcnt(8)
v_cvt_pk_bf16_f32 v68, v48, v49
v_mfma_f32_16x16x32_bf16 v[124:127], a[236:239], a[4:7], v[124:127]
v_exp_f32 v55, v55
v_mfma_f32_16x16x32_bf16 v[128:131], a[236:239], a[68:71], v[128:131]
s_waitcnt lgkmcnt(6)
s_waitcnt lgkmcnt(0) vmcnt(10)
s_barrier
ds_read_b128 a[224:227], v0 offset:16384
v_mfma_f32_16x16x32_bf16 v[132:135], a[240:243], a[4:7], v[132:135]
ds_read_b128 a[228:231], v1 offset:16384
buffer_load_dwordx4 v12, s[8:11], 0 offen nt lds
v_mfma_f32_16x16x32_bf16 v[136:139], a[240:243], a[68:71], v[136:139]
s_add_u32 m0, s41, 12160
ds_read_b128 a[232:235], v2 offset:16384
v_mfma_f32_16x16x32_bf16 v[140:143], a[244:247], a[4:7], v[140:143]
ds_read_b128 a[236:239], v3 offset:16384
v_mfma_f32_16x16x32_bf16 v[144:147], a[244:247], a[68:71], v[144:147]
ds_read_b128 a[240:243], v0 offset:16896
v_mfma_f32_16x16x32_bf16 v[148:151], a[248:251], a[4:7], v[148:151]
ds_read_b128 a[244:247], v1 offset:16896
buffer_load_dwordx4 v12, s[8:11], 0 offen offset:128 nt lds
v_mfma_f32_16x16x32_bf16 v[152:155], a[248:251], a[68:71], v[152:155]
s_mov_b32 m0, s42
v_exp_f32 v54, v54
v_mfma_f32_16x16x32_bf16 v[156:159], a[252:255], a[4:7], v[156:159]
v_exp_f32 v53, v53
v_mfma_f32_16x16x32_bf16 v[160:163], a[252:255], a[68:71], v[160:163]
s_waitcnt lgkmcnt(5)
v_exp_f32 v52, v52
v_mfma_f32_16x16x32_bf16 v[44:47], a[224:227], a[128:131], v[20:23]
ds_read_b128 a[248:251], v2 offset:16896
buffer_load_dwordx4 v13, s[12:15], 0 offen nt lds
v_mfma_f32_16x16x32_bf16 v[48:51], a[224:227], a[144:147], v[24:27]
s_waitcnt lgkmcnt(5)
v_exp_f32 v59, v59
v_mfma_f32_16x16x32_bf16 v[44:47], a[228:231], a[132:135], v[44:47]
s_add_u32 m0, s42, 4000
v_exp_f32 v58, v58
v_mfma_f32_16x16x32_bf16 v[48:51], a[228:231], a[148:151], v[48:51]
s_waitcnt lgkmcnt(4)
ds_read_b128 a[252:255], v3 offset:16896
v_cvt_pk_bf16_f32 v67, v54, v55
v_mfma_f32_16x16x32_bf16 v[44:47], a[232:235], a[136:139], v[44:47]
ds_read_b128 a[224:227], v4 offset:16384
buffer_load_dwordx4 v13, s[12:15], 0 offen offset:128 nt lds
v_mfma_f32_16x16x32_bf16 v[48:51], a[232:235], a[152:155], v[48:51]
s_waitcnt lgkmcnt(5)
v_exp_f32 v57, v57
v_mfma_f32_16x16x32_bf16 v[44:47], a[236:239], a[140:143], v[44:47]
s_add_u32 m0, s42, 41280
ds_read_b128 a[228:231], v5 offset:16384
v_cvt_pk_bf16_f32 v66, v52, v53
v_mfma_f32_16x16x32_bf16 v[48:51], a[236:239], a[156:159], v[48:51]
s_waitcnt lgkmcnt(5)
v_exp_f32 v56, v56
v_cvt_pk_bf16_f32 v71, v58, v59
v_mfma_f32_16x16x32_bf16 v[52:55], a[240:243], a[128:131], v[20:23]
ds_read_b128 a[232:235], v4 offset:20480
v_cvt_pk_bf16_f32 v70, v56, v57
v_mfma_f32_16x16x32_bf16 v[56:59], a[240:243], a[144:147], v[24:27]
s_waitcnt lgkmcnt(5)
ds_read_b128 a[236:239], v5 offset:20480
buffer_load_dwordx4 v14, s[16:19], 0 offen lds
v_mfma_f32_16x16x32_bf16 v[52:55], a[244:247], a[132:135], v[52:55]
s_add_u32 m0, s42, 45280
ds_read_b128 v[80:83], v10 offset:38144
v_add_u32 v12, s6, v12
v_mfma_f32_16x16x32_bf16 v[56:59], a[244:247], a[148:151], v[56:59]
s_waitcnt lgkmcnt(6)
ds_read_b64_tr_b16 a[242:243], v6 offset:8768
v_add_u32 v13, s7, v13
v_mfma_f32_16x16x32_bf16 v[52:55], a[248:251], a[136:139], v[52:55]
s_and_b32 s43, s43, 0x1ffff
s_cselect_b32 s7, s4, s5
ds_read_b64_tr_b16 a[240:241], v6 offset:8256
buffer_load_dwordx4 v14, s[16:19], 0 offen offset:128 lds
v_mfma_f32_16x16x32_bf16 v[56:59], a[248:251], a[152:155], v[56:59]
s_waitcnt lgkmcnt(7)
ds_read_b64_tr_b16 a[246:247], v6 offset:8776
s_add_u32 m0, s41, 16384
v_mfma_f32_16x16x32_bf16 v[52:55], a[252:255], a[140:143], v[52:55]
s_add_u32 s43, s43, 8192
ds_read_b64_tr_b16 a[244:245], v6 offset:8264
v_add_u32 v14, s67, v14
v_mfma_f32_16x16x32_bf16 v[56:59], a[252:255], a[156:159], v[56:59]
s_waitcnt lgkmcnt(8)
ds_read_b64_tr_b16 a[250:251], v7 offset:8768
v_mfma_f32_16x16x32_bf16 v[60:63], a[224:227], v[84:87], v[28:31]
s_waitcnt lgkmcnt(8)
ds_read_b64_tr_b16 a[248:249], v7 offset:8256
v_mfma_f32_16x16x32_bf16 v[60:63], a[228:231], v[88:91], v[60:63]
s_waitcnt lgkmcnt(8)
ds_read_b64_tr_b16 a[254:255], v7 offset:8776
v_mfma_f32_16x16x32_bf16 v[60:63], a[232:235], v[92:95], v[60:63]
s_waitcnt lgkmcnt(8)
ds_read_b64_tr_b16 a[252:253], v7 offset:8264
v_mfma_f32_16x16x32_bf16 v[60:63], a[236:239], v[96:99], v[60:63]
s_and_b32 s62, s62, 0x3fffff
s_cselect_b32 s67, 0x40000, s61
ds_read_b64_tr_b16 a[226:227], v8 offset:8768
s_add_u32 s62, s62, 0x80000
v_mfma_f32_16x16x32_bf16 v[32:35], v[16:19], v[64:67], v[32:35]
ds_read_b64_tr_b16 a[224:225], v8 offset:8256
v_mfma_f32_16x16x32_bf16 v[36:39], v[16:19], v[68:71], v[36:39]
s_waitcnt lgkmcnt(10)
ds_read_b64_tr_b16 a[230:231], v8 offset:8776
v_mfma_f32_16x16x32_bf16 v[40:43], v[16:19], v[80:83], v[40:43]
s_waitcnt lgkmcnt(9)
ds_read_b64_tr_b16 a[228:229], v8 offset:8264
v_mfma_f32_16x16x32_bf16 v[172:175], a[240:243], v[64:67], v[172:175]
ds_read_b64_tr_b16 a[234:235], v9 offset:8768
v_mfma_f32_16x16x32_bf16 v[176:179], a[240:243], v[68:71], v[176:179]
ds_read_b64_tr_b16 a[232:233], v9 offset:8256
v_mfma_f32_16x16x32_bf16 v[236:239], a[240:243], v[80:83], v[236:239]
s_waitcnt lgkmcnt(10)
ds_read_b64_tr_b16 a[238:239], v9 offset:8776
v_mfma_f32_16x16x32_bf16 v[180:183], a[244:247], v[64:67], v[180:183]
ds_read_b64_tr_b16 a[236:237], v9 offset:8264
v_mfma_f32_16x16x32_bf16 v[184:187], a[244:247], v[68:71], v[184:187]
ds_read_b64_tr_b16 a[242:243], v6 offset:50048
v_mfma_f32_16x16x32_bf16 v[240:243], a[244:247], v[80:83], v[240:243]
s_waitcnt lgkmcnt(11)
ds_read_b64_tr_b16 a[240:241], v6 offset:49536
v_mfma_f32_16x16x32_bf16 v[188:191], a[248:251], v[64:67], v[188:191]
ds_read_b128 v[76:79], v251 offset:2048
v_mfma_f32_16x16x32_bf16 v[192:195], a[248:251], v[68:71], v[192:195]
s_waitcnt lgkmcnt(11)
ds_read_b64_tr_b16 a[246:247], v6 offset:50056
v_mfma_f32_16x16x32_bf16 v[196:199], a[252:255], v[64:67], v[196:199]
ds_read_b64_tr_b16 a[244:245], v6 offset:49544
v_mfma_f32_16x16x32_bf16 v[200:203], a[252:255], v[68:71], v[200:203]
s_waitcnt lgkmcnt(11)
ds_read_b64_tr_b16 a[250:251], v7 offset:50048
v_mfma_f32_16x16x32_bf16 v[204:207], a[224:227], v[64:67], v[204:207]
ds_read_b64_tr_b16 a[248:249], v7 offset:49536
v_mfma_f32_16x16x32_bf16 v[208:211], a[224:227], v[68:71], v[208:211]
s_waitcnt lgkmcnt(11)
ds_read_b64_tr_b16 a[254:255], v7 offset:50056
v_mfma_f32_16x16x32_bf16 v[212:215], a[228:231], v[64:67], v[212:215]
ds_read_b64_tr_b16 a[252:253], v7 offset:49544
v_mfma_f32_16x16x32_bf16 v[216:219], a[228:231], v[68:71], v[216:219]
s_waitcnt lgkmcnt(11)
ds_read_b64_tr_b16 a[226:227], v8 offset:50048
v_mfma_f32_16x16x32_bf16 v[220:223], a[232:235], v[64:67], v[220:223]
ds_read_b64_tr_b16 a[224:225], v8 offset:49536
v_mfma_f32_16x16x32_bf16 v[224:227], a[232:235], v[68:71], v[224:227]
s_waitcnt lgkmcnt(11)
ds_read_b64_tr_b16 a[230:231], v8 offset:50056
v_mfma_f32_16x16x32_bf16 v[228:231], a[236:239], v[64:67], v[228:231]
ds_read_b64_tr_b16 a[228:229], v8 offset:49544
v_mfma_f32_16x16x32_bf16 v[232:235], a[236:239], v[68:71], v[232:235]
s_waitcnt lgkmcnt(11)
ds_read_b64_tr_b16 a[234:235], v9 offset:50048
v_mfma_f32_16x16x32_bf16 v[100:103], a[240:243], a[8:11], v[100:103]
v_exp_f32 v63, v63
v_mfma_f32_16x16x32_bf16 v[104:107], a[240:243], a[72:75], v[104:107]
s_waitcnt lgkmcnt(11)
ds_read_b64_tr_b16 a[232:233], v9 offset:49536
v_mfma_f32_16x16x32_bf16 v[164:167], a[240:243], v[76:79], v[164:167]
s_waitcnt lgkmcnt(10)
v_exp_f32 v62, v62
v_mfma_f32_16x16x32_bf16 v[108:111], a[244:247], a[8:11], v[108:111]
ds_read_b64_tr_b16 a[238:239], v9 offset:50056
v_exp_f32 v61, v61
v_mfma_f32_16x16x32_bf16 v[112:115], a[244:247], a[72:75], v[112:115]
ds_read_b64_tr_b16 a[236:237], v9 offset:49544
v_exp_f32 v60, v60
v_mfma_f32_16x16x32_bf16 v[168:171], a[244:247], v[76:79], v[168:171]
s_waitcnt lgkmcnt(10)
v_cvt_pk_bf16_f32 v73, v62, v63
v_cvt_pk_bf16_f32 v72, v60, v61
ds_write_b64 v11, v[72:73] offset:39168
v_mfma_f32_16x16x32_bf16 v[116:119], a[248:251], a[8:11], v[116:119]
v_exp_f32 v47, v47
v_mfma_f32_16x16x32_bf16 v[120:123], a[248:251], a[72:75], v[120:123]
s_waitcnt lgkmcnt(9)
v_exp_f32 v46, v46
v_mfma_f32_16x16x32_bf16 v[124:127], a[252:255], a[8:11], v[124:127]
v_exp_f32 v45, v45
v_mfma_f32_16x16x32_bf16 v[128:131], a[252:255], a[72:75], v[128:131]
s_waitcnt lgkmcnt(7)
s_waitcnt lgkmcnt(0) vmcnt(12)
s_barrier
ds_read_b128 a[240:243], v0 offset:24576
v_cvt_pk_bf16_f32 v65, v46, v47
v_mfma_f32_16x16x32_bf16 v[132:135], a[224:227], a[8:11], v[132:135]
ds_read_b128 a[244:247], v1 offset:24576
buffer_load_dwordx4 v12, s[8:11], 0 offen nt lds
v_mfma_f32_16x16x32_bf16 v[136:139], a[224:227], a[72:75], v[136:139]
s_add_u32 m0, s41, 20352
v_exp_f32 v44, v44
v_mfma_f32_16x16x32_bf16 v[140:143], a[228:231], a[8:11], v[140:143]
v_exp_f32 v51, v51
v_mfma_f32_16x16x32_bf16 v[144:147], a[228:231], a[72:75], v[144:147]
ds_read_b128 a[248:251], v2 offset:24576
v_cvt_pk_bf16_f32 v64, v44, v45
v_mfma_f32_16x16x32_bf16 v[148:151], a[232:235], a[8:11], v[148:151]
v_exp_f32 v50, v50
v_mfma_f32_16x16x32_bf16 v[152:155], a[232:235], a[72:75], v[152:155]
ds_read_b128 a[252:255], v3 offset:24576
buffer_load_dwordx4 v12, s[8:11], 0 offen offset:128 nt lds
v_mfma_f32_16x16x32_bf16 v[156:159], a[236:239], a[8:11], v[156:159]
s_add_u32 m0, s42, 8256
v_exp_f32 v49, v49
v_mfma_f32_16x16x32_bf16 v[160:163], a[236:239], a[72:75], v[160:163]
s_waitcnt lgkmcnt(3)
v_exp_f32 v48, v48
v_cvt_pk_bf16_f32 v69, v50, v51
v_mfma_f32_16x16x32_bf16 v[44:47], a[240:243], a[128:131], v[20:23]
ds_read_b128 a[224:227], v0 offset:25088
v_cvt_pk_bf16_f32 v68, v48, v49
v_exp_f32 v55, v55
v_mfma_f32_16x16x32_bf16 v[48:51], a[240:243], a[144:147], v[24:27]
s_waitcnt lgkmcnt(3)
v_exp_f32 v54, v54
v_mfma_f32_16x16x32_bf16 v[44:47], a[244:247], a[132:135], v[44:47]
ds_read_b128 a[228:231], v1 offset:25088
buffer_load_dwordx4 v13, s[12:15], 0 offen nt lds
v_exp_f32 v53, v53
v_mfma_f32_16x16x32_bf16 v[48:51], a[244:247], a[148:151], v[48:51]
s_waitcnt lgkmcnt(3)
v_exp_f32 v52, v52
v_mfma_f32_16x16x32_bf16 v[44:47], a[248:251], a[136:139], v[44:47]
s_add_u32 m0, s42, 12256
v_exp_f32 v59, v59
v_mfma_f32_16x16x32_bf16 v[48:51], a[248:251], a[152:155], v[48:51]
s_waitcnt lgkmcnt(2)
ds_read_b128 a[232:235], v2 offset:25088
v_exp_f32 v58, v58
v_mfma_f32_16x16x32_bf16 v[44:47], a[252:255], a[140:143], v[44:47]
ds_read_b128 a[236:239], v3 offset:25088
buffer_load_dwordx4 v13, s[12:15], 0 offen offset:128 nt lds
v_cvt_pk_bf16_f32 v67, v54, v55
v_mfma_f32_16x16x32_bf16 v[48:51], a[252:255], a[156:159], v[48:51]
s_waitcnt lgkmcnt(3)
v_exp_f32 v57, v57
v_cvt_pk_bf16_f32 v66, v52, v53
v_mfma_f32_16x16x32_bf16 v[52:55], a[224:227], a[128:131], v[20:23]
s_add_u32 m0, s42, 49536
ds_read_b128 v[80:83], v10 offset:39168
v_exp_f32 v56, v56
v_cvt_pk_bf16_f32 v71, v58, v59
v_cvt_pk_bf16_f32 v70, v56, v57
v_mfma_f32_16x16x32_bf16 v[56:59], a[224:227], a[144:147], v[24:27]
s_waitcnt lgkmcnt(3)
ds_read_b64_tr_b16 a[242:243], v6 offset:17024
buffer_load_dwordx4 v14, s[16:19], 0 offen lds
v_mfma_f32_16x16x32_bf16 v[52:55], a[228:231], a[132:135], v[52:55]
s_add_u32 m0, s42, 53536
ds_read_b64_tr_b16 a[240:241], v6 offset:16512
v_add_u32 v12, s7, v12
v_mfma_f32_16x16x32_bf16 v[56:59], a[228:231], a[148:151], v[56:59]
s_waitcnt lgkmcnt(4)
ds_read_b64_tr_b16 a[246:247], v6 offset:17032
v_add_u32 v13, s6, v13
v_mfma_f32_16x16x32_bf16 v[52:55], a[232:235], a[136:139], v[52:55]
s_and_b32 s43, s43, 0x1ffff
s_cselect_b32 s6, s4, s5
ds_read_b64_tr_b16 a[244:245], v6 offset:16520
buffer_load_dwordx4 v14, s[16:19], 0 offen offset:128 lds
v_mfma_f32_16x16x32_bf16 v[56:59], a[232:235], a[152:155], v[56:59]
s_waitcnt lgkmcnt(5)
ds_read_b64_tr_b16 a[250:251], v7 offset:17024
s_mov_b32 m0, 148224
v_mfma_f32_16x16x32_bf16 v[52:55], a[236:239], a[140:143], v[52:55]
s_add_u32 s43, s43, 8192
ds_read_b64_tr_b16 a[248:249], v7 offset:16512
v_add_u32 v14, 0x40000, v14
v_mfma_f32_16x16x32_bf16 v[56:59], a[236:239], a[156:159], v[56:59]
ds_read_b64_tr_b16 a[254:255], v7 offset:17032
v_mfma_f32_16x16x32_bf16 v[32:35], v[16:19], v[64:67], v[32:35]
ds_read_b64_tr_b16 a[252:253], v7 offset:16520
buffer_load_dwordx4 v253, s[92:95], s64 offen lds
v_mfma_f32_16x16x32_bf16 v[36:39], v[16:19], v[68:71], v[36:39]
s_waitcnt lgkmcnt(8)
ds_read_b64_tr_b16 a[226:227], v8 offset:17024
s_add_u32 m0, s41, 24576
v_mfma_f32_16x16x32_bf16 v[40:43], v[16:19], v[80:83], v[40:43]
s_waitcnt lgkmcnt(7)
ds_read_b64_tr_b16 a[224:225], v8 offset:16512
v_mfma_f32_16x16x32_bf16 v[172:175], a[240:243], v[64:67], v[172:175]
ds_read_b64_tr_b16 a[230:231], v8 offset:17032
v_mfma_f32_16x16x32_bf16 v[176:179], a[240:243], v[68:71], v[176:179]
ds_read_b64_tr_b16 a[228:229], v8 offset:16520
v_mfma_f32_16x16x32_bf16 v[236:239], a[240:243], v[80:83], v[236:239]
s_waitcnt lgkmcnt(8)
ds_read_b64_tr_b16 a[234:235], v9 offset:17024
v_mfma_f32_16x16x32_bf16 v[180:183], a[244:247], v[64:67], v[180:183]
ds_read_b64_tr_b16 a[232:233], v9 offset:16512
v_mfma_f32_16x16x32_bf16 v[184:187], a[244:247], v[68:71], v[184:187]
ds_read_b64_tr_b16 a[238:239], v9 offset:17032
v_mfma_f32_16x16x32_bf16 v[240:243], a[244:247], v[80:83], v[240:243]
s_waitcnt lgkmcnt(9)
ds_read_b64_tr_b16 a[236:237], v9 offset:16520
v_mfma_f32_16x16x32_bf16 v[188:191], a[248:251], v[64:67], v[188:191]
ds_read_b64_tr_b16 a[242:243], v6 offset:58304
v_mfma_f32_16x16x32_bf16 v[192:195], a[248:251], v[68:71], v[192:195]
s_waitcnt lgkmcnt(9)
ds_read_b64_tr_b16 a[240:241], v6 offset:57792
v_mfma_f32_16x16x32_bf16 v[196:199], a[252:255], v[64:67], v[196:199]
ds_read_b128 v[76:79], v252 offset:2048
v_mfma_f32_16x16x32_bf16 v[200:203], a[252:255], v[68:71], v[200:203]
s_waitcnt lgkmcnt(9)
ds_read_b64_tr_b16 a[246:247], v6 offset:58312
v_mfma_f32_16x16x32_bf16 v[204:207], a[224:227], v[64:67], v[204:207]
ds_read_b64_tr_b16 a[244:245], v6 offset:57800
v_mfma_f32_16x16x32_bf16 v[208:211], a[224:227], v[68:71], v[208:211]
s_waitcnt lgkmcnt(9)
ds_read_b64_tr_b16 a[250:251], v7 offset:58304
v_mfma_f32_16x16x32_bf16 v[212:215], a[228:231], v[64:67], v[212:215]
ds_read_b64_tr_b16 a[248:249], v7 offset:57792
v_mfma_f32_16x16x32_bf16 v[216:219], a[228:231], v[68:71], v[216:219]
s_waitcnt lgkmcnt(9)
ds_read_b64_tr_b16 a[254:255], v7 offset:58312
v_mfma_f32_16x16x32_bf16 v[220:223], a[232:235], v[64:67], v[220:223]
ds_read_b64_tr_b16 a[252:253], v7 offset:57800
v_mfma_f32_16x16x32_bf16 v[224:227], a[232:235], v[68:71], v[224:227]
s_waitcnt lgkmcnt(9)
ds_read_b64_tr_b16 a[226:227], v8 offset:58304
v_mfma_f32_16x16x32_bf16 v[228:231], a[236:239], v[64:67], v[228:231]
ds_read_b64_tr_b16 a[224:225], v8 offset:57792
v_mfma_f32_16x16x32_bf16 v[232:235], a[236:239], v[68:71], v[232:235]
s_waitcnt lgkmcnt(9)
ds_read_b64_tr_b16 a[230:231], v8 offset:58312
v_mfma_f32_16x16x32_bf16 v[100:103], a[240:243], a[12:15], v[100:103]
ds_read_b64_tr_b16 a[228:229], v8 offset:57800
v_mfma_f32_16x16x32_bf16 v[104:107], a[240:243], a[76:79], v[104:107]
s_waitcnt lgkmcnt(10)
ds_read_b64_tr_b16 a[234:235], v9 offset:58304
v_mfma_f32_16x16x32_bf16 v[164:167], a[240:243], v[76:79], v[164:167]
s_waitcnt lgkmcnt(9)
ds_read_b64_tr_b16 a[232:233], v9 offset:57792
v_mfma_f32_16x16x32_bf16 v[108:111], a[244:247], a[12:15], v[108:111]
ds_read_b64_tr_b16 a[238:239], v9 offset:58312
v_mfma_f32_16x16x32_bf16 v[112:115], a[244:247], a[76:79], v[112:115]
ds_read_b64_tr_b16 a[236:237], v9 offset:57800
v_mfma_f32_16x16x32_bf16 v[168:171], a[244:247], v[76:79], v[168:171]
s_waitcnt lgkmcnt(10)
v_exp_f32 v47, v47
v_mfma_f32_16x16x32_bf16 v[116:119], a[248:251], a[12:15], v[116:119]
v_exp_f32 v46, v46
v_mfma_f32_16x16x32_bf16 v[120:123], a[248:251], a[76:79], v[120:123]
s_waitcnt lgkmcnt(8)
v_exp_f32 v45, v45
v_mfma_f32_16x16x32_bf16 v[124:127], a[252:255], a[12:15], v[124:127]
v_exp_f32 v44, v44
v_mfma_f32_16x16x32_bf16 v[128:131], a[252:255], a[76:79], v[128:131]
s_waitcnt lgkmcnt(6)
s_waitcnt lgkmcnt(0) vmcnt(11)
s_barrier
ds_read_b128 a[240:243], v0 offset:0
v_cvt_pk_bf16_f32 v65, v46, v47
v_mfma_f32_16x16x32_bf16 v[132:135], a[224:227], a[12:15], v[132:135]
ds_read_b128 a[244:247], v1 offset:0
buffer_load_dwordx4 v12, s[8:11], 0 offen nt lds
v_mfma_f32_16x16x32_bf16 v[136:139], a[224:227], a[76:79], v[136:139]
s_add_u32 m0, s41, 28544
v_exp_f32 v51, v51
v_mfma_f32_16x16x32_bf16 v[140:143], a[228:231], a[12:15], v[140:143]
ds_read_b128 a[248:251], v2 offset:0
v_cvt_pk_bf16_f32 v64, v44, v45
v_mfma_f32_16x16x32_bf16 v[144:147], a[228:231], a[76:79], v[144:147]
v_exp_f32 v50, v50
v_mfma_f32_16x16x32_bf16 v[148:151], a[232:235], a[12:15], v[148:151]
ds_read_b128 a[252:255], v3 offset:0
buffer_load_dwordx4 v12, s[8:11], 0 offen offset:128 nt lds
v_mfma_f32_16x16x32_bf16 v[152:155], a[232:235], a[76:79], v[152:155]
s_add_u32 m0, s42, 16512
v_exp_f32 v49, v49
v_mfma_f32_16x16x32_bf16 v[156:159], a[236:239], a[12:15], v[156:159]
v_exp_f32 v48, v48
v_mfma_f32_16x16x32_bf16 v[160:163], a[236:239], a[76:79], v[160:163]
s_waitcnt lgkmcnt(3)
ds_read_b128 a[224:227], v0 offset:512
v_cvt_pk_bf16_f32 v69, v50, v51
v_mfma_f32_16x16x32_bf16 v[44:47], a[240:243], a[128:131], v[20:23]
ds_read_b128 a[228:231], v1 offset:512
v_cvt_pk_bf16_f32 v68, v48, v49
v_exp_f32 v55, v55
v_mfma_f32_16x16x32_bf16 v[48:51], a[240:243], a[144:147], v[24:27]
s_waitcnt lgkmcnt(4)
v_exp_f32 v54, v54
v_mfma_f32_16x16x32_bf16 v[44:47], a[244:247], a[132:135], v[44:47]
ds_read_b128 a[232:235], v2 offset:512
buffer_load_dwordx4 v13, s[12:15], 0 offen nt lds
v_exp_f32 v53, v53
v_mfma_f32_16x16x32_bf16 v[48:51], a[244:247], a[148:151], v[48:51]
s_waitcnt lgkmcnt(4)
v_exp_f32 v52, v52
v_mfma_f32_16x16x32_bf16 v[44:47], a[248:251], a[136:139], v[44:47]
s_add_u32 m0, s42, 20512
v_exp_f32 v59, v59
v_mfma_f32_16x16x32_bf16 v[48:51], a[248:251], a[152:155], v[48:51]
s_waitcnt lgkmcnt(3)
v_exp_f32 v58, v58
v_mfma_f32_16x16x32_bf16 v[44:47], a[252:255], a[140:143], v[44:47]
ds_read_b128 a[236:239], v3 offset:512
buffer_load_dwordx4 v13, s[12:15], 0 offen offset:128 nt lds
v_cvt_pk_bf16_f32 v67, v54, v55
v_mfma_f32_16x16x32_bf16 v[48:51], a[252:255], a[156:159], v[48:51]
s_waitcnt lgkmcnt(3)
v_exp_f32 v57, v57
v_cvt_pk_bf16_f32 v66, v52, v53
v_mfma_f32_16x16x32_bf16 v[52:55], a[224:227], a[128:131], v[20:23]
s_add_u32 m0, s42, 57792
ds_read_b128 a[240:243], v4 offset:0
v_exp_f32 v56, v56
v_cvt_pk_bf16_f32 v71, v58, v59
v_cvt_pk_bf16_f32 v70, v56, v57
v_mfma_f32_16x16x32_bf16 v[56:59], a[224:227], a[144:147], v[24:27]
s_waitcnt lgkmcnt(3)
ds_read_b128 a[244:247], v5 offset:0
buffer_load_dwordx4 v14, s[16:19], 0 offen lds
v_mfma_f32_16x16x32_bf16 v[52:55], a[228:231], a[132:135], v[52:55]
s_add_u32 m0, s42, 61792
ds_read_b128 a[248:251], v4 offset:4096
v_add_u32 v12, s6, v12
v_mfma_f32_16x16x32_bf16 v[56:59], a[228:231], a[148:151], v[56:59]
s_waitcnt lgkmcnt(4)
ds_read_b128 a[252:255], v5 offset:4096
v_add_u32 v13, s7, v13
v_mfma_f32_16x16x32_bf16 v[52:55], a[232:235], a[136:139], v[52:55]
s_and_b32 s43, s43, 0x1ffff
s_cselect_b32 s7, s4, s5
ds_read_b128 v[80:83], v10 offset:40192
buffer_load_dwordx4 v14, s[16:19], 0 offen offset:128 lds
v_mfma_f32_16x16x32_bf16 v[56:59], a[232:235], a[152:155], v[56:59]
s_waitcnt lgkmcnt(5)
ds_read_b64_tr_b16 a[226:227], v6 offset:25280
s_mov_b32 m0, s41
v_mfma_f32_16x16x32_bf16 v[52:55], a[236:239], a[140:143], v[52:55]
s_add_u32 s43, s43, 8192
ds_read_b64_tr_b16 a[224:225], v6 offset:24768
v_add_u32 v14, s67, v14
v_mfma_f32_16x16x32_bf16 v[56:59], a[236:239], a[156:159], v[56:59]
s_waitcnt lgkmcnt(6)
ds_read_b64_tr_b16 a[230:231], v6 offset:25288
v_mfma_f32_16x16x32_bf16 v[60:63], a[240:243], v[84:87], v[28:31]
s_waitcnt lgkmcnt(6)
ds_read_b64_tr_b16 a[228:229], v6 offset:24776
v_mfma_f32_16x16x32_bf16 v[60:63], a[244:247], v[88:91], v[60:63]
s_waitcnt lgkmcnt(6)
ds_read_b64_tr_b16 a[234:235], v7 offset:25280
v_mfma_f32_16x16x32_bf16 v[60:63], a[248:251], v[92:95], v[60:63]
s_waitcnt lgkmcnt(6)
ds_read_b64_tr_b16 a[232:233], v7 offset:24768
v_mfma_f32_16x16x32_bf16 v[60:63], a[252:255], v[96:99], v[60:63]
s_and_b32 s62, s62, 0x3fffff
s_cselect_b32 s67, 0x40000, s61
ds_read_b64_tr_b16 a[238:239], v7 offset:25288
s_add_u32 s62, s62, 0x80000
v_mfma_f32_16x16x32_bf16 v[32:35], v[16:19], v[64:67], v[32:35]
ds_read_b64_tr_b16 a[236:237], v7 offset:24776
v_mfma_f32_16x16x32_bf16 v[36:39], v[16:19], v[68:71], v[36:39]
s_waitcnt lgkmcnt(8)
ds_read_b64_tr_b16 a[242:243], v8 offset:25280
v_mfma_f32_16x16x32_bf16 v[40:43], v[16:19], v[80:83], v[40:43]
s_waitcnt lgkmcnt(7)
ds_read_b64_tr_b16 a[240:241], v8 offset:24768
v_mfma_f32_16x16x32_bf16 v[172:175], a[224:227], v[64:67], v[172:175]
ds_read_b64_tr_b16 a[246:247], v8 offset:25288
v_mfma_f32_16x16x32_bf16 v[176:179], a[224:227], v[68:71], v[176:179]
ds_read_b64_tr_b16 a[244:245], v8 offset:24776
v_mfma_f32_16x16x32_bf16 v[236:239], a[224:227], v[80:83], v[236:239]
s_waitcnt lgkmcnt(8)
ds_read_b64_tr_b16 a[250:251], v9 offset:25280
v_mfma_f32_16x16x32_bf16 v[180:183], a[228:231], v[64:67], v[180:183]
ds_read_b64_tr_b16 a[248:249], v9 offset:24768
v_mfma_f32_16x16x32_bf16 v[184:187], a[228:231], v[68:71], v[184:187]
ds_read_b64_tr_b16 a[254:255], v9 offset:25288
v_mfma_f32_16x16x32_bf16 v[240:243], a[228:231], v[80:83], v[240:243]
s_waitcnt lgkmcnt(9)
ds_read_b64_tr_b16 a[252:253], v9 offset:24776
v_mfma_f32_16x16x32_bf16 v[188:191], a[232:235], v[64:67], v[188:191]
ds_read_b64_tr_b16 a[226:227], v6 offset:33536
v_mfma_f32_16x16x32_bf16 v[192:195], a[232:235], v[68:71], v[192:195]
s_waitcnt lgkmcnt(9)
ds_read_b64_tr_b16 a[224:225], v6 offset:33024
v_mfma_f32_16x16x32_bf16 v[196:199], a[236:239], v[64:67], v[196:199]
ds_read_b128 v[76:79], v251 offset:4096
v_mfma_f32_16x16x32_bf16 v[200:203], a[236:239], v[68:71], v[200:203]
s_waitcnt lgkmcnt(9)
ds_read_b64_tr_b16 a[230:231], v6 offset:33544
v_mfma_f32_16x16x32_bf16 v[204:207], a[240:243], v[64:67], v[204:207]
ds_read_b64_tr_b16 a[228:229], v6 offset:33032
v_mfma_f32_16x16x32_bf16 v[208:211], a[240:243], v[68:71], v[208:211]
s_waitcnt lgkmcnt(9)
ds_read_b64_tr_b16 a[234:235], v7 offset:33536
v_mfma_f32_16x16x32_bf16 v[212:215], a[244:247], v[64:67], v[212:215]
ds_read_b64_tr_b16 a[232:233], v7 offset:33024
v_mfma_f32_16x16x32_bf16 v[216:219], a[244:247], v[68:71], v[216:219]
s_waitcnt lgkmcnt(9)
ds_read_b64_tr_b16 a[238:239], v7 offset:33544
v_mfma_f32_16x16x32_bf16 v[220:223], a[248:251], v[64:67], v[220:223]
ds_read_b64_tr_b16 a[236:237], v7 offset:33032
v_mfma_f32_16x16x32_bf16 v[224:227], a[248:251], v[68:71], v[224:227]
s_waitcnt lgkmcnt(9)
ds_read_b64_tr_b16 a[242:243], v8 offset:33536
v_mfma_f32_16x16x32_bf16 v[228:231], a[252:255], v[64:67], v[228:231]
ds_read_b64_tr_b16 a[240:241], v8 offset:33024
v_mfma_f32_16x16x32_bf16 v[232:235], a[252:255], v[68:71], v[232:235]
s_waitcnt lgkmcnt(9)
ds_read_b64_tr_b16 a[246:247], v8 offset:33544
v_mfma_f32_16x16x32_bf16 v[100:103], a[224:227], a[16:19], v[100:103]
ds_read_b64_tr_b16 a[244:245], v8 offset:33032
v_mfma_f32_16x16x32_bf16 v[104:107], a[224:227], a[80:83], v[104:107]
s_waitcnt lgkmcnt(10)
ds_read_b64_tr_b16 a[250:251], v9 offset:33536
v_exp_f32 v63, v63
v_mfma_f32_16x16x32_bf16 v[164:167], a[224:227], v[76:79], v[164:167]
s_waitcnt lgkmcnt(9)
ds_read_b64_tr_b16 a[248:249], v9 offset:33024
v_exp_f32 v62, v62
v_mfma_f32_16x16x32_bf16 v[108:111], a[228:231], a[16:19], v[108:111]
ds_read_b64_tr_b16 a[254:255], v9 offset:33544
v_exp_f32 v61, v61
v_mfma_f32_16x16x32_bf16 v[112:115], a[228:231], a[80:83], v[112:115]
ds_read_b64_tr_b16 a[252:253], v9 offset:33032
v_exp_f32 v60, v60
v_mfma_f32_16x16x32_bf16 v[168:171], a[228:231], v[76:79], v[168:171]
s_waitcnt lgkmcnt(10)
v_cvt_pk_bf16_f32 v73, v62, v63
v_cvt_pk_bf16_f32 v72, v60, v61
ds_write_b64 v11, v[72:73] offset:37120
v_mfma_f32_16x16x32_bf16 v[116:119], a[232:235], a[16:19], v[116:119]
v_exp_f32 v47, v47
v_mfma_f32_16x16x32_bf16 v[120:123], a[232:235], a[80:83], v[120:123]
s_waitcnt lgkmcnt(9)
v_exp_f32 v46, v46
v_mfma_f32_16x16x32_bf16 v[124:127], a[236:239], a[16:19], v[124:127]
v_exp_f32 v45, v45
v_mfma_f32_16x16x32_bf16 v[128:131], a[236:239], a[80:83], v[128:131]
s_waitcnt lgkmcnt(7)
s_waitcnt lgkmcnt(0) vmcnt(13)
s_barrier
ds_read_b128 a[224:227], v0 offset:8192
v_cvt_pk_bf16_f32 v65, v46, v47
v_mfma_f32_16x16x32_bf16 v[132:135], a[240:243], a[16:19], v[132:135]
ds_read_b128 a[228:231], v1 offset:8192
buffer_load_dwordx4 v12, s[8:11], 0 offen nt lds
v_mfma_f32_16x16x32_bf16 v[136:139], a[240:243], a[80:83], v[136:139]
s_add_u32 m0, s41, 3968
v_exp_f32 v44, v44
v_mfma_f32_16x16x32_bf16 v[140:143], a[244:247], a[16:19], v[140:143]
v_exp_f32 v51, v51
v_mfma_f32_16x16x32_bf16 v[144:147], a[244:247], a[80:83], v[144:147]
ds_read_b128 a[232:235], v2 offset:8192
v_cvt_pk_bf16_f32 v64, v44, v45
v_mfma_f32_16x16x32_bf16 v[148:151], a[248:251], a[16:19], v[148:151]
v_exp_f32 v50, v50
v_mfma_f32_16x16x32_bf16 v[152:155], a[248:251], a[80:83], v[152:155]
ds_read_b128 a[236:239], v3 offset:8192
buffer_load_dwordx4 v12, s[8:11], 0 offen offset:128 nt lds
v_mfma_f32_16x16x32_bf16 v[156:159], a[252:255], a[16:19], v[156:159]
s_add_u32 m0, s42, 24768
v_exp_f32 v49, v49
v_mfma_f32_16x16x32_bf16 v[160:163], a[252:255], a[80:83], v[160:163]
s_waitcnt lgkmcnt(3)
v_exp_f32 v48, v48
v_cvt_pk_bf16_f32 v69, v50, v51
v_mfma_f32_16x16x32_bf16 v[44:47], a[224:227], a[128:131], v[20:23]
ds_read_b128 a[240:243], v0 offset:8704
v_cvt_pk_bf16_f32 v68, v48, v49
v_exp_f32 v55, v55
v_mfma_f32_16x16x32_bf16 v[48:51], a[224:227], a[144:147], v[24:27]
s_waitcnt lgkmcnt(3)
v_exp_f32 v54, v54
v_mfma_f32_16x16x32_bf16 v[44:47], a[228:231], a[132:135], v[44:47]
ds_read_b128 a[244:247], v1 offset:8704
buffer_load_dwordx4 v13, s[12:15], 0 offen nt lds
v_exp_f32 v53, v53
v_mfma_f32_16x16x32_bf16 v[48:51], a[228:231], a[148:151], v[48:51]
s_waitcnt lgkmcnt(3)
v_exp_f32 v52, v52
v_mfma_f32_16x16x32_bf16 v[44:47], a[232:235], a[136:139], v[44:47]
s_add_u32 m0, s42, 28768
v_exp_f32 v59, v59
v_mfma_f32_16x16x32_bf16 v[48:51], a[232:235], a[152:155], v[48:51]
s_waitcnt lgkmcnt(2)
ds_read_b128 a[248:251], v2 offset:8704
v_exp_f32 v58, v58
v_mfma_f32_16x16x32_bf16 v[44:47], a[236:239], a[140:143], v[44:47]
ds_read_b128 a[252:255], v3 offset:8704
buffer_load_dwordx4 v13, s[12:15], 0 offen offset:128 nt lds
v_cvt_pk_bf16_f32 v67, v54, v55
v_mfma_f32_16x16x32_bf16 v[48:51], a[236:239], a[156:159], v[48:51]
s_waitcnt lgkmcnt(3)
v_exp_f32 v57, v57
v_cvt_pk_bf16_f32 v66, v52, v53
v_mfma_f32_16x16x32_bf16 v[52:55], a[240:243], a[128:131], v[20:23]
s_add_u32 m0, s42, 33024
ds_read_b128 v[80:83], v10 offset:37120
v_exp_f32 v56, v56
v_cvt_pk_bf16_f32 v71, v58, v59
v_cvt_pk_bf16_f32 v70, v56, v57
v_mfma_f32_16x16x32_bf16 v[56:59], a[240:243], a[144:147], v[24:27]
s_waitcnt lgkmcnt(3)
ds_read_b64_tr_b16 a[226:227], v6 offset:512
buffer_load_dwordx4 v14, s[16:19], 0 offen lds
v_mfma_f32_16x16x32_bf16 v[52:55], a[244:247], a[132:135], v[52:55]
s_add_u32 m0, s42, 37024
ds_read_b64_tr_b16 a[224:225], v6 offset:0
v_add_u32 v12, s7, v12
v_mfma_f32_16x16x32_bf16 v[56:59], a[244:247], a[148:151], v[56:59]
s_waitcnt lgkmcnt(4)
ds_read_b64_tr_b16 a[230:231], v6 offset:520
v_add_u32 v13, s6, v13
v_mfma_f32_16x16x32_bf16 v[52:55], a[248:251], a[136:139], v[52:55]
s_and_b32 s43, s43, 0x1ffff
s_cselect_b32 s6, s4, s5
ds_read_b64_tr_b16 a[228:229], v6 offset:8
buffer_load_dwordx4 v14, s[16:19], 0 offen offset:128 lds
v_mfma_f32_16x16x32_bf16 v[56:59], a[248:251], a[152:155], v[56:59]
s_waitcnt lgkmcnt(5)
ds_read_b64_tr_b16 a[234:235], v7 offset:512
s_add_u32 m0, s41, 8192
v_mfma_f32_16x16x32_bf16 v[52:55], a[252:255], a[140:143], v[52:55]
s_add_u32 s43, s43, 8192
ds_read_b64_tr_b16 a[232:233], v7 offset:0
v_add_u32 v14, 0x40000, v14
v_mfma_f32_16x16x32_bf16 v[56:59], a[252:255], a[156:159], v[56:59]
ds_read_b64_tr_b16 a[238:239], v7 offset:520
v_mfma_f32_16x16x32_bf16 v[32:35], v[16:19], v[64:67], v[32:35]
ds_read_b64_tr_b16 a[236:237], v7 offset:8
v_mfma_f32_16x16x32_bf16 v[36:39], v[16:19], v[68:71], v[36:39]
s_waitcnt lgkmcnt(8)
ds_read_b64_tr_b16 a[242:243], v8 offset:512
v_mfma_f32_16x16x32_bf16 v[40:43], v[16:19], v[80:83], v[40:43]
s_waitcnt lgkmcnt(7)
ds_read_b64_tr_b16 a[240:241], v8 offset:0
v_mfma_f32_16x16x32_bf16 v[172:175], a[224:227], v[64:67], v[172:175]
ds_read_b64_tr_b16 a[246:247], v8 offset:520
v_mfma_f32_16x16x32_bf16 v[176:179], a[224:227], v[68:71], v[176:179]
ds_read_b64_tr_b16 a[244:245], v8 offset:8
v_mfma_f32_16x16x32_bf16 v[236:239], a[224:227], v[80:83], v[236:239]
s_waitcnt lgkmcnt(8)
ds_read_b64_tr_b16 a[250:251], v9 offset:512
v_mfma_f32_16x16x32_bf16 v[180:183], a[228:231], v[64:67], v[180:183]
ds_read_b64_tr_b16 a[248:249], v9 offset:0
v_mfma_f32_16x16x32_bf16 v[184:187], a[228:231], v[68:71], v[184:187]
ds_read_b64_tr_b16 a[254:255], v9 offset:520
v_mfma_f32_16x16x32_bf16 v[240:243], a[228:231], v[80:83], v[240:243]
s_waitcnt lgkmcnt(9)
ds_read_b64_tr_b16 a[252:253], v9 offset:8
v_mfma_f32_16x16x32_bf16 v[188:191], a[232:235], v[64:67], v[188:191]
ds_read_b64_tr_b16 a[226:227], v6 offset:41792
v_mfma_f32_16x16x32_bf16 v[192:195], a[232:235], v[68:71], v[192:195]
s_waitcnt lgkmcnt(9)
ds_read_b64_tr_b16 a[224:225], v6 offset:41280
v_mfma_f32_16x16x32_bf16 v[196:199], a[236:239], v[64:67], v[196:199]
ds_read_b128 v[76:79], v252 offset:4096
v_mfma_f32_16x16x32_bf16 v[200:203], a[236:239], v[68:71], v[200:203]
s_waitcnt lgkmcnt(9)
ds_read_b64_tr_b16 a[230:231], v6 offset:41800
v_mfma_f32_16x16x32_bf16 v[204:207], a[240:243], v[64:67], v[204:207]
ds_read_b64_tr_b16 a[228:229], v6 offset:41288
v_mfma_f32_16x16x32_bf16 v[208:211], a[240:243], v[68:71], v[208:211]
s_waitcnt lgkmcnt(9)
ds_read_b64_tr_b16 a[234:235], v7 offset:41792
v_mfma_f32_16x16x32_bf16 v[212:215], a[244:247], v[64:67], v[212:215]
ds_read_b64_tr_b16 a[232:233], v7 offset:41280
v_mfma_f32_16x16x32_bf16 v[216:219], a[244:247], v[68:71], v[216:219]
s_waitcnt lgkmcnt(9)
ds_read_b64_tr_b16 a[238:239], v7 offset:41800
v_mfma_f32_16x16x32_bf16 v[220:223], a[248:251], v[64:67], v[220:223]
ds_read_b64_tr_b16 a[236:237], v7 offset:41288
v_mfma_f32_16x16x32_bf16 v[224:227], a[248:251], v[68:71], v[224:227]
s_waitcnt lgkmcnt(9)
ds_read_b64_tr_b16 a[242:243], v8 offset:41792
v_mfma_f32_16x16x32_bf16 v[228:231], a[252:255], v[64:67], v[228:231]
ds_read_b64_tr_b16 a[240:241], v8 offset:41280
v_mfma_f32_16x16x32_bf16 v[232:235], a[252:255], v[68:71], v[232:235]
s_waitcnt lgkmcnt(9)
ds_read_b64_tr_b16 a[246:247], v8 offset:41800
v_mfma_f32_16x16x32_bf16 v[100:103], a[224:227], a[20:23], v[100:103]
ds_read_b64_tr_b16 a[244:245], v8 offset:41288
v_mfma_f32_16x16x32_bf16 v[104:107], a[224:227], a[84:87], v[104:107]
s_waitcnt lgkmcnt(10)
ds_read_b64_tr_b16 a[250:251], v9 offset:41792
v_mfma_f32_16x16x32_bf16 v[164:167], a[224:227], v[76:79], v[164:167]
s_waitcnt lgkmcnt(9)
ds_read_b64_tr_b16 a[248:249], v9 offset:41280
v_mfma_f32_16x16x32_bf16 v[108:111], a[228:231], a[20:23], v[108:111]
ds_read_b64_tr_b16 a[254:255], v9 offset:41800
v_mfma_f32_16x16x32_bf16 v[112:115], a[228:231], a[84:87], v[112:115]
ds_read_b64_tr_b16 a[252:253], v9 offset:41288
v_mfma_f32_16x16x32_bf16 v[168:171], a[228:231], v[76:79], v[168:171]
s_waitcnt lgkmcnt(10)
v_exp_f32 v47, v47
v_mfma_f32_16x16x32_bf16 v[116:119], a[232:235], a[20:23], v[116:119]
v_exp_f32 v46, v46
v_mfma_f32_16x16x32_bf16 v[120:123], a[232:235], a[84:87], v[120:123]
s_waitcnt lgkmcnt(8)
v_exp_f32 v45, v45
v_mfma_f32_16x16x32_bf16 v[124:127], a[236:239], a[20:23], v[124:127]
v_exp_f32 v44, v44
v_mfma_f32_16x16x32_bf16 v[128:131], a[236:239], a[84:87], v[128:131]
s_waitcnt lgkmcnt(6)
s_waitcnt lgkmcnt(0) vmcnt(10)
s_barrier
ds_read_b128 a[224:227], v0 offset:16384
v_cvt_pk_bf16_f32 v65, v46, v47
v_mfma_f32_16x16x32_bf16 v[132:135], a[240:243], a[20:23], v[132:135]
ds_read_b128 a[228:231], v1 offset:16384
buffer_load_dwordx4 v12, s[8:11], 0 offen nt lds
v_mfma_f32_16x16x32_bf16 v[136:139], a[240:243], a[84:87], v[136:139]
s_add_u32 m0, s41, 12160
v_exp_f32 v51, v51
v_mfma_f32_16x16x32_bf16 v[140:143], a[244:247], a[20:23], v[140:143]
ds_read_b128 a[232:235], v2 offset:16384
v_cvt_pk_bf16_f32 v64, v44, v45
v_mfma_f32_16x16x32_bf16 v[144:147], a[244:247], a[84:87], v[144:147]
v_exp_f32 v50, v50
v_mfma_f32_16x16x32_bf16 v[148:151], a[248:251], a[20:23], v[148:151]
ds_read_b128 a[236:239], v3 offset:16384
buffer_load_dwordx4 v12, s[8:11], 0 offen offset:128 nt lds
v_mfma_f32_16x16x32_bf16 v[152:155], a[248:251], a[84:87], v[152:155]
s_mov_b32 m0, s42
v_exp_f32 v49, v49
v_mfma_f32_16x16x32_bf16 v[156:159], a[252:255], a[20:23], v[156:159]
v_exp_f32 v48, v48
v_mfma_f32_16x16x32_bf16 v[160:163], a[252:255], a[84:87], v[160:163]
s_waitcnt lgkmcnt(3)
ds_read_b128 a[240:243], v0 offset:16896
v_cvt_pk_bf16_f32 v69, v50, v51
v_mfma_f32_16x16x32_bf16 v[44:47], a[224:227], a[128:131], v[20:23]
ds_read_b128 a[244:247], v1 offset:16896
v_cvt_pk_bf16_f32 v68, v48, v49
v_exp_f32 v55, v55
v_mfma_f32_16x16x32_bf16 v[48:51], a[224:227], a[144:147], v[24:27]
s_waitcnt lgkmcnt(4)
v_exp_f32 v54, v54
v_mfma_f32_16x16x32_bf16 v[44:47], a[228:231], a[132:135], v[44:47]
ds_read_b128 a[248:251], v2 offset:16896
buffer_load_dwordx4 v13, s[12:15], 0 offen nt lds
v_exp_f32 v53, v53
v_mfma_f32_16x16x32_bf16 v[48:51], a[228:231], a[148:151], v[48:51]
s_waitcnt lgkmcnt(4)
v_exp_f32 v52, v52
v_mfma_f32_16x16x32_bf16 v[44:47], a[232:235], a[136:139], v[44:47]
s_add_u32 m0, s42, 4000
v_exp_f32 v59, v59
v_mfma_f32_16x16x32_bf16 v[48:51], a[232:235], a[152:155], v[48:51]
s_waitcnt lgkmcnt(3)
v_exp_f32 v58, v58
v_mfma_f32_16x16x32_bf16 v[44:47], a[236:239], a[140:143], v[44:47]
ds_read_b128 a[252:255], v3 offset:16896
buffer_load_dwordx4 v13, s[12:15], 0 offen offset:128 nt lds
v_cvt_pk_bf16_f32 v67, v54, v55
v_mfma_f32_16x16x32_bf16 v[48:51], a[236:239], a[156:159], v[48:51]
s_waitcnt lgkmcnt(3)
v_exp_f32 v57, v57
v_cvt_pk_bf16_f32 v66, v52, v53
v_mfma_f32_16x16x32_bf16 v[52:55], a[240:243], a[128:131], v[20:23]
s_add_u32 m0, s42, 41280
ds_read_b128 a[224:227], v4 offset:16384
v_exp_f32 v56, v56
v_cvt_pk_bf16_f32 v71, v58, v59
v_cvt_pk_bf16_f32 v70, v56, v57
v_mfma_f32_16x16x32_bf16 v[56:59], a[240:243], a[144:147], v[24:27]
s_waitcnt lgkmcnt(3)
ds_read_b128 a[228:231], v5 offset:16384
buffer_load_dwordx4 v14, s[16:19], 0 offen lds
v_mfma_f32_16x16x32_bf16 v[52:55], a[244:247], a[132:135], v[52:55]
s_add_u32 m0, s42, 45280
ds_read_b128 a[232:235], v4 offset:20480
v_add_u32 v12, s6, v12
v_mfma_f32_16x16x32_bf16 v[56:59], a[244:247], a[148:151], v[56:59]
s_waitcnt lgkmcnt(4)
ds_read_b128 a[236:239], v5 offset:20480
v_add_u32 v13, s7, v13
v_mfma_f32_16x16x32_bf16 v[52:55], a[248:251], a[136:139], v[52:55]
s_and_b32 s43, s43, 0x1ffff
s_cselect_b32 s7, s4, s5
ds_read_b128 v[80:83], v10 offset:38144
buffer_load_dwordx4 v14, s[16:19], 0 offen offset:128 lds
v_mfma_f32_16x16x32_bf16 v[56:59], a[248:251], a[152:155], v[56:59]
s_waitcnt lgkmcnt(5)
ds_read_b64_tr_b16 a[242:243], v6 offset:8768
s_add_u32 m0, s41, 16384
v_mfma_f32_16x16x32_bf16 v[52:55], a[252:255], a[140:143], v[52:55]
s_add_u32 s43, s43, 8192
ds_read_b64_tr_b16 a[240:241], v6 offset:8256
v_add_u32 v14, s67, v14
v_mfma_f32_16x16x32_bf16 v[56:59], a[252:255], a[156:159], v[56:59]
s_waitcnt lgkmcnt(6)
ds_read_b64_tr_b16 a[246:247], v6 offset:8776
v_mfma_f32_16x16x32_bf16 v[60:63], a[224:227], v[84:87], v[28:31]
s_waitcnt lgkmcnt(6)
ds_read_b64_tr_b16 a[244:245], v6 offset:8264
v_mfma_f32_16x16x32_bf16 v[60:63], a[228:231], v[88:91], v[60:63]
s_waitcnt lgkmcnt(6)
ds_read_b64_tr_b16 a[250:251], v7 offset:8768
v_mfma_f32_16x16x32_bf16 v[60:63], a[232:235], v[92:95], v[60:63]
s_waitcnt lgkmcnt(6)
ds_read_b64_tr_b16 a[248:249], v7 offset:8256
v_mfma_f32_16x16x32_bf16 v[60:63], a[236:239], v[96:99], v[60:63]
s_and_b32 s62, s62, 0x3fffff
s_cselect_b32 s67, 0x40000, s61
ds_read_b64_tr_b16 a[254:255], v7 offset:8776
s_add_u32 s62, s62, 0x80000
v_mfma_f32_16x16x32_bf16 v[32:35], v[16:19], v[64:67], v[32:35]
ds_read_b64_tr_b16 a[252:253], v7 offset:8264
v_mfma_f32_16x16x32_bf16 v[36:39], v[16:19], v[68:71], v[36:39]
s_waitcnt lgkmcnt(8)
ds_read_b64_tr_b16 a[226:227], v8 offset:8768
v_mfma_f32_16x16x32_bf16 v[40:43], v[16:19], v[80:83], v[40:43]
s_waitcnt lgkmcnt(7)
ds_read_b64_tr_b16 a[224:225], v8 offset:8256
v_mfma_f32_16x16x32_bf16 v[172:175], a[240:243], v[64:67], v[172:175]
ds_read_b64_tr_b16 a[230:231], v8 offset:8776
v_mfma_f32_16x16x32_bf16 v[176:179], a[240:243], v[68:71], v[176:179]
ds_read_b64_tr_b16 a[228:229], v8 offset:8264
v_mfma_f32_16x16x32_bf16 v[236:239], a[240:243], v[80:83], v[236:239]
s_waitcnt lgkmcnt(8)
ds_read_b64_tr_b16 a[234:235], v9 offset:8768
v_mfma_f32_16x16x32_bf16 v[180:183], a[244:247], v[64:67], v[180:183]
ds_read_b64_tr_b16 a[232:233], v9 offset:8256
v_mfma_f32_16x16x32_bf16 v[184:187], a[244:247], v[68:71], v[184:187]
ds_read_b64_tr_b16 a[238:239], v9 offset:8776
v_mfma_f32_16x16x32_bf16 v[240:243], a[244:247], v[80:83], v[240:243]
s_waitcnt lgkmcnt(9)
ds_read_b64_tr_b16 a[236:237], v9 offset:8264
v_mfma_f32_16x16x32_bf16 v[188:191], a[248:251], v[64:67], v[188:191]
ds_read_b64_tr_b16 a[242:243], v6 offset:50048
v_mfma_f32_16x16x32_bf16 v[192:195], a[248:251], v[68:71], v[192:195]
s_waitcnt lgkmcnt(9)
ds_read_b64_tr_b16 a[240:241], v6 offset:49536
v_mfma_f32_16x16x32_bf16 v[196:199], a[252:255], v[64:67], v[196:199]
ds_read_b128 v[76:79], v251 offset:6144
v_mfma_f32_16x16x32_bf16 v[200:203], a[252:255], v[68:71], v[200:203]
s_waitcnt lgkmcnt(9)
ds_read_b64_tr_b16 a[246:247], v6 offset:50056
v_mfma_f32_16x16x32_bf16 v[204:207], a[224:227], v[64:67], v[204:207]
ds_read_b64_tr_b16 a[244:245], v6 offset:49544
v_mfma_f32_16x16x32_bf16 v[208:211], a[224:227], v[68:71], v[208:211]
s_waitcnt lgkmcnt(9)
ds_read_b64_tr_b16 a[250:251], v7 offset:50048
v_mfma_f32_16x16x32_bf16 v[212:215], a[228:231], v[64:67], v[212:215]
ds_read_b64_tr_b16 a[248:249], v7 offset:49536
v_mfma_f32_16x16x32_bf16 v[216:219], a[228:231], v[68:71], v[216:219]
s_waitcnt lgkmcnt(9)
ds_read_b64_tr_b16 a[254:255], v7 offset:50056
v_mfma_f32_16x16x32_bf16 v[220:223], a[232:235], v[64:67], v[220:223]
ds_read_b64_tr_b16 a[252:253], v7 offset:49544
v_mfma_f32_16x16x32_bf16 v[224:227], a[232:235], v[68:71], v[224:227]
s_waitcnt lgkmcnt(9)
ds_read_b64_tr_b16 a[226:227], v8 offset:50048
v_mfma_f32_16x16x32_bf16 v[228:231], a[236:239], v[64:67], v[228:231]
ds_read_b64_tr_b16 a[224:225], v8 offset:49536
v_mfma_f32_16x16x32_bf16 v[232:235], a[236:239], v[68:71], v[232:235]
s_waitcnt lgkmcnt(9)
ds_read_b64_tr_b16 a[230:231], v8 offset:50056
v_mfma_f32_16x16x32_bf16 v[100:103], a[240:243], a[24:27], v[100:103]
ds_read_b64_tr_b16 a[228:229], v8 offset:49544
v_mfma_f32_16x16x32_bf16 v[104:107], a[240:243], a[88:91], v[104:107]
s_waitcnt lgkmcnt(10)
ds_read_b64_tr_b16 a[234:235], v9 offset:50048
v_exp_f32 v63, v63
v_mfma_f32_16x16x32_bf16 v[164:167], a[240:243], v[76:79], v[164:167]
s_waitcnt lgkmcnt(9)
ds_read_b64_tr_b16 a[232:233], v9 offset:49536
v_exp_f32 v62, v62
v_mfma_f32_16x16x32_bf16 v[108:111], a[244:247], a[24:27], v[108:111]
ds_read_b64_tr_b16 a[238:239], v9 offset:50056
v_exp_f32 v61, v61
v_mfma_f32_16x16x32_bf16 v[112:115], a[244:247], a[88:91], v[112:115]
ds_read_b64_tr_b16 a[236:237], v9 offset:49544
v_exp_f32 v60, v60
v_mfma_f32_16x16x32_bf16 v[168:171], a[244:247], v[76:79], v[168:171]
s_waitcnt lgkmcnt(10)
v_cvt_pk_bf16_f32 v73, v62, v63
v_cvt_pk_bf16_f32 v72, v60, v61
ds_write_b64 v11, v[72:73] offset:39168
v_mfma_f32_16x16x32_bf16 v[116:119], a[248:251], a[24:27], v[116:119]
v_exp_f32 v47, v47
v_mfma_f32_16x16x32_bf16 v[120:123], a[248:251], a[88:91], v[120:123]
s_waitcnt lgkmcnt(9)
v_exp_f32 v46, v46
v_mfma_f32_16x16x32_bf16 v[124:127], a[252:255], a[24:27], v[124:127]
v_exp_f32 v45, v45
v_mfma_f32_16x16x32_bf16 v[128:131], a[252:255], a[88:91], v[128:131]
s_waitcnt lgkmcnt(7)
s_waitcnt lgkmcnt(0) vmcnt(12)
s_barrier
ds_read_b128 a[240:243], v0 offset:24576
v_cvt_pk_bf16_f32 v65, v46, v47
v_mfma_f32_16x16x32_bf16 v[132:135], a[224:227], a[24:27], v[132:135]
ds_read_b128 a[244:247], v1 offset:24576
buffer_load_dwordx4 v12, s[8:11], 0 offen nt lds
v_mfma_f32_16x16x32_bf16 v[136:139], a[224:227], a[88:91], v[136:139]
s_add_u32 m0, s41, 20352
v_exp_f32 v44, v44
v_mfma_f32_16x16x32_bf16 v[140:143], a[228:231], a[24:27], v[140:143]
v_exp_f32 v51, v51
v_mfma_f32_16x16x32_bf16 v[144:147], a[228:231], a[88:91], v[144:147]
ds_read_b128 a[248:251], v2 offset:24576
v_cvt_pk_bf16_f32 v64, v44, v45
v_mfma_f32_16x16x32_bf16 v[148:151], a[232:235], a[24:27], v[148:151]
v_exp_f32 v50, v50
v_mfma_f32_16x16x32_bf16 v[152:155], a[232:235], a[88:91], v[152:155]
ds_read_b128 a[252:255], v3 offset:24576
buffer_load_dwordx4 v12, s[8:11], 0 offen offset:128 nt lds
v_mfma_f32_16x16x32_bf16 v[156:159], a[236:239], a[24:27], v[156:159]
s_add_u32 m0, s42, 8256
v_exp_f32 v49, v49
v_mfma_f32_16x16x32_bf16 v[160:163], a[236:239], a[88:91], v[160:163]
s_waitcnt lgkmcnt(3)
v_exp_f32 v48, v48
v_cvt_pk_bf16_f32 v69, v50, v51
v_mfma_f32_16x16x32_bf16 v[44:47], a[240:243], a[128:131], v[20:23]
ds_read_b128 a[224:227], v0 offset:25088
v_cvt_pk_bf16_f32 v68, v48, v49
v_exp_f32 v55, v55
v_mfma_f32_16x16x32_bf16 v[48:51], a[240:243], a[144:147], v[24:27]
s_waitcnt lgkmcnt(3)
v_exp_f32 v54, v54
v_mfma_f32_16x16x32_bf16 v[44:47], a[244:247], a[132:135], v[44:47]
ds_read_b128 a[228:231], v1 offset:25088
buffer_load_dwordx4 v13, s[12:15], 0 offen nt lds
v_exp_f32 v53, v53
v_mfma_f32_16x16x32_bf16 v[48:51], a[244:247], a[148:151], v[48:51]
s_waitcnt lgkmcnt(3)
v_exp_f32 v52, v52
v_mfma_f32_16x16x32_bf16 v[44:47], a[248:251], a[136:139], v[44:47]
s_add_u32 m0, s42, 12256
v_exp_f32 v59, v59
v_mfma_f32_16x16x32_bf16 v[48:51], a[248:251], a[152:155], v[48:51]
s_waitcnt lgkmcnt(2)
ds_read_b128 a[232:235], v2 offset:25088
v_exp_f32 v58, v58
v_mfma_f32_16x16x32_bf16 v[44:47], a[252:255], a[140:143], v[44:47]
ds_read_b128 a[236:239], v3 offset:25088
buffer_load_dwordx4 v13, s[12:15], 0 offen offset:128 nt lds
v_cvt_pk_bf16_f32 v67, v54, v55
v_mfma_f32_16x16x32_bf16 v[48:51], a[252:255], a[156:159], v[48:51]
s_waitcnt lgkmcnt(3)
v_exp_f32 v57, v57
v_cvt_pk_bf16_f32 v66, v52, v53
v_mfma_f32_16x16x32_bf16 v[52:55], a[224:227], a[128:131], v[20:23]
s_add_u32 m0, s42, 49536
ds_read_b128 v[80:83], v10 offset:39168
v_exp_f32 v56, v56
v_cvt_pk_bf16_f32 v71, v58, v59
v_cvt_pk_bf16_f32 v70, v56, v57
v_mfma_f32_16x16x32_bf16 v[56:59], a[224:227], a[144:147], v[24:27]
s_waitcnt lgkmcnt(3)
ds_read_b64_tr_b16 a[242:243], v6 offset:17024
buffer_load_dwordx4 v14, s[16:19], 0 offen lds
v_mfma_f32_16x16x32_bf16 v[52:55], a[228:231], a[132:135], v[52:55]
s_add_u32 m0, s42, 53536
ds_read_b64_tr_b16 a[240:241], v6 offset:16512
v_add_u32 v12, s7, v12
v_mfma_f32_16x16x32_bf16 v[56:59], a[228:231], a[148:151], v[56:59]
s_waitcnt lgkmcnt(4)
ds_read_b64_tr_b16 a[246:247], v6 offset:17032
v_add_u32 v13, s6, v13
v_mfma_f32_16x16x32_bf16 v[52:55], a[232:235], a[136:139], v[52:55]
s_and_b32 s43, s43, 0x1ffff
s_cselect_b32 s6, s4, s5
ds_read_b64_tr_b16 a[244:245], v6 offset:16520
buffer_load_dwordx4 v14, s[16:19], 0 offen offset:128 lds
v_mfma_f32_16x16x32_bf16 v[56:59], a[232:235], a[152:155], v[56:59]
s_waitcnt lgkmcnt(5)
ds_read_b64_tr_b16 a[250:251], v7 offset:17024
s_mov_b32 m0, 148224
v_mfma_f32_16x16x32_bf16 v[52:55], a[236:239], a[140:143], v[52:55]
s_add_u32 s43, s43, 8192
ds_read_b64_tr_b16 a[248:249], v7 offset:16512
v_add_u32 v14, 0x40000, v14
v_mfma_f32_16x16x32_bf16 v[56:59], a[236:239], a[156:159], v[56:59]
ds_read_b64_tr_b16 a[254:255], v7 offset:17032
v_mfma_f32_16x16x32_bf16 v[32:35], v[16:19], v[64:67], v[32:35]
ds_read_b64_tr_b16 a[252:253], v7 offset:16520
buffer_load_dwordx4 v253, s[92:95], s64 offen lds
v_mfma_f32_16x16x32_bf16 v[36:39], v[16:19], v[68:71], v[36:39]
s_waitcnt lgkmcnt(8)
ds_read_b64_tr_b16 a[226:227], v8 offset:17024
s_add_u32 m0, s41, 24576
v_mfma_f32_16x16x32_bf16 v[40:43], v[16:19], v[80:83], v[40:43]
s_waitcnt lgkmcnt(7)
ds_read_b64_tr_b16 a[224:225], v8 offset:16512
v_mfma_f32_16x16x32_bf16 v[172:175], a[240:243], v[64:67], v[172:175]
ds_read_b64_tr_b16 a[230:231], v8 offset:17032
v_mfma_f32_16x16x32_bf16 v[176:179], a[240:243], v[68:71], v[176:179]
ds_read_b64_tr_b16 a[228:229], v8 offset:16520
v_mfma_f32_16x16x32_bf16 v[236:239], a[240:243], v[80:83], v[236:239]
s_waitcnt lgkmcnt(8)
ds_read_b64_tr_b16 a[234:235], v9 offset:17024
v_mfma_f32_16x16x32_bf16 v[180:183], a[244:247], v[64:67], v[180:183]
ds_read_b64_tr_b16 a[232:233], v9 offset:16512
v_mfma_f32_16x16x32_bf16 v[184:187], a[244:247], v[68:71], v[184:187]
ds_read_b64_tr_b16 a[238:239], v9 offset:17032
v_mfma_f32_16x16x32_bf16 v[240:243], a[244:247], v[80:83], v[240:243]
s_waitcnt lgkmcnt(9)
ds_read_b64_tr_b16 a[236:237], v9 offset:16520
v_mfma_f32_16x16x32_bf16 v[188:191], a[248:251], v[64:67], v[188:191]
ds_read_b64_tr_b16 a[242:243], v6 offset:58304
v_mfma_f32_16x16x32_bf16 v[192:195], a[248:251], v[68:71], v[192:195]
s_waitcnt lgkmcnt(9)
ds_read_b64_tr_b16 a[240:241], v6 offset:57792
v_mfma_f32_16x16x32_bf16 v[196:199], a[252:255], v[64:67], v[196:199]
ds_read_b128 v[76:79], v252 offset:6144
v_mfma_f32_16x16x32_bf16 v[200:203], a[252:255], v[68:71], v[200:203]
s_waitcnt lgkmcnt(9)
ds_read_b64_tr_b16 a[246:247], v6 offset:58312
v_mfma_f32_16x16x32_bf16 v[204:207], a[224:227], v[64:67], v[204:207]
ds_read_b64_tr_b16 a[244:245], v6 offset:57800
v_mfma_f32_16x16x32_bf16 v[208:211], a[224:227], v[68:71], v[208:211]
s_waitcnt lgkmcnt(9)
ds_read_b64_tr_b16 a[250:251], v7 offset:58304
v_mfma_f32_16x16x32_bf16 v[212:215], a[228:231], v[64:67], v[212:215]
ds_read_b64_tr_b16 a[248:249], v7 offset:57792
v_mfma_f32_16x16x32_bf16 v[216:219], a[228:231], v[68:71], v[216:219]
s_waitcnt lgkmcnt(9)
ds_read_b64_tr_b16 a[254:255], v7 offset:58312
v_mfma_f32_16x16x32_bf16 v[220:223], a[232:235], v[64:67], v[220:223]
ds_read_b64_tr_b16 a[252:253], v7 offset:57800
v_mfma_f32_16x16x32_bf16 v[224:227], a[232:235], v[68:71], v[224:227]
s_waitcnt lgkmcnt(9)
ds_read_b64_tr_b16 a[226:227], v8 offset:58304
v_mfma_f32_16x16x32_bf16 v[228:231], a[236:239], v[64:67], v[228:231]
ds_read_b64_tr_b16 a[224:225], v8 offset:57792
v_mfma_f32_16x16x32_bf16 v[232:235], a[236:239], v[68:71], v[232:235]
s_waitcnt lgkmcnt(9)
ds_read_b64_tr_b16 a[230:231], v8 offset:58312
v_mfma_f32_16x16x32_bf16 v[100:103], a[240:243], a[28:31], v[100:103]
ds_read_b64_tr_b16 a[228:229], v8 offset:57800
v_mfma_f32_16x16x32_bf16 v[104:107], a[240:243], a[92:95], v[104:107]
s_waitcnt lgkmcnt(10)
ds_read_b64_tr_b16 a[234:235], v9 offset:58304
v_mfma_f32_16x16x32_bf16 v[164:167], a[240:243], v[76:79], v[164:167]
s_waitcnt lgkmcnt(9)
ds_read_b64_tr_b16 a[232:233], v9 offset:57792
v_mfma_f32_16x16x32_bf16 v[108:111], a[244:247], a[28:31], v[108:111]
ds_read_b64_tr_b16 a[238:239], v9 offset:58312
v_mfma_f32_16x16x32_bf16 v[112:115], a[244:247], a[92:95], v[112:115]
ds_read_b64_tr_b16 a[236:237], v9 offset:57800
v_mfma_f32_16x16x32_bf16 v[168:171], a[244:247], v[76:79], v[168:171]
s_waitcnt lgkmcnt(10)
v_exp_f32 v47, v47
v_mfma_f32_16x16x32_bf16 v[116:119], a[248:251], a[28:31], v[116:119]
v_exp_f32 v46, v46
v_mfma_f32_16x16x32_bf16 v[120:123], a[248:251], a[92:95], v[120:123]
s_waitcnt lgkmcnt(8)
v_exp_f32 v45, v45
v_mfma_f32_16x16x32_bf16 v[124:127], a[252:255], a[28:31], v[124:127]
v_exp_f32 v44, v44
v_mfma_f32_16x16x32_bf16 v[128:131], a[252:255], a[92:95], v[128:131]
s_waitcnt lgkmcnt(6)
s_waitcnt lgkmcnt(0) vmcnt(11)
s_barrier
ds_read_b128 a[240:243], v0 offset:0
v_cvt_pk_bf16_f32 v65, v46, v47
v_mfma_f32_16x16x32_bf16 v[132:135], a[224:227], a[28:31], v[132:135]
ds_read_b128 a[244:247], v1 offset:0
buffer_load_dwordx4 v12, s[8:11], 0 offen nt lds
v_mfma_f32_16x16x32_bf16 v[136:139], a[224:227], a[92:95], v[136:139]
s_add_u32 m0, s41, 28544
v_exp_f32 v51, v51
v_mfma_f32_16x16x32_bf16 v[140:143], a[228:231], a[28:31], v[140:143]
ds_read_b128 a[248:251], v2 offset:0
v_cvt_pk_bf16_f32 v64, v44, v45
v_mfma_f32_16x16x32_bf16 v[144:147], a[228:231], a[92:95], v[144:147]
v_exp_f32 v50, v50
v_mfma_f32_16x16x32_bf16 v[148:151], a[232:235], a[28:31], v[148:151]
ds_read_b128 a[252:255], v3 offset:0
buffer_load_dwordx4 v12, s[8:11], 0 offen offset:128 nt lds
v_mfma_f32_16x16x32_bf16 v[152:155], a[232:235], a[92:95], v[152:155]
s_add_u32 m0, s42, 16512
v_exp_f32 v49, v49
v_mfma_f32_16x16x32_bf16 v[156:159], a[236:239], a[28:31], v[156:159]
v_exp_f32 v48, v48
v_mfma_f32_16x16x32_bf16 v[160:163], a[236:239], a[92:95], v[160:163]
s_waitcnt lgkmcnt(3)
ds_read_b128 a[224:227], v0 offset:512
v_cvt_pk_bf16_f32 v69, v50, v51
v_mfma_f32_16x16x32_bf16 v[44:47], a[240:243], a[128:131], v[20:23]
ds_read_b128 a[228:231], v1 offset:512
v_cvt_pk_bf16_f32 v68, v48, v49
v_exp_f32 v55, v55
v_mfma_f32_16x16x32_bf16 v[48:51], a[240:243], a[144:147], v[24:27]
s_waitcnt lgkmcnt(4)
v_exp_f32 v54, v54
v_mfma_f32_16x16x32_bf16 v[44:47], a[244:247], a[132:135], v[44:47]
ds_read_b128 a[232:235], v2 offset:512
buffer_load_dwordx4 v13, s[12:15], 0 offen nt lds
v_exp_f32 v53, v53
v_mfma_f32_16x16x32_bf16 v[48:51], a[244:247], a[148:151], v[48:51]
s_waitcnt lgkmcnt(4)
v_exp_f32 v52, v52
v_mfma_f32_16x16x32_bf16 v[44:47], a[248:251], a[136:139], v[44:47]
s_add_u32 m0, s42, 20512
v_exp_f32 v59, v59
v_mfma_f32_16x16x32_bf16 v[48:51], a[248:251], a[152:155], v[48:51]
s_waitcnt lgkmcnt(3)
v_exp_f32 v58, v58
v_mfma_f32_16x16x32_bf16 v[44:47], a[252:255], a[140:143], v[44:47]
ds_read_b128 a[236:239], v3 offset:512
buffer_load_dwordx4 v13, s[12:15], 0 offen offset:128 nt lds
v_cvt_pk_bf16_f32 v67, v54, v55
v_mfma_f32_16x16x32_bf16 v[48:51], a[252:255], a[156:159], v[48:51]
s_waitcnt lgkmcnt(3)
v_exp_f32 v57, v57
v_cvt_pk_bf16_f32 v66, v52, v53
v_mfma_f32_16x16x32_bf16 v[52:55], a[224:227], a[128:131], v[20:23]
s_add_u32 m0, s42, 57792
ds_read_b128 a[240:243], v4 offset:0
v_exp_f32 v56, v56
v_cvt_pk_bf16_f32 v71, v58, v59
v_cvt_pk_bf16_f32 v70, v56, v57
v_mfma_f32_16x16x32_bf16 v[56:59], a[224:227], a[144:147], v[24:27]
s_waitcnt lgkmcnt(3)
ds_read_b128 a[244:247], v5 offset:0
buffer_load_dwordx4 v14, s[16:19], 0 offen lds
v_mfma_f32_16x16x32_bf16 v[52:55], a[228:231], a[132:135], v[52:55]
s_add_u32 m0, s42, 61792
ds_read_b128 a[248:251], v4 offset:4096
v_add_u32 v12, s6, v12
v_mfma_f32_16x16x32_bf16 v[56:59], a[228:231], a[148:151], v[56:59]
s_waitcnt lgkmcnt(4)
ds_read_b128 a[252:255], v5 offset:4096
v_add_u32 v13, s7, v13
v_mfma_f32_16x16x32_bf16 v[52:55], a[232:235], a[136:139], v[52:55]
s_and_b32 s43, s43, 0x1ffff
s_cselect_b32 s7, s4, s5
ds_read_b128 v[80:83], v10 offset:40192
buffer_load_dwordx4 v14, s[16:19], 0 offen offset:128 lds
v_mfma_f32_16x16x32_bf16 v[56:59], a[232:235], a[152:155], v[56:59]
s_waitcnt lgkmcnt(5)
ds_read_b64_tr_b16 a[226:227], v6 offset:25280
s_mov_b32 m0, s41
v_mfma_f32_16x16x32_bf16 v[52:55], a[236:239], a[140:143], v[52:55]
s_add_u32 s43, s43, 8192
ds_read_b64_tr_b16 a[224:225], v6 offset:24768
v_add_u32 v14, s67, v14
v_mfma_f32_16x16x32_bf16 v[56:59], a[236:239], a[156:159], v[56:59]
s_waitcnt lgkmcnt(6)
ds_read_b64_tr_b16 a[230:231], v6 offset:25288
v_mfma_f32_16x16x32_bf16 v[60:63], a[240:243], v[84:87], v[28:31]
s_waitcnt lgkmcnt(6)
ds_read_b64_tr_b16 a[228:229], v6 offset:24776
v_mfma_f32_16x16x32_bf16 v[60:63], a[244:247], v[88:91], v[60:63]
s_waitcnt lgkmcnt(6)
ds_read_b64_tr_b16 a[234:235], v7 offset:25280
v_mfma_f32_16x16x32_bf16 v[60:63], a[248:251], v[92:95], v[60:63]
s_waitcnt lgkmcnt(6)
ds_read_b64_tr_b16 a[232:233], v7 offset:24768
v_mfma_f32_16x16x32_bf16 v[60:63], a[252:255], v[96:99], v[60:63]
s_and_b32 s62, s62, 0x3fffff
s_cselect_b32 s67, 0x40000, s61
ds_read_b64_tr_b16 a[238:239], v7 offset:25288
s_add_u32 s62, s62, 0x80000
v_mfma_f32_16x16x32_bf16 v[32:35], v[16:19], v[64:67], v[32:35]
ds_read_b64_tr_b16 a[236:237], v7 offset:24776
v_mfma_f32_16x16x32_bf16 v[36:39], v[16:19], v[68:71], v[36:39]
s_waitcnt lgkmcnt(8)
ds_read_b64_tr_b16 a[242:243], v8 offset:25280
v_mfma_f32_16x16x32_bf16 v[40:43], v[16:19], v[80:83], v[40:43]
s_waitcnt lgkmcnt(7)
ds_read_b64_tr_b16 a[240:241], v8 offset:24768
v_mfma_f32_16x16x32_bf16 v[172:175], a[224:227], v[64:67], v[172:175]
ds_read_b64_tr_b16 a[246:247], v8 offset:25288
v_mfma_f32_16x16x32_bf16 v[176:179], a[224:227], v[68:71], v[176:179]
ds_read_b64_tr_b16 a[244:245], v8 offset:24776
v_mfma_f32_16x16x32_bf16 v[236:239], a[224:227], v[80:83], v[236:239]
s_waitcnt lgkmcnt(8)
ds_read_b64_tr_b16 a[250:251], v9 offset:25280
v_mfma_f32_16x16x32_bf16 v[180:183], a[228:231], v[64:67], v[180:183]
ds_read_b64_tr_b16 a[248:249], v9 offset:24768
v_mfma_f32_16x16x32_bf16 v[184:187], a[228:231], v[68:71], v[184:187]
ds_read_b64_tr_b16 a[254:255], v9 offset:25288
v_mfma_f32_16x16x32_bf16 v[240:243], a[228:231], v[80:83], v[240:243]
s_waitcnt lgkmcnt(9)
ds_read_b64_tr_b16 a[252:253], v9 offset:24776
v_mfma_f32_16x16x32_bf16 v[188:191], a[232:235], v[64:67], v[188:191]
ds_read_b64_tr_b16 a[226:227], v6 offset:33536
v_mfma_f32_16x16x32_bf16 v[192:195], a[232:235], v[68:71], v[192:195]
s_waitcnt lgkmcnt(9)
ds_read_b64_tr_b16 a[224:225], v6 offset:33024
v_mfma_f32_16x16x32_bf16 v[196:199], a[236:239], v[64:67], v[196:199]
ds_read_b128 v[76:79], v251 offset:8192
v_mfma_f32_16x16x32_bf16 v[200:203], a[236:239], v[68:71], v[200:203]
s_waitcnt lgkmcnt(9)
ds_read_b64_tr_b16 a[230:231], v6 offset:33544
v_mfma_f32_16x16x32_bf16 v[204:207], a[240:243], v[64:67], v[204:207]
ds_read_b64_tr_b16 a[228:229], v6 offset:33032
v_mfma_f32_16x16x32_bf16 v[208:211], a[240:243], v[68:71], v[208:211]
s_waitcnt lgkmcnt(9)
ds_read_b64_tr_b16 a[234:235], v7 offset:33536
v_mfma_f32_16x16x32_bf16 v[212:215], a[244:247], v[64:67], v[212:215]
ds_read_b64_tr_b16 a[232:233], v7 offset:33024
v_mfma_f32_16x16x32_bf16 v[216:219], a[244:247], v[68:71], v[216:219]
s_waitcnt lgkmcnt(9)
ds_read_b64_tr_b16 a[238:239], v7 offset:33544
v_mfma_f32_16x16x32_bf16 v[220:223], a[248:251], v[64:67], v[220:223]
ds_read_b64_tr_b16 a[236:237], v7 offset:33032
v_mfma_f32_16x16x32_bf16 v[224:227], a[248:251], v[68:71], v[224:227]
s_waitcnt lgkmcnt(9)
ds_read_b64_tr_b16 a[242:243], v8 offset:33536
v_mfma_f32_16x16x32_bf16 v[228:231], a[252:255], v[64:67], v[228:231]
ds_read_b64_tr_b16 a[240:241], v8 offset:33024
v_mfma_f32_16x16x32_bf16 v[232:235], a[252:255], v[68:71], v[232:235]
s_waitcnt lgkmcnt(9)
ds_read_b64_tr_b16 a[246:247], v8 offset:33544
v_mfma_f32_16x16x32_bf16 v[100:103], a[224:227], a[32:35], v[100:103]
ds_read_b64_tr_b16 a[244:245], v8 offset:33032
v_mfma_f32_16x16x32_bf16 v[104:107], a[224:227], a[96:99], v[104:107]
s_waitcnt lgkmcnt(10)
ds_read_b64_tr_b16 a[250:251], v9 offset:33536
v_exp_f32 v63, v63
v_mfma_f32_16x16x32_bf16 v[164:167], a[224:227], v[76:79], v[164:167]
s_waitcnt lgkmcnt(9)
ds_read_b64_tr_b16 a[248:249], v9 offset:33024
v_exp_f32 v62, v62
v_mfma_f32_16x16x32_bf16 v[108:111], a[228:231], a[32:35], v[108:111]
ds_read_b64_tr_b16 a[254:255], v9 offset:33544
v_exp_f32 v61, v61
v_mfma_f32_16x16x32_bf16 v[112:115], a[228:231], a[96:99], v[112:115]
ds_read_b64_tr_b16 a[252:253], v9 offset:33032
v_exp_f32 v60, v60
v_mfma_f32_16x16x32_bf16 v[168:171], a[228:231], v[76:79], v[168:171]
s_waitcnt lgkmcnt(10)
v_cvt_pk_bf16_f32 v73, v62, v63
v_cvt_pk_bf16_f32 v72, v60, v61
ds_write_b64 v11, v[72:73] offset:37120
v_mfma_f32_16x16x32_bf16 v[116:119], a[232:235], a[32:35], v[116:119]
v_exp_f32 v47, v47
v_mfma_f32_16x16x32_bf16 v[120:123], a[232:235], a[96:99], v[120:123]
s_waitcnt lgkmcnt(9)
v_exp_f32 v46, v46
v_mfma_f32_16x16x32_bf16 v[124:127], a[236:239], a[32:35], v[124:127]
v_exp_f32 v45, v45
v_mfma_f32_16x16x32_bf16 v[128:131], a[236:239], a[96:99], v[128:131]
s_waitcnt lgkmcnt(7)
s_waitcnt lgkmcnt(0) vmcnt(13)
s_barrier
ds_read_b128 a[224:227], v0 offset:8192
v_cvt_pk_bf16_f32 v65, v46, v47
v_mfma_f32_16x16x32_bf16 v[132:135], a[240:243], a[32:35], v[132:135]
ds_read_b128 a[228:231], v1 offset:8192
buffer_load_dwordx4 v12, s[8:11], 0 offen nt lds
v_mfma_f32_16x16x32_bf16 v[136:139], a[240:243], a[96:99], v[136:139]
s_add_u32 m0, s41, 3968
v_exp_f32 v44, v44
v_mfma_f32_16x16x32_bf16 v[140:143], a[244:247], a[32:35], v[140:143]
v_exp_f32 v51, v51
v_mfma_f32_16x16x32_bf16 v[144:147], a[244:247], a[96:99], v[144:147]
ds_read_b128 a[232:235], v2 offset:8192
v_cvt_pk_bf16_f32 v64, v44, v45
v_mfma_f32_16x16x32_bf16 v[148:151], a[248:251], a[32:35], v[148:151]
v_exp_f32 v50, v50
v_mfma_f32_16x16x32_bf16 v[152:155], a[248:251], a[96:99], v[152:155]
ds_read_b128 a[236:239], v3 offset:8192
buffer_load_dwordx4 v12, s[8:11], 0 offen offset:128 nt lds
v_mfma_f32_16x16x32_bf16 v[156:159], a[252:255], a[32:35], v[156:159]
s_add_u32 m0, s42, 24768
v_exp_f32 v49, v49
v_mfma_f32_16x16x32_bf16 v[160:163], a[252:255], a[96:99], v[160:163]
s_waitcnt lgkmcnt(3)
v_exp_f32 v48, v48
v_cvt_pk_bf16_f32 v69, v50, v51
v_mfma_f32_16x16x32_bf16 v[44:47], a[224:227], a[128:131], v[20:23]
ds_read_b128 a[240:243], v0 offset:8704
v_cvt_pk_bf16_f32 v68, v48, v49
v_exp_f32 v55, v55
v_mfma_f32_16x16x32_bf16 v[48:51], a[224:227], a[144:147], v[24:27]
s_waitcnt lgkmcnt(3)
v_exp_f32 v54, v54
v_mfma_f32_16x16x32_bf16 v[44:47], a[228:231], a[132:135], v[44:47]
ds_read_b128 a[244:247], v1 offset:8704
buffer_load_dwordx4 v13, s[12:15], 0 offen nt lds
v_exp_f32 v53, v53
v_mfma_f32_16x16x32_bf16 v[48:51], a[228:231], a[148:151], v[48:51]
s_waitcnt lgkmcnt(3)
v_exp_f32 v52, v52
v_mfma_f32_16x16x32_bf16 v[44:47], a[232:235], a[136:139], v[44:47]
s_add_u32 m0, s42, 28768
v_exp_f32 v59, v59
v_mfma_f32_16x16x32_bf16 v[48:51], a[232:235], a[152:155], v[48:51]
s_waitcnt lgkmcnt(2)
ds_read_b128 a[248:251], v2 offset:8704
v_exp_f32 v58, v58
v_mfma_f32_16x16x32_bf16 v[44:47], a[236:239], a[140:143], v[44:47]
ds_read_b128 a[252:255], v3 offset:8704
buffer_load_dwordx4 v13, s[12:15], 0 offen offset:128 nt lds
v_cvt_pk_bf16_f32 v67, v54, v55
v_mfma_f32_16x16x32_bf16 v[48:51], a[236:239], a[156:159], v[48:51]
s_waitcnt lgkmcnt(3)
v_exp_f32 v57, v57
v_cvt_pk_bf16_f32 v66, v52, v53
v_mfma_f32_16x16x32_bf16 v[52:55], a[240:243], a[128:131], v[20:23]
s_add_u32 m0, s42, 33024
ds_read_b128 v[80:83], v10 offset:37120
v_exp_f32 v56, v56
v_cvt_pk_bf16_f32 v71, v58, v59
v_cvt_pk_bf16_f32 v70, v56, v57
v_mfma_f32_16x16x32_bf16 v[56:59], a[240:243], a[144:147], v[24:27]
s_waitcnt lgkmcnt(3)
ds_read_b64_tr_b16 a[226:227], v6 offset:512
buffer_load_dwordx4 v14, s[16:19], 0 offen lds
v_mfma_f32_16x16x32_bf16 v[52:55], a[244:247], a[132:135], v[52:55]
s_add_u32 m0, s42, 37024
ds_read_b64_tr_b16 a[224:225], v6 offset:0
v_add_u32 v12, s7, v12
v_mfma_f32_16x16x32_bf16 v[56:59], a[244:247], a[148:151], v[56:59]
s_waitcnt lgkmcnt(4)
ds_read_b64_tr_b16 a[230:231], v6 offset:520
v_add_u32 v13, s6, v13
v_mfma_f32_16x16x32_bf16 v[52:55], a[248:251], a[136:139], v[52:55]
s_and_b32 s43, s43, 0x1ffff
s_cselect_b32 s6, s4, s5
ds_read_b64_tr_b16 a[228:229], v6 offset:8
buffer_load_dwordx4 v14, s[16:19], 0 offen offset:128 lds
v_mfma_f32_16x16x32_bf16 v[56:59], a[248:251], a[152:155], v[56:59]
s_waitcnt lgkmcnt(5)
ds_read_b64_tr_b16 a[234:235], v7 offset:512
s_add_u32 m0, s41, 8192
v_mfma_f32_16x16x32_bf16 v[52:55], a[252:255], a[140:143], v[52:55]
s_add_u32 s43, s43, 8192
ds_read_b64_tr_b16 a[232:233], v7 offset:0
v_add_u32 v14, 0x40000, v14
v_mfma_f32_16x16x32_bf16 v[56:59], a[252:255], a[156:159], v[56:59]
ds_read_b64_tr_b16 a[238:239], v7 offset:520
v_mfma_f32_16x16x32_bf16 v[32:35], v[16:19], v[64:67], v[32:35]
ds_read_b64_tr_b16 a[236:237], v7 offset:8
v_mfma_f32_16x16x32_bf16 v[36:39], v[16:19], v[68:71], v[36:39]
s_waitcnt lgkmcnt(8)
ds_read_b64_tr_b16 a[242:243], v8 offset:512
v_mfma_f32_16x16x32_bf16 v[40:43], v[16:19], v[80:83], v[40:43]
s_waitcnt lgkmcnt(7)
ds_read_b64_tr_b16 a[240:241], v8 offset:0
v_mfma_f32_16x16x32_bf16 v[172:175], a[224:227], v[64:67], v[172:175]
ds_read_b64_tr_b16 a[246:247], v8 offset:520
v_mfma_f32_16x16x32_bf16 v[176:179], a[224:227], v[68:71], v[176:179]
ds_read_b64_tr_b16 a[244:245], v8 offset:8
v_mfma_f32_16x16x32_bf16 v[236:239], a[224:227], v[80:83], v[236:239]
s_waitcnt lgkmcnt(8)
ds_read_b64_tr_b16 a[250:251], v9 offset:512
v_mfma_f32_16x16x32_bf16 v[180:183], a[228:231], v[64:67], v[180:183]
ds_read_b64_tr_b16 a[248:249], v9 offset:0
v_mfma_f32_16x16x32_bf16 v[184:187], a[228:231], v[68:71], v[184:187]
ds_read_b64_tr_b16 a[254:255], v9 offset:520
v_mfma_f32_16x16x32_bf16 v[240:243], a[228:231], v[80:83], v[240:243]
s_waitcnt lgkmcnt(9)
ds_read_b64_tr_b16 a[252:253], v9 offset:8
v_mfma_f32_16x16x32_bf16 v[188:191], a[232:235], v[64:67], v[188:191]
ds_read_b64_tr_b16 a[226:227], v6 offset:41792
v_mfma_f32_16x16x32_bf16 v[192:195], a[232:235], v[68:71], v[192:195]
s_waitcnt lgkmcnt(9)
ds_read_b64_tr_b16 a[224:225], v6 offset:41280
v_mfma_f32_16x16x32_bf16 v[196:199], a[236:239], v[64:67], v[196:199]
ds_read_b128 v[76:79], v252 offset:8192
v_mfma_f32_16x16x32_bf16 v[200:203], a[236:239], v[68:71], v[200:203]
s_waitcnt lgkmcnt(9)
ds_read_b64_tr_b16 a[230:231], v6 offset:41800
v_mfma_f32_16x16x32_bf16 v[204:207], a[240:243], v[64:67], v[204:207]
ds_read_b64_tr_b16 a[228:229], v6 offset:41288
v_mfma_f32_16x16x32_bf16 v[208:211], a[240:243], v[68:71], v[208:211]
s_waitcnt lgkmcnt(9)
ds_read_b64_tr_b16 a[234:235], v7 offset:41792
v_mfma_f32_16x16x32_bf16 v[212:215], a[244:247], v[64:67], v[212:215]
ds_read_b64_tr_b16 a[232:233], v7 offset:41280
v_mfma_f32_16x16x32_bf16 v[216:219], a[244:247], v[68:71], v[216:219]
s_waitcnt lgkmcnt(9)
ds_read_b64_tr_b16 a[238:239], v7 offset:41800
v_mfma_f32_16x16x32_bf16 v[220:223], a[248:251], v[64:67], v[220:223]
ds_read_b64_tr_b16 a[236:237], v7 offset:41288
v_mfma_f32_16x16x32_bf16 v[224:227], a[248:251], v[68:71], v[224:227]
s_waitcnt lgkmcnt(9)
ds_read_b64_tr_b16 a[242:243], v8 offset:41792
v_mfma_f32_16x16x32_bf16 v[228:231], a[252:255], v[64:67], v[228:231]
ds_read_b64_tr_b16 a[240:241], v8 offset:41280
v_mfma_f32_16x16x32_bf16 v[232:235], a[252:255], v[68:71], v[232:235]
s_waitcnt lgkmcnt(9)
ds_read_b64_tr_b16 a[246:247], v8 offset:41800
v_mfma_f32_16x16x32_bf16 v[100:103], a[224:227], a[36:39], v[100:103]
ds_read_b64_tr_b16 a[244:245], v8 offset:41288
v_mfma_f32_16x16x32_bf16 v[104:107], a[224:227], a[100:103], v[104:107]
s_waitcnt lgkmcnt(10)
ds_read_b64_tr_b16 a[250:251], v9 offset:41792
v_mfma_f32_16x16x32_bf16 v[164:167], a[224:227], v[76:79], v[164:167]
s_waitcnt lgkmcnt(9)
ds_read_b64_tr_b16 a[248:249], v9 offset:41280
v_mfma_f32_16x16x32_bf16 v[108:111], a[228:231], a[36:39], v[108:111]
ds_read_b64_tr_b16 a[254:255], v9 offset:41800
v_mfma_f32_16x16x32_bf16 v[112:115], a[228:231], a[100:103], v[112:115]
ds_read_b64_tr_b16 a[252:253], v9 offset:41288
v_mfma_f32_16x16x32_bf16 v[168:171], a[228:231], v[76:79], v[168:171]
s_waitcnt lgkmcnt(10)
v_exp_f32 v47, v47
v_mfma_f32_16x16x32_bf16 v[116:119], a[232:235], a[36:39], v[116:119]
v_exp_f32 v46, v46
v_mfma_f32_16x16x32_bf16 v[120:123], a[232:235], a[100:103], v[120:123]
s_waitcnt lgkmcnt(8)
v_exp_f32 v45, v45
v_mfma_f32_16x16x32_bf16 v[124:127], a[236:239], a[36:39], v[124:127]
v_exp_f32 v44, v44
v_mfma_f32_16x16x32_bf16 v[128:131], a[236:239], a[100:103], v[128:131]
s_waitcnt lgkmcnt(6)
s_waitcnt lgkmcnt(0) vmcnt(10)
s_barrier
ds_read_b128 a[224:227], v0 offset:16384
v_cvt_pk_bf16_f32 v65, v46, v47
v_mfma_f32_16x16x32_bf16 v[132:135], a[240:243], a[36:39], v[132:135]
ds_read_b128 a[228:231], v1 offset:16384
buffer_load_dwordx4 v12, s[8:11], 0 offen nt lds
v_mfma_f32_16x16x32_bf16 v[136:139], a[240:243], a[100:103], v[136:139]
s_add_u32 m0, s41, 12160
v_exp_f32 v51, v51
v_mfma_f32_16x16x32_bf16 v[140:143], a[244:247], a[36:39], v[140:143]
ds_read_b128 a[232:235], v2 offset:16384
v_cvt_pk_bf16_f32 v64, v44, v45
v_mfma_f32_16x16x32_bf16 v[144:147], a[244:247], a[100:103], v[144:147]
v_exp_f32 v50, v50
v_mfma_f32_16x16x32_bf16 v[148:151], a[248:251], a[36:39], v[148:151]
ds_read_b128 a[236:239], v3 offset:16384
buffer_load_dwordx4 v12, s[8:11], 0 offen offset:128 nt lds
v_mfma_f32_16x16x32_bf16 v[152:155], a[248:251], a[100:103], v[152:155]
s_mov_b32 m0, s42
v_exp_f32 v49, v49
v_mfma_f32_16x16x32_bf16 v[156:159], a[252:255], a[36:39], v[156:159]
v_exp_f32 v48, v48
v_mfma_f32_16x16x32_bf16 v[160:163], a[252:255], a[100:103], v[160:163]
s_waitcnt lgkmcnt(3)
ds_read_b128 a[240:243], v0 offset:16896
v_cvt_pk_bf16_f32 v69, v50, v51
v_mfma_f32_16x16x32_bf16 v[44:47], a[224:227], a[128:131], v[20:23]
ds_read_b128 a[244:247], v1 offset:16896
v_cvt_pk_bf16_f32 v68, v48, v49
v_exp_f32 v55, v55
v_mfma_f32_16x16x32_bf16 v[48:51], a[224:227], a[144:147], v[24:27]
s_waitcnt lgkmcnt(4)
v_exp_f32 v54, v54
v_mfma_f32_16x16x32_bf16 v[44:47], a[228:231], a[132:135], v[44:47]
ds_read_b128 a[248:251], v2 offset:16896
buffer_load_dwordx4 v13, s[12:15], 0 offen nt lds
v_exp_f32 v53, v53
v_mfma_f32_16x16x32_bf16 v[48:51], a[228:231], a[148:151], v[48:51]
s_waitcnt lgkmcnt(4)
v_exp_f32 v52, v52
v_mfma_f32_16x16x32_bf16 v[44:47], a[232:235], a[136:139], v[44:47]
s_add_u32 m0, s42, 4000
v_exp_f32 v59, v59
v_mfma_f32_16x16x32_bf16 v[48:51], a[232:235], a[152:155], v[48:51]
s_waitcnt lgkmcnt(3)
v_exp_f32 v58, v58
v_mfma_f32_16x16x32_bf16 v[44:47], a[236:239], a[140:143], v[44:47]
ds_read_b128 a[252:255], v3 offset:16896
buffer_load_dwordx4 v13, s[12:15], 0 offen offset:128 nt lds
v_cvt_pk_bf16_f32 v67, v54, v55
v_mfma_f32_16x16x32_bf16 v[48:51], a[236:239], a[156:159], v[48:51]
s_waitcnt lgkmcnt(3)
v_exp_f32 v57, v57
v_cvt_pk_bf16_f32 v66, v52, v53
v_mfma_f32_16x16x32_bf16 v[52:55], a[240:243], a[128:131], v[20:23]
s_add_u32 m0, s42, 41280
ds_read_b128 a[224:227], v4 offset:16384
v_exp_f32 v56, v56
v_cvt_pk_bf16_f32 v71, v58, v59
v_cvt_pk_bf16_f32 v70, v56, v57
v_mfma_f32_16x16x32_bf16 v[56:59], a[240:243], a[144:147], v[24:27]
s_waitcnt lgkmcnt(3)
ds_read_b128 a[228:231], v5 offset:16384
buffer_load_dwordx4 v14, s[16:19], 0 offen lds
v_mfma_f32_16x16x32_bf16 v[52:55], a[244:247], a[132:135], v[52:55]
s_add_u32 m0, s42, 45280
ds_read_b128 a[232:235], v4 offset:20480
v_add_u32 v12, s6, v12
v_mfma_f32_16x16x32_bf16 v[56:59], a[244:247], a[148:151], v[56:59]
s_waitcnt lgkmcnt(4)
ds_read_b128 a[236:239], v5 offset:20480
v_add_u32 v13, s7, v13
v_mfma_f32_16x16x32_bf16 v[52:55], a[248:251], a[136:139], v[52:55]
s_and_b32 s43, s43, 0x1ffff
s_cselect_b32 s7, s4, s5
ds_read_b128 v[80:83], v10 offset:38144
buffer_load_dwordx4 v14, s[16:19], 0 offen offset:128 lds
v_mfma_f32_16x16x32_bf16 v[56:59], a[248:251], a[152:155], v[56:59]
s_waitcnt lgkmcnt(5)
ds_read_b64_tr_b16 a[242:243], v6 offset:8768
s_add_u32 m0, s41, 16384
v_mfma_f32_16x16x32_bf16 v[52:55], a[252:255], a[140:143], v[52:55]
s_add_u32 s43, s43, 8192
ds_read_b64_tr_b16 a[240:241], v6 offset:8256
v_add_u32 v14, s67, v14
v_mfma_f32_16x16x32_bf16 v[56:59], a[252:255], a[156:159], v[56:59]
s_waitcnt lgkmcnt(6)
ds_read_b64_tr_b16 a[246:247], v6 offset:8776
v_mfma_f32_16x16x32_bf16 v[60:63], a[224:227], v[84:87], v[28:31]
s_waitcnt lgkmcnt(6)
ds_read_b64_tr_b16 a[244:245], v6 offset:8264
v_mfma_f32_16x16x32_bf16 v[60:63], a[228:231], v[88:91], v[60:63]
s_waitcnt lgkmcnt(6)
ds_read_b64_tr_b16 a[250:251], v7 offset:8768
v_mfma_f32_16x16x32_bf16 v[60:63], a[232:235], v[92:95], v[60:63]
s_waitcnt lgkmcnt(6)
ds_read_b64_tr_b16 a[248:249], v7 offset:8256
v_mfma_f32_16x16x32_bf16 v[60:63], a[236:239], v[96:99], v[60:63]
s_and_b32 s62, s62, 0x3fffff
s_cselect_b32 s67, s45, s44
ds_read_b64_tr_b16 a[254:255], v7 offset:8776
s_add_u32 s62, s62, 0x80000
v_mfma_f32_16x16x32_bf16 v[32:35], v[16:19], v[64:67], v[32:35]
ds_read_b64_tr_b16 a[252:253], v7 offset:8264
v_mfma_f32_16x16x32_bf16 v[36:39], v[16:19], v[68:71], v[36:39]
s_waitcnt lgkmcnt(8)
ds_read_b64_tr_b16 a[226:227], v8 offset:8768
v_mfma_f32_16x16x32_bf16 v[40:43], v[16:19], v[80:83], v[40:43]
s_waitcnt lgkmcnt(7)
ds_read_b64_tr_b16 a[224:225], v8 offset:8256
v_mfma_f32_16x16x32_bf16 v[172:175], a[240:243], v[64:67], v[172:175]
ds_read_b64_tr_b16 a[230:231], v8 offset:8776
v_mfma_f32_16x16x32_bf16 v[176:179], a[240:243], v[68:71], v[176:179]
ds_read_b64_tr_b16 a[228:229], v8 offset:8264
v_mfma_f32_16x16x32_bf16 v[236:239], a[240:243], v[80:83], v[236:239]
s_waitcnt lgkmcnt(8)
ds_read_b64_tr_b16 a[234:235], v9 offset:8768
v_mfma_f32_16x16x32_bf16 v[180:183], a[244:247], v[64:67], v[180:183]
ds_read_b64_tr_b16 a[232:233], v9 offset:8256
v_mfma_f32_16x16x32_bf16 v[184:187], a[244:247], v[68:71], v[184:187]
ds_read_b64_tr_b16 a[238:239], v9 offset:8776
v_mfma_f32_16x16x32_bf16 v[240:243], a[244:247], v[80:83], v[240:243]
s_waitcnt lgkmcnt(9)
ds_read_b64_tr_b16 a[236:237], v9 offset:8264
v_mfma_f32_16x16x32_bf16 v[188:191], a[248:251], v[64:67], v[188:191]
ds_read_b64_tr_b16 a[242:243], v6 offset:50048
v_mfma_f32_16x16x32_bf16 v[192:195], a[248:251], v[68:71], v[192:195]
s_waitcnt lgkmcnt(9)
ds_read_b64_tr_b16 a[240:241], v6 offset:49536
v_mfma_f32_16x16x32_bf16 v[196:199], a[252:255], v[64:67], v[196:199]
ds_read_b128 v[76:79], v251 offset:10240
v_mfma_f32_16x16x32_bf16 v[200:203], a[252:255], v[68:71], v[200:203]
s_waitcnt lgkmcnt(9)
ds_read_b64_tr_b16 a[246:247], v6 offset:50056
v_mfma_f32_16x16x32_bf16 v[204:207], a[224:227], v[64:67], v[204:207]
ds_read_b64_tr_b16 a[244:245], v6 offset:49544
v_mfma_f32_16x16x32_bf16 v[208:211], a[224:227], v[68:71], v[208:211]
s_waitcnt lgkmcnt(9)
ds_read_b64_tr_b16 a[250:251], v7 offset:50048
v_mfma_f32_16x16x32_bf16 v[212:215], a[228:231], v[64:67], v[212:215]
ds_read_b64_tr_b16 a[248:249], v7 offset:49536
v_mfma_f32_16x16x32_bf16 v[216:219], a[228:231], v[68:71], v[216:219]
s_waitcnt lgkmcnt(9)
ds_read_b64_tr_b16 a[254:255], v7 offset:50056
v_mfma_f32_16x16x32_bf16 v[220:223], a[232:235], v[64:67], v[220:223]
ds_read_b64_tr_b16 a[252:253], v7 offset:49544
v_mfma_f32_16x16x32_bf16 v[224:227], a[232:235], v[68:71], v[224:227]
s_waitcnt lgkmcnt(9)
ds_read_b64_tr_b16 a[226:227], v8 offset:50048
v_mfma_f32_16x16x32_bf16 v[228:231], a[236:239], v[64:67], v[228:231]
ds_read_b64_tr_b16 a[224:225], v8 offset:49536
v_mfma_f32_16x16x32_bf16 v[232:235], a[236:239], v[68:71], v[232:235]
s_waitcnt lgkmcnt(9)
ds_read_b64_tr_b16 a[230:231], v8 offset:50056
v_mfma_f32_16x16x32_bf16 v[100:103], a[240:243], a[40:43], v[100:103]
ds_read_b64_tr_b16 a[228:229], v8 offset:49544
v_mfma_f32_16x16x32_bf16 v[104:107], a[240:243], a[104:107], v[104:107]
s_waitcnt lgkmcnt(10)
ds_read_b64_tr_b16 a[234:235], v9 offset:50048
v_exp_f32 v63, v63
v_mfma_f32_16x16x32_bf16 v[164:167], a[240:243], v[76:79], v[164:167]
s_waitcnt lgkmcnt(9)
ds_read_b64_tr_b16 a[232:233], v9 offset:49536
v_exp_f32 v62, v62
v_mfma_f32_16x16x32_bf16 v[108:111], a[244:247], a[40:43], v[108:111]
ds_read_b64_tr_b16 a[238:239], v9 offset:50056
v_exp_f32 v61, v61
v_mfma_f32_16x16x32_bf16 v[112:115], a[244:247], a[104:107], v[112:115]
ds_read_b64_tr_b16 a[236:237], v9 offset:49544
v_exp_f32 v60, v60
v_mfma_f32_16x16x32_bf16 v[168:171], a[244:247], v[76:79], v[168:171]
s_waitcnt lgkmcnt(10)
v_cvt_pk_bf16_f32 v73, v62, v63
v_cvt_pk_bf16_f32 v72, v60, v61
ds_write_b64 v11, v[72:73] offset:39168
v_mfma_f32_16x16x32_bf16 v[116:119], a[248:251], a[40:43], v[116:119]
v_exp_f32 v47, v47
v_mfma_f32_16x16x32_bf16 v[120:123], a[248:251], a[104:107], v[120:123]
s_waitcnt lgkmcnt(9)
v_exp_f32 v46, v46
v_mfma_f32_16x16x32_bf16 v[124:127], a[252:255], a[40:43], v[124:127]
v_exp_f32 v45, v45
v_mfma_f32_16x16x32_bf16 v[128:131], a[252:255], a[104:107], v[128:131]
s_waitcnt lgkmcnt(7)
s_waitcnt lgkmcnt(0) vmcnt(12)
s_barrier
ds_read_b128 a[240:243], v0 offset:24576
v_cvt_pk_bf16_f32 v65, v46, v47
v_mfma_f32_16x16x32_bf16 v[132:135], a[224:227], a[40:43], v[132:135]
ds_read_b128 a[244:247], v1 offset:24576
buffer_load_dwordx4 v12, s[8:11], 0 offen nt lds
v_mfma_f32_16x16x32_bf16 v[136:139], a[224:227], a[104:107], v[136:139]
s_add_u32 m0, s41, 20352
v_exp_f32 v44, v44
v_mfma_f32_16x16x32_bf16 v[140:143], a[228:231], a[40:43], v[140:143]
v_exp_f32 v51, v51
v_mfma_f32_16x16x32_bf16 v[144:147], a[228:231], a[104:107], v[144:147]
ds_read_b128 a[248:251], v2 offset:24576
v_cvt_pk_bf16_f32 v64, v44, v45
v_mfma_f32_16x16x32_bf16 v[148:151], a[232:235], a[40:43], v[148:151]
v_exp_f32 v50, v50
v_mfma_f32_16x16x32_bf16 v[152:155], a[232:235], a[104:107], v[152:155]
ds_read_b128 a[252:255], v3 offset:24576
buffer_load_dwordx4 v12, s[8:11], 0 offen offset:128 nt lds
v_mfma_f32_16x16x32_bf16 v[156:159], a[236:239], a[40:43], v[156:159]
s_add_u32 m0, s42, 8256
v_exp_f32 v49, v49
v_mfma_f32_16x16x32_bf16 v[160:163], a[236:239], a[104:107], v[160:163]
s_waitcnt lgkmcnt(3)
v_exp_f32 v48, v48
v_cvt_pk_bf16_f32 v69, v50, v51
v_mfma_f32_16x16x32_bf16 v[44:47], a[240:243], a[128:131], v[20:23]
ds_read_b128 a[224:227], v0 offset:25088
v_cvt_pk_bf16_f32 v68, v48, v49
v_exp_f32 v55, v55
v_mfma_f32_16x16x32_bf16 v[48:51], a[240:243], a[144:147], v[24:27]
s_waitcnt lgkmcnt(3)
v_exp_f32 v54, v54
v_mfma_f32_16x16x32_bf16 v[44:47], a[244:247], a[132:135], v[44:47]
ds_read_b128 a[228:231], v1 offset:25088
buffer_load_dwordx4 v13, s[12:15], 0 offen nt lds
v_exp_f32 v53, v53
v_mfma_f32_16x16x32_bf16 v[48:51], a[244:247], a[148:151], v[48:51]
s_waitcnt lgkmcnt(3)
v_exp_f32 v52, v52
v_mfma_f32_16x16x32_bf16 v[44:47], a[248:251], a[136:139], v[44:47]
s_add_u32 m0, s42, 12256
v_exp_f32 v59, v59
v_mfma_f32_16x16x32_bf16 v[48:51], a[248:251], a[152:155], v[48:51]
s_waitcnt lgkmcnt(2)
ds_read_b128 a[232:235], v2 offset:25088
v_exp_f32 v58, v58
v_mfma_f32_16x16x32_bf16 v[44:47], a[252:255], a[140:143], v[44:47]
ds_read_b128 a[236:239], v3 offset:25088
buffer_load_dwordx4 v13, s[12:15], 0 offen offset:128 nt lds
v_cvt_pk_bf16_f32 v67, v54, v55
v_mfma_f32_16x16x32_bf16 v[48:51], a[252:255], a[156:159], v[48:51]
s_waitcnt lgkmcnt(3)
v_exp_f32 v57, v57
v_cvt_pk_bf16_f32 v66, v52, v53
v_mfma_f32_16x16x32_bf16 v[52:55], a[224:227], a[128:131], v[20:23]
s_add_u32 m0, s42, 49536
ds_read_b128 v[80:83], v10 offset:39168
v_exp_f32 v56, v56
v_cvt_pk_bf16_f32 v71, v58, v59
v_cvt_pk_bf16_f32 v70, v56, v57
v_mfma_f32_16x16x32_bf16 v[56:59], a[224:227], a[144:147], v[24:27]
s_waitcnt lgkmcnt(3)
ds_read_b64_tr_b16 a[242:243], v6 offset:17024
buffer_load_dwordx4 v14, s[16:19], 0 offen lds
v_mfma_f32_16x16x32_bf16 v[52:55], a[228:231], a[132:135], v[52:55]
s_add_u32 m0, s42, 53536
ds_read_b64_tr_b16 a[240:241], v6 offset:16512
v_add_u32 v12, s7, v12
v_mfma_f32_16x16x32_bf16 v[56:59], a[228:231], a[148:151], v[56:59]
s_waitcnt lgkmcnt(4)
ds_read_b64_tr_b16 a[246:247], v6 offset:17032
v_add_u32 v13, s6, v13
v_mfma_f32_16x16x32_bf16 v[52:55], a[232:235], a[136:139], v[52:55]
s_and_b32 s43, s43, 0x1ffff
s_cselect_b32 s6, 0x22000, s4
ds_read_b64_tr_b16 a[244:245], v6 offset:16520
buffer_load_dwordx4 v14, s[16:19], 0 offen offset:128 lds
v_mfma_f32_16x16x32_bf16 v[56:59], a[232:235], a[152:155], v[56:59]
s_waitcnt lgkmcnt(5)
ds_read_b64_tr_b16 a[250:251], v7 offset:17024
s_mov_b32 m0, 148224
v_mfma_f32_16x16x32_bf16 v[52:55], a[236:239], a[140:143], v[52:55]
s_add_u32 s43, s43, 8192
ds_read_b64_tr_b16 a[248:249], v7 offset:16512
v_add_u32 v14, 0x40000, v14
v_mfma_f32_16x16x32_bf16 v[56:59], a[236:239], a[156:159], v[56:59]
ds_read_b64_tr_b16 a[254:255], v7 offset:17032
v_mfma_f32_16x16x32_bf16 v[32:35], v[16:19], v[64:67], v[32:35]
ds_read_b64_tr_b16 a[252:253], v7 offset:16520
buffer_load_dwordx4 v253, s[92:95], s64 offen lds
v_mfma_f32_16x16x32_bf16 v[36:39], v[16:19], v[68:71], v[36:39]
s_waitcnt lgkmcnt(8)
ds_read_b64_tr_b16 a[226:227], v8 offset:17024
s_add_u32 m0, s41, 24576
v_mfma_f32_16x16x32_bf16 v[40:43], v[16:19], v[80:83], v[40:43]
s_waitcnt lgkmcnt(7)
ds_read_b64_tr_b16 a[224:225], v8 offset:16512
v_mfma_f32_16x16x32_bf16 v[172:175], a[240:243], v[64:67], v[172:175]
ds_read_b64_tr_b16 a[230:231], v8 offset:17032
v_mfma_f32_16x16x32_bf16 v[176:179], a[240:243], v[68:71], v[176:179]
ds_read_b64_tr_b16 a[228:229], v8 offset:16520
v_mfma_f32_16x16x32_bf16 v[236:239], a[240:243], v[80:83], v[236:239]
s_waitcnt lgkmcnt(8)
ds_read_b64_tr_b16 a[234:235], v9 offset:17024
v_mfma_f32_16x16x32_bf16 v[180:183], a[244:247], v[64:67], v[180:183]
ds_read_b64_tr_b16 a[232:233], v9 offset:16512
v_mfma_f32_16x16x32_bf16 v[184:187], a[244:247], v[68:71], v[184:187]
ds_read_b64_tr_b16 a[238:239], v9 offset:17032
v_mfma_f32_16x16x32_bf16 v[240:243], a[244:247], v[80:83], v[240:243]
s_waitcnt lgkmcnt(9)
ds_read_b64_tr_b16 a[236:237], v9 offset:16520
v_mfma_f32_16x16x32_bf16 v[188:191], a[248:251], v[64:67], v[188:191]
ds_read_b64_tr_b16 a[242:243], v6 offset:58304
v_mfma_f32_16x16x32_bf16 v[192:195], a[248:251], v[68:71], v[192:195]
s_waitcnt lgkmcnt(9)
ds_read_b64_tr_b16 a[240:241], v6 offset:57792
v_mfma_f32_16x16x32_bf16 v[196:199], a[252:255], v[64:67], v[196:199]
ds_read_b128 v[76:79], v252 offset:10240
v_mfma_f32_16x16x32_bf16 v[200:203], a[252:255], v[68:71], v[200:203]
s_waitcnt lgkmcnt(9)
ds_read_b64_tr_b16 a[246:247], v6 offset:58312
v_mfma_f32_16x16x32_bf16 v[204:207], a[224:227], v[64:67], v[204:207]
ds_read_b64_tr_b16 a[244:245], v6 offset:57800
v_mfma_f32_16x16x32_bf16 v[208:211], a[224:227], v[68:71], v[208:211]
s_waitcnt lgkmcnt(9)
ds_read_b64_tr_b16 a[250:251], v7 offset:58304
v_mfma_f32_16x16x32_bf16 v[212:215], a[228:231], v[64:67], v[212:215]
ds_read_b64_tr_b16 a[248:249], v7 offset:57792
v_mfma_f32_16x16x32_bf16 v[216:219], a[228:231], v[68:71], v[216:219]
s_waitcnt lgkmcnt(9)
ds_read_b64_tr_b16 a[254:255], v7 offset:58312
v_mfma_f32_16x16x32_bf16 v[220:223], a[232:235], v[64:67], v[220:223]
ds_read_b64_tr_b16 a[252:253], v7 offset:57800
v_mfma_f32_16x16x32_bf16 v[224:227], a[232:235], v[68:71], v[224:227]
s_waitcnt lgkmcnt(9)
ds_read_b64_tr_b16 a[226:227], v8 offset:58304
v_mfma_f32_16x16x32_bf16 v[228:231], a[236:239], v[64:67], v[228:231]
ds_read_b64_tr_b16 a[224:225], v8 offset:57792
v_mfma_f32_16x16x32_bf16 v[232:235], a[236:239], v[68:71], v[232:235]
s_waitcnt lgkmcnt(9)
ds_read_b64_tr_b16 a[230:231], v8 offset:58312
v_mfma_f32_16x16x32_bf16 v[100:103], a[240:243], a[44:47], v[100:103]
ds_read_b64_tr_b16 a[228:229], v8 offset:57800
v_mfma_f32_16x16x32_bf16 v[104:107], a[240:243], a[108:111], v[104:107]
s_waitcnt lgkmcnt(10)
ds_read_b64_tr_b16 a[234:235], v9 offset:58304
v_mfma_f32_16x16x32_bf16 v[164:167], a[240:243], v[76:79], v[164:167]
s_waitcnt lgkmcnt(9)
ds_read_b64_tr_b16 a[232:233], v9 offset:57792
v_mfma_f32_16x16x32_bf16 v[108:111], a[244:247], a[44:47], v[108:111]
ds_read_b64_tr_b16 a[238:239], v9 offset:58312
v_mfma_f32_16x16x32_bf16 v[112:115], a[244:247], a[108:111], v[112:115]
ds_read_b64_tr_b16 a[236:237], v9 offset:57800
v_mfma_f32_16x16x32_bf16 v[168:171], a[244:247], v[76:79], v[168:171]
s_waitcnt lgkmcnt(10)
v_exp_f32 v47, v47
v_mfma_f32_16x16x32_bf16 v[116:119], a[248:251], a[44:47], v[116:119]
v_exp_f32 v46, v46
v_mfma_f32_16x16x32_bf16 v[120:123], a[248:251], a[108:111], v[120:123]
s_waitcnt lgkmcnt(8)
v_exp_f32 v45, v45
v_mfma_f32_16x16x32_bf16 v[124:127], a[252:255], a[44:47], v[124:127]
v_exp_f32 v44, v44
v_mfma_f32_16x16x32_bf16 v[128:131], a[252:255], a[108:111], v[128:131]
s_waitcnt lgkmcnt(6)
s_waitcnt lgkmcnt(0) vmcnt(11)
s_barrier
ds_read_b128 a[240:243], v0 offset:0
v_cvt_pk_bf16_f32 v65, v46, v47
v_mfma_f32_16x16x32_bf16 v[132:135], a[224:227], a[44:47], v[132:135]
ds_read_b128 a[244:247], v1 offset:0
buffer_load_dwordx4 v12, s[8:11], 0 offen nt lds
v_mfma_f32_16x16x32_bf16 v[136:139], a[224:227], a[108:111], v[136:139]
s_add_u32 m0, s41, 28544
v_exp_f32 v51, v51
v_mfma_f32_16x16x32_bf16 v[140:143], a[228:231], a[44:47], v[140:143]
ds_read_b128 a[248:251], v2 offset:0
v_cvt_pk_bf16_f32 v64, v44, v45
v_mfma_f32_16x16x32_bf16 v[144:147], a[228:231], a[108:111], v[144:147]
v_exp_f32 v50, v50
v_mfma_f32_16x16x32_bf16 v[148:151], a[232:235], a[44:47], v[148:151]
ds_read_b128 a[252:255], v3 offset:0
buffer_load_dwordx4 v12, s[8:11], 0 offen offset:128 nt lds
v_mfma_f32_16x16x32_bf16 v[152:155], a[232:235], a[108:111], v[152:155]
s_add_u32 m0, s42, 16512
v_exp_f32 v49, v49
v_mfma_f32_16x16x32_bf16 v[156:159], a[236:239], a[44:47], v[156:159]
v_exp_f32 v48, v48
v_mfma_f32_16x16x32_bf16 v[160:163], a[236:239], a[108:111], v[160:163]
s_waitcnt lgkmcnt(3)
ds_read_b128 a[224:227], v0 offset:512
v_cvt_pk_bf16_f32 v69, v50, v51
v_mfma_f32_16x16x32_bf16 v[44:47], a[240:243], a[128:131], v[20:23]
ds_read_b128 a[228:231], v1 offset:512
v_cvt_pk_bf16_f32 v68, v48, v49
v_exp_f32 v55, v55
v_mfma_f32_16x16x32_bf16 v[48:51], a[240:243], a[144:147], v[24:27]
s_waitcnt lgkmcnt(4)
v_exp_f32 v54, v54
v_mfma_f32_16x16x32_bf16 v[44:47], a[244:247], a[132:135], v[44:47]
ds_read_b128 a[232:235], v2 offset:512
buffer_load_dwordx4 v13, s[12:15], 0 offen nt lds
v_exp_f32 v53, v53
v_mfma_f32_16x16x32_bf16 v[48:51], a[244:247], a[148:151], v[48:51]
s_waitcnt lgkmcnt(4)
v_exp_f32 v52, v52
v_mfma_f32_16x16x32_bf16 v[44:47], a[248:251], a[136:139], v[44:47]
s_add_u32 m0, s42, 20512
v_exp_f32 v59, v59
v_mfma_f32_16x16x32_bf16 v[48:51], a[248:251], a[152:155], v[48:51]
s_waitcnt lgkmcnt(3)
v_exp_f32 v58, v58
v_mfma_f32_16x16x32_bf16 v[44:47], a[252:255], a[140:143], v[44:47]
ds_read_b128 a[236:239], v3 offset:512
buffer_load_dwordx4 v13, s[12:15], 0 offen offset:128 nt lds
v_cvt_pk_bf16_f32 v67, v54, v55
v_mfma_f32_16x16x32_bf16 v[48:51], a[252:255], a[156:159], v[48:51]
s_waitcnt lgkmcnt(3)
v_exp_f32 v57, v57
v_cvt_pk_bf16_f32 v66, v52, v53
v_mfma_f32_16x16x32_bf16 v[52:55], a[224:227], a[128:131], v[20:23]
s_add_u32 m0, s42, 57792
ds_read_b128 a[240:243], v4 offset:0
v_exp_f32 v56, v56
v_cvt_pk_bf16_f32 v71, v58, v59
v_cvt_pk_bf16_f32 v70, v56, v57
v_mfma_f32_16x16x32_bf16 v[56:59], a[224:227], a[144:147], v[24:27]
s_waitcnt lgkmcnt(3)
ds_read_b128 a[244:247], v5 offset:0
buffer_load_dwordx4 v14, s[16:19], 0 offen lds
v_mfma_f32_16x16x32_bf16 v[52:55], a[228:231], a[132:135], v[52:55]
s_add_u32 m0, s42, 61792
ds_read_b128 a[248:251], v4 offset:4096
v_add_u32 v12, s6, v12
v_mfma_f32_16x16x32_bf16 v[56:59], a[228:231], a[148:151], v[56:59]
s_waitcnt lgkmcnt(4)
ds_read_b128 a[252:255], v5 offset:4096
v_add_u32 v13, s7, v13
v_mfma_f32_16x16x32_bf16 v[52:55], a[232:235], a[136:139], v[52:55]
s_and_b32 s43, s43, 0x1ffff
s_cselect_b32 s7, s4, s5
ds_read_b128 v[80:83], v10 offset:40192
buffer_load_dwordx4 v14, s[16:19], 0 offen offset:128 lds
v_mfma_f32_16x16x32_bf16 v[56:59], a[232:235], a[152:155], v[56:59]
s_waitcnt lgkmcnt(5)
ds_read_b64_tr_b16 a[226:227], v6 offset:25280
s_mov_b32 m0, s41
v_mfma_f32_16x16x32_bf16 v[52:55], a[236:239], a[140:143], v[52:55]
s_add_u32 s43, s43, 8192
ds_read_b64_tr_b16 a[224:225], v6 offset:24768
v_add_u32 v14, s67, v14
v_mfma_f32_16x16x32_bf16 v[56:59], a[236:239], a[156:159], v[56:59]
s_waitcnt lgkmcnt(6)
ds_read_b64_tr_b16 a[230:231], v6 offset:25288
v_mfma_f32_16x16x32_bf16 v[60:63], a[240:243], v[84:87], v[28:31]
s_waitcnt lgkmcnt(6)
ds_read_b64_tr_b16 a[228:229], v6 offset:24776
v_mfma_f32_16x16x32_bf16 v[60:63], a[244:247], v[88:91], v[60:63]
s_waitcnt lgkmcnt(6)
ds_read_b64_tr_b16 a[234:235], v7 offset:25280
v_mfma_f32_16x16x32_bf16 v[60:63], a[248:251], v[92:95], v[60:63]
s_waitcnt lgkmcnt(6)
ds_read_b64_tr_b16 a[232:233], v7 offset:24768
v_mfma_f32_16x16x32_bf16 v[60:63], a[252:255], v[96:99], v[60:63]
s_and_b32 s62, s62, 0x3fffff
s_cselect_b32 s67, 0x40000, s61
ds_read_b64_tr_b16 a[238:239], v7 offset:25288
v_mfma_f32_16x16x32_bf16 v[32:35], v[16:19], v[64:67], v[32:35]
ds_read_b64_tr_b16 a[236:237], v7 offset:24776
v_mfma_f32_16x16x32_bf16 v[36:39], v[16:19], v[68:71], v[36:39]
s_waitcnt lgkmcnt(8)
ds_read_b64_tr_b16 a[242:243], v8 offset:25280
v_mfma_f32_16x16x32_bf16 v[40:43], v[16:19], v[80:83], v[40:43]
s_waitcnt lgkmcnt(7)
ds_read_b64_tr_b16 a[240:241], v8 offset:24768
v_mfma_f32_16x16x32_bf16 v[172:175], a[224:227], v[64:67], v[172:175]
ds_read_b64_tr_b16 a[246:247], v8 offset:25288
v_mfma_f32_16x16x32_bf16 v[176:179], a[224:227], v[68:71], v[176:179]
ds_read_b64_tr_b16 a[244:245], v8 offset:24776
v_mfma_f32_16x16x32_bf16 v[236:239], a[224:227], v[80:83], v[236:239]
s_waitcnt lgkmcnt(8)
ds_read_b64_tr_b16 a[250:251], v9 offset:25280
v_mfma_f32_16x16x32_bf16 v[180:183], a[228:231], v[64:67], v[180:183]
ds_read_b64_tr_b16 a[248:249], v9 offset:24768
v_mfma_f32_16x16x32_bf16 v[184:187], a[228:231], v[68:71], v[184:187]
ds_read_b64_tr_b16 a[254:255], v9 offset:25288
v_mfma_f32_16x16x32_bf16 v[240:243], a[228:231], v[80:83], v[240:243]
s_waitcnt lgkmcnt(9)
ds_read_b64_tr_b16 a[252:253], v9 offset:24776
v_mfma_f32_16x16x32_bf16 v[188:191], a[232:235], v[64:67], v[188:191]
ds_read_b64_tr_b16 a[226:227], v6 offset:33536
v_mfma_f32_16x16x32_bf16 v[192:195], a[232:235], v[68:71], v[192:195]
s_waitcnt lgkmcnt(9)
ds_read_b64_tr_b16 a[224:225], v6 offset:33024
v_mfma_f32_16x16x32_bf16 v[196:199], a[236:239], v[64:67], v[196:199]
ds_read_b128 v[76:79], v251 offset:12288
v_mfma_f32_16x16x32_bf16 v[200:203], a[236:239], v[68:71], v[200:203]
s_waitcnt lgkmcnt(9)
ds_read_b64_tr_b16 a[230:231], v6 offset:33544
v_mfma_f32_16x16x32_bf16 v[204:207], a[240:243], v[64:67], v[204:207]
ds_read_b64_tr_b16 a[228:229], v6 offset:33032
v_mfma_f32_16x16x32_bf16 v[208:211], a[240:243], v[68:71], v[208:211]
s_waitcnt lgkmcnt(9)
ds_read_b64_tr_b16 a[234:235], v7 offset:33536
v_mfma_f32_16x16x32_bf16 v[212:215], a[244:247], v[64:67], v[212:215]
ds_read_b64_tr_b16 a[232:233], v7 offset:33024
v_mfma_f32_16x16x32_bf16 v[216:219], a[244:247], v[68:71], v[216:219]
s_waitcnt lgkmcnt(9)
ds_read_b64_tr_b16 a[238:239], v7 offset:33544
v_mfma_f32_16x16x32_bf16 v[220:223], a[248:251], v[64:67], v[220:223]
ds_read_b64_tr_b16 a[236:237], v7 offset:33032
v_mfma_f32_16x16x32_bf16 v[224:227], a[248:251], v[68:71], v[224:227]
s_waitcnt lgkmcnt(9)
ds_read_b64_tr_b16 a[242:243], v8 offset:33536
v_mfma_f32_16x16x32_bf16 v[228:231], a[252:255], v[64:67], v[228:231]
ds_read_b64_tr_b16 a[240:241], v8 offset:33024
v_mfma_f32_16x16x32_bf16 v[232:235], a[252:255], v[68:71], v[232:235]
s_waitcnt lgkmcnt(9)
ds_read_b64_tr_b16 a[246:247], v8 offset:33544
v_mfma_f32_16x16x32_bf16 v[100:103], a[224:227], a[48:51], v[100:103]
ds_read_b64_tr_b16 a[244:245], v8 offset:33032
v_mfma_f32_16x16x32_bf16 v[104:107], a[224:227], a[112:115], v[104:107]
s_waitcnt lgkmcnt(10)
ds_read_b64_tr_b16 a[250:251], v9 offset:33536
v_exp_f32 v63, v63
v_mfma_f32_16x16x32_bf16 v[164:167], a[224:227], v[76:79], v[164:167]
s_waitcnt lgkmcnt(9)
ds_read_b64_tr_b16 a[248:249], v9 offset:33024
v_exp_f32 v62, v62
v_mfma_f32_16x16x32_bf16 v[108:111], a[228:231], a[48:51], v[108:111]
ds_read_b64_tr_b16 a[254:255], v9 offset:33544
v_exp_f32 v61, v61
v_mfma_f32_16x16x32_bf16 v[112:115], a[228:231], a[112:115], v[112:115]
ds_read_b64_tr_b16 a[252:253], v9 offset:33032
v_exp_f32 v60, v60
v_mfma_f32_16x16x32_bf16 v[168:171], a[228:231], v[76:79], v[168:171]
s_waitcnt lgkmcnt(10)
v_cvt_pk_bf16_f32 v73, v62, v63
v_cvt_pk_bf16_f32 v72, v60, v61
ds_write_b64 v11, v[72:73] offset:37120
v_mfma_f32_16x16x32_bf16 v[116:119], a[232:235], a[48:51], v[116:119]
v_exp_f32 v47, v47
v_mfma_f32_16x16x32_bf16 v[120:123], a[232:235], a[112:115], v[120:123]
s_waitcnt lgkmcnt(9)
v_exp_f32 v46, v46
v_mfma_f32_16x16x32_bf16 v[124:127], a[236:239], a[48:51], v[124:127]
v_exp_f32 v45, v45
v_mfma_f32_16x16x32_bf16 v[128:131], a[236:239], a[112:115], v[128:131]
s_waitcnt lgkmcnt(7)
s_waitcnt lgkmcnt(0) vmcnt(13)
s_barrier
ds_read_b128 a[224:227], v0 offset:8192
v_cvt_pk_bf16_f32 v65, v46, v47
v_mfma_f32_16x16x32_bf16 v[132:135], a[240:243], a[48:51], v[132:135]
ds_read_b128 a[228:231], v1 offset:8192
buffer_load_dwordx4 v12, s[8:11], 0 offen nt lds
v_mfma_f32_16x16x32_bf16 v[136:139], a[240:243], a[112:115], v[136:139]
s_add_u32 m0, s41, 3968
v_exp_f32 v44, v44
v_mfma_f32_16x16x32_bf16 v[140:143], a[244:247], a[48:51], v[140:143]
v_exp_f32 v51, v51
v_mfma_f32_16x16x32_bf16 v[144:147], a[244:247], a[112:115], v[144:147]
ds_read_b128 a[232:235], v2 offset:8192
v_cvt_pk_bf16_f32 v64, v44, v45
v_mfma_f32_16x16x32_bf16 v[148:151], a[248:251], a[48:51], v[148:151]
v_exp_f32 v50, v50
v_mfma_f32_16x16x32_bf16 v[152:155], a[248:251], a[112:115], v[152:155]
ds_read_b128 a[236:239], v3 offset:8192
buffer_load_dwordx4 v12, s[8:11], 0 offen offset:128 nt lds
v_mfma_f32_16x16x32_bf16 v[156:159], a[252:255], a[48:51], v[156:159]
s_add_u32 m0, s42, 24768
v_exp_f32 v49, v49
v_mfma_f32_16x16x32_bf16 v[160:163], a[252:255], a[112:115], v[160:163]
s_waitcnt lgkmcnt(3)
v_exp_f32 v48, v48
v_cvt_pk_bf16_f32 v69, v50, v51
v_mfma_f32_16x16x32_bf16 v[44:47], a[224:227], a[128:131], v[20:23]
ds_read_b128 a[240:243], v0 offset:8704
v_cvt_pk_bf16_f32 v68, v48, v49
v_exp_f32 v55, v55
v_mfma_f32_16x16x32_bf16 v[48:51], a[224:227], a[144:147], v[24:27]
s_waitcnt lgkmcnt(3)
v_exp_f32 v54, v54
v_mfma_f32_16x16x32_bf16 v[44:47], a[228:231], a[132:135], v[44:47]
ds_read_b128 a[244:247], v1 offset:8704
buffer_load_dwordx4 v13, s[12:15], 0 offen nt lds
v_exp_f32 v53, v53
v_mfma_f32_16x16x32_bf16 v[48:51], a[228:231], a[148:151], v[48:51]
s_waitcnt lgkmcnt(3)
v_exp_f32 v52, v52
v_mfma_f32_16x16x32_bf16 v[44:47], a[232:235], a[136:139], v[44:47]
s_add_u32 m0, s42, 28768
v_exp_f32 v59, v59
v_mfma_f32_16x16x32_bf16 v[48:51], a[232:235], a[152:155], v[48:51]
s_waitcnt lgkmcnt(2)
ds_read_b128 a[248:251], v2 offset:8704
v_exp_f32 v58, v58
v_mfma_f32_16x16x32_bf16 v[44:47], a[236:239], a[140:143], v[44:47]
ds_read_b128 a[252:255], v3 offset:8704
buffer_load_dwordx4 v13, s[12:15], 0 offen offset:128 nt lds
v_cvt_pk_bf16_f32 v67, v54, v55
v_mfma_f32_16x16x32_bf16 v[48:51], a[236:239], a[156:159], v[48:51]
s_waitcnt lgkmcnt(3)
v_exp_f32 v57, v57
v_cvt_pk_bf16_f32 v66, v52, v53
v_mfma_f32_16x16x32_bf16 v[52:55], a[240:243], a[128:131], v[20:23]
s_add_u32 m0, s42, 33024
ds_read_b128 v[80:83], v10 offset:37120
v_exp_f32 v56, v56
v_cvt_pk_bf16_f32 v71, v58, v59
v_cvt_pk_bf16_f32 v70, v56, v57
v_mfma_f32_16x16x32_bf16 v[56:59], a[240:243], a[144:147], v[24:27]
s_waitcnt lgkmcnt(3)
ds_read_b64_tr_b16 a[226:227], v6 offset:512
buffer_load_dwordx4 v14, s[16:19], 0 offen lds
v_mfma_f32_16x16x32_bf16 v[52:55], a[244:247], a[132:135], v[52:55]
s_add_u32 m0, s42, 37024
ds_read_b64_tr_b16 a[224:225], v6 offset:0
v_add_u32 v12, s7, v12
v_mfma_f32_16x16x32_bf16 v[56:59], a[244:247], a[148:151], v[56:59]
s_waitcnt lgkmcnt(4)
ds_read_b64_tr_b16 a[230:231], v6 offset:520
v_add_u32 v13, s6, v13
v_mfma_f32_16x16x32_bf16 v[52:55], a[248:251], a[136:139], v[52:55]
s_and_b32 s43, s43, 0x1ffff
s_cselect_b32 s6, s4, s5
ds_read_b64_tr_b16 a[228:229], v6 offset:8
buffer_load_dwordx4 v14, s[16:19], 0 offen offset:128 lds
v_mfma_f32_16x16x32_bf16 v[56:59], a[248:251], a[152:155], v[56:59]
s_waitcnt lgkmcnt(5)
ds_read_b64_tr_b16 a[234:235], v7 offset:512
s_add_u32 m0, s41, 8192
v_mfma_f32_16x16x32_bf16 v[52:55], a[252:255], a[140:143], v[52:55]
s_add_u32 s43, s43, 8192
ds_read_b64_tr_b16 a[232:233], v7 offset:0
v_add_u32 v14, 0x40000, v14
v_mfma_f32_16x16x32_bf16 v[56:59], a[252:255], a[156:159], v[56:59]
ds_read_b64_tr_b16 a[238:239], v7 offset:520
v_mfma_f32_16x16x32_bf16 v[32:35], v[16:19], v[64:67], v[32:35]
ds_read_b64_tr_b16 a[236:237], v7 offset:8
v_mfma_f32_16x16x32_bf16 v[36:39], v[16:19], v[68:71], v[36:39]
s_waitcnt lgkmcnt(8)
ds_read_b64_tr_b16 a[242:243], v8 offset:512
v_mfma_f32_16x16x32_bf16 v[40:43], v[16:19], v[80:83], v[40:43]
s_waitcnt lgkmcnt(7)
ds_read_b64_tr_b16 a[240:241], v8 offset:0
v_mfma_f32_16x16x32_bf16 v[172:175], a[224:227], v[64:67], v[172:175]
ds_read_b64_tr_b16 a[246:247], v8 offset:520
v_mfma_f32_16x16x32_bf16 v[176:179], a[224:227], v[68:71], v[176:179]
ds_read_b64_tr_b16 a[244:245], v8 offset:8
v_mfma_f32_16x16x32_bf16 v[236:239], a[224:227], v[80:83], v[236:239]
s_waitcnt lgkmcnt(8)
ds_read_b64_tr_b16 a[250:251], v9 offset:512
v_mfma_f32_16x16x32_bf16 v[180:183], a[228:231], v[64:67], v[180:183]
ds_read_b64_tr_b16 a[248:249], v9 offset:0
v_mfma_f32_16x16x32_bf16 v[184:187], a[228:231], v[68:71], v[184:187]
ds_read_b64_tr_b16 a[254:255], v9 offset:520
v_mfma_f32_16x16x32_bf16 v[240:243], a[228:231], v[80:83], v[240:243]
s_waitcnt lgkmcnt(9)
ds_read_b64_tr_b16 a[252:253], v9 offset:8
v_mfma_f32_16x16x32_bf16 v[188:191], a[232:235], v[64:67], v[188:191]
ds_read_b64_tr_b16 a[226:227], v6 offset:41792
v_mfma_f32_16x16x32_bf16 v[192:195], a[232:235], v[68:71], v[192:195]
s_waitcnt lgkmcnt(9)
ds_read_b64_tr_b16 a[224:225], v6 offset:41280
v_mfma_f32_16x16x32_bf16 v[196:199], a[236:239], v[64:67], v[196:199]
ds_read_b128 v[76:79], v252 offset:12288
v_mfma_f32_16x16x32_bf16 v[200:203], a[236:239], v[68:71], v[200:203]
s_waitcnt lgkmcnt(9)
ds_read_b64_tr_b16 a[230:231], v6 offset:41800
v_mfma_f32_16x16x32_bf16 v[204:207], a[240:243], v[64:67], v[204:207]
ds_read_b64_tr_b16 a[228:229], v6 offset:41288
v_mfma_f32_16x16x32_bf16 v[208:211], a[240:243], v[68:71], v[208:211]
s_waitcnt lgkmcnt(9)
ds_read_b64_tr_b16 a[234:235], v7 offset:41792
v_mfma_f32_16x16x32_bf16 v[212:215], a[244:247], v[64:67], v[212:215]
ds_read_b64_tr_b16 a[232:233], v7 offset:41280
v_mfma_f32_16x16x32_bf16 v[216:219], a[244:247], v[68:71], v[216:219]
s_waitcnt lgkmcnt(9)
ds_read_b64_tr_b16 a[238:239], v7 offset:41800
v_mfma_f32_16x16x32_bf16 v[220:223], a[248:251], v[64:67], v[220:223]
ds_read_b64_tr_b16 a[236:237], v7 offset:41288
v_mfma_f32_16x16x32_bf16 v[224:227], a[248:251], v[68:71], v[224:227]
s_waitcnt lgkmcnt(9)
ds_read_b64_tr_b16 a[242:243], v8 offset:41792
v_mfma_f32_16x16x32_bf16 v[228:231], a[252:255], v[64:67], v[228:231]
ds_read_b64_tr_b16 a[240:241], v8 offset:41280
v_mfma_f32_16x16x32_bf16 v[232:235], a[252:255], v[68:71], v[232:235]
s_waitcnt lgkmcnt(9)
ds_read_b64_tr_b16 a[246:247], v8 offset:41800
v_mfma_f32_16x16x32_bf16 v[100:103], a[224:227], a[52:55], v[100:103]
ds_read_b64_tr_b16 a[244:245], v8 offset:41288
v_mfma_f32_16x16x32_bf16 v[104:107], a[224:227], a[116:119], v[104:107]
s_waitcnt lgkmcnt(10)
ds_read_b64_tr_b16 a[250:251], v9 offset:41792
v_mfma_f32_16x16x32_bf16 v[164:167], a[224:227], v[76:79], v[164:167]
s_waitcnt lgkmcnt(9)
ds_read_b64_tr_b16 a[248:249], v9 offset:41280
v_mfma_f32_16x16x32_bf16 v[108:111], a[228:231], a[52:55], v[108:111]
ds_read_b64_tr_b16 a[254:255], v9 offset:41800
v_mfma_f32_16x16x32_bf16 v[112:115], a[228:231], a[116:119], v[112:115]
ds_read_b64_tr_b16 a[252:253], v9 offset:41288
v_mfma_f32_16x16x32_bf16 v[168:171], a[228:231], v[76:79], v[168:171]
s_waitcnt lgkmcnt(10)
v_exp_f32 v47, v47
v_mfma_f32_16x16x32_bf16 v[116:119], a[232:235], a[52:55], v[116:119]
v_exp_f32 v46, v46
v_mfma_f32_16x16x32_bf16 v[120:123], a[232:235], a[116:119], v[120:123]
s_waitcnt lgkmcnt(8)
v_exp_f32 v45, v45
v_mfma_f32_16x16x32_bf16 v[124:127], a[236:239], a[52:55], v[124:127]
v_exp_f32 v44, v44
v_mfma_f32_16x16x32_bf16 v[128:131], a[236:239], a[116:119], v[128:131]
s_waitcnt lgkmcnt(6)
s_waitcnt lgkmcnt(0) vmcnt(10)
s_barrier
ds_read_b128 a[224:227], v0 offset:16384
v_cvt_pk_bf16_f32 v65, v46, v47
v_mfma_f32_16x16x32_bf16 v[132:135], a[240:243], a[52:55], v[132:135]
ds_read_b128 a[228:231], v1 offset:16384
buffer_load_dwordx4 v12, s[8:11], 0 offen nt lds
v_mfma_f32_16x16x32_bf16 v[136:139], a[240:243], a[116:119], v[136:139]
s_add_u32 m0, s41, 12160
v_exp_f32 v51, v51
v_mfma_f32_16x16x32_bf16 v[140:143], a[244:247], a[52:55], v[140:143]
ds_read_b128 a[232:235], v2 offset:16384
v_cvt_pk_bf16_f32 v64, v44, v45
v_mfma_f32_16x16x32_bf16 v[144:147], a[244:247], a[116:119], v[144:147]
v_exp_f32 v50, v50
v_mfma_f32_16x16x32_bf16 v[148:151], a[248:251], a[52:55], v[148:151]
ds_read_b128 a[236:239], v3 offset:16384
buffer_load_dwordx4 v12, s[8:11], 0 offen offset:128 nt lds
v_mfma_f32_16x16x32_bf16 v[152:155], a[248:251], a[116:119], v[152:155]
s_mov_b32 m0, s42
v_exp_f32 v49, v49
v_mfma_f32_16x16x32_bf16 v[156:159], a[252:255], a[52:55], v[156:159]
v_exp_f32 v48, v48
v_mfma_f32_16x16x32_bf16 v[160:163], a[252:255], a[116:119], v[160:163]
s_waitcnt lgkmcnt(3)
ds_read_b128 a[240:243], v0 offset:16896
v_cvt_pk_bf16_f32 v69, v50, v51
v_mfma_f32_16x16x32_bf16 v[44:47], a[224:227], a[128:131], v[20:23]
ds_read_b128 a[244:247], v1 offset:16896
v_cvt_pk_bf16_f32 v68, v48, v49
v_exp_f32 v55, v55
v_mfma_f32_16x16x32_bf16 v[48:51], a[224:227], a[144:147], v[24:27]
s_waitcnt lgkmcnt(4)
v_exp_f32 v54, v54
v_mfma_f32_16x16x32_bf16 v[44:47], a[228:231], a[132:135], v[44:47]
ds_read_b128 a[248:251], v2 offset:16896
buffer_load_dwordx4 v13, s[12:15], 0 offen nt lds
v_exp_f32 v53, v53
v_mfma_f32_16x16x32_bf16 v[48:51], a[228:231], a[148:151], v[48:51]
s_waitcnt lgkmcnt(4)
v_exp_f32 v52, v52
v_mfma_f32_16x16x32_bf16 v[44:47], a[232:235], a[136:139], v[44:47]
s_add_u32 m0, s42, 4000
v_exp_f32 v59, v59
v_mfma_f32_16x16x32_bf16 v[48:51], a[232:235], a[152:155], v[48:51]
s_waitcnt lgkmcnt(3)
v_exp_f32 v58, v58
v_mfma_f32_16x16x32_bf16 v[44:47], a[236:239], a[140:143], v[44:47]
ds_read_b128 a[252:255], v3 offset:16896
buffer_load_dwordx4 v13, s[12:15], 0 offen offset:128 nt lds
v_cvt_pk_bf16_f32 v67, v54, v55
v_mfma_f32_16x16x32_bf16 v[48:51], a[236:239], a[156:159], v[48:51]
s_waitcnt lgkmcnt(3)
v_exp_f32 v57, v57
v_cvt_pk_bf16_f32 v66, v52, v53
v_mfma_f32_16x16x32_bf16 v[52:55], a[240:243], a[128:131], v[20:23]
s_add_u32 m0, s42, 41280
ds_read_b128 a[224:227], v4 offset:16384
v_exp_f32 v56, v56
v_cvt_pk_bf16_f32 v71, v58, v59
v_cvt_pk_bf16_f32 v70, v56, v57
v_mfma_f32_16x16x32_bf16 v[56:59], a[240:243], a[144:147], v[24:27]
s_waitcnt lgkmcnt(3)
ds_read_b128 a[228:231], v5 offset:16384
buffer_load_dwordx4 v14, s[16:19], 0 offen lds
v_mfma_f32_16x16x32_bf16 v[52:55], a[244:247], a[132:135], v[52:55]
s_add_u32 m0, s42, 45280
ds_read_b128 a[232:235], v4 offset:20480
v_add_u32 v12, s6, v12
v_mfma_f32_16x16x32_bf16 v[56:59], a[244:247], a[148:151], v[56:59]
s_waitcnt lgkmcnt(4)
ds_read_b128 a[236:239], v5 offset:20480
v_add_u32 v13, s7, v13
v_mfma_f32_16x16x32_bf16 v[52:55], a[248:251], a[136:139], v[52:55]
s_and_b32 s43, s43, 0x1ffff
s_cselect_b32 s7, s4, s5
ds_read_b128 v[80:83], v10 offset:38144
buffer_load_dwordx4 v14, s[16:19], 0 offen offset:128 lds
v_mfma_f32_16x16x32_bf16 v[56:59], a[248:251], a[152:155], v[56:59]
s_waitcnt lgkmcnt(5)
ds_read_b64_tr_b16 a[242:243], v6 offset:8768
s_add_u32 m0, s41, 16384
v_mfma_f32_16x16x32_bf16 v[52:55], a[252:255], a[140:143], v[52:55]
ds_read_b64_tr_b16 a[240:241], v6 offset:8256
v_add_u32 v14, s67, v14
v_mfma_f32_16x16x32_bf16 v[56:59], a[252:255], a[156:159], v[56:59]
s_waitcnt lgkmcnt(6)
ds_read_b64_tr_b16 a[246:247], v6 offset:8776
v_mfma_f32_16x16x32_bf16 v[60:63], a[224:227], v[84:87], v[28:31]
s_waitcnt lgkmcnt(6)
ds_read_b64_tr_b16 a[244:245], v6 offset:8264
v_mfma_f32_16x16x32_bf16 v[60:63], a[228:231], v[88:91], v[60:63]
s_waitcnt lgkmcnt(6)
ds_read_b64_tr_b16 a[250:251], v7 offset:8768
v_mfma_f32_16x16x32_bf16 v[60:63], a[232:235], v[92:95], v[60:63]
s_waitcnt lgkmcnt(6)
ds_read_b64_tr_b16 a[248:249], v7 offset:8256
v_mfma_f32_16x16x32_bf16 v[60:63], a[236:239], v[96:99], v[60:63]
ds_read_b64_tr_b16 a[254:255], v7 offset:8776
v_mfma_f32_16x16x32_bf16 v[32:35], v[16:19], v[64:67], v[32:35]
ds_read_b64_tr_b16 a[252:253], v7 offset:8264
v_mfma_f32_16x16x32_bf16 v[36:39], v[16:19], v[68:71], v[36:39]
s_waitcnt lgkmcnt(8)
ds_read_b64_tr_b16 a[226:227], v8 offset:8768
v_mfma_f32_16x16x32_bf16 v[40:43], v[16:19], v[80:83], v[40:43]
s_waitcnt lgkmcnt(7)
ds_read_b64_tr_b16 a[224:225], v8 offset:8256
v_mfma_f32_16x16x32_bf16 v[172:175], a[240:243], v[64:67], v[172:175]
ds_read_b64_tr_b16 a[230:231], v8 offset:8776
v_mfma_f32_16x16x32_bf16 v[176:179], a[240:243], v[68:71], v[176:179]
ds_read_b64_tr_b16 a[228:229], v8 offset:8264
v_mfma_f32_16x16x32_bf16 v[236:239], a[240:243], v[80:83], v[236:239]
s_waitcnt lgkmcnt(8)
ds_read_b64_tr_b16 a[234:235], v9 offset:8768
v_mfma_f32_16x16x32_bf16 v[180:183], a[244:247], v[64:67], v[180:183]
ds_read_b64_tr_b16 a[232:233], v9 offset:8256
v_mfma_f32_16x16x32_bf16 v[184:187], a[244:247], v[68:71], v[184:187]
ds_read_b64_tr_b16 a[238:239], v9 offset:8776
v_mfma_f32_16x16x32_bf16 v[240:243], a[244:247], v[80:83], v[240:243]
s_waitcnt lgkmcnt(9)
ds_read_b64_tr_b16 a[236:237], v9 offset:8264
v_mfma_f32_16x16x32_bf16 v[188:191], a[248:251], v[64:67], v[188:191]
ds_read_b64_tr_b16 a[242:243], v6 offset:50048
v_mfma_f32_16x16x32_bf16 v[192:195], a[248:251], v[68:71], v[192:195]
s_waitcnt lgkmcnt(9)
ds_read_b64_tr_b16 a[240:241], v6 offset:49536
v_mfma_f32_16x16x32_bf16 v[196:199], a[252:255], v[64:67], v[196:199]
ds_read_b128 v[76:79], v251 offset:14336
v_mfma_f32_16x16x32_bf16 v[200:203], a[252:255], v[68:71], v[200:203]
s_waitcnt lgkmcnt(9)
ds_read_b64_tr_b16 a[246:247], v6 offset:50056
v_mfma_f32_16x16x32_bf16 v[204:207], a[224:227], v[64:67], v[204:207]
ds_read_b64_tr_b16 a[244:245], v6 offset:49544
v_mfma_f32_16x16x32_bf16 v[208:211], a[224:227], v[68:71], v[208:211]
s_waitcnt lgkmcnt(9)
ds_read_b64_tr_b16 a[250:251], v7 offset:50048
v_mfma_f32_16x16x32_bf16 v[212:215], a[228:231], v[64:67], v[212:215]
ds_read_b64_tr_b16 a[248:249], v7 offset:49536
v_mfma_f32_16x16x32_bf16 v[216:219], a[228:231], v[68:71], v[216:219]
s_waitcnt lgkmcnt(9)
ds_read_b64_tr_b16 a[254:255], v7 offset:50056
v_mfma_f32_16x16x32_bf16 v[220:223], a[232:235], v[64:67], v[220:223]
ds_read_b64_tr_b16 a[252:253], v7 offset:49544
v_mfma_f32_16x16x32_bf16 v[224:227], a[232:235], v[68:71], v[224:227]
s_waitcnt lgkmcnt(9)
ds_read_b64_tr_b16 a[226:227], v8 offset:50048
v_mfma_f32_16x16x32_bf16 v[228:231], a[236:239], v[64:67], v[228:231]
ds_read_b64_tr_b16 a[224:225], v8 offset:49536
v_mfma_f32_16x16x32_bf16 v[232:235], a[236:239], v[68:71], v[232:235]
s_waitcnt lgkmcnt(9)
ds_read_b64_tr_b16 a[230:231], v8 offset:50056
v_mfma_f32_16x16x32_bf16 v[100:103], a[240:243], a[56:59], v[100:103]
ds_read_b64_tr_b16 a[228:229], v8 offset:49544
v_mfma_f32_16x16x32_bf16 v[104:107], a[240:243], a[120:123], v[104:107]
s_waitcnt lgkmcnt(10)
ds_read_b64_tr_b16 a[234:235], v9 offset:50048
v_exp_f32 v63, v63
v_mfma_f32_16x16x32_bf16 v[164:167], a[240:243], v[76:79], v[164:167]
s_waitcnt lgkmcnt(9)
ds_read_b64_tr_b16 a[232:233], v9 offset:49536
v_exp_f32 v62, v62
v_mfma_f32_16x16x32_bf16 v[108:111], a[244:247], a[56:59], v[108:111]
ds_read_b64_tr_b16 a[238:239], v9 offset:50056
v_exp_f32 v61, v61
v_mfma_f32_16x16x32_bf16 v[112:115], a[244:247], a[120:123], v[112:115]
ds_read_b64_tr_b16 a[236:237], v9 offset:49544
v_exp_f32 v60, v60
v_mfma_f32_16x16x32_bf16 v[168:171], a[244:247], v[76:79], v[168:171]
s_waitcnt lgkmcnt(10)
v_cvt_pk_bf16_f32 v73, v62, v63
v_cvt_pk_bf16_f32 v72, v60, v61
ds_write_b64 v11, v[72:73] offset:39168
v_mfma_f32_16x16x32_bf16 v[116:119], a[248:251], a[56:59], v[116:119]
v_exp_f32 v47, v47
v_mfma_f32_16x16x32_bf16 v[120:123], a[248:251], a[120:123], v[120:123]
s_waitcnt lgkmcnt(9)
v_exp_f32 v46, v46
v_mfma_f32_16x16x32_bf16 v[124:127], a[252:255], a[56:59], v[124:127]
v_exp_f32 v45, v45
v_mfma_f32_16x16x32_bf16 v[128:131], a[252:255], a[120:123], v[128:131]
s_waitcnt lgkmcnt(7)
s_waitcnt lgkmcnt(0) vmcnt(12)
s_barrier
ds_read_b128 a[240:243], v0 offset:24576
v_cvt_pk_bf16_f32 v65, v46, v47
v_mfma_f32_16x16x32_bf16 v[132:135], a[224:227], a[56:59], v[132:135]
ds_read_b128 a[244:247], v1 offset:24576
buffer_load_dwordx4 v12, s[8:11], 0 offen nt lds
v_mfma_f32_16x16x32_bf16 v[136:139], a[224:227], a[120:123], v[136:139]
s_add_u32 m0, s41, 20352
v_exp_f32 v44, v44
v_mfma_f32_16x16x32_bf16 v[140:143], a[228:231], a[56:59], v[140:143]
v_exp_f32 v51, v51
v_mfma_f32_16x16x32_bf16 v[144:147], a[228:231], a[120:123], v[144:147]
ds_read_b128 a[248:251], v2 offset:24576
v_cvt_pk_bf16_f32 v64, v44, v45
v_mfma_f32_16x16x32_bf16 v[148:151], a[232:235], a[56:59], v[148:151]
v_exp_f32 v50, v50
v_mfma_f32_16x16x32_bf16 v[152:155], a[232:235], a[120:123], v[152:155]
ds_read_b128 a[252:255], v3 offset:24576
buffer_load_dwordx4 v12, s[8:11], 0 offen offset:128 nt lds
v_mfma_f32_16x16x32_bf16 v[156:159], a[236:239], a[56:59], v[156:159]
s_add_u32 m0, s42, 8256
v_exp_f32 v49, v49
v_mfma_f32_16x16x32_bf16 v[160:163], a[236:239], a[120:123], v[160:163]
s_waitcnt lgkmcnt(3)
v_exp_f32 v48, v48
v_cvt_pk_bf16_f32 v69, v50, v51
v_mfma_f32_16x16x32_bf16 v[44:47], a[240:243], a[128:131], v[20:23]
ds_read_b128 a[224:227], v0 offset:25088
v_cvt_pk_bf16_f32 v68, v48, v49
v_exp_f32 v55, v55
v_mfma_f32_16x16x32_bf16 v[48:51], a[240:243], a[144:147], v[24:27]
s_waitcnt lgkmcnt(3)
v_exp_f32 v54, v54
v_mfma_f32_16x16x32_bf16 v[44:47], a[244:247], a[132:135], v[44:47]
ds_read_b128 a[228:231], v1 offset:25088
buffer_load_dwordx4 v13, s[12:15], 0 offen nt lds
v_exp_f32 v53, v53
v_mfma_f32_16x16x32_bf16 v[48:51], a[244:247], a[148:151], v[48:51]
s_waitcnt lgkmcnt(3)
v_exp_f32 v52, v52
v_mfma_f32_16x16x32_bf16 v[44:47], a[248:251], a[136:139], v[44:47]
s_add_u32 m0, s42, 12256
v_exp_f32 v59, v59
v_mfma_f32_16x16x32_bf16 v[48:51], a[248:251], a[152:155], v[48:51]
s_waitcnt lgkmcnt(2)
ds_read_b128 a[232:235], v2 offset:25088
v_exp_f32 v58, v58
v_mfma_f32_16x16x32_bf16 v[44:47], a[252:255], a[140:143], v[44:47]
ds_read_b128 a[236:239], v3 offset:25088
buffer_load_dwordx4 v13, s[12:15], 0 offen offset:128 nt lds
v_cvt_pk_bf16_f32 v67, v54, v55
v_mfma_f32_16x16x32_bf16 v[48:51], a[252:255], a[156:159], v[48:51]
s_waitcnt lgkmcnt(3)
v_exp_f32 v57, v57
v_cvt_pk_bf16_f32 v66, v52, v53
v_mfma_f32_16x16x32_bf16 v[52:55], a[224:227], a[128:131], v[20:23]
s_add_u32 m0, s42, 49536
v_exp_f32 v56, v56
v_cvt_pk_bf16_f32 v71, v58, v59
v_cvt_pk_bf16_f32 v70, v56, v57
v_mfma_f32_16x16x32_bf16 v[56:59], a[224:227], a[144:147], v[24:27]
s_waitcnt lgkmcnt(2)
ds_read_b128 v[80:83], v10 offset:39168
buffer_load_dwordx4 v14, s[16:19], 0 offen lds
v_mfma_f32_16x16x32_bf16 v[52:55], a[228:231], a[132:135], v[52:55]
s_add_u32 m0, s42, 53536
ds_read_b64_tr_b16 a[242:243], v6 offset:17024
v_add_u32 v13, s6, v13
v_mfma_f32_16x16x32_bf16 v[56:59], a[228:231], a[148:151], v[56:59]
s_waitcnt lgkmcnt(3)
ds_read_b64_tr_b16 a[240:241], v6 offset:16512
v_add_u32 v12, s7, v12
v_mfma_f32_16x16x32_bf16 v[52:55], a[232:235], a[136:139], v[52:55]
ds_read_b64_tr_b16 a[246:247], v6 offset:17032
buffer_load_dwordx4 v14, s[16:19], 0 offen offset:128 lds
v_mfma_f32_16x16x32_bf16 v[56:59], a[232:235], a[152:155], v[56:59]
s_waitcnt lgkmcnt(4)
ds_read_b64_tr_b16 a[244:245], v6 offset:16520
v_add_u32 v14, 0x40000, v14
v_mfma_f32_16x16x32_bf16 v[52:55], a[236:239], a[140:143], v[52:55]
ds_read_b64_tr_b16 a[250:251], v7 offset:17024
v_mfma_f32_16x16x32_bf16 v[56:59], a[236:239], a[156:159], v[56:59]
ds_read_b64_tr_b16 a[248:249], v7 offset:16512
v_mfma_f32_16x16x32_bf16 v[32:35], v[16:19], v[64:67], v[32:35]
ds_read_b64_tr_b16 a[254:255], v7 offset:17032
v_mfma_f32_16x16x32_bf16 v[36:39], v[16:19], v[68:71], v[36:39]
s_waitcnt lgkmcnt(7)
ds_read_b64_tr_b16 a[252:253], v7 offset:16520
v_mfma_f32_16x16x32_bf16 v[40:43], v[16:19], v[80:83], v[40:43]
s_waitcnt lgkmcnt(6)
ds_read_b64_tr_b16 a[226:227], v8 offset:17024
v_mfma_f32_16x16x32_bf16 v[172:175], a[240:243], v[64:67], v[172:175]
ds_read_b64_tr_b16 a[224:225], v8 offset:16512
v_mfma_f32_16x16x32_bf16 v[176:179], a[240:243], v[68:71], v[176:179]
ds_read_b64_tr_b16 a[230:231], v8 offset:17032
v_mfma_f32_16x16x32_bf16 v[236:239], a[240:243], v[80:83], v[236:239]
s_waitcnt lgkmcnt(7)
ds_read_b64_tr_b16 a[228:229], v8 offset:16520
v_mfma_f32_16x16x32_bf16 v[180:183], a[244:247], v[64:67], v[180:183]
ds_read_b64_tr_b16 a[234:235], v9 offset:17024
v_mfma_f32_16x16x32_bf16 v[184:187], a[244:247], v[68:71], v[184:187]
ds_read_b64_tr_b16 a[232:233], v9 offset:16512
v_mfma_f32_16x16x32_bf16 v[240:243], a[244:247], v[80:83], v[240:243]
s_waitcnt lgkmcnt(8)
ds_read_b64_tr_b16 a[238:239], v9 offset:17032
v_mfma_f32_16x16x32_bf16 v[188:191], a[248:251], v[64:67], v[188:191]
ds_read_b64_tr_b16 a[236:237], v9 offset:16520
v_mfma_f32_16x16x32_bf16 v[192:195], a[248:251], v[68:71], v[192:195]
s_waitcnt lgkmcnt(8)
ds_read_b64_tr_b16 a[242:243], v6 offset:58304
v_mfma_f32_16x16x32_bf16 v[196:199], a[252:255], v[64:67], v[196:199]
ds_read_b64_tr_b16 a[240:241], v6 offset:57792
v_mfma_f32_16x16x32_bf16 v[200:203], a[252:255], v[68:71], v[200:203]
s_waitcnt lgkmcnt(8)
ds_read_b128 v[76:79], v252 offset:14336
v_mfma_f32_16x16x32_bf16 v[204:207], a[224:227], v[64:67], v[204:207]
ds_read_b64_tr_b16 a[246:247], v6 offset:58312
v_mfma_f32_16x16x32_bf16 v[208:211], a[224:227], v[68:71], v[208:211]
s_waitcnt lgkmcnt(8)
ds_read_b64_tr_b16 a[244:245], v6 offset:57800
v_mfma_f32_16x16x32_bf16 v[212:215], a[228:231], v[64:67], v[212:215]
ds_read_b64_tr_b16 a[250:251], v7 offset:58304
v_mfma_f32_16x16x32_bf16 v[216:219], a[228:231], v[68:71], v[216:219]
s_waitcnt lgkmcnt(8)
ds_read_b64_tr_b16 a[248:249], v7 offset:57792
v_mfma_f32_16x16x32_bf16 v[220:223], a[232:235], v[64:67], v[220:223]
ds_read_b64_tr_b16 a[254:255], v7 offset:58312
v_mfma_f32_16x16x32_bf16 v[224:227], a[232:235], v[68:71], v[224:227]
s_waitcnt lgkmcnt(8)
ds_read_b64_tr_b16 a[252:253], v7 offset:57800
v_mfma_f32_16x16x32_bf16 v[228:231], a[236:239], v[64:67], v[228:231]
v_exp_f32 v59, v59
v_mfma_f32_16x16x32_bf16 v[232:235], a[236:239], v[68:71], v[232:235]
s_waitcnt lgkmcnt(7)
ds_read_b64_tr_b16 a[226:227], v8 offset:58304
v_mfma_f32_16x16x32_bf16 v[100:103], a[240:243], a[60:63], v[100:103]
v_exp_f32 v58, v58
v_mfma_f32_16x16x32_bf16 v[104:107], a[240:243], a[124:127], v[104:107]
s_waitcnt lgkmcnt(7)
ds_read_b64_tr_b16 a[224:225], v8 offset:57792
v_cvt_pk_bf16_f32 v71, v58, v59
v_mfma_f32_16x16x32_bf16 v[164:167], a[240:243], v[76:79], v[164:167]
s_waitcnt lgkmcnt(6)
v_exp_f32 v57, v57
v_mfma_f32_16x16x32_bf16 v[108:111], a[244:247], a[60:63], v[108:111]
ds_read_b64_tr_b16 a[230:231], v8 offset:58312
v_mfma_f32_16x16x32_bf16 v[112:115], a[244:247], a[124:127], v[112:115]
v_exp_f32 v56, v56
v_mfma_f32_16x16x32_bf16 v[168:171], a[244:247], v[76:79], v[168:171]
s_waitcnt lgkmcnt(5)
ds_read_b64_tr_b16 a[228:229], v8 offset:57800
v_mul_f32 v165, s48, v165
v_mfma_f32_16x16x32_bf16 v[116:119], a[248:251], a[60:63], v[116:119]
ds_read_b64_tr_b16 a[234:235], v9 offset:58304
v_exp_f32 v55, v55
v_mfma_f32_16x16x32_bf16 v[120:123], a[248:251], a[124:127], v[120:123]
s_waitcnt lgkmcnt(5)
ds_read_b64_tr_b16 a[232:233], v9 offset:57792
v_mul_f32 v164, s48, v164
v_cvt_pk_bf16_f32 v164, v164, v165
v_mfma_f32_16x16x32_bf16 v[124:127], a[252:255], a[60:63], v[124:127]
ds_read_b64_tr_b16 a[238:239], v9 offset:58312
v_exp_f32 v54, v54
v_mfma_f32_16x16x32_bf16 v[128:131], a[252:255], a[124:127], v[128:131]
s_waitcnt lgkmcnt(5)
ds_read_b64_tr_b16 a[236:237], v9 offset:57800
v_mul_f32 v167, s48, v167
v_mul_f32 v166, s48, v166
v_mfma_f32_16x16x32_bf16 v[132:135], a[224:227], a[60:63], v[132:135]
v_exp_f32 v53, v53
v_cvt_pk_bf16_f32 v165, v166, v167
v_mfma_f32_16x16x32_bf16 v[136:139], a[224:227], a[124:127], v[136:139]
s_waitcnt lgkmcnt(4)
v_exp_f32 v52, v52
v_mul_f32 v171, s48, v171
v_mul_f32 v170, s48, v170
v_mfma_f32_16x16x32_bf16 v[140:143], a[228:231], a[60:63], v[140:143]
v_exp_f32 v51, v51
v_mul_f32 v169, s48, v169
v_mfma_f32_16x16x32_bf16 v[144:147], a[228:231], a[124:127], v[144:147]
s_waitcnt lgkmcnt(2)
v_mul_f32 v168, s48, v168
v_exp_f32 v50, v50
v_cvt_pk_bf16_f32 v167, v170, v171
v_mfma_f32_16x16x32_bf16 v[148:151], a[232:235], a[60:63], v[148:151]
v_exp_f32 v49, v49
v_cvt_pk_bf16_f32 v166, v168, v169
v_mfma_f32_16x16x32_bf16 v[152:155], a[232:235], a[124:127], v[152:155]
s_waitcnt lgkmcnt(0)
v_exp_f32 v48, v48
v_cvt_pk_bf16_f32 v70, v56, v57
v_mfma_f32_16x16x32_bf16 v[156:159], a[236:239], a[60:63], v[156:159]
v_exp_f32 v47, v47
v_cvt_pk_bf16_f32 v67, v54, v55
v_mfma_f32_16x16x32_bf16 v[160:163], a[236:239], a[124:127], v[160:163]
v_exp_f32 v46, v46
v_cvt_pk_bf16_f32 v66, v52, v53
v_cvt_pk_bf16_f32 v69, v50, v51
v_exp_f32 v45, v45
v_cvt_pk_bf16_f32 v68, v48, v49
v_exp_f32 v44, v44
v_cvt_pk_bf16_f32 v65, v46, v47
v_cvt_pk_bf16_f32 v64, v44, v45
ds_write_b128 v15, v[164:167] offset:33024
s_mov_b64 s[52:53], -1
v_mov_b32 v254, s75
v_mov_b32 v255, s75
s_lshl_b32 s3, s47, 12
s_add_u32 s3, s3, s56
s_add_u32 s54, s3, 16640
s_cmp_ge_u32 s47, 1
s_cselect_b32 s45, s75, s45
s_cselect_b32 s44, s75, s44
s_add_u32 s47, s47, 1
s_cmp_lt_u32 s47, 3
s_cbranch_scc1 L_round
s_add_u32 s3, s58, s59
s_lshl_b32 s3, s3, 7
s_add_u32 s3, s3, 128
s_and_b32 s44, s3, 0x3ff
s_add_u32 s3, s3, 128
s_and_b32 s45, s3, 0x3ff
s_add_u32 s3, s3, 128
s_and_b32 s47, s3, 0x3ff
s_add_u32 s3, s3, 128
s_and_b32 s71, s3, 0x3ff
s_add_u32 s3, s3, 128
s_and_b32 s65, s3, 0x3ff
s_add_u32 s3, s3, 128
s_and_b32 s66, s3, 0x3ff
s_waitcnt lgkmcnt(0) vmcnt(10)
s_barrier
v_mfma_f32_16x16x32_bf16 v[32:35], v[16:19], v[64:67], v[32:35]
s_add_u32 m0, s41, 24576
ds_read_b128 v[80:83], v10 offset:40192
ds_read_b64_tr_b16 a[224:225], v6 offset:24768
ds_read_b64_tr_b16 a[226:227], v6 offset:25280
v_mul_f32 v100, s48, v100
v_mul_f32 v101, s48, v101
v_mul_f32 v108, s48, v108
v_mul_f32 v109, s48, v109
v_mul_f32 v104, s48, v104
v_mul_f32 v105, s48, v105
v_mul_f32 v112, s48, v112
v_mul_f32 v113, s48, v113
v_mul_f32 v116, s48, v116
v_mul_f32 v117, s48, v117
v_mul_f32 v124, s48, v124
v_mul_f32 v125, s48, v125
v_mul_f32 v120, s48, v120
v_mul_f32 v121, s48, v121
v_mul_f32 v128, s48, v128
v_mul_f32 v129, s48, v129
v_mul_f32 v132, s48, v132
v_mul_f32 v133, s48, v133
v_mul_f32 v140, s48, v140
v_mul_f32 v141, s48, v141
v_mfma_f32_16x16x32_bf16 v[36:39], v[16:19], v[68:71], v[36:39]
s_waitcnt lgkmcnt(2)
ds_read_b64_tr_b16 a[228:229], v6 offset:24776
v_mul_f32 v102, s48, v102
v_mul_f32 v103, s48, v103
v_mul_f32 v110, s48, v110
v_mul_f32 v111, s48, v111
v_mul_f32 v106, s48, v106
v_mul_f32 v107, s48, v107
v_mul_f32 v114, s48, v114
v_mul_f32 v115, s48, v115
v_mul_f32 v118, s48, v118
v_mul_f32 v119, s48, v119
v_mul_f32 v126, s48, v126
v_mul_f32 v127, s48, v127
v_mul_f32 v122, s48, v122
v_mul_f32 v123, s48, v123
v_mul_f32 v130, s48, v130
v_mul_f32 v131, s48, v131
v_mul_f32 v134, s48, v134
v_mul_f32 v135, s48, v135
v_mul_f32 v142, s48, v142
v_mul_f32 v143, s48, v143
v_mul_f32 v136, s48, v136
v_mul_f32 v137, s48, v137
v_mul_f32 v144, s48, v144
v_mul_f32 v145, s48, v145
v_mul_f32 v148, s48, v148
v_mul_f32 v149, s48, v149
v_mul_f32 v156, s48, v156
v_mul_f32 v157, s48, v157
v_cvt_pk_bf16_f32 v100, v100, v101
v_cvt_pk_bf16_f32 v108, v108, v109
v_cvt_pk_bf16_f32 v104, v104, v105
v_cvt_pk_bf16_f32 v112, v112, v113
v_cvt_pk_bf16_f32 v116, v116, v117
v_cvt_pk_bf16_f32 v124, v124, v125
v_cvt_pk_bf16_f32 v120, v120, v121
v_cvt_pk_bf16_f32 v128, v128, v129
v_cvt_pk_bf16_f32 v132, v132, v133
v_cvt_pk_bf16_f32 v140, v140, v141
v_mul_f32 v138, s48, v138
v_mul_f32 v139, s48, v139
v_mul_f32 v146, s48, v146
v_mul_f32 v147, s48, v147
v_mul_f32 v150, s48, v150
v_mul_f32 v151, s48, v151
v_mul_f32 v158, s48, v158
v_mul_f32 v159, s48, v159
v_mul_f32 v160, s48, v160
v_mul_f32 v161, s48, v161
ds_read_b64_tr_b16 a[230:231], v6 offset:25288
v_cvt_pk_bf16_f32 v136, v136, v137
v_cvt_pk_bf16_f32 v144, v144, v145
v_cvt_pk_bf16_f32 v148, v148, v149
v_cvt_pk_bf16_f32 v156, v156, v157
v_cvt_pk_bf16_f32 v101, v102, v103
v_cvt_pk_bf16_f32 v109, v110, v111
v_cvt_pk_bf16_f32 v105, v106, v107
v_cvt_pk_bf16_f32 v113, v114, v115
v_cvt_pk_bf16_f32 v117, v118, v119
v_cvt_pk_bf16_f32 v125, v126, v127
v_cvt_pk_bf16_f32 v121, v122, v123
v_cvt_pk_bf16_f32 v129, v130, v131
v_cvt_pk_bf16_f32 v133, v134, v135
v_cvt_pk_bf16_f32 v141, v142, v143
v_mul_f32 v153, s48, v153
v_mfma_f32_16x16x32_bf16 v[40:43], v[16:19], v[80:83], v[40:43]
s_waitcnt lgkmcnt(2)
ds_read_b64_tr_b16 a[234:235], v7 offset:25280
buffer_load_dwordx4 v12, s[8:11], 0 offen nt lds
v_mul_f32 v152, s48, v152
v_cvt_pk_bf16_f32 v160, v160, v161
v_mfma_f32_16x16x32_bf16 v[172:175], a[224:227], v[64:67], v[172:175]
s_add_u32 m0, s41, 28544
ds_read_b64_tr_b16 a[232:233], v7 offset:24768
v_mul_f32 v163, s48, v163
v_mul_f32 v162, s48, v162
v_mfma_f32_16x16x32_bf16 v[176:179], a[224:227], v[68:71], v[176:179]
s_add_u32 s43, s43, 8192
ds_read_b64_tr_b16 a[238:239], v7 offset:25288
v_cvt_pk_bf16_f32 v137, v138, v139
v_accvgpr_write_b32 a129, v101
v_mfma_f32_16x16x32_bf16 v[236:239], a[224:227], v[80:83], v[236:239]
s_waitcnt lgkmcnt(3)
ds_read_b64_tr_b16 a[236:237], v7 offset:24776
v_accvgpr_write_b32 a128, v100
v_accvgpr_write_b32 a131, v109
v_mfma_f32_16x16x32_bf16 v[180:183], a[228:231], v[64:67], v[180:183]
s_and_b32 s43, s43, 0x1ffff
s_cselect_b32 s6, s4, s5
ds_read_b64_tr_b16 a[242:243], v8 offset:25280
buffer_load_dwordx4 v12, s[8:11], 0 offen offset:128 nt lds
v_accvgpr_write_b32 a130, v108
v_mfma_f32_16x16x32_bf16 v[184:187], a[228:231], v[68:71], v[184:187]
s_add_u32 m0, s42, 16512
ds_read_b64_tr_b16 a[240:241], v8 offset:24768
v_cvt_pk_bf16_f32 v145, v146, v147
v_accvgpr_write_b32 a145, v105
v_mfma_f32_16x16x32_bf16 v[240:243], a[228:231], v[80:83], v[240:243]
s_waitcnt lgkmcnt(4)
ds_read_b64_tr_b16 a[246:247], v8 offset:25288
v_accvgpr_write_b32 a144, v104
v_accvgpr_write_b32 a147, v113
v_mfma_f32_16x16x32_bf16 v[188:191], a[232:235], v[64:67], v[188:191]
s_add_u32 s43, s43, 8192
ds_read_b64_tr_b16 a[244:245], v8 offset:24776
v_accvgpr_write_b32 a146, v112
v_cvt_pk_bf16_f32 v157, v158, v159
v_mfma_f32_16x16x32_bf16 v[192:195], a[232:235], v[68:71], v[192:195]
s_waitcnt lgkmcnt(4)
ds_read_b64_tr_b16 a[250:251], v9 offset:25280
buffer_load_dwordx4 v13, s[12:15], 0 offen nt lds
v_accvgpr_write_b32 a133, v117
v_mfma_f32_16x16x32_bf16 v[196:199], a[236:239], v[64:67], v[196:199]
s_add_u32 m0, s42, 20512
ds_read_b64_tr_b16 a[248:249], v9 offset:24768
v_accvgpr_write_b32 a132, v116
v_accvgpr_write_b32 a135, v125
v_mfma_f32_16x16x32_bf16 v[200:203], a[236:239], v[68:71], v[200:203]
s_waitcnt lgkmcnt(4)
ds_read_b64_tr_b16 a[254:255], v9 offset:25288
v_accvgpr_write_b32 a134, v124
v_accvgpr_write_b32 a149, v121
v_mfma_f32_16x16x32_bf16 v[204:207], a[240:243], v[64:67], v[204:207]
s_mov_b32 s46, s44
ds_read_b64_tr_b16 a[252:253], v9 offset:24776
v_accvgpr_write_b32 a148, v120
v_accvgpr_write_b32 a151, v129
v_mfma_f32_16x16x32_bf16 v[208:211], a[240:243], v[68:71], v[208:211]
s_waitcnt lgkmcnt(4)
ds_read_b128 a[224:227], v0 offset:0
buffer_load_dwordx4 v13, s[12:15], 0 offen offset:128 nt lds
v_accvgpr_write_b32 a150, v128
v_mfma_f32_16x16x32_bf16 v[212:215], a[244:247], v[64:67], v[212:215]
s_mov_b32 m0, s41
ds_read_b128 a[228:231], v1 offset:0
v_cvt_pk_bf16_f32 v149, v150, v151
v_accvgpr_write_b32 a136, v132
v_mfma_f32_16x16x32_bf16 v[216:219], a[244:247], v[68:71], v[216:219]
s_waitcnt lgkmcnt(4)
ds_read_b128 a[232:235], v2 offset:0
v_accvgpr_write_b32 a137, v133
v_accvgpr_write_b32 a138, v140
v_mfma_f32_16x16x32_bf16 v[220:223], a[248:251], v[64:67], v[220:223]
s_lshr_b32 s61, s40, 1
ds_read_b128 a[236:239], v3 offset:0
v_accvgpr_write_b32 a139, v141
v_cvt_pk_bf16_f32 v152, v152, v153
v_mfma_f32_16x16x32_bf16 v[224:227], a[248:251], v[68:71], v[224:227]
s_waitcnt lgkmcnt(4)
ds_read_b128 a[240:243], v0 offset:512
v_mul_f32 v155, s48, v155
v_mul_f32 v154, s48, v154
v_mfma_f32_16x16x32_bf16 v[228:231], a[252:255], v[64:67], v[228:231]
s_lshl_b32 s61, s61, 6
ds_read_b128 a[244:247], v1 offset:512
v_cvt_pk_bf16_f32 v161, v162, v163
v_accvgpr_write_b32 a152, v136
v_mfma_f32_16x16x32_bf16 v[232:235], a[252:255], v[68:71], v[232:235]
s_waitcnt lgkmcnt(5)
ds_read_b128 a[248:251], v2 offset:512
v_accvgpr_write_b32 a153, v137
v_accvgpr_write_b32 a154, v144
v_mfma_f32_16x16x32_bf16 v[44:47], a[224:227], a[128:131], 0
s_and_b32 s62, s40, 1
ds_read_b128 a[252:255], v3 offset:512
v_accvgpr_write_b32 a155, v145
v_subrev_u32 v74, s55, v4
v_mfma_f32_16x16x32_bf16 v[48:51], a[224:227], a[144:147], 0
s_waitcnt lgkmcnt(6)
ds_read_b128 a[224:227], v74 offset:0
v_accvgpr_write_b32 a143, v157
v_accvgpr_write_b32 a142, v156
v_mfma_f32_16x16x32_bf16 v[44:47], a[228:231], a[132:135], v[44:47]
s_lshl_b32 s62, s62, 3
ds_read_b128 v[84:87], v10 offset:33024
v_accvgpr_write_b32 a141, v149
v_mfma_f32_16x16x32_bf16 v[48:51], a[228:231], a[148:151], v[48:51]
s_waitcnt lgkmcnt(7)
ds_read_b128 v[88:91], v10 offset:34048
v_accvgpr_write_b32 a140, v148
v_cvt_pk_bf16_f32 v153, v154, v155
v_mfma_f32_16x16x32_bf16 v[44:47], a[232:235], a[136:139], v[44:47]
ds_read_b128 v[92:95], v10 offset:35072
v_accvgpr_write_b32 a159, v161
v_accvgpr_write_b32 a158, v160
v_mfma_f32_16x16x32_bf16 v[48:51], a[232:235], a[152:155], v[48:51]
s_waitcnt lgkmcnt(8)
ds_read_b128 a[232:235], v74 offset:4096
v_accvgpr_write_b32 a157, v153
v_mfma_f32_16x16x32_bf16 v[44:47], a[236:239], a[140:143], v[44:47]
ds_read_b128 v[96:99], v10 offset:36096
v_accvgpr_write_b32 a156, v152
s_nop 1
v_mfma_f32_16x16x32_bf16 v[48:51], a[236:239], a[156:159], v[48:51]
s_waitcnt lgkmcnt(9)
v_subrev_u32 v75, s55, v5
ds_read_b128 a[228:231], v75 offset:0
v_mfma_f32_16x16x32_bf16 v[52:55], a[240:243], a[128:131], 0
v_rcp_f32 v248, v32
v_mfma_f32_16x16x32_bf16 v[56:59], a[240:243], a[144:147], 0
s_waitcnt lgkmcnt(9)
ds_read_b128 a[236:239], v75 offset:4096
v_mul_f32 v191, v248, v191
v_mfma_f32_16x16x32_bf16 v[52:55], a[244:247], a[132:135], v[52:55]
ds_read_b128 a[240:243], v4 offset:0
v_mul_f32 v190, v248, v190
v_mfma_f32_16x16x32_bf16 v[56:59], a[244:247], a[148:151], v[56:59]
s_waitcnt lgkmcnt(10)
ds_read_b128 a[244:247], v5 offset:0
v_mul_f32 v189, v248, v189
v_mul_f32 v188, v248, v188
v_mfma_f32_16x16x32_bf16 v[52:55], a[248:251], a[136:139], v[52:55]
v_rcp_f32 v249, v36
v_add_u32 v13, s7, v13
v_mfma_f32_16x16x32_bf16 v[56:59], a[248:251], a[152:155], v[56:59]
s_waitcnt lgkmcnt(10)
ds_read_b128 a[248:251], v4 offset:4096
v_mul_f32 v195, v249, v195
v_rcp_f32 v250, v40
v_mfma_f32_16x16x32_bf16 v[52:55], a[252:255], a[140:143], v[52:55]
s_and_b32 s43, s43, 0x1ffff
s_cselect_b32 s7, s4, s5
v_mul_f32 v194, v249, v194
v_mul_f32 v237, v250, v237
v_max3_f32 v244, v44, v45, v46
v_mfma_f32_16x16x32_bf16 v[56:59], a[252:255], a[156:159], v[56:59]
s_waitcnt lgkmcnt(9)
ds_read_b128 a[252:255], v5 offset:4096
v_mul_f32 v179, v249, v179
v_mul_f32 v193, v249, v193
v_mfma_f32_16x16x32_bf16 v[60:63], a[224:227], v[84:87], 0
s_waitcnt lgkmcnt(5)
v_mul_f32 v236, v250, v236
v_max3_f32 v244, v244, v47, v52
v_mul_f32 v178, v249, v178
v_mul_f32 v192, v249, v192
v_mfma_f32_16x16x32_bf16 v[60:63], a[228:231], v[88:91], v[60:63]
s_add_u32 s43, s43, 8192
v_max3_f32 v244, v244, v53, v54
v_max_f32 v244, v244, v55
v_mul_f32 v199, v248, v199
v_mul_f32 v177, v249, v177
v_cvt_pk_bf16_f32 v236, v236, v237
v_max3_f32 v246, v48, v49, v50
v_mov_b32 v245, v244
v_mfma_f32_16x16x32_bf16 v[60:63], a[232:235], v[92:95], v[60:63]
s_waitcnt lgkmcnt(4)
v_permlane32_swap_b32 v244, v245
v_cmp_nge_f32 vcc, s49, v40
v_mul_f32 v198, v248, v198
v_mul_f32 v176, v249, v176
v_mul_f32 v239, v250, v239
v_max_f32 v244, v244, v245
v_max3_f32 v246, v246, v51, v56
v_mov_b32 v245, v244
v_max3_f32 v246, v246, v57, v58
v_add_u32 v12, s6, v12
v_mul_f32 v197, v248, v197
v_mul_f32 v238, v250, v238
v_permlane16_swap_b32 v244, v245
s_and_b64 vcc, vcc, s[52:53]
v_max_f32 v246, v246, v59
v_mfma_f32_16x16x32_bf16 v[60:63], a[236:239], v[96:99], v[60:63]
s_waitcnt lgkmcnt(3)
v_max_f32 v244, v244, v245
s_or_b64 s[50:51], s[50:51], vcc
v_mov_b32 v247, v246
v_mul_f32 v183, v248, v183
v_mul_f32 v196, v248, v196
v_cmp_nge_f32 vcc, s49, v32
v_permlane32_swap_b32 v246, v247
v_max3_f32 v74, v60, v61, v62
v_max_f32 v74, v74, v63
v_mov_b32 v75, v74
v_cvt_pk_bf16_f32 v237, v238, v239
v_max_f32 v246, v246, v247
v_permlane32_swap_b32 v74, v75
v_max_f32 v74, v74, v75
v_mul_f32 v182, v248, v182
v_mul_f32 v203, v249, v203
v_mov_b32 v75, v74
s_nop 1
v_permlane16_swap_b32 v74, v75
v_max_f32 v74, v74, v75
s_cmp_eq_u32 s97, 2
s_cbranch_scc1 L_tm5
L_tr5:
v_sub_f32 v28, 0, v74
v_sub_f32 v29, 0, v74
v_sub_f32 v30, 0, v74
v_sub_f32 v31, 0, v74
s_nop 1
v_mfma_f32_16x16x32_bf16 v[60:63], a[240:243], v[84:87], v[28:31]
s_waitcnt lgkmcnt(2)
v_mov_b32 v247, v246
v_mul_f32 v243, v250, v243
v_mul_f32 v181, v248, v181
v_mul_f32 v202, v249, v202
s_and_b64 vcc, vcc, s[52:53]
v_permlane16_swap_b32 v246, v247
v_mul_f32 v242, v250, v242
s_or_b64 s[50:51], s[50:51], vcc
v_mfma_f32_16x16x32_bf16 v[60:63], a[244:247], v[88:91], v[60:63]
s_waitcnt lgkmcnt(1)
v_mul_f32 v180, v248, v180
v_cmp_nge_f32 vcc, s49, v36
v_max_f32 v246, v246, v247
v_mul_f32 v241, v250, v241
v_mul_f32 v187, v249, v187
v_mul_f32 v201, v249, v201
v_mfma_f32_16x16x32_bf16 v[60:63], a[248:251], v[92:95], v[60:63]
s_waitcnt lgkmcnt(0)
v_mul_f32 v175, v248, v175
v_mul_f32 v240, v250, v240
v_mul_f32 v186, v249, v186
v_mul_f32 v200, v249, v200
v_mul_f32 v174, v248, v174
s_cmp_eq_u32 s97, 2
s_cbranch_scc1 L_tm6
L_tr6:
v_mul_f32 v173, v248, v173
v_mul_f32 v185, v249, v185
v_cvt_pk_bf16_f32 v239, v242, v243
s_cmp_eq_u32 s97, 2
s_cbranch_scc1 L_tm7
L_tr7:
v_mfma_f32_16x16x32_bf16 v[60:63], a[252:255], v[96:99], v[60:63]
s_nop 7
v_exp_f32 v60, v60
v_exp_f32 v61, v61
s_nop 0
v_cvt_pk_bf16_f32 v72, v60, v61
v_exp_f32 v62, v62
v_exp_f32 v63, v63
s_nop 0
v_cvt_pk_bf16_f32 v73, v62, v63
ds_write_b64 v11, v[72:73] offset:37120
s_waitcnt lgkmcnt(0) vmcnt(12)
s_barrier
ds_read_b128 a[224:227], v0 offset:8192
ds_read_b128 a[228:231], v1 offset:8192
v_cvt_pk_bf16_f32 v101, v174, v175
v_sub_f32 v44, v44, v244
v_sub_f32 v45, v45, v244
v_sub_f32 v46, v46, v244
v_sub_f32 v47, v47, v244
v_sub_f32 v52, v52, v244
v_sub_f32 v53, v53, v244
v_sub_f32 v54, v54, v244
v_sub_f32 v55, v55, v244
v_sub_f32 v48, v48, v246
v_sub_f32 v49, v49, v246
v_sub_f32 v50, v50, v246
v_sub_f32 v51, v51, v246
v_sub_f32 v56, v56, v246
v_sub_f32 v57, v57, v246
v_sub_f32 v58, v58, v246
v_sub_f32 v59, v59, v246
v_mul_f32 v172, v248, v172
ds_read_b128 a[232:235], v2 offset:8192
v_mul_f32 v184, v249, v184
v_cvt_pk_bf16_f32 v238, v240, v241
v_exp_f32 v44, v44
v_exp_f32 v45, v45
v_exp_f32 v46, v46
v_exp_f32 v47, v47
v_exp_f32 v52, v52
v_exp_f32 v53, v53
v_exp_f32 v54, v54
v_exp_f32 v55, v55
v_exp_f32 v48, v48
v_exp_f32 v49, v49
v_exp_f32 v50, v50
v_exp_f32 v51, v51
v_exp_f32 v56, v56
v_exp_f32 v57, v57
v_exp_f32 v58, v58
v_exp_f32 v59, v59
v_cvt_pk_bf16_f32 v100, v172, v173
v_sub_f32 v20, 0, v244
v_sub_f32 v21, 0, v244
v_sub_f32 v22, 0, v244
v_sub_f32 v23, 0, v244
v_cvt_pk_bf16_f32 v64, v44, v45
v_cvt_pk_bf16_f32 v65, v46, v47
s_waitcnt lgkmcnt(2)
v_mfma_f32_16x16x32_bf16 v[44:47], a[224:227], a[128:131], v[20:23]
s_and_b64 vcc, vcc, s[52:53]
ds_read_b128 a[236:239], v3 offset:8192
v_sub_f32 v24, 0, v246
v_sub_f32 v25, 0, v246
v_sub_f32 v26, 0, v246
v_sub_f32 v27, 0, v246
v_add_u32 v15, s54, v10
v_cvt_pk_bf16_f32 v66, v52, v53
v_cvt_pk_bf16_f32 v67, v54, v55
v_cvt_pk_bf16_f32 v68, v48, v49
v_cvt_pk_bf16_f32 v69, v50, v51
v_cvt_pk_bf16_f32 v70, v56, v57
v_cvt_pk_bf16_f32 v71, v58, v59
v_mul_f32 v207, v248, v207
v_mul_f32 v206, v248, v206
v_mfma_f32_16x16x32_bf16 v[48:51], a[224:227], a[144:147], v[24:27]
s_waitcnt lgkmcnt(2)
ds_read_b128 a[240:243], v0 offset:8704
v_mul_f32 v205, v248, v205
v_mul_f32 v204, v248, v204
v_mfma_f32_16x16x32_bf16 v[44:47], a[228:231], a[132:135], v[44:47]
s_or_b64 s[50:51], s[50:51], vcc
ds_read_b128 a[244:247], v1 offset:8704
buffer_load_dwordx4 v12, s[8:11], 0 offen nt lds
v_cvt_pk_bf16_f32 v117, v178, v179
v_mfma_f32_16x16x32_bf16 v[48:51], a[228:231], a[148:151], v[48:51]
s_waitcnt lgkmcnt(3)
ds_read_b128 a[248:251], v2 offset:8704
v_cvt_pk_bf16_f32 v116, v176, v177
v_mul_f32 v211, v249, v211
v_mfma_f32_16x16x32_bf16 v[44:47], a[232:235], a[136:139], v[44:47]
s_add_u32 m0, s41, 3968
ds_read_b128 a[252:255], v3 offset:8704
v_mul_f32 v210, v249, v210
v_mul_f32 v209, v249, v209
v_mfma_f32_16x16x32_bf16 v[48:51], a[232:235], a[152:155], v[48:51]
s_waitcnt lgkmcnt(4)
ds_read_b128 v[80:83], v10 offset:37120
v_mul_f32 v208, v249, v208
v_cvt_pk_bf16_f32 v103, v182, v183
v_mfma_f32_16x16x32_bf16 v[44:47], a[236:239], a[140:143], v[44:47]
s_add_u32 s54, s54, 4096
ds_read_b64_tr_b16 a[226:227], v6 offset:512
buffer_load_dwordx4 v12, s[8:11], 0 offen offset:128 nt lds
v_cvt_pk_bf16_f32 v102, v180, v181
v_mfma_f32_16x16x32_bf16 v[48:51], a[236:239], a[156:159], v[48:51]
s_waitcnt lgkmcnt(5)
ds_read_b64_tr_b16 a[224:225], v6 offset:0
v_cvt_pk_bf16_f32 v119, v186, v187
v_cvt_pk_bf16_f32 v118, v184, v185
v_mfma_f32_16x16x32_bf16 v[52:55], a[240:243], a[128:131], v[20:23]
s_add_u32 m0, s42, 24768
ds_read_b64_tr_b16 a[230:231], v6 offset:520
v_mul_f32 v215, v248, v215
v_mul_f32 v214, v248, v214
v_mfma_f32_16x16x32_bf16 v[56:59], a[240:243], a[144:147], v[24:27]
s_waitcnt lgkmcnt(6)
ds_read_b64_tr_b16 a[228:229], v6 offset:8
v_mul_f32 v213, v248, v213
v_mul_f32 v212, v248, v212
v_mfma_f32_16x16x32_bf16 v[52:55], a[244:247], a[132:135], v[52:55]
ds_read_b64_tr_b16 a[234:235], v7 offset:512
buffer_load_dwordx4 v13, s[12:15], 0 offen nt lds
v_cvt_pk_bf16_f32 v105, v190, v191
v_mfma_f32_16x16x32_bf16 v[56:59], a[244:247], a[148:151], v[56:59]
s_waitcnt lgkmcnt(7)
ds_read_b64_tr_b16 a[232:233], v7 offset:0
v_cvt_pk_bf16_f32 v104, v188, v189
v_mul_f32 v219, v249, v219
v_mfma_f32_16x16x32_bf16 v[52:55], a[248:251], a[136:139], v[52:55]
s_add_u32 m0, s42, 28768
ds_read_b64_tr_b16 a[238:239], v7 offset:520
v_mul_f32 v218, v249, v218
v_mul_f32 v217, v249, v217
v_mfma_f32_16x16x32_bf16 v[56:59], a[248:251], a[152:155], v[56:59]
s_waitcnt lgkmcnt(8)
ds_read_b64_tr_b16 a[236:237], v7 offset:8
v_mul_f32 v216, v249, v216
v_cvt_pk_bf16_f32 v121, v194, v195
v_mfma_f32_16x16x32_bf16 v[52:55], a[252:255], a[140:143], v[52:55]
ds_read_b64_tr_b16 a[242:243], v8 offset:512
buffer_load_dwordx4 v13, s[12:15], 0 offen offset:128 nt lds
v_cvt_pk_bf16_f32 v120, v192, v193
v_mfma_f32_16x16x32_bf16 v[56:59], a[252:255], a[156:159], v[56:59]
s_add_u32 m0, s41, 8192
ds_read_b64_tr_b16 a[240:241], v8 offset:0
v_cvt_pk_bf16_f32 v107, v198, v199
v_cvt_pk_bf16_f32 v106, v196, v197
v_mfma_f32_16x16x32_bf16 v[32:35], v[16:19], v[64:67], 0
ds_read_b64_tr_b16 a[246:247], v8 offset:520
v_mul_f32 v223, v248, v223
v_mul_f32 v222, v248, v222
v_mfma_f32_16x16x32_bf16 v[36:39], v[16:19], v[68:71], 0
s_waitcnt lgkmcnt(11)
ds_read_b64_tr_b16 a[244:245], v8 offset:8
v_cvt_pk_bf16_f32 v123, v202, v203
v_cvt_pk_bf16_f32 v122, v200, v201
v_mfma_f32_16x16x32_bf16 v[40:43], v[16:19], v[80:83], 0
s_waitcnt lgkmcnt(10)
ds_read_b64_tr_b16 a[250:251], v9 offset:512
v_mul_f32 v221, v248, v221
v_mul_f32 v220, v248, v220
v_mfma_f32_16x16x32_bf16 v[172:175], a[224:227], v[64:67], 0
ds_write_b128 v15, v[236:239] offset:0
v_mfma_f32_16x16x32_bf16 v[176:179], a[224:227], v[68:71], 0
ds_read_b64_tr_b16 a[248:249], v9 offset:0
v_cvt_pk_bf16_f32 v109, v206, v207
v_cvt_pk_bf16_f32 v108, v204, v205
v_mfma_f32_16x16x32_bf16 v[236:239], a[224:227], v[80:83], 0
s_waitcnt lgkmcnt(11)
ds_read_b64_tr_b16 a[254:255], v9 offset:520
v_cvt_pk_bf16_f32 v125, v210, v211
v_cvt_pk_bf16_f32 v124, v208, v209
v_mfma_f32_16x16x32_bf16 v[180:183], a[228:231], v[64:67], 0
ds_read_b64_tr_b16 a[252:253], v9 offset:8
v_mul_f32 v227, v249, v227
v_mul_f32 v226, v249, v226
v_mfma_f32_16x16x32_bf16 v[184:187], a[228:231], v[68:71], 0
v_mul_f32 v225, v249, v225
v_mul_f32 v224, v249, v224
v_cvt_pk_bf16_f32 v111, v214, v215
v_mfma_f32_16x16x32_bf16 v[240:243], a[228:231], v[80:83], 0
s_waitcnt lgkmcnt(11)
v_cvt_pk_bf16_f32 v110, v212, v213
v_cvt_pk_bf16_f32 v127, v218, v219
v_mfma_f32_16x16x32_bf16 v[188:191], a[232:235], v[64:67], 0
v_cvt_pk_bf16_f32 v126, v216, v217
v_mul_f32 v231, v248, v231
v_mfma_f32_16x16x32_bf16 v[192:195], a[232:235], v[68:71], 0
s_waitcnt lgkmcnt(9)
v_mul_f32 v230, v248, v230
v_cvt_pk_bf16_f32 v113, v222, v223
v_mfma_f32_16x16x32_bf16 v[196:199], a[236:239], v[64:67], 0
v_cvt_pk_bf16_f32 v112, v220, v221
v_mul_f32 v229, v248, v229
v_mfma_f32_16x16x32_bf16 v[200:203], a[236:239], v[68:71], 0
s_waitcnt lgkmcnt(7)
v_mul_f32 v228, v248, v228
v_cvt_pk_bf16_f32 v129, v226, v227
v_mfma_f32_16x16x32_bf16 v[204:207], a[240:243], v[64:67], 0
v_exp_f32 v47, v47
v_mfma_f32_16x16x32_bf16 v[208:211], a[240:243], v[68:71], 0
s_waitcnt lgkmcnt(5)
v_cvt_pk_bf16_f32 v128, v224, v225
v_exp_f32 v46, v46
v_mfma_f32_16x16x32_bf16 v[212:215], a[244:247], v[64:67], 0
v_mul_f32 v235, v249, v235
v_mul_f32 v234, v249, v234
v_exp_f32 v45, v45
v_mfma_f32_16x16x32_bf16 v[216:219], a[244:247], v[68:71], 0
s_waitcnt lgkmcnt(2)
v_cvt_pk_bf16_f32 v115, v230, v231
v_cvt_pk_bf16_f32 v114, v228, v229
v_exp_f32 v44, v44
v_mfma_f32_16x16x32_bf16 v[220:223], a[248:251], v[64:67], 0
v_mul_f32 v233, v249, v233
v_exp_f32 v51, v51
v_mfma_f32_16x16x32_bf16 v[224:227], a[248:251], v[68:71], 0
s_waitcnt lgkmcnt(0)
v_mul_f32 v232, v249, v232
v_cvt_pk_bf16_f32 v131, v234, v235
v_exp_f32 v50, v50
v_mfma_f32_16x16x32_bf16 v[228:231], a[252:255], v[64:67], 0
v_cvt_pk_bf16_f32 v130, v232, v233
v_cvt_pk_bf16_f32 v65, v46, v47
v_exp_f32 v49, v49
v_mfma_f32_16x16x32_bf16 v[232:235], a[252:255], v[68:71], 0
s_waitcnt lgkmcnt(0) vmcnt(6)
s_barrier
ds_read_b128 a[224:227], v0 offset:16384
ds_read_b128 a[228:231], v1 offset:16384
ds_read_b128 a[232:235], v2 offset:16384
v_cvt_pk_bf16_f32 v64, v44, v45
s_waitcnt lgkmcnt(2)
v_mfma_f32_16x16x32_bf16 v[44:47], a[224:227], a[128:131], v[20:23]
ds_read_b128 a[236:239], v3 offset:16384
v_exp_f32 v48, v48
v_cvt_pk_bf16_f32 v69, v50, v51
v_cvt_pk_bf16_f32 v68, v48, v49
v_mfma_f32_16x16x32_bf16 v[48:51], a[224:227], a[144:147], v[24:27]
s_waitcnt lgkmcnt(2)
ds_read_b128 a[240:243], v0 offset:16896
v_exp_f32 v55, v55
v_mfma_f32_16x16x32_bf16 v[44:47], a[228:231], a[132:135], v[44:47]
v_exp_f32 v54, v54
v_add_u32 v12, s7, v12
v_mfma_f32_16x16x32_bf16 v[48:51], a[228:231], a[148:151], v[48:51]
s_waitcnt lgkmcnt(2)
ds_read_b128 a[244:247], v1 offset:16896
buffer_load_dwordx4 v12, s[8:11], 0 offen nt lds
v_exp_f32 v53, v53
v_mfma_f32_16x16x32_bf16 v[44:47], a[232:235], a[136:139], v[44:47]
s_add_u32 m0, s41, 12160
v_exp_f32 v52, v52
v_exp_f32 v59, v59
v_mfma_f32_16x16x32_bf16 v[48:51], a[232:235], a[152:155], v[48:51]
s_waitcnt lgkmcnt(2)
ds_read_b128 a[248:251], v2 offset:16896
v_exp_f32 v58, v58
v_mfma_f32_16x16x32_bf16 v[44:47], a[236:239], a[140:143], v[44:47]
ds_read_b128 a[252:255], v3 offset:16896
buffer_load_dwordx4 v12, s[8:11], 0 offen offset:128 nt lds
v_cvt_pk_bf16_f32 v67, v54, v55
v_mfma_f32_16x16x32_bf16 v[48:51], a[236:239], a[156:159], v[48:51]
s_waitcnt lgkmcnt(3)
v_exp_f32 v57, v57
v_cvt_pk_bf16_f32 v66, v52, v53
v_mfma_f32_16x16x32_bf16 v[52:55], a[240:243], a[128:131], v[20:23]
s_mov_b32 m0, s42
v_exp_f32 v56, v56
v_cvt_pk_bf16_f32 v71, v58, v59
v_cvt_pk_bf16_f32 v70, v56, v57
v_mfma_f32_16x16x32_bf16 v[56:59], a[240:243], a[144:147], v[24:27]
s_waitcnt lgkmcnt(2)
ds_read_b128 a[224:227], v4 offset:16384
v_add_u32 v13, s6, v13
v_mfma_f32_16x16x32_bf16 v[52:55], a[244:247], a[132:135], v[52:55]
s_and_b32 s43, s43, 0x1ffff
s_cselect_b32 s6, s4, s5
ds_read_b128 a[228:231], v5 offset:16384
buffer_load_dwordx4 v13, s[12:15], 0 offen nt lds
v_mfma_f32_16x16x32_bf16 v[56:59], a[244:247], a[148:151], v[56:59]
s_waitcnt lgkmcnt(3)
ds_read_b128 a[232:235], v4 offset:20480
s_add_u32 m0, s42, 4000
v_mfma_f32_16x16x32_bf16 v[52:55], a[248:251], a[136:139], v[52:55]
s_add_u32 s43, s43, 8192
ds_read_b128 a[236:239], v5 offset:20480
buffer_load_dwordx4 v13, s[12:15], 0 offen offset:128 nt lds
v_mfma_f32_16x16x32_bf16 v[56:59], a[248:251], a[152:155], v[56:59]
s_waitcnt lgkmcnt(4)
ds_read_b128 v[80:83], v10 offset:38144
s_mov_b32 m0, 148224
v_mfma_f32_16x16x32_bf16 v[52:55], a[252:255], a[140:143], v[52:55]
ds_read_b64_tr_b16 a[242:243], v6 offset:8768
v_add_u32 v12, s6, v12
v_mfma_f32_16x16x32_bf16 v[56:59], a[252:255], a[156:159], v[56:59]
s_waitcnt lgkmcnt(5)
ds_read_b64_tr_b16 a[240:241], v6 offset:8256
v_bfe_u32 v14, v13, 8, 5
v_mfma_f32_16x16x32_bf16 v[60:63], a[224:227], v[84:87], v[28:31]
s_waitcnt lgkmcnt(5)
ds_read_b64_tr_b16 a[246:247], v6 offset:8776
v_and_b32 v15, 0x7f, v13
v_mfma_f32_16x16x32_bf16 v[60:63], a[228:231], v[88:91], v[60:63]
s_waitcnt lgkmcnt(5)
ds_read_b64_tr_b16 a[244:245], v6 offset:8264
v_add_u32 v13, s7, v13
v_mfma_f32_16x16x32_bf16 v[60:63], a[232:235], v[92:95], v[60:63]
s_waitcnt lgkmcnt(5)
ds_read_b64_tr_b16 a[250:251], v7 offset:8768
v_lshl_add_u32 v14, v14, 10, v15
v_mfma_f32_16x16x32_bf16 v[60:63], a[236:239], v[96:99], v[60:63]
s_and_b32 s43, s43, 0x1ffff
s_cselect_b32 s7, s4, s5
ds_read_b64_tr_b16 a[248:249], v7 offset:8256
v_add_u32 v255, s46, v14
v_mfma_f32_16x16x32_bf16 v[32:35], v[16:19], v[64:67], v[32:35]
s_add_u32 s46, s44, 32768
ds_read_b64_tr_b16 a[254:255], v7 offset:8776
s_add_u32 s43, s43, 8192
v_mfma_f32_16x16x32_bf16 v[36:39], v[16:19], v[68:71], v[36:39]
s_waitcnt lgkmcnt(7)
ds_read_b64_tr_b16 a[252:253], v7 offset:8264
v_bfe_u32 v169, v253, 8, 1
v_mfma_f32_16x16x32_bf16 v[40:43], v[16:19], v[80:83], v[40:43]
s_waitcnt lgkmcnt(6)
ds_read_b64_tr_b16 a[226:227], v8 offset:8768
v_lshrrev_b32 v168, 9, v253
v_mfma_f32_16x16x32_bf16 v[172:175], a[240:243], v[64:67], v[172:175]
ds_read_b64_tr_b16 a[224:225], v8 offset:8256
v_mul_u32_u24 v169, 1032, v169
v_mfma_f32_16x16x32_bf16 v[176:179], a[240:243], v[68:71], v[176:179]
ds_read_b64_tr_b16 a[230:231], v8 offset:8776
v_mul_u32_u24 v168, 2064, v168
v_mfma_f32_16x16x32_bf16 v[236:239], a[240:243], v[80:83], v[236:239]
s_waitcnt lgkmcnt(7)
ds_read_b64_tr_b16 a[228:229], v8 offset:8264
v_add_u32 v168, v168, v169
v_mfma_f32_16x16x32_bf16 v[180:183], a[244:247], v[64:67], v[180:183]
ds_read_b64_tr_b16 a[234:235], v9 offset:8768
v_bfe_u32 v169, v253, 6, 2
v_mfma_f32_16x16x32_bf16 v[184:187], a[244:247], v[68:71], v[184:187]
v_exp_f32 v63, v63
v_mfma_f32_16x16x32_bf16 v[240:243], a[244:247], v[80:83], v[240:243]
s_waitcnt lgkmcnt(7)
ds_read_b64_tr_b16 a[232:233], v9 offset:8256
v_lshrrev_b32 v171, 1, v169
v_mfma_f32_16x16x32_bf16 v[188:191], a[248:251], v[64:67], v[188:191]
v_exp_f32 v62, v62
v_mfma_f32_16x16x32_bf16 v[192:195], a[248:251], v[68:71], v[192:195]
s_waitcnt lgkmcnt(6)
ds_read_b64_tr_b16 a[238:239], v9 offset:8776
v_cvt_pk_bf16_f32 v73, v62, v63
v_mfma_f32_16x16x32_bf16 v[196:199], a[252:255], v[64:67], v[196:199]
v_exp_f32 v61, v61
v_mfma_f32_16x16x32_bf16 v[200:203], a[252:255], v[68:71], v[200:203]
s_waitcnt lgkmcnt(5)
ds_read_b64_tr_b16 a[236:237], v9 offset:8264
v_exp_f32 v60, v60
v_mfma_f32_16x16x32_bf16 v[204:207], a[224:227], v[64:67], v[204:207]
v_exp_f32 v47, v47
v_mfma_f32_16x16x32_bf16 v[208:211], a[224:227], v[68:71], v[208:211]
s_waitcnt lgkmcnt(4)
buffer_load_dwordx4 v253, s[92:95], s64 offen lds
v_exp_f32 v46, v46
v_mfma_f32_16x16x32_bf16 v[212:215], a[228:231], v[64:67], v[212:215]
s_add_u32 m0, s41, 16384
v_exp_f32 v45, v45
v_mfma_f32_16x16x32_bf16 v[216:219], a[228:231], v[68:71], v[216:219]
s_waitcnt lgkmcnt(2)
v_cvt_pk_bf16_f32 v72, v60, v61
ds_write_b64 v11, v[72:73] offset:39168
v_mfma_f32_16x16x32_bf16 v[220:223], a[232:235], v[64:67], v[220:223]
v_exp_f32 v44, v44
v_exp_f32 v51, v51
v_mfma_f32_16x16x32_bf16 v[224:227], a[232:235], v[68:71], v[224:227]
s_waitcnt lgkmcnt(1)
v_exp_f32 v50, v50
v_mfma_f32_16x16x32_bf16 v[228:231], a[236:239], v[64:67], v[228:231]
v_cvt_pk_bf16_f32 v65, v46, v47
v_exp_f32 v49, v49
v_mfma_f32_16x16x32_bf16 v[232:235], a[236:239], v[68:71], v[232:235]
s_waitcnt lgkmcnt(0) vmcnt(9)
s_barrier
ds_read_b128 a[240:243], v0 offset:24576
ds_read_b128 a[244:247], v1 offset:24576
ds_read_b128 a[248:251], v2 offset:24576
v_cvt_pk_bf16_f32 v64, v44, v45
s_waitcnt lgkmcnt(2)
v_mfma_f32_16x16x32_bf16 v[44:47], a[240:243], a[128:131], v[20:23]
ds_read_b128 a[252:255], v3 offset:24576
v_exp_f32 v48, v48
v_cvt_pk_bf16_f32 v69, v50, v51
v_cvt_pk_bf16_f32 v68, v48, v49
v_mfma_f32_16x16x32_bf16 v[48:51], a[240:243], a[144:147], v[24:27]
s_waitcnt lgkmcnt(2)
ds_read_b128 a[224:227], v0 offset:25088
v_exp_f32 v55, v55
v_mfma_f32_16x16x32_bf16 v[44:47], a[244:247], a[132:135], v[44:47]
ds_read_b128 a[228:231], v1 offset:25088
buffer_load_dwordx4 v12, s[8:11], 0 offen nt lds
v_exp_f32 v54, v54
v_mfma_f32_16x16x32_bf16 v[48:51], a[244:247], a[148:151], v[48:51]
s_waitcnt lgkmcnt(3)
v_exp_f32 v53, v53
v_exp_f32 v52, v52
v_mfma_f32_16x16x32_bf16 v[44:47], a[248:251], a[136:139], v[44:47]
s_add_u32 m0, s41, 20352
v_exp_f32 v59, v59
v_mfma_f32_16x16x32_bf16 v[48:51], a[248:251], a[152:155], v[48:51]
s_waitcnt lgkmcnt(2)
ds_read_b128 a[232:235], v2 offset:25088
v_exp_f32 v58, v58
v_mfma_f32_16x16x32_bf16 v[44:47], a[252:255], a[140:143], v[44:47]
ds_read_b128 a[236:239], v3 offset:25088
buffer_load_dwordx4 v12, s[8:11], 0 offen offset:128 nt lds
v_cvt_pk_bf16_f32 v67, v54, v55
v_mfma_f32_16x16x32_bf16 v[48:51], a[252:255], a[156:159], v[48:51]
s_waitcnt lgkmcnt(3)
v_exp_f32 v57, v57
v_cvt_pk_bf16_f32 v66, v52, v53
v_mfma_f32_16x16x32_bf16 v[52:55], a[224:227], a[128:131], v[20:23]
s_add_u32 m0, s42, 8256
v_exp_f32 v56, v56
v_cvt_pk_bf16_f32 v71, v58, v59
v_cvt_pk_bf16_f32 v70, v56, v57
v_mfma_f32_16x16x32_bf16 v[56:59], a[224:227], a[144:147], v[24:27]
s_waitcnt lgkmcnt(2)
ds_read_b128 v[80:83], v10 offset:39168
buffer_load_dwordx4 v13, s[12:15], 0 offen nt lds
v_mfma_f32_16x16x32_bf16 v[52:55], a[228:231], a[132:135], v[52:55]
s_add_u32 m0, s42, 12256
ds_read_b64_tr_b16 a[242:243], v6 offset:17024
v_add_u32 v12, s7, v12
v_mfma_f32_16x16x32_bf16 v[56:59], a[228:231], a[148:151], v[56:59]
s_waitcnt lgkmcnt(3)
ds_read_b64_tr_b16 a[240:241], v6 offset:16512
v_lshlrev_b32 v171, 2, v171
v_mfma_f32_16x16x32_bf16 v[52:55], a[232:235], a[136:139], v[52:55]
ds_read_b64_tr_b16 a[246:247], v6 offset:17032
buffer_load_dwordx4 v13, s[12:15], 0 offen offset:128 nt lds
v_mfma_f32_16x16x32_bf16 v[56:59], a[232:235], a[152:155], v[56:59]
s_waitcnt lgkmcnt(4)
ds_read_b64_tr_b16 a[244:245], v6 offset:16520
s_add_u32 m0, s42, 33024
v_mfma_f32_16x16x32_bf16 v[52:55], a[236:239], a[140:143], v[52:55]
ds_read_b64_tr_b16 a[250:251], v7 offset:17024
v_add_u32 v13, s6, v13
v_mfma_f32_16x16x32_bf16 v[56:59], a[236:239], a[156:159], v[56:59]
s_and_b32 s43, s43, 0x1ffff
s_cselect_b32 s6, s4, s5
ds_read_b64_tr_b16 a[248:249], v7 offset:16512
v_bfe_u32 v170, v253, 4, 2
v_mfma_f32_16x16x32_bf16 v[32:35], v[16:19], v[64:67], v[32:35]
s_add_u32 s43, s43, 8192
ds_read_b64_tr_b16 a[254:255], v7 offset:17032
buffer_load_dwordx4 v255, s[36:39], 0 offen lds
v_mfma_f32_16x16x32_bf16 v[36:39], v[16:19], v[68:71], v[36:39]
s_waitcnt lgkmcnt(7)
ds_read_b64_tr_b16 a[252:253], v7 offset:16520
s_add_u32 m0, s42, 37152
v_mfma_f32_16x16x32_bf16 v[40:43], v[16:19], v[80:83], v[40:43]
s_waitcnt lgkmcnt(6)
ds_read_b64_tr_b16 a[226:227], v8 offset:17024
v_add_u32 v255, s46, v14
v_mfma_f32_16x16x32_bf16 v[172:175], a[240:243], v[64:67], v[172:175]
s_add_u32 s46, s44, 65536
ds_read_b64_tr_b16 a[224:225], v8 offset:16512
v_xor_b32 v170, v170, v171
v_mfma_f32_16x16x32_bf16 v[176:179], a[240:243], v[68:71], v[176:179]
ds_read_b64_tr_b16 a[230:231], v8 offset:17032
buffer_load_dwordx4 v255, s[36:39], 0 offen lds
v_mfma_f32_16x16x32_bf16 v[236:239], a[240:243], v[80:83], v[236:239]
s_waitcnt lgkmcnt(7)
ds_read_b64_tr_b16 a[228:229], v8 offset:16520
s_add_u32 m0, s42, 41280
v_mfma_f32_16x16x32_bf16 v[180:183], a[244:247], v[64:67], v[180:183]
ds_read_b64_tr_b16 a[234:235], v9 offset:17024
v_add_u32 v255, s46, v14
v_mfma_f32_16x16x32_bf16 v[184:187], a[244:247], v[68:71], v[184:187]
s_add_u32 s46, s44, 98304
ds_read_b64_tr_b16 a[232:233], v9 offset:16512
v_lshlrev_b32 v170, 4, v170
v_mfma_f32_16x16x32_bf16 v[240:243], a[244:247], v[80:83], v[240:243]
s_waitcnt lgkmcnt(8)
ds_read_b64_tr_b16 a[238:239], v9 offset:17032
buffer_load_dwordx4 v255, s[36:39], 0 offen lds
v_mfma_f32_16x16x32_bf16 v[188:191], a[248:251], v[64:67], v[188:191]
s_add_u32 m0, s42, 45408
ds_read_b64_tr_b16 a[236:237], v9 offset:16520
v_add_u32 v255, s46, v14
v_mfma_f32_16x16x32_bf16 v[192:195], a[248:251], v[68:71], v[192:195]
s_waitcnt lgkmcnt(8)
v_exp_f32 v47, v47
v_mfma_f32_16x16x32_bf16 v[196:199], a[252:255], v[64:67], v[196:199]
s_mov_b32 s46, s45
v_exp_f32 v46, v46
v_mfma_f32_16x16x32_bf16 v[200:203], a[252:255], v[68:71], v[200:203]
s_waitcnt lgkmcnt(6)
buffer_load_dwordx4 v255, s[36:39], 0 offen lds
s_add_u32 m0, s41, 24576
v_mfma_f32_16x16x32_bf16 v[204:207], a[224:227], v[64:67], v[204:207]
v_exp_f32 v45, v45
v_mfma_f32_16x16x32_bf16 v[208:211], a[224:227], v[68:71], v[208:211]
s_waitcnt lgkmcnt(4)
v_exp_f32 v44, v44
v_mfma_f32_16x16x32_bf16 v[212:215], a[228:231], v[64:67], v[212:215]
v_exp_f32 v51, v51
v_mfma_f32_16x16x32_bf16 v[216:219], a[228:231], v[68:71], v[216:219]
s_waitcnt lgkmcnt(2)
v_exp_f32 v50, v50
v_mfma_f32_16x16x32_bf16 v[220:223], a[232:235], v[64:67], v[220:223]
v_exp_f32 v49, v49
v_mfma_f32_16x16x32_bf16 v[224:227], a[232:235], v[68:71], v[224:227]
s_waitcnt lgkmcnt(0)
v_exp_f32 v48, v48
v_mfma_f32_16x16x32_bf16 v[228:231], a[236:239], v[64:67], v[228:231]
v_cvt_pk_bf16_f32 v65, v46, v47
v_cvt_pk_bf16_f32 v64, v44, v45
v_mfma_f32_16x16x32_bf16 v[232:235], a[236:239], v[68:71], v[232:235]
s_waitcnt lgkmcnt(0) vmcnt(11)
s_barrier
ds_read_b128 a[240:243], v0 offset:0
ds_read_b128 a[244:247], v1 offset:0
ds_read_b128 a[248:251], v2 offset:0
s_waitcnt lgkmcnt(2)
v_mfma_f32_16x16x32_bf16 v[44:47], a[240:243], a[128:131], v[20:23]
ds_read_b128 a[252:255], v3 offset:0
v_cvt_pk_bf16_f32 v69, v50, v51
v_cvt_pk_bf16_f32 v68, v48, v49
v_mfma_f32_16x16x32_bf16 v[48:51], a[240:243], a[144:147], v[24:27]
s_waitcnt lgkmcnt(2)
ds_read_b128 a[224:227], v0 offset:512
v_exp_f32 v55, v55
v_mfma_f32_16x16x32_bf16 v[44:47], a[244:247], a[132:135], v[44:47]
ds_read_b128 a[228:231], v1 offset:512
buffer_load_dwordx4 v12, s[8:11], 0 offen nt lds
v_exp_f32 v54, v54
v_mfma_f32_16x16x32_bf16 v[48:51], a[244:247], a[148:151], v[48:51]
s_waitcnt lgkmcnt(3)
v_exp_f32 v53, v53
v_exp_f32 v52, v52
v_mfma_f32_16x16x32_bf16 v[44:47], a[248:251], a[136:139], v[44:47]
s_add_u32 m0, s41, 28544
v_exp_f32 v59, v59
v_mfma_f32_16x16x32_bf16 v[48:51], a[248:251], a[152:155], v[48:51]
s_waitcnt lgkmcnt(2)
ds_read_b128 a[232:235], v2 offset:512
v_exp_f32 v58, v58
v_mfma_f32_16x16x32_bf16 v[44:47], a[252:255], a[140:143], v[44:47]
ds_read_b128 a[236:239], v3 offset:512
buffer_load_dwordx4 v12, s[8:11], 0 offen offset:128 nt lds
v_cvt_pk_bf16_f32 v67, v54, v55
v_mfma_f32_16x16x32_bf16 v[48:51], a[252:255], a[156:159], v[48:51]
s_waitcnt lgkmcnt(3)
v_exp_f32 v57, v57
v_cvt_pk_bf16_f32 v66, v52, v53
v_mfma_f32_16x16x32_bf16 v[52:55], a[224:227], a[128:131], v[20:23]
s_add_u32 m0, s42, 16512
v_exp_f32 v56, v56
v_cvt_pk_bf16_f32 v71, v58, v59
v_cvt_pk_bf16_f32 v70, v56, v57
v_mfma_f32_16x16x32_bf16 v[56:59], a[224:227], a[144:147], v[24:27]
s_waitcnt lgkmcnt(2)
ds_read_b128 a[240:243], v4 offset:0
buffer_load_dwordx4 v13, s[12:15], 0 offen nt lds
v_mfma_f32_16x16x32_bf16 v[52:55], a[228:231], a[132:135], v[52:55]
s_add_u32 m0, s42, 20512
ds_read_b128 a[244:247], v5 offset:0
v_add_u32 v255, s46, v14
v_mfma_f32_16x16x32_bf16 v[56:59], a[228:231], a[148:151], v[56:59]
s_waitcnt lgkmcnt(3)
ds_read_b128 a[248:251], v4 offset:4096
s_add_u32 s46, s45, 32768
v_mfma_f32_16x16x32_bf16 v[52:55], a[232:235], a[136:139], v[52:55]
ds_read_b128 a[252:255], v5 offset:4096
buffer_load_dwordx4 v13, s[12:15], 0 offen offset:128 nt lds
v_mfma_f32_16x16x32_bf16 v[56:59], a[232:235], a[152:155], v[56:59]
s_waitcnt lgkmcnt(4)
ds_read_b128 v[80:83], v10 offset:40192
s_add_u32 m0, s42, 49536
v_mfma_f32_16x16x32_bf16 v[52:55], a[236:239], a[140:143], v[52:55]
ds_read_b64_tr_b16 a[226:227], v6 offset:25280
v_add_u32 v12, s6, v12
v_mfma_f32_16x16x32_bf16 v[56:59], a[236:239], a[156:159], v[56:59]
s_waitcnt lgkmcnt(5)
ds_read_b64_tr_b16 a[224:225], v6 offset:24768
v_add_u32 v13, s7, v13
v_mfma_f32_16x16x32_bf16 v[60:63], a[240:243], v[84:87], v[28:31]
s_waitcnt lgkmcnt(5)
ds_read_b64_tr_b16 a[230:231], v6 offset:25288
buffer_load_dwordx4 v255, s[36:39], 0 offen lds
v_mfma_f32_16x16x32_bf16 v[60:63], a[244:247], v[88:91], v[60:63]
s_waitcnt lgkmcnt(5)
ds_read_b64_tr_b16 a[228:229], v6 offset:24776
s_add_u32 m0, s42, 53664
v_mfma_f32_16x16x32_bf16 v[60:63], a[248:251], v[92:95], v[60:63]
s_waitcnt lgkmcnt(5)
ds_read_b64_tr_b16 a[234:235], v7 offset:25280
v_add_u32 v255, s46, v14
v_mfma_f32_16x16x32_bf16 v[60:63], a[252:255], v[96:99], v[60:63]
s_add_u32 s46, s45, 65536
ds_read_b64_tr_b16 a[232:233], v7 offset:24768
v_lshl_add_u32 v170, v169, 7, v170
v_mfma_f32_16x16x32_bf16 v[32:35], v[16:19], v[64:67], v[32:35]
s_and_b32 s43, s43, 0x1ffff
s_cselect_b32 s7, s4, s5
ds_read_b64_tr_b16 a[238:239], v7 offset:25288
buffer_load_dwordx4 v255, s[36:39], 0 offen lds
v_mfma_f32_16x16x32_bf16 v[36:39], v[16:19], v[68:71], v[36:39]
s_waitcnt lgkmcnt(7)
ds_read_b64_tr_b16 a[236:237], v7 offset:24776
s_add_u32 m0, s42, 57792
v_mfma_f32_16x16x32_bf16 v[40:43], v[16:19], v[80:83], v[40:43]
s_waitcnt lgkmcnt(6)
ds_read_b64_tr_b16 a[242:243], v8 offset:25280
v_add_u32 v255, s46, v14
v_mfma_f32_16x16x32_bf16 v[172:175], a[224:227], v[64:67], v[172:175]
s_add_u32 s46, s45, 98304
ds_read_b64_tr_b16 a[240:241], v8 offset:24768
v_xor_b32 v170, s61, v170
v_mfma_f32_16x16x32_bf16 v[176:179], a[224:227], v[68:71], v[176:179]
s_xor_b32 s61, s40, 0
ds_read_b64_tr_b16 a[246:247], v8 offset:25288
buffer_load_dwordx4 v255, s[36:39], 0 offen lds
v_mfma_f32_16x16x32_bf16 v[236:239], a[224:227], v[80:83], v[236:239]
s_waitcnt lgkmcnt(7)
ds_read_b64_tr_b16 a[244:245], v8 offset:24776
s_add_u32 m0, s42, 61920
v_mfma_f32_16x16x32_bf16 v[180:183], a[228:231], v[64:67], v[180:183]
s_lshl_b32 s63, s61, 10
ds_read_b64_tr_b16 a[250:251], v9 offset:25280
v_add_u32 v255, s46, v14
v_mfma_f32_16x16x32_bf16 v[184:187], a[228:231], v[68:71], v[184:187]
s_mov_b32 s46, s47
v_exp_f32 v63, v63
v_mfma_f32_16x16x32_bf16 v[240:243], a[228:231], v[80:83], v[240:243]
s_waitcnt lgkmcnt(7)
ds_read_b64_tr_b16 a[248:249], v9 offset:24768
buffer_load_dwordx4 v255, s[36:39], 0 offen lds
v_mfma_f32_16x16x32_bf16 v[188:191], a[232:235], v[64:67], v[188:191]
s_mov_b32 m0, s41
v_exp_f32 v62, v62
v_mfma_f32_16x16x32_bf16 v[192:195], a[232:235], v[68:71], v[192:195]
s_waitcnt lgkmcnt(6)
ds_read_b64_tr_b16 a[254:255], v9 offset:25288
v_cvt_pk_bf16_f32 v73, v62, v63
v_mfma_f32_16x16x32_bf16 v[196:199], a[236:239], v[64:67], v[196:199]
s_mul_i32 s61, s61, 4128
v_exp_f32 v61, v61
v_mfma_f32_16x16x32_bf16 v[200:203], a[236:239], v[68:71], v[200:203]
s_waitcnt lgkmcnt(5)
ds_read_b64_tr_b16 a[252:253], v9 offset:24776
v_exp_f32 v60, v60
v_mfma_f32_16x16x32_bf16 v[204:207], a[240:243], v[64:67], v[204:207]
s_add_u32 s61, s61, s62
v_exp_f32 v47, v47
v_mfma_f32_16x16x32_bf16 v[208:211], a[240:243], v[68:71], v[208:211]
s_waitcnt lgkmcnt(4)
v_exp_f32 v46, v46
v_mfma_f32_16x16x32_bf16 v[212:215], a[244:247], v[64:67], v[212:215]
s_add_u32 s43, s43, 8192
v_exp_f32 v45, v45
v_mfma_f32_16x16x32_bf16 v[216:219], a[244:247], v[68:71], v[216:219]
s_waitcnt lgkmcnt(2)
v_cvt_pk_bf16_f32 v72, v60, v61
ds_write_b64 v11, v[72:73] offset:37120
v_mfma_f32_16x16x32_bf16 v[220:223], a[248:251], v[64:67], v[220:223]
v_exp_f32 v44, v44
v_exp_f32 v51, v51
v_mfma_f32_16x16x32_bf16 v[224:227], a[248:251], v[68:71], v[224:227]
s_waitcnt lgkmcnt(1)
v_exp_f32 v50, v50
v_mfma_f32_16x16x32_bf16 v[228:231], a[252:255], v[64:67], v[228:231]
v_cvt_pk_bf16_f32 v65, v46, v47
v_exp_f32 v49, v49
v_mfma_f32_16x16x32_bf16 v[232:235], a[252:255], v[68:71], v[232:235]
s_waitcnt lgkmcnt(0) vmcnt(8)
s_barrier
ds_read_b128 a[224:227], v0 offset:8192
ds_read_b128 a[228:231], v1 offset:8192
ds_read_b128 a[232:235], v2 offset:8192
v_cvt_pk_bf16_f32 v64, v44, v45
s_waitcnt lgkmcnt(2)
v_mfma_f32_16x16x32_bf16 v[44:47], a[224:227], a[128:131], v[20:23]
ds_read_b128 a[236:239], v3 offset:8192
v_exp_f32 v48, v48
v_cvt_pk_bf16_f32 v69, v50, v51
v_cvt_pk_bf16_f32 v68, v48, v49
v_mfma_f32_16x16x32_bf16 v[48:51], a[224:227], a[144:147], v[24:27]
s_waitcnt lgkmcnt(2)
ds_read_b128 a[240:243], v0 offset:8704
v_exp_f32 v55, v55
v_mfma_f32_16x16x32_bf16 v[44:47], a[228:231], a[132:135], v[44:47]
ds_read_b128 a[244:247], v1 offset:8704
buffer_load_dwordx4 v12, s[8:11], 0 offen nt lds
v_exp_f32 v54, v54
v_mfma_f32_16x16x32_bf16 v[48:51], a[228:231], a[148:151], v[48:51]
s_waitcnt lgkmcnt(3)
v_exp_f32 v53, v53
v_exp_f32 v52, v52
v_mfma_f32_16x16x32_bf16 v[44:47], a[232:235], a[136:139], v[44:47]
s_add_u32 m0, s41, 3968
v_exp_f32 v59, v59
v_mfma_f32_16x16x32_bf16 v[48:51], a[232:235], a[152:155], v[48:51]
s_waitcnt lgkmcnt(2)
ds_read_b128 a[248:251], v2 offset:8704
v_exp_f32 v58, v58
v_mfma_f32_16x16x32_bf16 v[44:47], a[236:239], a[140:143], v[44:47]
ds_read_b128 a[252:255], v3 offset:8704
buffer_load_dwordx4 v12, s[8:11], 0 offen offset:128 nt lds
v_cvt_pk_bf16_f32 v67, v54, v55
v_mfma_f32_16x16x32_bf16 v[48:51], a[236:239], a[156:159], v[48:51]
s_waitcnt lgkmcnt(3)
v_exp_f32 v57, v57
v_cvt_pk_bf16_f32 v66, v52, v53
v_mfma_f32_16x16x32_bf16 v[52:55], a[240:243], a[128:131], v[20:23]
s_add_u32 m0, s42, 24768
v_exp_f32 v56, v56
v_cvt_pk_bf16_f32 v71, v58, v59
v_cvt_pk_bf16_f32 v70, v56, v57
v_mfma_f32_16x16x32_bf16 v[56:59], a[240:243], a[144:147], v[24:27]
s_waitcnt lgkmcnt(2)
ds_read_b128 v[80:83], v10 offset:37120
buffer_load_dwordx4 v13, s[12:15], 0 offen nt lds
v_mfma_f32_16x16x32_bf16 v[52:55], a[244:247], a[132:135], v[52:55]
s_add_u32 m0, s42, 28768
ds_read_b64_tr_b16 a[226:227], v6 offset:512
v_add_u32 v255, s46, v14
v_mfma_f32_16x16x32_bf16 v[56:59], a[244:247], a[148:151], v[56:59]
s_waitcnt lgkmcnt(3)
ds_read_b64_tr_b16 a[224:225], v6 offset:0
s_add_u32 s46, s47, 32768
v_mfma_f32_16x16x32_bf16 v[52:55], a[248:251], a[136:139], v[52:55]
ds_read_b64_tr_b16 a[230:231], v6 offset:520
buffer_load_dwordx4 v13, s[12:15], 0 offen offset:128 nt lds
v_mfma_f32_16x16x32_bf16 v[56:59], a[248:251], a[152:155], v[56:59]
s_waitcnt lgkmcnt(4)
ds_read_b64_tr_b16 a[228:229], v6 offset:8
s_add_u32 m0, s42, 66048
v_mfma_f32_16x16x32_bf16 v[52:55], a[252:255], a[140:143], v[52:55]
ds_read_b64_tr_b16 a[234:235], v7 offset:512
v_xor_b32 v171, 64, v170
v_mfma_f32_16x16x32_bf16 v[56:59], a[252:255], a[156:159], v[56:59]
ds_read_b64_tr_b16 a[232:233], v7 offset:0
v_add_u32 v168, 65792, v168
v_mfma_f32_16x16x32_bf16 v[32:35], v[16:19], v[64:67], v[32:35]
ds_read_b64_tr_b16 a[238:239], v7 offset:520
buffer_load_dwordx4 v255, s[36:39], 0 offen lds
v_mfma_f32_16x16x32_bf16 v[36:39], v[16:19], v[68:71], v[36:39]
s_waitcnt lgkmcnt(7)
ds_read_b64_tr_b16 a[236:237], v7 offset:8
v_add_u32 v255, s46, v14
v_mfma_f32_16x16x32_bf16 v[40:43], v[16:19], v[80:83], v[40:43]
s_waitcnt lgkmcnt(6)
ds_read_b64_tr_b16 a[242:243], v8 offset:512
s_add_u32 m0, s42, 70176
v_mfma_f32_16x16x32_bf16 v[172:175], a[224:227], v[64:67], v[172:175]
s_add_u32 s46, s47, 65536
ds_read_b64_tr_b16 a[240:241], v8 offset:0
v_add_u32 v170, v170, v168
v_mfma_f32_16x16x32_bf16 v[176:179], a[224:227], v[68:71], v[176:179]
ds_read_b64_tr_b16 a[246:247], v8 offset:520
buffer_load_dwordx4 v255, s[36:39], 0 offen lds
v_mfma_f32_16x16x32_bf16 v[236:239], a[224:227], v[80:83], v[236:239]
s_waitcnt lgkmcnt(7)
ds_read_b64_tr_b16 a[244:245], v8 offset:8
v_add_u32 v255, s46, v14
v_mfma_f32_16x16x32_bf16 v[180:183], a[228:231], v[64:67], v[180:183]
s_add_u32 m0, s42, 74304
ds_read_b64_tr_b16 a[250:251], v9 offset:512
v_add_u32 v132, s61, v170
v_mfma_f32_16x16x32_bf16 v[184:187], a[228:231], v[68:71], v[184:187]
s_add_u32 s46, s47, 98304
ds_read_b64_tr_b16 a[248:249], v9 offset:0
v_add_u32 v164, s63, v10
v_mfma_f32_16x16x32_bf16 v[240:243], a[228:231], v[80:83], v[240:243]
s_waitcnt lgkmcnt(8)
ds_read_b64_tr_b16 a[254:255], v9 offset:520
buffer_load_dwordx4 v255, s[36:39], 0 offen lds
v_mfma_f32_16x16x32_bf16 v[188:191], a[232:235], v[64:67], v[188:191]
s_add_u32 m0, s42, 78432
ds_read_b64_tr_b16 a[252:253], v9 offset:8
v_add_u32 v255, s46, v14
v_mfma_f32_16x16x32_bf16 v[192:195], a[232:235], v[68:71], v[192:195]
s_waitcnt lgkmcnt(8)
ds_read_b64_tr_b16 a[226:227], v132 offset:512
v_add_u32 v171, v171, v168
v_mfma_f32_16x16x32_bf16 v[196:199], a[236:239], v[64:67], v[196:199]
s_mov_b32 s46, s71
ds_read_b64_tr_b16 a[224:225], v132 offset:0
v_add_u32 v134, s61, v171
v_mfma_f32_16x16x32_bf16 v[200:203], a[236:239], v[68:71], v[200:203]
s_waitcnt lgkmcnt(8)
ds_read_b128 v[76:79], v164 offset:16640
buffer_load_dwordx4 v255, s[36:39], 0 offen lds
v_mfma_f32_16x16x32_bf16 v[204:207], a[240:243], v[64:67], v[204:207]
s_xor_b32 s61, s61, 8
ds_read_b64_tr_b16 a[234:235], v134 offset:512
v_add_u32 v133, s61, v170
v_mfma_f32_16x16x32_bf16 v[208:211], a[240:243], v[68:71], v[208:211]
s_waitcnt lgkmcnt(8)
ds_read_b64_tr_b16 a[230:231], v133 offset:512
v_add_u32 v135, s61, v171
v_mfma_f32_16x16x32_bf16 v[212:215], a[244:247], v[64:67], v[212:215]
s_xor_b32 s61, s40, 1
ds_read_b64_tr_b16 a[228:229], v133 offset:0
s_lshl_b32 s63, s61, 10
v_mfma_f32_16x16x32_bf16 v[216:219], a[244:247], v[68:71], v[216:219]
s_waitcnt lgkmcnt(8)
ds_read_b64_tr_b16 a[232:233], v134 offset:0
s_mul_i32 s61, s61, 4128
v_mfma_f32_16x16x32_bf16 v[220:223], a[248:251], v[64:67], v[220:223]
s_add_u32 s61, s61, s62
ds_read_b64_tr_b16 a[238:239], v135 offset:512
v_add_u32 v136, s61, v170
v_mfma_f32_16x16x32_bf16 v[224:227], a[248:251], v[68:71], v[224:227]
s_waitcnt lgkmcnt(8)
ds_read_b64_tr_b16 a[236:237], v135 offset:0
v_add_u32 v165, s63, v10
v_mfma_f32_16x16x32_bf16 v[228:231], a[252:255], v[64:67], v[228:231]
s_add_u32 m0, s41, 8192
ds_read_b64_tr_b16 a[242:243], v136 offset:512
v_add_u32 v138, s61, v171
v_mfma_f32_16x16x32_bf16 v[232:235], a[252:255], v[68:71], v[232:235]
s_waitcnt lgkmcnt(8)
ds_read_b64_tr_b16 a[240:241], v136 offset:0
s_xor_b32 s61, s61, 8
v_mfma_f32_16x16x32_bf16 a[0:3], a[224:227], a[160:163], 0
ds_read_b64_tr_b16 a[250:251], v138 offset:512
v_add_u32 v137, s61, v170
v_mfma_f32_16x16x32_bf16 a[4:7], a[224:227], a[176:179], 0
s_waitcnt lgkmcnt(9)
ds_read_b64_tr_b16 a[246:247], v137 offset:512
v_add_u32 v139, s61, v171
v_mfma_f32_16x16x32_bf16 v[148:151], a[224:227], v[76:79], 0
s_waitcnt lgkmcnt(7)
ds_read_b128 v[76:79], v165 offset:16640
s_xor_b32 s61, s40, 2
v_mfma_f32_16x16x32_bf16 a[8:11], a[228:231], a[160:163], 0
s_lshl_b32 s63, s61, 10
ds_read_b64_tr_b16 a[244:245], v137 offset:0
s_mul_i32 s61, s61, 4128
v_mfma_f32_16x16x32_bf16 a[12:15], a[228:231], a[176:179], 0
s_waitcnt lgkmcnt(8)
ds_read_b64_tr_b16 a[248:249], v138 offset:0
s_add_u32 s61, s61, s62
v_mfma_f32_16x16x32_bf16 a[16:19], a[232:235], a[160:163], 0
ds_read_b64_tr_b16 a[254:255], v139 offset:512
v_add_u32 v142, s61, v171
v_mfma_f32_16x16x32_bf16 a[20:23], a[232:235], a[176:179], 0
s_waitcnt lgkmcnt(8)
ds_read_b64_tr_b16 a[252:253], v139 offset:0
v_add_u32 v140, s61, v170
v_mfma_f32_16x16x32_bf16 a[24:27], a[236:239], a[160:163], 0
s_xor_b32 s61, s61, 8
ds_read_b64_tr_b16 a[226:227], v140 offset:512
v_add_u32 v141, s61, v170
ds_read_b64_tr_b16 a[230:231], v141 offset:512
v_mfma_f32_16x16x32_bf16 a[28:31], a[236:239], a[176:179], 0
s_waitcnt lgkmcnt(9)
ds_read_b64_tr_b16 a[228:229], v141 offset:0
v_add_u32 v166, s63, v10
v_mfma_f32_16x16x32_bf16 a[0:3], a[240:243], a[164:167], a[0:3]
ds_read_b64_tr_b16 a[234:235], v142 offset:512
v_add_u32 v143, s61, v171
v_mfma_f32_16x16x32_bf16 a[4:7], a[240:243], a[180:183], a[4:7]
s_waitcnt lgkmcnt(8)
ds_read_b64_tr_b16 a[224:225], v140 offset:0
ds_read_b64_tr_b16 a[232:233], v142 offset:0
v_mfma_f32_16x16x32_bf16 v[148:151], a[240:243], v[76:79], v[148:151]
s_waitcnt lgkmcnt(9)
ds_read_b128 v[76:79], v166 offset:16640
ds_read_b64_tr_b16 a[238:239], v143 offset:512
v_mfma_f32_16x16x32_bf16 a[8:11], a[244:247], a[164:167], a[8:11]
s_xor_b32 s61, s40, 3
ds_read_b64_tr_b16 a[236:237], v143 offset:0
s_lshl_b32 s63, s61, 10
s_mul_i32 s61, s61, 4128
v_mfma_f32_16x16x32_bf16 a[12:15], a[244:247], a[180:183], a[12:15]
s_waitcnt lgkmcnt(11)
s_add_u32 s61, s61, s62
v_add_u32 v144, s61, v170
ds_read_b64_tr_b16 a[242:243], v144 offset:512
v_mfma_f32_16x16x32_bf16 a[16:19], a[248:251], a[164:167], a[16:19]
s_lshl_b32 s62, s40, 2
ds_read_b64_tr_b16 a[240:241], v144 offset:0
v_add_u32 v146, s61, v171
v_mfma_f32_16x16x32_bf16 a[20:23], a[248:251], a[180:183], a[20:23]
s_waitcnt lgkmcnt(11)
ds_read_b64_tr_b16 a[250:251], v146 offset:512
s_xor_b32 s61, s61, 8
v_add_u32 v145, s61, v170
v_mfma_f32_16x16x32_bf16 a[24:27], a[252:255], a[164:167], a[24:27]
s_add_u32 s62, s62, 161536
ds_read_b64_tr_b16 a[246:247], v145 offset:512
ds_read_b64_tr_b16 a[244:245], v145 offset:0
v_mfma_f32_16x16x32_bf16 a[28:31], a[252:255], a[180:183], a[28:31]
s_waitcnt lgkmcnt(9)
ds_read_b64_tr_b16 a[248:249], v146 offset:0
v_add_u32 v147, s61, v171
v_mfma_f32_16x16x32_bf16 a[0:3], a[224:227], a[168:171], a[0:3]
ds_read_b64_tr_b16 a[254:255], v147 offset:512
v_add_u32 v167, s63, v10
v_mfma_f32_16x16x32_bf16 a[4:7], a[224:227], a[184:187], a[4:7]
s_waitcnt lgkmcnt(9)
ds_read_b64_tr_b16 a[252:253], v147 offset:0
v_add_u32 v12, s7, v12
v_mfma_f32_16x16x32_bf16 v[148:151], a[224:227], v[76:79], v[148:151]
ds_read_b128 v[76:79], v167 offset:16640
v_add_u32 v13, s6, v13
v_mfma_f32_16x16x32_bf16 a[8:11], a[228:231], a[168:171], a[8:11]
s_and_b32 s43, s43, 0x1ffff
s_cselect_b32 s6, s4, s5
v_exp_f32 v47, v47
v_mfma_f32_16x16x32_bf16 a[12:15], a[228:231], a[184:187], a[12:15]
s_add_u32 s43, s43, 8192
v_exp_f32 v46, v46
v_mfma_f32_16x16x32_bf16 a[16:19], a[232:235], a[168:171], a[16:19]
v_exp_f32 v45, v45
v_mfma_f32_16x16x32_bf16 a[20:23], a[232:235], a[184:187], a[20:23]
s_waitcnt lgkmcnt(9)
v_exp_f32 v44, v44
v_mfma_f32_16x16x32_bf16 a[24:27], a[236:239], a[168:171], a[24:27]
v_exp_f32 v51, v51
v_mfma_f32_16x16x32_bf16 a[28:31], a[236:239], a[184:187], a[28:31]
s_waitcnt lgkmcnt(7)
s_waitcnt lgkmcnt(0) vmcnt(8)
s_barrier
ds_read_b128 a[224:227], v0 offset:16384
v_cvt_pk_bf16_f32 v65, v46, v47
v_mfma_f32_16x16x32_bf16 a[0:3], a[240:243], a[172:175], a[0:3]
ds_read_b128 a[228:231], v1 offset:16384
buffer_load_dwordx4 v12, s[8:11], 0 offen nt lds
v_mfma_f32_16x16x32_bf16 a[4:7], a[240:243], a[188:191], a[4:7]
s_add_u32 m0, s41, 12160
ds_read_b128 a[232:235], v2 offset:16384
v_cvt_pk_bf16_f32 v64, v44, v45
v_mfma_f32_16x16x32_bf16 v[148:151], a[240:243], v[76:79], v[148:151]
v_exp_f32 v50, v50
v_mfma_f32_16x16x32_bf16 a[8:11], a[244:247], a[172:175], a[8:11]
v_exp_f32 v49, v49
v_mfma_f32_16x16x32_bf16 a[12:15], a[244:247], a[188:191], a[12:15]
ds_read_b128 a[236:239], v3 offset:16384
buffer_load_dwordx4 v12, s[8:11], 0 offen offset:128 nt lds
v_mfma_f32_16x16x32_bf16 a[16:19], a[248:251], a[172:175], a[16:19]
s_mov_b32 m0, s42
v_exp_f32 v48, v48
v_mfma_f32_16x16x32_bf16 a[20:23], a[248:251], a[188:191], a[20:23]
ds_read_b128 a[240:243], v0 offset:16896
v_cvt_pk_bf16_f32 v69, v50, v51
v_mfma_f32_16x16x32_bf16 a[24:27], a[252:255], a[172:175], a[24:27]
ds_read_b128 a[244:247], v1 offset:16896
v_cvt_pk_bf16_f32 v68, v48, v49
v_mfma_f32_16x16x32_bf16 a[28:31], a[252:255], a[188:191], a[28:31]
s_waitcnt lgkmcnt(5)
v_exp_f32 v55, v55
v_mfma_f32_16x16x32_bf16 v[44:47], a[224:227], a[128:131], v[20:23]
ds_read_b128 a[248:251], v2 offset:16896
buffer_load_dwordx4 v13, s[12:15], 0 offen nt lds
v_mfma_f32_16x16x32_bf16 v[48:51], a[224:227], a[144:147], v[24:27]
s_waitcnt lgkmcnt(5)
v_exp_f32 v54, v54
v_mfma_f32_16x16x32_bf16 v[44:47], a[228:231], a[132:135], v[44:47]
s_add_u32 m0, s42, 4000
v_exp_f32 v53, v53
v_mfma_f32_16x16x32_bf16 v[48:51], a[228:231], a[148:151], v[48:51]
s_waitcnt lgkmcnt(4)
v_exp_f32 v52, v52
v_mfma_f32_16x16x32_bf16 v[44:47], a[232:235], a[136:139], v[44:47]
v_exp_f32 v59, v59
v_mfma_f32_16x16x32_bf16 v[48:51], a[232:235], a[152:155], v[48:51]
s_waitcnt lgkmcnt(3)
ds_read_b128 a[252:255], v3 offset:16896
buffer_load_dwordx4 v13, s[12:15], 0 offen offset:128 nt lds
v_exp_f32 v58, v58
v_mfma_f32_16x16x32_bf16 v[44:47], a[236:239], a[140:143], v[44:47]
s_add_u32 m0, s42, 33024
ds_read_b128 a[224:227], v4 offset:16384
v_cvt_pk_bf16_f32 v67, v54, v55
v_exp_f32 v57, v57
v_mfma_f32_16x16x32_bf16 v[48:51], a[236:239], a[156:159], v[48:51]
s_waitcnt lgkmcnt(4)
ds_read_b128 a[228:231], v5 offset:16384
v_cvt_pk_bf16_f32 v66, v52, v53
v_exp_f32 v56, v56
v_mfma_f32_16x16x32_bf16 v[52:55], a[240:243], a[128:131], v[20:23]
ds_read_b128 a[232:235], v4 offset:20480
v_cvt_pk_bf16_f32 v71, v58, v59
v_cvt_pk_bf16_f32 v70, v56, v57
v_mfma_f32_16x16x32_bf16 v[56:59], a[240:243], a[144:147], v[24:27]
s_waitcnt lgkmcnt(5)
ds_read_b128 a[236:239], v5 offset:20480
v_add_u32 v255, s46, v14
buffer_load_dwordx4 v255, s[36:39], 0 offen lds
v_mfma_f32_16x16x32_bf16 v[52:55], a[244:247], a[132:135], v[52:55]
s_add_u32 s46, s71, 32768
ds_read_b128 v[80:83], v10 offset:38144
s_add_u32 m0, s42, 37152
v_mfma_f32_16x16x32_bf16 v[56:59], a[244:247], a[148:151], v[56:59]
s_waitcnt lgkmcnt(6)
ds_read_b64_tr_b16 a[242:243], v6 offset:8768
v_add_u32 v255, s46, v14
v_mfma_f32_16x16x32_bf16 v[52:55], a[248:251], a[136:139], v[52:55]
s_add_u32 s46, s71, 65536
ds_read_b64_tr_b16 a[240:241], v6 offset:8256
buffer_load_dwordx4 v255, s[36:39], 0 offen lds
v_mfma_f32_16x16x32_bf16 v[56:59], a[248:251], a[152:155], v[56:59]
s_waitcnt lgkmcnt(7)
ds_read_b64_tr_b16 a[246:247], v6 offset:8776
s_add_u32 m0, s42, 41280
v_mfma_f32_16x16x32_bf16 v[52:55], a[252:255], a[140:143], v[52:55]
ds_read_b64_tr_b16 a[244:245], v6 offset:8264
v_add_u32 v255, s46, v14
v_mfma_f32_16x16x32_bf16 v[56:59], a[252:255], a[156:159], v[56:59]
s_waitcnt lgkmcnt(8)
ds_read_b64_tr_b16 a[250:251], v7 offset:8768
buffer_load_dwordx4 v255, s[36:39], 0 offen lds
v_mfma_f32_16x16x32_bf16 v[60:63], a[224:227], v[84:87], v[28:31]
s_waitcnt lgkmcnt(8)
ds_read_b64_tr_b16 a[248:249], v7 offset:8256
s_add_u32 s46, s71, 98304
v_mfma_f32_16x16x32_bf16 v[60:63], a[228:231], v[88:91], v[60:63]
s_waitcnt lgkmcnt(8)
ds_read_b64_tr_b16 a[254:255], v7 offset:8776
s_add_u32 m0, s42, 45408
v_mfma_f32_16x16x32_bf16 v[60:63], a[232:235], v[92:95], v[60:63]
s_waitcnt lgkmcnt(8)
ds_read_b64_tr_b16 a[252:253], v7 offset:8264
v_add_u32 v255, s46, v14
v_mfma_f32_16x16x32_bf16 v[60:63], a[236:239], v[96:99], v[60:63]
s_add_u32 s46, s44, 131072
ds_read_b64_tr_b16 a[226:227], v8 offset:8768
buffer_load_dwordx4 v255, s[36:39], 0 offen lds
v_mfma_f32_16x16x32_bf16 v[32:35], v[16:19], v[64:67], v[32:35]
s_add_u32 m0, s41, 16384
ds_read_b64_tr_b16 a[224:225], v8 offset:8256
v_add_u32 v12, s6, v12
v_mfma_f32_16x16x32_bf16 v[36:39], v[16:19], v[68:71], v[36:39]
s_waitcnt lgkmcnt(10)
ds_read_b64_tr_b16 a[230:231], v8 offset:8776
v_add_u32 v13, s7, v13
v_mfma_f32_16x16x32_bf16 v[40:43], v[16:19], v[80:83], v[40:43]
s_waitcnt lgkmcnt(9)
ds_read_b64_tr_b16 a[228:229], v8 offset:8264
v_add_u32 v255, s46, v14
v_mfma_f32_16x16x32_bf16 v[172:175], a[240:243], v[64:67], v[172:175]
s_add_u32 s46, s44, 163840
ds_read_b64_tr_b16 a[234:235], v9 offset:8768
v_mov_b32 v75, s62
v_mfma_f32_16x16x32_bf16 v[176:179], a[240:243], v[68:71], v[176:179]
s_and_b32 s43, s43, 0x1ffff
s_cselect_b32 s7, s4, s5
ds_read_b64_tr_b16 a[232:233], v9 offset:8256
s_add_u32 s43, s43, 8192
v_mfma_f32_16x16x32_bf16 v[236:239], a[240:243], v[80:83], v[236:239]
s_waitcnt lgkmcnt(10)
ds_read_b64_tr_b16 a[238:239], v9 offset:8776
v_add_u32 v15, s54, v10
v_mfma_f32_16x16x32_bf16 v[180:183], a[244:247], v[64:67], v[180:183]
ds_read_b64_tr_b16 a[236:237], v9 offset:8264
v_mfma_f32_16x16x32_bf16 v[184:187], a[244:247], v[68:71], v[184:187]
ds_read_b64_tr_b16 a[242:243], v132 offset:17024
v_mfma_f32_16x16x32_bf16 v[240:243], a[244:247], v[80:83], v[240:243]
s_waitcnt lgkmcnt(11)
ds_read_b64_tr_b16 a[240:241], v132 offset:16512
v_mfma_f32_16x16x32_bf16 v[188:191], a[248:251], v[64:67], v[188:191]
ds_read_b128 v[76:79], v164 offset:16640
v_mfma_f32_16x16x32_bf16 v[192:195], a[248:251], v[68:71], v[192:195]
s_waitcnt lgkmcnt(11)
ds_read_b64_tr_b16 a[246:247], v133 offset:17024
v_mfma_f32_16x16x32_bf16 v[196:199], a[252:255], v[64:67], v[196:199]
ds_read_b64_tr_b16 a[244:245], v133 offset:16512
v_mfma_f32_16x16x32_bf16 v[200:203], a[252:255], v[68:71], v[200:203]
s_waitcnt lgkmcnt(11)
ds_read_b64_tr_b16 a[250:251], v134 offset:17024
v_mfma_f32_16x16x32_bf16 v[204:207], a[224:227], v[64:67], v[204:207]
ds_read_b64_tr_b16 a[248:249], v134 offset:16512
v_mfma_f32_16x16x32_bf16 v[208:211], a[224:227], v[68:71], v[208:211]
s_waitcnt lgkmcnt(11)
ds_read_b64_tr_b16 a[254:255], v135 offset:17024
v_mfma_f32_16x16x32_bf16 v[212:215], a[228:231], v[64:67], v[212:215]
ds_read_b64_tr_b16 a[252:253], v135 offset:16512
v_mfma_f32_16x16x32_bf16 v[216:219], a[228:231], v[68:71], v[216:219]
s_waitcnt lgkmcnt(11)
ds_read_b64_tr_b16 a[226:227], v136 offset:17024
v_mfma_f32_16x16x32_bf16 v[220:223], a[232:235], v[64:67], v[220:223]
ds_read_b64_tr_b16 a[224:225], v136 offset:16512
v_mfma_f32_16x16x32_bf16 v[224:227], a[232:235], v[68:71], v[224:227]
s_waitcnt lgkmcnt(11)
ds_read_b64_tr_b16 a[230:231], v137 offset:17024
v_mfma_f32_16x16x32_bf16 v[228:231], a[236:239], v[64:67], v[228:231]
ds_read_b64_tr_b16 a[228:229], v137 offset:16512
v_mfma_f32_16x16x32_bf16 v[232:235], a[236:239], v[68:71], v[232:235]
s_waitcnt lgkmcnt(11)
ds_read_b64_tr_b16 a[234:235], v138 offset:17024
v_mfma_f32_16x16x32_bf16 a[32:35], a[240:243], a[160:163], 0
ds_read_b64_tr_b16 a[232:233], v138 offset:16512
v_mfma_f32_16x16x32_bf16 a[36:39], a[240:243], a[176:179], 0
s_waitcnt lgkmcnt(12)
ds_read_b64_tr_b16 a[238:239], v139 offset:17024
v_mfma_f32_16x16x32_bf16 v[152:155], a[240:243], v[76:79], 0
s_waitcnt lgkmcnt(11)
ds_read_b128 v[76:79], v165 offset:16640
v_mfma_f32_16x16x32_bf16 a[40:43], a[244:247], a[160:163], 0
ds_read_b64_tr_b16 a[236:237], v139 offset:16512
v_mfma_f32_16x16x32_bf16 a[44:47], a[244:247], a[176:179], 0
s_waitcnt lgkmcnt(11)
ds_read_b64_tr_b16 a[246:247], v141 offset:17024
v_mfma_f32_16x16x32_bf16 a[48:51], a[248:251], a[160:163], 0
ds_read_b64_tr_b16 a[244:245], v141 offset:16512
v_mfma_f32_16x16x32_bf16 a[52:55], a[248:251], a[176:179], 0
s_waitcnt lgkmcnt(11)
ds_read_b64_tr_b16 a[242:243], v140 offset:17024
v_mfma_f32_16x16x32_bf16 a[56:59], a[252:255], a[160:163], 0
ds_read_b64_tr_b16 a[250:251], v142 offset:17024
v_mfma_f32_16x16x32_bf16 a[60:63], a[252:255], a[176:179], 0
s_waitcnt lgkmcnt(11)
ds_read_b64_tr_b16 a[240:241], v140 offset:16512
v_mfma_f32_16x16x32_bf16 a[32:35], a[224:227], a[164:167], a[32:35]
ds_read_b64_tr_b16 a[248:249], v142 offset:16512
v_mfma_f32_16x16x32_bf16 a[36:39], a[224:227], a[180:183], a[36:39]
s_waitcnt lgkmcnt(7)
ds_read_b64_tr_b16 a[254:255], v143 offset:17024
v_mfma_f32_16x16x32_bf16 v[152:155], a[224:227], v[76:79], v[152:155]
ds_read_b128 v[76:79], v166 offset:16640
v_mfma_f32_16x16x32_bf16 a[40:43], a[228:231], a[164:167], a[40:43]
ds_read_b64_tr_b16 a[252:253], v143 offset:16512
v_mfma_f32_16x16x32_bf16 a[44:47], a[228:231], a[180:183], a[44:47]
ds_read_b64_tr_b16 a[226:227], v144 offset:17024
v_mfma_f32_16x16x32_bf16 a[48:51], a[232:235], a[164:167], a[48:51]
ds_read_b64_tr_b16 a[224:225], v144 offset:16512
v_mfma_f32_16x16x32_bf16 a[52:55], a[232:235], a[180:183], a[52:55]
s_waitcnt lgkmcnt(11)
ds_read_b64_tr_b16 a[230:231], v145 offset:17024
v_mfma_f32_16x16x32_bf16 a[56:59], a[236:239], a[164:167], a[56:59]
ds_read_b64_tr_b16 a[228:229], v145 offset:16512
v_mfma_f32_16x16x32_bf16 a[60:63], a[236:239], a[180:183], a[60:63]
s_waitcnt lgkmcnt(8)
ds_read_b64_tr_b16 a[234:235], v146 offset:17024
v_mfma_f32_16x16x32_bf16 a[32:35], a[240:243], a[168:171], a[32:35]
ds_read_b64_tr_b16 a[232:233], v146 offset:16512
v_exp_f32 v63, v63
v_mfma_f32_16x16x32_bf16 a[36:39], a[240:243], a[184:187], a[36:39]
s_waitcnt lgkmcnt(7)
ds_read_b64_tr_b16 a[238:239], v147 offset:17024
v_exp_f32 v62, v62
v_mfma_f32_16x16x32_bf16 v[152:155], a[240:243], v[76:79], v[152:155]
ds_read_b64_tr_b16 a[236:237], v147 offset:16512
v_exp_f32 v61, v61
v_mfma_f32_16x16x32_bf16 a[40:43], a[244:247], a[168:171], a[40:43]
ds_read_b128 v[76:79], v167 offset:16640
v_exp_f32 v60, v60
v_mfma_f32_16x16x32_bf16 a[44:47], a[244:247], a[184:187], a[44:47]
v_cvt_pk_bf16_f32 v73, v62, v63
v_cvt_pk_bf16_f32 v72, v60, v61
ds_write_b64 v11, v[72:73] offset:39168
v_mfma_f32_16x16x32_bf16 a[48:51], a[248:251], a[168:171], a[48:51]
v_exp_f32 v47, v47
v_mfma_f32_16x16x32_bf16 a[52:55], a[248:251], a[184:187], a[52:55]
s_waitcnt lgkmcnt(10)
v_exp_f32 v46, v46
v_mfma_f32_16x16x32_bf16 a[56:59], a[252:255], a[168:171], a[56:59]
v_exp_f32 v45, v45
v_mfma_f32_16x16x32_bf16 a[60:63], a[252:255], a[184:187], a[60:63]
s_waitcnt lgkmcnt(8)
s_waitcnt lgkmcnt(0) vmcnt(8)
s_barrier
ds_read_b128 a[240:243], v0 offset:24576
v_cvt_pk_bf16_f32 v65, v46, v47
v_mfma_f32_16x16x32_bf16 a[32:35], a[224:227], a[172:175], a[32:35]
ds_read_b128 a[244:247], v1 offset:24576
buffer_load_dwordx4 v12, s[8:11], 0 offen nt lds
v_mfma_f32_16x16x32_bf16 a[36:39], a[224:227], a[188:191], a[36:39]
s_add_u32 m0, s41, 20352
v_exp_f32 v44, v44
v_mfma_f32_16x16x32_bf16 v[152:155], a[224:227], v[76:79], v[152:155]
v_exp_f32 v51, v51
v_mfma_f32_16x16x32_bf16 a[40:43], a[228:231], a[172:175], a[40:43]
ds_read_b128 a[248:251], v2 offset:24576
v_cvt_pk_bf16_f32 v64, v44, v45
v_mfma_f32_16x16x32_bf16 a[44:47], a[228:231], a[188:191], a[44:47]
ds_read_b128 a[252:255], v3 offset:24576
buffer_load_dwordx4 v12, s[8:11], 0 offen offset:128 nt lds
v_mfma_f32_16x16x32_bf16 a[48:51], a[232:235], a[172:175], a[48:51]
s_add_u32 m0, s42, 8256
v_exp_f32 v50, v50
v_mfma_f32_16x16x32_bf16 a[52:55], a[232:235], a[188:191], a[52:55]
v_exp_f32 v49, v49
v_mfma_f32_16x16x32_bf16 a[56:59], a[236:239], a[172:175], a[56:59]
v_exp_f32 v48, v48
v_mfma_f32_16x16x32_bf16 a[60:63], a[236:239], a[188:191], a[60:63]
s_waitcnt lgkmcnt(3)
ds_read_b128 a[224:227], v0 offset:25088
v_cvt_pk_bf16_f32 v69, v50, v51
v_mfma_f32_16x16x32_bf16 v[44:47], a[240:243], a[128:131], v[20:23]
ds_read_b128 a[228:231], v1 offset:25088
v_cvt_pk_bf16_f32 v68, v48, v49
v_exp_f32 v55, v55
v_mfma_f32_16x16x32_bf16 v[48:51], a[240:243], a[144:147], v[24:27]
s_waitcnt lgkmcnt(4)
ds_read_b128 a[232:235], v2 offset:25088
buffer_load_dwordx4 v13, s[12:15], 0 offen nt lds
v_exp_f32 v54, v54
v_mfma_f32_16x16x32_bf16 v[44:47], a[244:247], a[132:135], v[44:47]
s_add_u32 m0, s42, 12256
v_exp_f32 v53, v53
v_mfma_f32_16x16x32_bf16 v[48:51], a[244:247], a[148:151], v[48:51]
s_waitcnt lgkmcnt(4)
v_exp_f32 v52, v52
v_mfma_f32_16x16x32_bf16 v[44:47], a[248:251], a[136:139], v[44:47]
v_exp_f32 v59, v59
v_mfma_f32_16x16x32_bf16 v[48:51], a[248:251], a[152:155], v[48:51]
s_waitcnt lgkmcnt(3)
ds_read_b128 a[236:239], v3 offset:25088
buffer_load_dwordx4 v13, s[12:15], 0 offen offset:128 nt lds
v_exp_f32 v58, v58
v_mfma_f32_16x16x32_bf16 v[44:47], a[252:255], a[140:143], v[44:47]
s_add_u32 m0, s42, 49536
ds_read_b128 v[80:83], v10 offset:39168
v_cvt_pk_bf16_f32 v67, v54, v55
v_exp_f32 v57, v57
v_mfma_f32_16x16x32_bf16 v[48:51], a[252:255], a[156:159], v[48:51]
s_waitcnt lgkmcnt(4)
ds_read_b64_tr_b16 a[242:243], v6 offset:17024
v_cvt_pk_bf16_f32 v66, v52, v53
v_exp_f32 v56, v56
v_mfma_f32_16x16x32_bf16 v[52:55], a[224:227], a[128:131], v[20:23]
ds_read_b64_tr_b16 a[240:241], v6 offset:16512
v_cvt_pk_bf16_f32 v71, v58, v59
v_cvt_pk_bf16_f32 v70, v56, v57
v_mfma_f32_16x16x32_bf16 v[56:59], a[224:227], a[144:147], v[24:27]
s_waitcnt lgkmcnt(5)
ds_read_b64_tr_b16 a[246:247], v6 offset:17032
buffer_load_dwordx4 v255, s[36:39], 0 offen lds
v_mfma_f32_16x16x32_bf16 v[52:55], a[228:231], a[132:135], v[52:55]
s_add_u32 m0, s42, 53664
ds_read_b64_tr_b16 a[244:245], v6 offset:16520
v_add_u32 v255, s46, v14
v_mfma_f32_16x16x32_bf16 v[56:59], a[228:231], a[148:151], v[56:59]
s_waitcnt lgkmcnt(6)
ds_read_b64_tr_b16 a[250:251], v7 offset:17024
buffer_load_dwordx4 v255, s[36:39], 0 offen lds
v_mfma_f32_16x16x32_bf16 v[52:55], a[232:235], a[136:139], v[52:55]
s_add_u32 s46, s44, 196608
ds_read_b64_tr_b16 a[248:249], v7 offset:16512
s_add_u32 m0, s42, 57792
v_mfma_f32_16x16x32_bf16 v[56:59], a[232:235], a[152:155], v[56:59]
s_waitcnt lgkmcnt(7)
ds_read_b64_tr_b16 a[254:255], v7 offset:17032
v_add_u32 v255, s46, v14
v_mfma_f32_16x16x32_bf16 v[52:55], a[236:239], a[140:143], v[52:55]
s_add_u32 s46, s44, 229376
ds_read_b64_tr_b16 a[252:253], v7 offset:16520
v_add_u32 v12, s7, v12
v_mfma_f32_16x16x32_bf16 v[56:59], a[236:239], a[156:159], v[56:59]
ds_read_b64_tr_b16 a[226:227], v8 offset:17024
buffer_load_dwordx4 v255, s[36:39], 0 offen lds
v_mfma_f32_16x16x32_bf16 v[32:35], v[16:19], v[64:67], v[32:35]
s_add_u32 m0, s42, 61920
ds_read_b64_tr_b16 a[224:225], v8 offset:16512
v_add_u32 v255, s46, v14
v_mfma_f32_16x16x32_bf16 v[36:39], v[16:19], v[68:71], v[36:39]
s_waitcnt lgkmcnt(10)
ds_read_b64_tr_b16 a[230:231], v8 offset:17032
v_add_u32 v13, s6, v13
v_mfma_f32_16x16x32_bf16 v[40:43], v[16:19], v[80:83], v[40:43]
s_waitcnt lgkmcnt(9)
ds_read_b64_tr_b16 a[228:229], v8 offset:16520
s_add_u32 s46, s45, 131072
v_mfma_f32_16x16x32_bf16 v[172:175], a[240:243], v[64:67], v[172:175]
s_and_b32 s43, s43, 0x1ffff
s_cselect_b32 s6, s4, s5
ds_read_b64_tr_b16 a[234:235], v9 offset:17024
buffer_load_dwordx4 v255, s[36:39], 0 offen lds
v_mfma_f32_16x16x32_bf16 v[176:179], a[240:243], v[68:71], v[176:179]
s_mov_b32 m0, 148224
ds_read_b64_tr_b16 a[232:233], v9 offset:16512
v_add_u32 v255, s46, v14
v_mfma_f32_16x16x32_bf16 v[236:239], a[240:243], v[80:83], v[236:239]
s_waitcnt lgkmcnt(10)
ds_read_b64_tr_b16 a[238:239], v9 offset:17032
s_add_u32 s46, s45, 163840
v_mfma_f32_16x16x32_bf16 v[180:183], a[244:247], v[64:67], v[180:183]
s_add_u32 s43, s43, 8192
ds_read_b64_tr_b16 a[236:237], v9 offset:16520
v_mfma_f32_16x16x32_bf16 v[184:187], a[244:247], v[68:71], v[184:187]
ds_read_b64_tr_b16 a[242:243], v132 offset:33536
buffer_load_dwordx4 v253, s[92:95], s64 offen lds
v_mfma_f32_16x16x32_bf16 v[240:243], a[244:247], v[80:83], v[240:243]
s_waitcnt lgkmcnt(11)
ds_read_b64_tr_b16 a[240:241], v132 offset:33024
s_add_u32 m0, s41, 24576
v_mfma_f32_16x16x32_bf16 v[188:191], a[248:251], v[64:67], v[188:191]
ds_read_b128 v[76:79], v164 offset:16640
v_mfma_f32_16x16x32_bf16 v[192:195], a[248:251], v[68:71], v[192:195]
s_waitcnt lgkmcnt(11)
ds_read_b64_tr_b16 a[246:247], v133 offset:33536
v_mfma_f32_16x16x32_bf16 v[196:199], a[252:255], v[64:67], v[196:199]
ds_read_b64_tr_b16 a[244:245], v133 offset:33024
v_mfma_f32_16x16x32_bf16 v[200:203], a[252:255], v[68:71], v[200:203]
s_waitcnt lgkmcnt(11)
ds_read_b64_tr_b16 a[250:251], v134 offset:33536
v_mfma_f32_16x16x32_bf16 v[204:207], a[224:227], v[64:67], v[204:207]
ds_read_b64_tr_b16 a[248:249], v134 offset:33024
v_mfma_f32_16x16x32_bf16 v[208:211], a[224:227], v[68:71], v[208:211]
s_waitcnt lgkmcnt(11)
ds_read_b64_tr_b16 a[254:255], v135 offset:33536
v_mfma_f32_16x16x32_bf16 v[212:215], a[228:231], v[64:67], v[212:215]
ds_read_b64_tr_b16 a[252:253], v135 offset:33024
v_mfma_f32_16x16x32_bf16 v[216:219], a[228:231], v[68:71], v[216:219]
s_waitcnt lgkmcnt(11)
ds_read_b64_tr_b16 a[226:227], v136 offset:33536
v_mfma_f32_16x16x32_bf16 v[220:223], a[232:235], v[64:67], v[220:223]
ds_read_b64_tr_b16 a[224:225], v136 offset:33024
v_mfma_f32_16x16x32_bf16 v[224:227], a[232:235], v[68:71], v[224:227]
s_waitcnt lgkmcnt(11)
ds_read_b64_tr_b16 a[230:231], v137 offset:33536
v_mfma_f32_16x16x32_bf16 v[228:231], a[236:239], v[64:67], v[228:231]
ds_read_b64_tr_b16 a[228:229], v137 offset:33024
v_mfma_f32_16x16x32_bf16 v[232:235], a[236:239], v[68:71], v[232:235]
s_waitcnt lgkmcnt(11)
ds_read_b64_tr_b16 a[234:235], v138 offset:33536
v_mfma_f32_16x16x32_bf16 a[64:67], a[240:243], a[160:163], 0
ds_read_b64_tr_b16 a[232:233], v138 offset:33024
v_mfma_f32_16x16x32_bf16 a[68:71], a[240:243], a[176:179], 0
s_waitcnt lgkmcnt(12)
ds_read_b64_tr_b16 a[238:239], v139 offset:33536
v_mfma_f32_16x16x32_bf16 v[156:159], a[240:243], v[76:79], 0
s_waitcnt lgkmcnt(11)
ds_read_b128 v[76:79], v165 offset:16640
v_mfma_f32_16x16x32_bf16 a[72:75], a[244:247], a[160:163], 0
ds_read_b64_tr_b16 a[236:237], v139 offset:33024
v_mfma_f32_16x16x32_bf16 a[76:79], a[244:247], a[176:179], 0
s_waitcnt lgkmcnt(11)
ds_read_b64_tr_b16 a[246:247], v141 offset:33536
v_mfma_f32_16x16x32_bf16 a[80:83], a[248:251], a[160:163], 0
ds_read_b64_tr_b16 a[244:245], v141 offset:33024
v_mfma_f32_16x16x32_bf16 a[84:87], a[248:251], a[176:179], 0
s_waitcnt lgkmcnt(11)
ds_read_b64_tr_b16 a[242:243], v140 offset:33536
v_mfma_f32_16x16x32_bf16 a[88:91], a[252:255], a[160:163], 0
ds_read_b64_tr_b16 a[250:251], v142 offset:33536
v_mfma_f32_16x16x32_bf16 a[92:95], a[252:255], a[176:179], 0
s_waitcnt lgkmcnt(11)
ds_read_b64_tr_b16 a[240:241], v140 offset:33024
v_mfma_f32_16x16x32_bf16 a[64:67], a[224:227], a[164:167], a[64:67]
ds_read_b64_tr_b16 a[248:249], v142 offset:33024
v_mfma_f32_16x16x32_bf16 a[68:71], a[224:227], a[180:183], a[68:71]
s_waitcnt lgkmcnt(7)
ds_read_b64_tr_b16 a[254:255], v143 offset:33536
v_mfma_f32_16x16x32_bf16 v[156:159], a[224:227], v[76:79], v[156:159]
ds_read_b128 v[76:79], v166 offset:16640
v_mfma_f32_16x16x32_bf16 a[72:75], a[228:231], a[164:167], a[72:75]
ds_read_b64_tr_b16 a[252:253], v143 offset:33024
v_mfma_f32_16x16x32_bf16 a[76:79], a[228:231], a[180:183], a[76:79]
ds_read_b64_tr_b16 a[226:227], v144 offset:33536
v_mfma_f32_16x16x32_bf16 a[80:83], a[232:235], a[164:167], a[80:83]
ds_read_b64_tr_b16 a[224:225], v144 offset:33024
v_mfma_f32_16x16x32_bf16 a[84:87], a[232:235], a[180:183], a[84:87]
s_waitcnt lgkmcnt(11)
ds_read_b64_tr_b16 a[230:231], v145 offset:33536
v_mfma_f32_16x16x32_bf16 a[88:91], a[236:239], a[164:167], a[88:91]
ds_read_b64_tr_b16 a[228:229], v145 offset:33024
v_mfma_f32_16x16x32_bf16 a[92:95], a[236:239], a[180:183], a[92:95]
s_waitcnt lgkmcnt(8)
ds_read_b64_tr_b16 a[234:235], v146 offset:33536
v_mfma_f32_16x16x32_bf16 a[64:67], a[240:243], a[168:171], a[64:67]
ds_read_b64_tr_b16 a[232:233], v146 offset:33024
v_mfma_f32_16x16x32_bf16 a[68:71], a[240:243], a[184:187], a[68:71]
s_waitcnt lgkmcnt(7)
ds_read_b64_tr_b16 a[238:239], v147 offset:33536
v_mfma_f32_16x16x32_bf16 v[156:159], a[240:243], v[76:79], v[156:159]
ds_read_b64_tr_b16 a[236:237], v147 offset:33024
v_mfma_f32_16x16x32_bf16 a[72:75], a[244:247], a[168:171], a[72:75]
ds_read_b128 v[76:79], v167 offset:16640
v_mfma_f32_16x16x32_bf16 a[76:79], a[244:247], a[184:187], a[76:79]
v_exp_f32 v47, v47
v_mfma_f32_16x16x32_bf16 a[80:83], a[248:251], a[168:171], a[80:83]
v_exp_f32 v46, v46
v_mfma_f32_16x16x32_bf16 a[84:87], a[248:251], a[184:187], a[84:87]
s_waitcnt lgkmcnt(9)
v_exp_f32 v45, v45
v_mfma_f32_16x16x32_bf16 a[88:91], a[252:255], a[168:171], a[88:91]
v_exp_f32 v44, v44
v_mfma_f32_16x16x32_bf16 a[92:95], a[252:255], a[184:187], a[92:95]
s_waitcnt lgkmcnt(7)
s_waitcnt lgkmcnt(0) vmcnt(9)
s_barrier
ds_read_b128 a[240:243], v0 offset:0
v_cvt_pk_bf16_f32 v65, v46, v47
v_mfma_f32_16x16x32_bf16 a[64:67], a[224:227], a[172:175], a[64:67]
ds_read_b128 a[244:247], v1 offset:0
buffer_load_dwordx4 v12, s[8:11], 0 offen nt lds
v_mfma_f32_16x16x32_bf16 a[68:71], a[224:227], a[188:191], a[68:71]
s_add_u32 m0, s41, 28544
v_exp_f32 v51, v51
v_mfma_f32_16x16x32_bf16 v[156:159], a[224:227], v[76:79], v[156:159]
ds_read_b128 a[248:251], v2 offset:0
v_cvt_pk_bf16_f32 v64, v44, v45
v_mfma_f32_16x16x32_bf16 a[72:75], a[228:231], a[172:175], a[72:75]
v_exp_f32 v50, v50
v_mfma_f32_16x16x32_bf16 a[76:79], a[228:231], a[188:191], a[76:79]
ds_read_b128 a[252:255], v3 offset:0
buffer_load_dwordx4 v12, s[8:11], 0 offen offset:128 nt lds
v_mfma_f32_16x16x32_bf16 a[80:83], a[232:235], a[172:175], a[80:83]
s_add_u32 m0, s42, 16512
v_exp_f32 v49, v49
v_mfma_f32_16x16x32_bf16 a[84:87], a[232:235], a[188:191], a[84:87]
v_exp_f32 v48, v48
v_mfma_f32_16x16x32_bf16 a[88:91], a[236:239], a[172:175], a[88:91]
ds_read_b128 a[224:227], v0 offset:512
v_cvt_pk_bf16_f32 v69, v50, v51
v_mfma_f32_16x16x32_bf16 a[92:95], a[236:239], a[188:191], a[92:95]
s_waitcnt lgkmcnt(4)
ds_read_b128 a[228:231], v1 offset:512
v_cvt_pk_bf16_f32 v68, v48, v49
v_mfma_f32_16x16x32_bf16 v[44:47], a[240:243], a[128:131], v[20:23]
v_exp_f32 v55, v55
v_mfma_f32_16x16x32_bf16 v[48:51], a[240:243], a[144:147], v[24:27]
s_waitcnt lgkmcnt(4)
ds_read_b128 a[232:235], v2 offset:512
buffer_load_dwordx4 v13, s[12:15], 0 offen nt lds
v_exp_f32 v54, v54
v_mfma_f32_16x16x32_bf16 v[44:47], a[244:247], a[132:135], v[44:47]
s_add_u32 m0, s42, 20512
v_exp_f32 v53, v53
v_mfma_f32_16x16x32_bf16 v[48:51], a[244:247], a[148:151], v[48:51]
s_waitcnt lgkmcnt(4)
v_exp_f32 v52, v52
v_mfma_f32_16x16x32_bf16 v[44:47], a[248:251], a[136:139], v[44:47]
v_exp_f32 v59, v59
v_mfma_f32_16x16x32_bf16 v[48:51], a[248:251], a[152:155], v[48:51]
s_waitcnt lgkmcnt(3)
ds_read_b128 a[236:239], v3 offset:512
buffer_load_dwordx4 v13, s[12:15], 0 offen offset:128 nt lds
v_exp_f32 v58, v58
v_mfma_f32_16x16x32_bf16 v[44:47], a[252:255], a[140:143], v[44:47]
s_add_u32 m0, s42, 66048
ds_read_b128 a[240:243], v4 offset:0
v_cvt_pk_bf16_f32 v67, v54, v55
v_exp_f32 v57, v57
v_mfma_f32_16x16x32_bf16 v[48:51], a[252:255], a[156:159], v[48:51]
s_waitcnt lgkmcnt(4)
ds_read_b128 a[244:247], v5 offset:0
v_cvt_pk_bf16_f32 v66, v52, v53
v_exp_f32 v56, v56
v_mfma_f32_16x16x32_bf16 v[52:55], a[224:227], a[128:131], v[20:23]
ds_read_b128 a[248:251], v4 offset:4096
v_cvt_pk_bf16_f32 v71, v58, v59
v_cvt_pk_bf16_f32 v70, v56, v57
v_mfma_f32_16x16x32_bf16 v[56:59], a[224:227], a[144:147], v[24:27]
s_waitcnt lgkmcnt(5)
ds_read_b128 a[252:255], v5 offset:4096
buffer_load_dwordx4 v255, s[36:39], 0 offen lds
v_mfma_f32_16x16x32_bf16 v[52:55], a[228:231], a[132:135], v[52:55]
s_add_u32 m0, s42, 70176
ds_read_b128 v[80:83], v10 offset:40192
v_add_u32 v255, s46, v14
v_mfma_f32_16x16x32_bf16 v[56:59], a[228:231], a[148:151], v[56:59]
s_waitcnt lgkmcnt(6)
ds_read_b64_tr_b16 a[226:227], v6 offset:25280
buffer_load_dwordx4 v255, s[36:39], 0 offen lds
v_mfma_f32_16x16x32_bf16 v[52:55], a[232:235], a[136:139], v[52:55]
s_add_u32 s46, s45, 196608
ds_read_b64_tr_b16 a[224:225], v6 offset:24768
s_add_u32 m0, s42, 74304
v_mfma_f32_16x16x32_bf16 v[56:59], a[232:235], a[152:155], v[56:59]
s_waitcnt lgkmcnt(7)
ds_read_b64_tr_b16 a[230:231], v6 offset:25288
v_add_u32 v255, s46, v14
v_mfma_f32_16x16x32_bf16 v[52:55], a[236:239], a[140:143], v[52:55]
s_add_u32 s46, s45, 229376
ds_read_b64_tr_b16 a[228:229], v6 offset:24776
v_add_u32 v12, s6, v12
v_mfma_f32_16x16x32_bf16 v[56:59], a[236:239], a[156:159], v[56:59]
s_waitcnt lgkmcnt(8)
ds_read_b64_tr_b16 a[234:235], v7 offset:25280
buffer_load_dwordx4 v255, s[36:39], 0 offen lds
v_mfma_f32_16x16x32_bf16 v[60:63], a[240:243], v[84:87], v[28:31]
s_waitcnt lgkmcnt(8)
ds_read_b64_tr_b16 a[232:233], v7 offset:24768
s_add_u32 m0, s42, 78432
v_mfma_f32_16x16x32_bf16 v[60:63], a[244:247], v[88:91], v[60:63]
s_waitcnt lgkmcnt(8)
ds_read_b64_tr_b16 a[238:239], v7 offset:25288
v_add_u32 v255, s46, v14
v_mfma_f32_16x16x32_bf16 v[60:63], a[248:251], v[92:95], v[60:63]
s_waitcnt lgkmcnt(8)
ds_read_b64_tr_b16 a[236:237], v7 offset:24776
v_add_u32 v13, s7, v13
v_mfma_f32_16x16x32_bf16 v[60:63], a[252:255], v[96:99], v[60:63]
s_add_u32 s46, s47, 131072
ds_read_b64_tr_b16 a[242:243], v8 offset:25280
buffer_load_dwordx4 v255, s[36:39], 0 offen lds
v_mfma_f32_16x16x32_bf16 v[32:35], v[16:19], v[64:67], v[32:35]
s_mov_b32 m0, s41
ds_read_b64_tr_b16 a[240:241], v8 offset:24768
v_add_u32 v255, s46, v14
v_mfma_f32_16x16x32_bf16 v[36:39], v[16:19], v[68:71], v[36:39]
s_waitcnt lgkmcnt(10)
ds_read_b64_tr_b16 a[246:247], v8 offset:25288
s_add_u32 s46, s47, 163840
v_mfma_f32_16x16x32_bf16 v[40:43], v[16:19], v[80:83], v[40:43]
s_waitcnt lgkmcnt(9)
ds_read_b64_tr_b16 a[244:245], v8 offset:24776
v_mfma_f32_16x16x32_bf16 v[172:175], a[224:227], v[64:67], v[172:175]
s_and_b32 s43, s43, 0x1ffff
s_cselect_b32 s7, s4, s5
ds_read_b64_tr_b16 a[250:251], v9 offset:25280
s_add_u32 s43, s43, 8192
v_mfma_f32_16x16x32_bf16 v[176:179], a[224:227], v[68:71], v[176:179]
ds_read_b64_tr_b16 a[248:249], v9 offset:24768
v_mfma_f32_16x16x32_bf16 v[236:239], a[224:227], v[80:83], v[236:239]
s_waitcnt lgkmcnt(10)
ds_read_b64_tr_b16 a[254:255], v9 offset:25288
v_mfma_f32_16x16x32_bf16 v[180:183], a[228:231], v[64:67], v[180:183]
ds_read_b64_tr_b16 a[252:253], v9 offset:24776
v_mfma_f32_16x16x32_bf16 v[184:187], a[228:231], v[68:71], v[184:187]
ds_read_b64_tr_b16 a[226:227], v132 offset:512
v_mfma_f32_16x16x32_bf16 v[240:243], a[228:231], v[80:83], v[240:243]
s_waitcnt lgkmcnt(11)
ds_read_b64_tr_b16 a[224:225], v132 offset:0
v_mfma_f32_16x16x32_bf16 v[188:191], a[232:235], v[64:67], v[188:191]
ds_read_b128 v[76:79], v164 offset:16640
v_mfma_f32_16x16x32_bf16 v[192:195], a[232:235], v[68:71], v[192:195]
s_waitcnt lgkmcnt(11)
ds_read_b64_tr_b16 a[230:231], v133 offset:512
v_mfma_f32_16x16x32_bf16 v[196:199], a[236:239], v[64:67], v[196:199]
ds_read_b64_tr_b16 a[228:229], v133 offset:0
v_mfma_f32_16x16x32_bf16 v[200:203], a[236:239], v[68:71], v[200:203]
s_waitcnt lgkmcnt(11)
ds_read_b64_tr_b16 a[234:235], v134 offset:512
v_mfma_f32_16x16x32_bf16 v[204:207], a[240:243], v[64:67], v[204:207]
ds_read_b64_tr_b16 a[232:233], v134 offset:0
v_mfma_f32_16x16x32_bf16 v[208:211], a[240:243], v[68:71], v[208:211]
s_waitcnt lgkmcnt(11)
ds_read_b64_tr_b16 a[238:239], v135 offset:512
v_mfma_f32_16x16x32_bf16 v[212:215], a[244:247], v[64:67], v[212:215]
ds_read_b64_tr_b16 a[236:237], v135 offset:0
v_mfma_f32_16x16x32_bf16 v[216:219], a[244:247], v[68:71], v[216:219]
s_waitcnt lgkmcnt(11)
ds_read_b64_tr_b16 a[242:243], v136 offset:512
v_mfma_f32_16x16x32_bf16 v[220:223], a[248:251], v[64:67], v[220:223]
ds_read_b64_tr_b16 a[240:241], v136 offset:0
v_mfma_f32_16x16x32_bf16 v[224:227], a[248:251], v[68:71], v[224:227]
s_waitcnt lgkmcnt(11)
ds_read_b64_tr_b16 a[246:247], v137 offset:512
v_mfma_f32_16x16x32_bf16 v[228:231], a[252:255], v[64:67], v[228:231]
ds_read_b64_tr_b16 a[244:245], v137 offset:0
v_mfma_f32_16x16x32_bf16 v[232:235], a[252:255], v[68:71], v[232:235]
s_waitcnt lgkmcnt(11)
ds_read_b64_tr_b16 a[250:251], v138 offset:512
v_mfma_f32_16x16x32_bf16 a[96:99], a[224:227], a[160:163], 0
ds_read_b64_tr_b16 a[248:249], v138 offset:0
v_mfma_f32_16x16x32_bf16 a[100:103], a[224:227], a[176:179], 0
s_waitcnt lgkmcnt(12)
ds_read_b64_tr_b16 a[254:255], v139 offset:512
v_mfma_f32_16x16x32_bf16 v[160:163], a[224:227], v[76:79], 0
s_waitcnt lgkmcnt(11)
ds_read_b128 v[76:79], v165 offset:16640
v_mfma_f32_16x16x32_bf16 a[104:107], a[228:231], a[160:163], 0
ds_read_b64_tr_b16 a[252:253], v139 offset:0
v_mfma_f32_16x16x32_bf16 a[108:111], a[228:231], a[176:179], 0
s_waitcnt lgkmcnt(11)
ds_read_b64_tr_b16 a[230:231], v141 offset:512
v_mfma_f32_16x16x32_bf16 a[112:115], a[232:235], a[160:163], 0
ds_read_b64_tr_b16 a[228:229], v141 offset:0
v_mfma_f32_16x16x32_bf16 a[116:119], a[232:235], a[176:179], 0
s_waitcnt lgkmcnt(11)
ds_read_b64_tr_b16 a[226:227], v140 offset:512
v_mfma_f32_16x16x32_bf16 a[120:123], a[236:239], a[160:163], 0
ds_read_b64_tr_b16 a[234:235], v142 offset:512
v_mfma_f32_16x16x32_bf16 a[124:127], a[236:239], a[176:179], 0
s_waitcnt lgkmcnt(11)
ds_read_b64_tr_b16 a[224:225], v140 offset:0
v_mfma_f32_16x16x32_bf16 a[96:99], a[240:243], a[164:167], a[96:99]
ds_read_b64_tr_b16 a[232:233], v142 offset:0
v_mfma_f32_16x16x32_bf16 a[100:103], a[240:243], a[180:183], a[100:103]
s_waitcnt lgkmcnt(7)
ds_read_b64_tr_b16 a[238:239], v143 offset:512
v_mfma_f32_16x16x32_bf16 v[160:163], a[240:243], v[76:79], v[160:163]
ds_read_b128 v[76:79], v166 offset:16640
v_mfma_f32_16x16x32_bf16 a[104:107], a[244:247], a[164:167], a[104:107]
ds_read_b64_tr_b16 a[236:237], v143 offset:0
v_mfma_f32_16x16x32_bf16 a[108:111], a[244:247], a[180:183], a[108:111]
ds_read_b64_tr_b16 a[242:243], v144 offset:512
v_mfma_f32_16x16x32_bf16 a[112:115], a[248:251], a[164:167], a[112:115]
ds_read_b64_tr_b16 a[240:241], v144 offset:0
v_mfma_f32_16x16x32_bf16 a[116:119], a[248:251], a[180:183], a[116:119]
s_waitcnt lgkmcnt(11)
ds_read_b64_tr_b16 a[246:247], v145 offset:512
v_mfma_f32_16x16x32_bf16 a[120:123], a[252:255], a[164:167], a[120:123]
ds_read_b64_tr_b16 a[244:245], v145 offset:0
v_mfma_f32_16x16x32_bf16 a[124:127], a[252:255], a[180:183], a[124:127]
s_waitcnt lgkmcnt(8)
ds_read_b64_tr_b16 a[250:251], v146 offset:512
v_mfma_f32_16x16x32_bf16 a[96:99], a[224:227], a[168:171], a[96:99]
ds_read_b64_tr_b16 a[248:249], v146 offset:0
v_exp_f32 v63, v63
v_mfma_f32_16x16x32_bf16 a[100:103], a[224:227], a[184:187], a[100:103]
s_waitcnt lgkmcnt(7)
ds_read_b64_tr_b16 a[254:255], v147 offset:512
v_exp_f32 v62, v62
v_mfma_f32_16x16x32_bf16 v[160:163], a[224:227], v[76:79], v[160:163]
ds_read_b64_tr_b16 a[252:253], v147 offset:0
v_exp_f32 v61, v61
v_mfma_f32_16x16x32_bf16 a[104:107], a[228:231], a[168:171], a[104:107]
ds_read_b128 v[76:79], v167 offset:16640
v_exp_f32 v60, v60
v_mfma_f32_16x16x32_bf16 a[108:111], a[228:231], a[184:187], a[108:111]
v_cvt_pk_bf16_f32 v73, v62, v63
v_cvt_pk_bf16_f32 v72, v60, v61
ds_write_b64 v11, v[72:73] offset:37120
v_mfma_f32_16x16x32_bf16 a[112:115], a[232:235], a[168:171], a[112:115]
v_exp_f32 v47, v47
v_mfma_f32_16x16x32_bf16 a[116:119], a[232:235], a[184:187], a[116:119]
s_waitcnt lgkmcnt(10)
v_exp_f32 v46, v46
v_mfma_f32_16x16x32_bf16 a[120:123], a[236:239], a[168:171], a[120:123]
v_exp_f32 v45, v45
v_mfma_f32_16x16x32_bf16 a[124:127], a[236:239], a[184:187], a[124:127]
s_waitcnt lgkmcnt(8)
s_waitcnt lgkmcnt(0) vmcnt(9)
s_barrier
ds_read_b128 a[224:227], v0 offset:8192
v_cvt_pk_bf16_f32 v65, v46, v47
v_mfma_f32_16x16x32_bf16 a[96:99], a[240:243], a[172:175], a[96:99]
ds_read_b128 a[228:231], v1 offset:8192
buffer_load_dwordx4 v12, s[8:11], 0 offen nt lds
v_mfma_f32_16x16x32_bf16 a[100:103], a[240:243], a[188:191], a[100:103]
s_add_u32 m0, s41, 3968
v_exp_f32 v44, v44
v_mfma_f32_16x16x32_bf16 v[160:163], a[240:243], v[76:79], v[160:163]
v_exp_f32 v51, v51
v_mfma_f32_16x16x32_bf16 a[104:107], a[244:247], a[172:175], a[104:107]
ds_read_b128 a[232:235], v2 offset:8192
v_cvt_pk_bf16_f32 v64, v44, v45
v_mfma_f32_16x16x32_bf16 a[108:111], a[244:247], a[188:191], a[108:111]
ds_read_b128 a[236:239], v3 offset:8192
buffer_load_dwordx4 v12, s[8:11], 0 offen offset:128 nt lds
v_mfma_f32_16x16x32_bf16 a[112:115], a[248:251], a[172:175], a[112:115]
s_add_u32 m0, s42, 24768
v_exp_f32 v50, v50
v_mfma_f32_16x16x32_bf16 a[116:119], a[248:251], a[188:191], a[116:119]
v_exp_f32 v49, v49
v_mfma_f32_16x16x32_bf16 a[120:123], a[252:255], a[172:175], a[120:123]
v_exp_f32 v48, v48
v_mfma_f32_16x16x32_bf16 a[124:127], a[252:255], a[188:191], a[124:127]
s_waitcnt lgkmcnt(3)
ds_read_b128 a[240:243], v0 offset:8704
v_cvt_pk_bf16_f32 v69, v50, v51
v_mfma_f32_16x16x32_bf16 v[44:47], a[224:227], a[128:131], v[20:23]
ds_read_b128 a[244:247], v1 offset:8704
v_cvt_pk_bf16_f32 v68, v48, v49
v_exp_f32 v55, v55
v_mfma_f32_16x16x32_bf16 v[48:51], a[224:227], a[144:147], v[24:27]
s_waitcnt lgkmcnt(4)
ds_read_b128 a[248:251], v2 offset:8704
buffer_load_dwordx4 v13, s[12:15], 0 offen nt lds
v_exp_f32 v54, v54
v_mfma_f32_16x16x32_bf16 v[44:47], a[228:231], a[132:135], v[44:47]
s_add_u32 m0, s42, 28768
v_exp_f32 v53, v53
v_mfma_f32_16x16x32_bf16 v[48:51], a[228:231], a[148:151], v[48:51]
s_waitcnt lgkmcnt(4)
v_exp_f32 v52, v52
v_mfma_f32_16x16x32_bf16 v[44:47], a[232:235], a[136:139], v[44:47]
v_exp_f32 v59, v59
v_mfma_f32_16x16x32_bf16 v[48:51], a[232:235], a[152:155], v[48:51]
s_waitcnt lgkmcnt(3)
ds_read_b128 a[252:255], v3 offset:8704
buffer_load_dwordx4 v13, s[12:15], 0 offen offset:128 nt lds
v_exp_f32 v58, v58
v_mfma_f32_16x16x32_bf16 v[44:47], a[236:239], a[140:143], v[44:47]
s_add_u32 m0, s42, 33024
ds_read_b128 v[80:83], v10 offset:37120
v_cvt_pk_bf16_f32 v67, v54, v55
v_exp_f32 v57, v57
v_mfma_f32_16x16x32_bf16 v[48:51], a[236:239], a[156:159], v[48:51]
s_waitcnt lgkmcnt(4)
ds_read_b64_tr_b16 a[226:227], v6 offset:512
v_cvt_pk_bf16_f32 v66, v52, v53
v_exp_f32 v56, v56
v_mfma_f32_16x16x32_bf16 v[52:55], a[240:243], a[128:131], v[20:23]
ds_read_b64_tr_b16 a[224:225], v6 offset:0
v_cvt_pk_bf16_f32 v71, v58, v59
v_cvt_pk_bf16_f32 v70, v56, v57
v_mfma_f32_16x16x32_bf16 v[56:59], a[240:243], a[144:147], v[24:27]
s_waitcnt lgkmcnt(5)
ds_read_b64_tr_b16 a[230:231], v6 offset:520
buffer_load_dwordx4 v255, s[36:39], 0 offen lds
v_mfma_f32_16x16x32_bf16 v[52:55], a[244:247], a[132:135], v[52:55]
s_add_u32 m0, s42, 37152
ds_read_b64_tr_b16 a[228:229], v6 offset:8
v_add_u32 v255, s46, v14
v_mfma_f32_16x16x32_bf16 v[56:59], a[244:247], a[148:151], v[56:59]
s_waitcnt lgkmcnt(6)
ds_read_b64_tr_b16 a[234:235], v7 offset:512
buffer_load_dwordx4 v255, s[36:39], 0 offen lds
v_mfma_f32_16x16x32_bf16 v[52:55], a[248:251], a[136:139], v[52:55]
s_add_u32 s46, s47, 196608
ds_read_b64_tr_b16 a[232:233], v7 offset:0
s_add_u32 m0, s42, 41280
v_mfma_f32_16x16x32_bf16 v[56:59], a[248:251], a[152:155], v[56:59]
s_waitcnt lgkmcnt(7)
ds_read_b64_tr_b16 a[238:239], v7 offset:520
v_add_u32 v255, s46, v14
v_mfma_f32_16x16x32_bf16 v[52:55], a[252:255], a[140:143], v[52:55]
s_add_u32 s46, s47, 229376
ds_read_b64_tr_b16 a[236:237], v7 offset:8
v_add_u32 v12, s7, v12
v_mfma_f32_16x16x32_bf16 v[56:59], a[252:255], a[156:159], v[56:59]
ds_read_b64_tr_b16 a[242:243], v8 offset:512
buffer_load_dwordx4 v255, s[36:39], 0 offen lds
v_mfma_f32_16x16x32_bf16 v[32:35], v[16:19], v[64:67], v[32:35]
s_add_u32 m0, s42, 45408
ds_read_b64_tr_b16 a[240:241], v8 offset:0
v_add_u32 v255, s46, v14
v_mfma_f32_16x16x32_bf16 v[36:39], v[16:19], v[68:71], v[36:39]
s_waitcnt lgkmcnt(10)
ds_read_b64_tr_b16 a[246:247], v8 offset:520
v_add_u32 v13, s6, v13
v_mfma_f32_16x16x32_bf16 v[40:43], v[16:19], v[80:83], v[40:43]
s_waitcnt lgkmcnt(9)
ds_read_b64_tr_b16 a[244:245], v8 offset:8
s_add_u32 s46, s71, 131072
v_mfma_f32_16x16x32_bf16 v[172:175], a[224:227], v[64:67], v[172:175]
s_and_b32 s43, s43, 0x1ffff
s_cselect_b32 s6, s4, s5
ds_read_b64_tr_b16 a[250:251], v9 offset:512
buffer_load_dwordx4 v255, s[36:39], 0 offen lds
v_mfma_f32_16x16x32_bf16 v[176:179], a[224:227], v[68:71], v[176:179]
s_add_u32 m0, s41, 8192
ds_read_b64_tr_b16 a[248:249], v9 offset:0
v_add_u32 v255, s46, v14
v_mfma_f32_16x16x32_bf16 v[236:239], a[224:227], v[80:83], v[236:239]
s_waitcnt lgkmcnt(10)
ds_read_b64_tr_b16 a[254:255], v9 offset:520
s_add_u32 s46, s71, 163840
v_mfma_f32_16x16x32_bf16 v[180:183], a[228:231], v[64:67], v[180:183]
s_add_u32 s43, s43, 8192
ds_read_b64_tr_b16 a[252:253], v9 offset:8
v_mfma_f32_16x16x32_bf16 v[184:187], a[228:231], v[68:71], v[184:187]
ds_read_b64_tr_b16 a[226:227], v132 offset:17024
v_mfma_f32_16x16x32_bf16 v[240:243], a[228:231], v[80:83], v[240:243]
s_waitcnt lgkmcnt(11)
ds_read_b64_tr_b16 a[224:225], v132 offset:16512
v_mfma_f32_16x16x32_bf16 v[188:191], a[232:235], v[64:67], v[188:191]
ds_read_b128 v[76:79], v164 offset:20736
v_mfma_f32_16x16x32_bf16 v[192:195], a[232:235], v[68:71], v[192:195]
s_waitcnt lgkmcnt(11)
ds_read_b64_tr_b16 a[230:231], v133 offset:17024
v_mfma_f32_16x16x32_bf16 v[196:199], a[236:239], v[64:67], v[196:199]
ds_read_b64_tr_b16 a[228:229], v133 offset:16512
v_mfma_f32_16x16x32_bf16 v[200:203], a[236:239], v[68:71], v[200:203]
s_waitcnt lgkmcnt(11)
ds_read_b64_tr_b16 a[234:235], v134 offset:17024
v_mfma_f32_16x16x32_bf16 v[204:207], a[240:243], v[64:67], v[204:207]
ds_read_b64_tr_b16 a[232:233], v134 offset:16512
v_mfma_f32_16x16x32_bf16 v[208:211], a[240:243], v[68:71], v[208:211]
s_waitcnt lgkmcnt(11)
ds_read_b64_tr_b16 a[238:239], v135 offset:17024
v_mfma_f32_16x16x32_bf16 v[212:215], a[244:247], v[64:67], v[212:215]
ds_read_b64_tr_b16 a[236:237], v135 offset:16512
v_mfma_f32_16x16x32_bf16 v[216:219], a[244:247], v[68:71], v[216:219]
s_waitcnt lgkmcnt(11)
ds_read_b64_tr_b16 a[242:243], v136 offset:17024
v_mfma_f32_16x16x32_bf16 v[220:223], a[248:251], v[64:67], v[220:223]
ds_read_b64_tr_b16 a[240:241], v136 offset:16512
v_mfma_f32_16x16x32_bf16 v[224:227], a[248:251], v[68:71], v[224:227]
s_waitcnt lgkmcnt(11)
ds_read_b64_tr_b16 a[246:247], v137 offset:17024
v_mfma_f32_16x16x32_bf16 v[228:231], a[252:255], v[64:67], v[228:231]
ds_read_b64_tr_b16 a[244:245], v137 offset:16512
v_mfma_f32_16x16x32_bf16 v[232:235], a[252:255], v[68:71], v[232:235]
s_waitcnt lgkmcnt(11)
ds_read_b64_tr_b16 a[250:251], v138 offset:17024
v_mfma_f32_16x16x32_bf16 a[0:3], a[224:227], a[192:195], a[0:3]
ds_read_b64_tr_b16 a[248:249], v138 offset:16512
v_mfma_f32_16x16x32_bf16 a[4:7], a[224:227], a[208:211], a[4:7]
s_waitcnt lgkmcnt(12)
ds_read_b64_tr_b16 a[254:255], v139 offset:17024
v_mfma_f32_16x16x32_bf16 v[148:151], a[224:227], v[76:79], v[148:151]
s_waitcnt lgkmcnt(11)
ds_read_b128 v[76:79], v165 offset:20736
v_mfma_f32_16x16x32_bf16 a[8:11], a[228:231], a[192:195], a[8:11]
ds_read_b64_tr_b16 a[252:253], v139 offset:16512
v_mfma_f32_16x16x32_bf16 a[12:15], a[228:231], a[208:211], a[12:15]
s_waitcnt lgkmcnt(11)
ds_read_b64_tr_b16 a[230:231], v141 offset:17024
v_mfma_f32_16x16x32_bf16 a[16:19], a[232:235], a[192:195], a[16:19]
ds_read_b64_tr_b16 a[228:229], v141 offset:16512
v_mfma_f32_16x16x32_bf16 a[20:23], a[232:235], a[208:211], a[20:23]
s_waitcnt lgkmcnt(11)
ds_read_b64_tr_b16 a[226:227], v140 offset:17024
v_mfma_f32_16x16x32_bf16 a[24:27], a[236:239], a[192:195], a[24:27]
ds_read_b64_tr_b16 a[234:235], v142 offset:17024
v_mfma_f32_16x16x32_bf16 a[28:31], a[236:239], a[208:211], a[28:31]
s_waitcnt lgkmcnt(11)
ds_read_b64_tr_b16 a[224:225], v140 offset:16512
v_mfma_f32_16x16x32_bf16 a[0:3], a[240:243], a[196:199], a[0:3]
ds_read_b64_tr_b16 a[232:233], v142 offset:16512
v_mfma_f32_16x16x32_bf16 a[4:7], a[240:243], a[212:215], a[4:7]
s_waitcnt lgkmcnt(7)
ds_read_b64_tr_b16 a[238:239], v143 offset:17024
v_mfma_f32_16x16x32_bf16 v[148:151], a[240:243], v[76:79], v[148:151]
ds_read_b128 v[76:79], v166 offset:20736
v_mfma_f32_16x16x32_bf16 a[8:11], a[244:247], a[196:199], a[8:11]
ds_read_b64_tr_b16 a[236:237], v143 offset:16512
v_mfma_f32_16x16x32_bf16 a[12:15], a[244:247], a[212:215], a[12:15]
ds_read_b64_tr_b16 a[242:243], v144 offset:17024
v_mfma_f32_16x16x32_bf16 a[16:19], a[248:251], a[196:199], a[16:19]
ds_read_b64_tr_b16 a[240:241], v144 offset:16512
v_mfma_f32_16x16x32_bf16 a[20:23], a[248:251], a[212:215], a[20:23]
s_waitcnt lgkmcnt(11)
ds_read_b64_tr_b16 a[246:247], v145 offset:17024
v_mfma_f32_16x16x32_bf16 a[24:27], a[252:255], a[196:199], a[24:27]
ds_read_b64_tr_b16 a[244:245], v145 offset:16512
v_mfma_f32_16x16x32_bf16 a[28:31], a[252:255], a[212:215], a[28:31]
s_waitcnt lgkmcnt(8)
ds_read_b64_tr_b16 a[250:251], v146 offset:17024
v_mfma_f32_16x16x32_bf16 a[0:3], a[224:227], a[200:203], a[0:3]
ds_read_b64_tr_b16 a[248:249], v146 offset:16512
v_mfma_f32_16x16x32_bf16 a[4:7], a[224:227], a[216:219], a[4:7]
s_waitcnt lgkmcnt(7)
ds_read_b64_tr_b16 a[254:255], v147 offset:17024
v_mfma_f32_16x16x32_bf16 v[148:151], a[224:227], v[76:79], v[148:151]
ds_read_b64_tr_b16 a[252:253], v147 offset:16512
v_mfma_f32_16x16x32_bf16 a[8:11], a[228:231], a[200:203], a[8:11]
ds_read_b128 v[76:79], v167 offset:20736
v_mfma_f32_16x16x32_bf16 a[12:15], a[228:231], a[216:219], a[12:15]
v_exp_f32 v47, v47
v_mfma_f32_16x16x32_bf16 a[16:19], a[232:235], a[200:203], a[16:19]
v_exp_f32 v46, v46
v_mfma_f32_16x16x32_bf16 a[20:23], a[232:235], a[216:219], a[20:23]
s_waitcnt lgkmcnt(9)
v_exp_f32 v45, v45
v_mfma_f32_16x16x32_bf16 a[24:27], a[236:239], a[200:203], a[24:27]
v_exp_f32 v44, v44
v_mfma_f32_16x16x32_bf16 a[28:31], a[236:239], a[216:219], a[28:31]
s_waitcnt lgkmcnt(7)
s_waitcnt lgkmcnt(0) vmcnt(8)
s_barrier
ds_read_b128 a[224:227], v0 offset:16384
v_cvt_pk_bf16_f32 v65, v46, v47
v_mfma_f32_16x16x32_bf16 a[0:3], a[240:243], a[204:207], a[0:3]
ds_read_b128 a[228:231], v1 offset:16384
buffer_load_dwordx4 v12, s[8:11], 0 offen nt lds
v_mfma_f32_16x16x32_bf16 a[4:7], a[240:243], a[220:223], a[4:7]
s_add_u32 m0, s41, 12160
v_exp_f32 v51, v51
v_mfma_f32_16x16x32_bf16 v[148:151], a[240:243], v[76:79], v[148:151]
ds_read_b128 a[232:235], v2 offset:16384
v_cvt_pk_bf16_f32 v64, v44, v45
v_mfma_f32_16x16x32_bf16 a[8:11], a[244:247], a[204:207], a[8:11]
v_exp_f32 v50, v50
v_mfma_f32_16x16x32_bf16 a[12:15], a[244:247], a[220:223], a[12:15]
ds_read_b128 a[236:239], v3 offset:16384
buffer_load_dwordx4 v12, s[8:11], 0 offen offset:128 nt lds
v_mfma_f32_16x16x32_bf16 a[16:19], a[248:251], a[204:207], a[16:19]
s_mov_b32 m0, s42
v_exp_f32 v49, v49
v_mfma_f32_16x16x32_bf16 a[20:23], a[248:251], a[220:223], a[20:23]
v_exp_f32 v48, v48
v_mfma_f32_16x16x32_bf16 a[24:27], a[252:255], a[204:207], a[24:27]
ds_read_b128 a[240:243], v0 offset:16896
v_cvt_pk_bf16_f32 v69, v50, v51
v_mfma_f32_16x16x32_bf16 a[28:31], a[252:255], a[220:223], a[28:31]
s_waitcnt lgkmcnt(4)
ds_read_b128 a[244:247], v1 offset:16896
v_cvt_pk_bf16_f32 v68, v48, v49
v_mfma_f32_16x16x32_bf16 v[44:47], a[224:227], a[128:131], v[20:23]
v_exp_f32 v55, v55
v_mfma_f32_16x16x32_bf16 v[48:51], a[224:227], a[144:147], v[24:27]
s_waitcnt lgkmcnt(4)
ds_read_b128 a[248:251], v2 offset:16896
buffer_load_dwordx4 v13, s[12:15], 0 offen nt lds
v_exp_f32 v54, v54
v_mfma_f32_16x16x32_bf16 v[44:47], a[228:231], a[132:135], v[44:47]
s_add_u32 m0, s42, 4000
v_exp_f32 v53, v53
v_mfma_f32_16x16x32_bf16 v[48:51], a[228:231], a[148:151], v[48:51]
s_waitcnt lgkmcnt(4)
v_exp_f32 v52, v52
v_mfma_f32_16x16x32_bf16 v[44:47], a[232:235], a[136:139], v[44:47]
v_exp_f32 v59, v59
v_mfma_f32_16x16x32_bf16 v[48:51], a[232:235], a[152:155], v[48:51]
s_waitcnt lgkmcnt(3)
ds_read_b128 a[252:255], v3 offset:16896
buffer_load_dwordx4 v13, s[12:15], 0 offen offset:128 nt lds
v_exp_f32 v58, v58
v_mfma_f32_16x16x32_bf16 v[44:47], a[236:239], a[140:143], v[44:47]
s_add_u32 m0, s42, 49536
ds_read_b128 a[224:227], v4 offset:16384
v_cvt_pk_bf16_f32 v67, v54, v55
v_exp_f32 v57, v57
v_mfma_f32_16x16x32_bf16 v[48:51], a[236:239], a[156:159], v[48:51]
s_waitcnt lgkmcnt(4)
ds_read_b128 a[228:231], v5 offset:16384
v_cvt_pk_bf16_f32 v66, v52, v53
v_exp_f32 v56, v56
v_mfma_f32_16x16x32_bf16 v[52:55], a[240:243], a[128:131], v[20:23]
ds_read_b128 a[232:235], v4 offset:20480
v_cvt_pk_bf16_f32 v71, v58, v59
v_cvt_pk_bf16_f32 v70, v56, v57
v_mfma_f32_16x16x32_bf16 v[56:59], a[240:243], a[144:147], v[24:27]
s_waitcnt lgkmcnt(5)
ds_read_b128 a[236:239], v5 offset:20480
buffer_load_dwordx4 v255, s[36:39], 0 offen lds
v_mfma_f32_16x16x32_bf16 v[52:55], a[244:247], a[132:135], v[52:55]
s_add_u32 m0, s42, 53664
ds_read_b128 v[80:83], v10 offset:38144
v_add_u32 v255, s46, v14
v_mfma_f32_16x16x32_bf16 v[56:59], a[244:247], a[148:151], v[56:59]
s_waitcnt lgkmcnt(6)
ds_read_b64_tr_b16 a[242:243], v6 offset:8768
buffer_load_dwordx4 v255, s[36:39], 0 offen lds
v_mfma_f32_16x16x32_bf16 v[52:55], a[248:251], a[136:139], v[52:55]
s_add_u32 s46, s71, 196608
ds_read_b64_tr_b16 a[240:241], v6 offset:8256
s_add_u32 m0, s42, 57792
v_mfma_f32_16x16x32_bf16 v[56:59], a[248:251], a[152:155], v[56:59]
s_waitcnt lgkmcnt(7)
ds_read_b64_tr_b16 a[246:247], v6 offset:8776
v_add_u32 v255, s46, v14
v_mfma_f32_16x16x32_bf16 v[52:55], a[252:255], a[140:143], v[52:55]
s_add_u32 s46, s71, 229376
ds_read_b64_tr_b16 a[244:245], v6 offset:8264
v_add_u32 v12, s6, v12
v_mfma_f32_16x16x32_bf16 v[56:59], a[252:255], a[156:159], v[56:59]
s_waitcnt lgkmcnt(8)
ds_read_b64_tr_b16 a[250:251], v7 offset:8768
buffer_load_dwordx4 v255, s[36:39], 0 offen lds
v_mfma_f32_16x16x32_bf16 v[60:63], a[224:227], v[84:87], v[28:31]
s_waitcnt lgkmcnt(8)
ds_read_b64_tr_b16 a[248:249], v7 offset:8256
s_add_u32 m0, s42, 61920
v_mfma_f32_16x16x32_bf16 v[60:63], a[228:231], v[88:91], v[60:63]
s_waitcnt lgkmcnt(8)
ds_read_b64_tr_b16 a[254:255], v7 offset:8776
v_add_u32 v255, s46, v14
v_mfma_f32_16x16x32_bf16 v[60:63], a[232:235], v[92:95], v[60:63]
s_waitcnt lgkmcnt(8)
ds_read_b64_tr_b16 a[252:253], v7 offset:8264
v_add_u32 v13, s7, v13
v_mfma_f32_16x16x32_bf16 v[60:63], a[236:239], v[96:99], v[60:63]
s_add_u32 s46, s44, 262144
ds_read_b64_tr_b16 a[226:227], v8 offset:8768
buffer_load_dwordx4 v255, s[36:39], 0 offen lds
v_mfma_f32_16x16x32_bf16 v[32:35], v[16:19], v[64:67], v[32:35]
s_add_u32 m0, s41, 16384
ds_read_b64_tr_b16 a[224:225], v8 offset:8256
v_add_u32 v255, s46, v14
v_mfma_f32_16x16x32_bf16 v[36:39], v[16:19], v[68:71], v[36:39]
s_waitcnt lgkmcnt(10)
ds_read_b64_tr_b16 a[230:231], v8 offset:8776
s_add_u32 s46, s44, 294912
v_mfma_f32_16x16x32_bf16 v[40:43], v[16:19], v[80:83], v[40:43]
s_waitcnt lgkmcnt(9)
ds_read_b64_tr_b16 a[228:229], v8 offset:8264
v_mfma_f32_16x16x32_bf16 v[172:175], a[240:243], v[64:67], v[172:175]
s_and_b32 s43, s43, 0x1ffff
s_cselect_b32 s7, s4, s5
ds_read_b64_tr_b16 a[234:235], v9 offset:8768
s_add_u32 s43, s43, 8192
v_mfma_f32_16x16x32_bf16 v[176:179], a[240:243], v[68:71], v[176:179]
ds_read_b64_tr_b16 a[232:233], v9 offset:8256
v_mfma_f32_16x16x32_bf16 v[236:239], a[240:243], v[80:83], v[236:239]
s_waitcnt lgkmcnt(10)
ds_read_b64_tr_b16 a[238:239], v9 offset:8776
v_mfma_f32_16x16x32_bf16 v[180:183], a[244:247], v[64:67], v[180:183]
ds_read_b64_tr_b16 a[236:237], v9 offset:8264
v_mfma_f32_16x16x32_bf16 v[184:187], a[244:247], v[68:71], v[184:187]
ds_read_b64_tr_b16 a[242:243], v132 offset:33536
v_mfma_f32_16x16x32_bf16 v[240:243], a[244:247], v[80:83], v[240:243]
s_waitcnt lgkmcnt(11)
ds_read_b64_tr_b16 a[240:241], v132 offset:33024
v_mfma_f32_16x16x32_bf16 v[188:191], a[248:251], v[64:67], v[188:191]
ds_read_b128 v[76:79], v164 offset:20736
v_mfma_f32_16x16x32_bf16 v[192:195], a[248:251], v[68:71], v[192:195]
s_waitcnt lgkmcnt(11)
ds_read_b64_tr_b16 a[246:247], v133 offset:33536
v_mfma_f32_16x16x32_bf16 v[196:199], a[252:255], v[64:67], v[196:199]
ds_read_b64_tr_b16 a[244:245], v133 offset:33024
v_mfma_f32_16x16x32_bf16 v[200:203], a[252:255], v[68:71], v[200:203]
s_waitcnt lgkmcnt(11)
ds_read_b64_tr_b16 a[250:251], v134 offset:33536
v_mfma_f32_16x16x32_bf16 v[204:207], a[224:227], v[64:67], v[204:207]
ds_read_b64_tr_b16 a[248:249], v134 offset:33024
v_mfma_f32_16x16x32_bf16 v[208:211], a[224:227], v[68:71], v[208:211]
s_waitcnt lgkmcnt(11)
ds_read_b64_tr_b16 a[254:255], v135 offset:33536
v_mfma_f32_16x16x32_bf16 v[212:215], a[228:231], v[64:67], v[212:215]
ds_read_b64_tr_b16 a[252:253], v135 offset:33024
v_mfma_f32_16x16x32_bf16 v[216:219], a[228:231], v[68:71], v[216:219]
s_waitcnt lgkmcnt(11)
ds_read_b64_tr_b16 a[226:227], v136 offset:33536
v_mfma_f32_16x16x32_bf16 v[220:223], a[232:235], v[64:67], v[220:223]
ds_read_b64_tr_b16 a[224:225], v136 offset:33024
v_mfma_f32_16x16x32_bf16 v[224:227], a[232:235], v[68:71], v[224:227]
s_waitcnt lgkmcnt(11)
ds_read_b64_tr_b16 a[230:231], v137 offset:33536
v_mfma_f32_16x16x32_bf16 v[228:231], a[236:239], v[64:67], v[228:231]
ds_read_b64_tr_b16 a[228:229], v137 offset:33024
v_mfma_f32_16x16x32_bf16 v[232:235], a[236:239], v[68:71], v[232:235]
s_waitcnt lgkmcnt(11)
ds_read_b64_tr_b16 a[234:235], v138 offset:33536
v_mfma_f32_16x16x32_bf16 a[32:35], a[240:243], a[192:195], a[32:35]
ds_read_b64_tr_b16 a[232:233], v138 offset:33024
v_mfma_f32_16x16x32_bf16 a[36:39], a[240:243], a[208:211], a[36:39]
s_waitcnt lgkmcnt(12)
ds_read_b64_tr_b16 a[238:239], v139 offset:33536
v_mfma_f32_16x16x32_bf16 v[152:155], a[240:243], v[76:79], v[152:155]
s_waitcnt lgkmcnt(11)
ds_read_b128 v[76:79], v165 offset:20736
v_mfma_f32_16x16x32_bf16 a[40:43], a[244:247], a[192:195], a[40:43]
ds_read_b64_tr_b16 a[236:237], v139 offset:33024
v_mfma_f32_16x16x32_bf16 a[44:47], a[244:247], a[208:211], a[44:47]
s_waitcnt lgkmcnt(11)
ds_read_b64_tr_b16 a[246:247], v141 offset:33536
v_mfma_f32_16x16x32_bf16 a[48:51], a[248:251], a[192:195], a[48:51]
ds_read_b64_tr_b16 a[244:245], v141 offset:33024
v_mfma_f32_16x16x32_bf16 a[52:55], a[248:251], a[208:211], a[52:55]
s_waitcnt lgkmcnt(11)
ds_read_b64_tr_b16 a[242:243], v140 offset:33536
v_mfma_f32_16x16x32_bf16 a[56:59], a[252:255], a[192:195], a[56:59]
ds_read_b64_tr_b16 a[250:251], v142 offset:33536
v_mfma_f32_16x16x32_bf16 a[60:63], a[252:255], a[208:211], a[60:63]
s_waitcnt lgkmcnt(11)
ds_read_b64_tr_b16 a[240:241], v140 offset:33024
v_mfma_f32_16x16x32_bf16 a[32:35], a[224:227], a[196:199], a[32:35]
ds_read_b64_tr_b16 a[248:249], v142 offset:33024
v_mfma_f32_16x16x32_bf16 a[36:39], a[224:227], a[212:215], a[36:39]
s_waitcnt lgkmcnt(7)
ds_read_b64_tr_b16 a[254:255], v143 offset:33536
v_mfma_f32_16x16x32_bf16 v[152:155], a[224:227], v[76:79], v[152:155]
ds_read_b128 v[76:79], v166 offset:20736
v_mfma_f32_16x16x32_bf16 a[40:43], a[228:231], a[196:199], a[40:43]
ds_read_b64_tr_b16 a[252:253], v143 offset:33024
v_mfma_f32_16x16x32_bf16 a[44:47], a[228:231], a[212:215], a[44:47]
ds_read_b64_tr_b16 a[226:227], v144 offset:33536
v_mfma_f32_16x16x32_bf16 a[48:51], a[232:235], a[196:199], a[48:51]
ds_read_b64_tr_b16 a[224:225], v144 offset:33024
v_mfma_f32_16x16x32_bf16 a[52:55], a[232:235], a[212:215], a[52:55]
s_waitcnt lgkmcnt(11)
ds_read_b64_tr_b16 a[230:231], v145 offset:33536
v_mfma_f32_16x16x32_bf16 a[56:59], a[236:239], a[196:199], a[56:59]
ds_read_b64_tr_b16 a[228:229], v145 offset:33024
v_mfma_f32_16x16x32_bf16 a[60:63], a[236:239], a[212:215], a[60:63]
s_waitcnt lgkmcnt(8)
ds_read_b64_tr_b16 a[234:235], v146 offset:33536
v_mfma_f32_16x16x32_bf16 a[32:35], a[240:243], a[200:203], a[32:35]
ds_read_b64_tr_b16 a[232:233], v146 offset:33024
v_exp_f32 v63, v63
v_mfma_f32_16x16x32_bf16 a[36:39], a[240:243], a[216:219], a[36:39]
s_waitcnt lgkmcnt(7)
ds_read_b64_tr_b16 a[238:239], v147 offset:33536
v_exp_f32 v62, v62
v_mfma_f32_16x16x32_bf16 v[152:155], a[240:243], v[76:79], v[152:155]
ds_read_b64_tr_b16 a[236:237], v147 offset:33024
v_exp_f32 v61, v61
v_mfma_f32_16x16x32_bf16 a[40:43], a[244:247], a[200:203], a[40:43]
ds_read_b128 v[76:79], v167 offset:20736
v_exp_f32 v60, v60
v_mfma_f32_16x16x32_bf16 a[44:47], a[244:247], a[216:219], a[44:47]
v_cvt_pk_bf16_f32 v73, v62, v63
v_cvt_pk_bf16_f32 v72, v60, v61
ds_write_b64 v11, v[72:73] offset:39168
v_mfma_f32_16x16x32_bf16 a[48:51], a[248:251], a[200:203], a[48:51]
v_exp_f32 v47, v47
v_mfma_f32_16x16x32_bf16 a[52:55], a[248:251], a[216:219], a[52:55]
s_waitcnt lgkmcnt(10)
v_exp_f32 v46, v46
v_mfma_f32_16x16x32_bf16 a[56:59], a[252:255], a[200:203], a[56:59]
v_exp_f32 v45, v45
v_mfma_f32_16x16x32_bf16 a[60:63], a[252:255], a[216:219], a[60:63]
s_waitcnt lgkmcnt(8)
s_waitcnt lgkmcnt(0) vmcnt(8)
s_barrier
ds_read_b128 a[240:243], v0 offset:24576
v_cvt_pk_bf16_f32 v65, v46, v47
v_mfma_f32_16x16x32_bf16 a[32:35], a[224:227], a[204:207], a[32:35]
ds_read_b128 a[244:247], v1 offset:24576
buffer_load_dwordx4 v12, s[8:11], 0 offen nt lds
v_mfma_f32_16x16x32_bf16 a[36:39], a[224:227], a[220:223], a[36:39]
s_add_u32 m0, s41, 20352
v_exp_f32 v44, v44
v_mfma_f32_16x16x32_bf16 v[152:155], a[224:227], v[76:79], v[152:155]
v_exp_f32 v51, v51
v_mfma_f32_16x16x32_bf16 a[40:43], a[228:231], a[204:207], a[40:43]
ds_read_b128 a[248:251], v2 offset:24576
v_cvt_pk_bf16_f32 v64, v44, v45
v_mfma_f32_16x16x32_bf16 a[44:47], a[228:231], a[220:223], a[44:47]
ds_read_b128 a[252:255], v3 offset:24576
buffer_load_dwordx4 v12, s[8:11], 0 offen offset:128 nt lds
v_mfma_f32_16x16x32_bf16 a[48:51], a[232:235], a[204:207], a[48:51]
s_add_u32 m0, s42, 8256
v_exp_f32 v50, v50
v_mfma_f32_16x16x32_bf16 a[52:55], a[232:235], a[220:223], a[52:55]
v_exp_f32 v49, v49
v_mfma_f32_16x16x32_bf16 a[56:59], a[236:239], a[204:207], a[56:59]
v_exp_f32 v48, v48
v_mfma_f32_16x16x32_bf16 a[60:63], a[236:239], a[220:223], a[60:63]
s_waitcnt lgkmcnt(3)
ds_read_b128 a[224:227], v0 offset:25088
v_cvt_pk_bf16_f32 v69, v50, v51
v_mfma_f32_16x16x32_bf16 v[44:47], a[240:243], a[128:131], v[20:23]
ds_read_b128 a[228:231], v1 offset:25088
v_cvt_pk_bf16_f32 v68, v48, v49
v_exp_f32 v55, v55
v_mfma_f32_16x16x32_bf16 v[48:51], a[240:243], a[144:147], v[24:27]
s_waitcnt lgkmcnt(4)
ds_read_b128 a[232:235], v2 offset:25088
buffer_load_dwordx4 v13, s[12:15], 0 offen nt lds
v_exp_f32 v54, v54
v_mfma_f32_16x16x32_bf16 v[44:47], a[244:247], a[132:135], v[44:47]
s_add_u32 m0, s42, 12256
v_exp_f32 v53, v53
v_mfma_f32_16x16x32_bf16 v[48:51], a[244:247], a[148:151], v[48:51]
s_waitcnt lgkmcnt(4)
v_exp_f32 v52, v52
v_mfma_f32_16x16x32_bf16 v[44:47], a[248:251], a[136:139], v[44:47]
v_exp_f32 v59, v59
v_mfma_f32_16x16x32_bf16 v[48:51], a[248:251], a[152:155], v[48:51]
s_waitcnt lgkmcnt(3)
ds_read_b128 a[236:239], v3 offset:25088
buffer_load_dwordx4 v13, s[12:15], 0 offen offset:128 nt lds
v_exp_f32 v58, v58
v_mfma_f32_16x16x32_bf16 v[44:47], a[252:255], a[140:143], v[44:47]
s_add_u32 m0, s42, 66048
ds_read_b128 v[80:83], v10 offset:39168
v_cvt_pk_bf16_f32 v67, v54, v55
v_exp_f32 v57, v57
v_mfma_f32_16x16x32_bf16 v[48:51], a[252:255], a[156:159], v[48:51]
s_waitcnt lgkmcnt(4)
ds_read_b64_tr_b16 a[242:243], v6 offset:17024
v_cvt_pk_bf16_f32 v66, v52, v53
v_exp_f32 v56, v56
v_mfma_f32_16x16x32_bf16 v[52:55], a[224:227], a[128:131], v[20:23]
ds_read_b64_tr_b16 a[240:241], v6 offset:16512
v_cvt_pk_bf16_f32 v71, v58, v59
v_cvt_pk_bf16_f32 v70, v56, v57
v_mfma_f32_16x16x32_bf16 v[56:59], a[224:227], a[144:147], v[24:27]
s_waitcnt lgkmcnt(5)
ds_read_b64_tr_b16 a[246:247], v6 offset:17032
buffer_load_dwordx4 v255, s[36:39], 0 offen lds
v_mfma_f32_16x16x32_bf16 v[52:55], a[228:231], a[132:135], v[52:55]
s_add_u32 m0, s42, 70176
ds_read_b64_tr_b16 a[244:245], v6 offset:16520
v_add_u32 v255, s46, v14
v_mfma_f32_16x16x32_bf16 v[56:59], a[228:231], a[148:151], v[56:59]
s_waitcnt lgkmcnt(6)
ds_read_b64_tr_b16 a[250:251], v7 offset:17024
buffer_load_dwordx4 v255, s[36:39], 0 offen lds
v_mfma_f32_16x16x32_bf16 v[52:55], a[232:235], a[136:139], v[52:55]
s_add_u32 s46, s44, 327680
ds_read_b64_tr_b16 a[248:249], v7 offset:16512
s_add_u32 m0, s42, 74304
v_mfma_f32_16x16x32_bf16 v[56:59], a[232:235], a[152:155], v[56:59]
s_waitcnt lgkmcnt(7)
ds_read_b64_tr_b16 a[254:255], v7 offset:17032
v_add_u32 v255, s46, v14
v_mfma_f32_16x16x32_bf16 v[52:55], a[236:239], a[140:143], v[52:55]
s_add_u32 s46, s44, 360448
ds_read_b64_tr_b16 a[252:253], v7 offset:16520
v_add_u32 v12, s7, v12
v_mfma_f32_16x16x32_bf16 v[56:59], a[236:239], a[156:159], v[56:59]
ds_read_b64_tr_b16 a[226:227], v8 offset:17024
buffer_load_dwordx4 v255, s[36:39], 0 offen lds
v_mfma_f32_16x16x32_bf16 v[32:35], v[16:19], v[64:67], v[32:35]
s_add_u32 m0, s42, 78432
ds_read_b64_tr_b16 a[224:225], v8 offset:16512
v_add_u32 v255, s46, v14
v_mfma_f32_16x16x32_bf16 v[36:39], v[16:19], v[68:71], v[36:39]
s_waitcnt lgkmcnt(10)
ds_read_b64_tr_b16 a[230:231], v8 offset:17032
v_add_u32 v13, s6, v13
v_mfma_f32_16x16x32_bf16 v[40:43], v[16:19], v[80:83], v[40:43]
s_waitcnt lgkmcnt(9)
ds_read_b64_tr_b16 a[228:229], v8 offset:16520
s_add_u32 s46, s45, 262144
v_mfma_f32_16x16x32_bf16 v[172:175], a[240:243], v[64:67], v[172:175]
s_and_b32 s43, s43, 0x1ffff
s_cselect_b32 s6, 0x22000, s4
ds_read_b64_tr_b16 a[234:235], v9 offset:17024
buffer_load_dwordx4 v255, s[36:39], 0 offen lds
v_mfma_f32_16x16x32_bf16 v[176:179], a[240:243], v[68:71], v[176:179]
s_add_u32 m0, s41, 24576
ds_read_b64_tr_b16 a[232:233], v9 offset:16512
v_add_u32 v255, s46, v14
v_mfma_f32_16x16x32_bf16 v[236:239], a[240:243], v[80:83], v[236:239]
s_waitcnt lgkmcnt(10)
ds_read_b64_tr_b16 a[238:239], v9 offset:17032
s_add_u32 s46, s45, 294912
v_mfma_f32_16x16x32_bf16 v[180:183], a[244:247], v[64:67], v[180:183]
ds_read_b64_tr_b16 a[236:237], v9 offset:16520
v_mfma_f32_16x16x32_bf16 v[184:187], a[244:247], v[68:71], v[184:187]
ds_read_b64_tr_b16 a[242:243], v132 offset:512
v_mfma_f32_16x16x32_bf16 v[240:243], a[244:247], v[80:83], v[240:243]
s_waitcnt lgkmcnt(11)
ds_read_b64_tr_b16 a[240:241], v132 offset:0
v_mfma_f32_16x16x32_bf16 v[188:191], a[248:251], v[64:67], v[188:191]
ds_read_b128 v[76:79], v164 offset:20736
v_mfma_f32_16x16x32_bf16 v[192:195], a[248:251], v[68:71], v[192:195]
s_waitcnt lgkmcnt(11)
ds_read_b64_tr_b16 a[246:247], v133 offset:512
v_mfma_f32_16x16x32_bf16 v[196:199], a[252:255], v[64:67], v[196:199]
ds_read_b64_tr_b16 a[244:245], v133 offset:0
v_mfma_f32_16x16x32_bf16 v[200:203], a[252:255], v[68:71], v[200:203]
s_waitcnt lgkmcnt(11)
ds_read_b64_tr_b16 a[250:251], v134 offset:512
v_mfma_f32_16x16x32_bf16 v[204:207], a[224:227], v[64:67], v[204:207]
ds_read_b64_tr_b16 a[248:249], v134 offset:0
v_mfma_f32_16x16x32_bf16 v[208:211], a[224:227], v[68:71], v[208:211]
s_waitcnt lgkmcnt(11)
ds_read_b64_tr_b16 a[254:255], v135 offset:512
v_mfma_f32_16x16x32_bf16 v[212:215], a[228:231], v[64:67], v[212:215]
ds_read_b64_tr_b16 a[252:253], v135 offset:0
v_mfma_f32_16x16x32_bf16 v[216:219], a[228:231], v[68:71], v[216:219]
s_waitcnt lgkmcnt(11)
ds_read_b64_tr_b16 a[226:227], v136 offset:512
v_mfma_f32_16x16x32_bf16 v[220:223], a[232:235], v[64:67], v[220:223]
ds_read_b64_tr_b16 a[224:225], v136 offset:0
v_mfma_f32_16x16x32_bf16 v[224:227], a[232:235], v[68:71], v[224:227]
s_waitcnt lgkmcnt(11)
ds_read_b64_tr_b16 a[230:231], v137 offset:512
v_mfma_f32_16x16x32_bf16 v[228:231], a[236:239], v[64:67], v[228:231]
ds_read_b64_tr_b16 a[228:229], v137 offset:0
v_mfma_f32_16x16x32_bf16 v[232:235], a[236:239], v[68:71], v[232:235]
s_waitcnt lgkmcnt(11)
ds_read_b64_tr_b16 a[234:235], v138 offset:512
v_mfma_f32_16x16x32_bf16 a[64:67], a[240:243], a[192:195], a[64:67]
ds_read_b64_tr_b16 a[232:233], v138 offset:0
v_mfma_f32_16x16x32_bf16 a[68:71], a[240:243], a[208:211], a[68:71]
s_waitcnt lgkmcnt(12)
ds_read_b64_tr_b16 a[238:239], v139 offset:512
v_mfma_f32_16x16x32_bf16 v[156:159], a[240:243], v[76:79], v[156:159]
s_waitcnt lgkmcnt(11)
ds_read_b128 v[76:79], v165 offset:20736
v_mfma_f32_16x16x32_bf16 a[72:75], a[244:247], a[192:195], a[72:75]
ds_read_b64_tr_b16 a[236:237], v139 offset:0
v_mfma_f32_16x16x32_bf16 a[76:79], a[244:247], a[208:211], a[76:79]
s_waitcnt lgkmcnt(11)
ds_read_b64_tr_b16 a[246:247], v141 offset:512
v_mfma_f32_16x16x32_bf16 a[80:83], a[248:251], a[192:195], a[80:83]
ds_read_b64_tr_b16 a[244:245], v141 offset:0
v_mfma_f32_16x16x32_bf16 a[84:87], a[248:251], a[208:211], a[84:87]
s_waitcnt lgkmcnt(11)
ds_read_b64_tr_b16 a[242:243], v140 offset:512
v_mfma_f32_16x16x32_bf16 a[88:91], a[252:255], a[192:195], a[88:91]
ds_read_b64_tr_b16 a[250:251], v142 offset:512
v_mfma_f32_16x16x32_bf16 a[92:95], a[252:255], a[208:211], a[92:95]
s_waitcnt lgkmcnt(11)
ds_read_b64_tr_b16 a[240:241], v140 offset:0
v_mfma_f32_16x16x32_bf16 a[64:67], a[224:227], a[196:199], a[64:67]
ds_read_b64_tr_b16 a[248:249], v142 offset:0
v_mfma_f32_16x16x32_bf16 a[68:71], a[224:227], a[212:215], a[68:71]
s_waitcnt lgkmcnt(7)
ds_read_b64_tr_b16 a[254:255], v143 offset:512
v_mfma_f32_16x16x32_bf16 v[156:159], a[224:227], v[76:79], v[156:159]
ds_read_b128 v[76:79], v166 offset:20736
v_mfma_f32_16x16x32_bf16 a[72:75], a[228:231], a[196:199], a[72:75]
ds_read_b64_tr_b16 a[252:253], v143 offset:0
v_mfma_f32_16x16x32_bf16 a[76:79], a[228:231], a[212:215], a[76:79]
ds_read_b64_tr_b16 a[226:227], v144 offset:512
v_mfma_f32_16x16x32_bf16 a[80:83], a[232:235], a[196:199], a[80:83]
ds_read_b64_tr_b16 a[224:225], v144 offset:0
v_mfma_f32_16x16x32_bf16 a[84:87], a[232:235], a[212:215], a[84:87]
s_waitcnt lgkmcnt(11)
ds_read_b64_tr_b16 a[230:231], v145 offset:512
v_mfma_f32_16x16x32_bf16 a[88:91], a[236:239], a[196:199], a[88:91]
ds_read_b64_tr_b16 a[228:229], v145 offset:0
v_mfma_f32_16x16x32_bf16 a[92:95], a[236:239], a[212:215], a[92:95]
s_waitcnt lgkmcnt(8)
ds_read_b64_tr_b16 a[234:235], v146 offset:512
v_mfma_f32_16x16x32_bf16 a[64:67], a[240:243], a[200:203], a[64:67]
ds_read_b64_tr_b16 a[232:233], v146 offset:0
v_mfma_f32_16x16x32_bf16 a[68:71], a[240:243], a[216:219], a[68:71]
s_waitcnt lgkmcnt(7)
ds_read_b64_tr_b16 a[238:239], v147 offset:512
v_mfma_f32_16x16x32_bf16 v[156:159], a[240:243], v[76:79], v[156:159]
ds_read_b64_tr_b16 a[236:237], v147 offset:0
v_mfma_f32_16x16x32_bf16 a[72:75], a[244:247], a[200:203], a[72:75]
ds_read_b128 v[76:79], v167 offset:20736
v_mfma_f32_16x16x32_bf16 a[76:79], a[244:247], a[216:219], a[76:79]
v_exp_f32 v47, v47
v_mfma_f32_16x16x32_bf16 a[80:83], a[248:251], a[200:203], a[80:83]
v_exp_f32 v46, v46
v_mfma_f32_16x16x32_bf16 a[84:87], a[248:251], a[216:219], a[84:87]
s_waitcnt lgkmcnt(9)
v_exp_f32 v45, v45
v_mfma_f32_16x16x32_bf16 a[88:91], a[252:255], a[200:203], a[88:91]
v_exp_f32 v44, v44
v_mfma_f32_16x16x32_bf16 a[92:95], a[252:255], a[216:219], a[92:95]
s_waitcnt lgkmcnt(7)
s_waitcnt lgkmcnt(0) vmcnt(8)
s_barrier
ds_read_b128 a[240:243], v0 offset:0
v_cvt_pk_bf16_f32 v65, v46, v47
v_mfma_f32_16x16x32_bf16 a[64:67], a[224:227], a[204:207], a[64:67]
ds_read_b128 a[244:247], v1 offset:0
buffer_load_dwordx4 v12, s[8:11], 0 offen nt lds
v_mfma_f32_16x16x32_bf16 a[68:71], a[224:227], a[220:223], a[68:71]
s_add_u32 m0, s41, 28544
v_exp_f32 v51, v51
v_mfma_f32_16x16x32_bf16 v[156:159], a[224:227], v[76:79], v[156:159]
ds_read_b128 a[248:251], v2 offset:0
v_cvt_pk_bf16_f32 v64, v44, v45
v_mfma_f32_16x16x32_bf16 a[72:75], a[228:231], a[204:207], a[72:75]
v_exp_f32 v50, v50
v_mfma_f32_16x16x32_bf16 a[76:79], a[228:231], a[220:223], a[76:79]
ds_read_b128 a[252:255], v3 offset:0
buffer_load_dwordx4 v12, s[8:11], 0 offen offset:128 nt lds
v_mfma_f32_16x16x32_bf16 a[80:83], a[232:235], a[204:207], a[80:83]
s_add_u32 m0, s42, 16512
v_exp_f32 v49, v49
v_mfma_f32_16x16x32_bf16 a[84:87], a[232:235], a[220:223], a[84:87]
v_exp_f32 v48, v48
v_mfma_f32_16x16x32_bf16 a[88:91], a[236:239], a[204:207], a[88:91]
ds_read_b128 a[224:227], v0 offset:512
v_cvt_pk_bf16_f32 v69, v50, v51
v_mfma_f32_16x16x32_bf16 a[92:95], a[236:239], a[220:223], a[92:95]
s_waitcnt lgkmcnt(4)
ds_read_b128 a[228:231], v1 offset:512
v_cvt_pk_bf16_f32 v68, v48, v49
v_mfma_f32_16x16x32_bf16 v[44:47], a[240:243], a[128:131], v[20:23]
v_exp_f32 v55, v55
v_mfma_f32_16x16x32_bf16 v[48:51], a[240:243], a[144:147], v[24:27]
s_waitcnt lgkmcnt(4)
ds_read_b128 a[232:235], v2 offset:512
buffer_load_dwordx4 v13, s[12:15], 0 offen nt lds
v_exp_f32 v54, v54
v_mfma_f32_16x16x32_bf16 v[44:47], a[244:247], a[132:135], v[44:47]
s_add_u32 m0, s42, 20512
v_exp_f32 v53, v53
v_mfma_f32_16x16x32_bf16 v[48:51], a[244:247], a[148:151], v[48:51]
s_waitcnt lgkmcnt(4)
v_exp_f32 v52, v52
v_mfma_f32_16x16x32_bf16 v[44:47], a[248:251], a[136:139], v[44:47]
v_exp_f32 v59, v59
v_mfma_f32_16x16x32_bf16 v[48:51], a[248:251], a[152:155], v[48:51]
s_waitcnt lgkmcnt(3)
ds_read_b128 a[236:239], v3 offset:512
buffer_load_dwordx4 v13, s[12:15], 0 offen offset:128 nt lds
v_exp_f32 v58, v58
v_mfma_f32_16x16x32_bf16 v[44:47], a[252:255], a[140:143], v[44:47]
s_add_u32 m0, s42, 33024
ds_read_b128 a[240:243], v4 offset:0
v_cvt_pk_bf16_f32 v67, v54, v55
v_exp_f32 v57, v57
v_mfma_f32_16x16x32_bf16 v[48:51], a[252:255], a[156:159], v[48:51]
s_waitcnt lgkmcnt(4)
ds_read_b128 a[244:247], v5 offset:0
v_cvt_pk_bf16_f32 v66, v52, v53
v_exp_f32 v56, v56
v_mfma_f32_16x16x32_bf16 v[52:55], a[224:227], a[128:131], v[20:23]
ds_read_b128 a[248:251], v4 offset:4096
v_cvt_pk_bf16_f32 v71, v58, v59
v_cvt_pk_bf16_f32 v70, v56, v57
v_mfma_f32_16x16x32_bf16 v[56:59], a[224:227], a[144:147], v[24:27]
s_waitcnt lgkmcnt(5)
ds_read_b128 a[252:255], v5 offset:4096
buffer_load_dwordx4 v255, s[36:39], 0 offen lds
v_mfma_f32_16x16x32_bf16 v[52:55], a[228:231], a[132:135], v[52:55]
s_add_u32 m0, s42, 37152
ds_read_b128 v[80:83], v10 offset:40192
v_add_u32 v255, s46, v14
v_mfma_f32_16x16x32_bf16 v[56:59], a[228:231], a[148:151], v[56:59]
s_waitcnt lgkmcnt(6)
ds_read_b64_tr_b16 a[226:227], v6 offset:25280
buffer_load_dwordx4 v255, s[36:39], 0 offen lds
v_mfma_f32_16x16x32_bf16 v[52:55], a[232:235], a[136:139], v[52:55]
s_add_u32 s46, s45, 327680
ds_read_b64_tr_b16 a[224:225], v6 offset:24768
s_add_u32 m0, s42, 41280
v_mfma_f32_16x16x32_bf16 v[56:59], a[232:235], a[152:155], v[56:59]
s_waitcnt lgkmcnt(7)
ds_read_b64_tr_b16 a[230:231], v6 offset:25288
v_add_u32 v255, s46, v14
v_mfma_f32_16x16x32_bf16 v[52:55], a[236:239], a[140:143], v[52:55]
s_add_u32 s46, s45, 360448
ds_read_b64_tr_b16 a[228:229], v6 offset:24776
v_add_u32 v13, s7, v13
v_mfma_f32_16x16x32_bf16 v[56:59], a[236:239], a[156:159], v[56:59]
s_waitcnt lgkmcnt(8)
ds_read_b64_tr_b16 a[234:235], v7 offset:25280
buffer_load_dwordx4 v255, s[36:39], 0 offen lds
v_mfma_f32_16x16x32_bf16 v[60:63], a[240:243], v[84:87], v[28:31]
s_waitcnt lgkmcnt(8)
ds_read_b64_tr_b16 a[232:233], v7 offset:24768
s_add_u32 m0, s42, 45408
v_mfma_f32_16x16x32_bf16 v[60:63], a[244:247], v[88:91], v[60:63]
s_waitcnt lgkmcnt(8)
ds_read_b64_tr_b16 a[238:239], v7 offset:25288
v_add_u32 v255, s46, v14
v_mfma_f32_16x16x32_bf16 v[60:63], a[248:251], v[92:95], v[60:63]
s_waitcnt lgkmcnt(8)
ds_read_b64_tr_b16 a[236:237], v7 offset:24776
s_add_u32 s46, s47, 262144
v_mfma_f32_16x16x32_bf16 v[60:63], a[252:255], v[96:99], v[60:63]
ds_read_b64_tr_b16 a[242:243], v8 offset:25280
buffer_load_dwordx4 v255, s[36:39], 0 offen lds
v_mfma_f32_16x16x32_bf16 v[32:35], v[16:19], v[64:67], v[32:35]
s_mov_b32 m0, 148224
ds_read_b64_tr_b16 a[240:241], v8 offset:24768
v_add_u32 v255, s46, v14
v_mfma_f32_16x16x32_bf16 v[36:39], v[16:19], v[68:71], v[36:39]
s_waitcnt lgkmcnt(10)
ds_read_b64_tr_b16 a[246:247], v8 offset:25288
s_add_u32 s46, s47, 294912
v_mfma_f32_16x16x32_bf16 v[40:43], v[16:19], v[80:83], v[40:43]
s_waitcnt lgkmcnt(9)
ds_read_b64_tr_b16 a[244:245], v8 offset:24776
v_add_u32 v12, s6, v12
v_mfma_f32_16x16x32_bf16 v[172:175], a[224:227], v[64:67], v[172:175]
ds_read_b64_tr_b16 a[250:251], v9 offset:25280
buffer_load_dwordx4 v253, s[92:95], s64 offen lds
v_mfma_f32_16x16x32_bf16 v[176:179], a[224:227], v[68:71], v[176:179]
s_add_u32 m0, s42, 24768
ds_read_b64_tr_b16 a[248:249], v9 offset:24768
v_mfma_f32_16x16x32_bf16 v[236:239], a[224:227], v[80:83], v[236:239]
s_waitcnt lgkmcnt(10)
ds_read_b64_tr_b16 a[254:255], v9 offset:25288
v_mfma_f32_16x16x32_bf16 v[180:183], a[228:231], v[64:67], v[180:183]
ds_read_b64_tr_b16 a[252:253], v9 offset:24776
v_mfma_f32_16x16x32_bf16 v[184:187], a[228:231], v[68:71], v[184:187]
ds_read_b64_tr_b16 a[226:227], v132 offset:17024
v_mfma_f32_16x16x32_bf16 v[240:243], a[228:231], v[80:83], v[240:243]
s_waitcnt lgkmcnt(11)
ds_read_b64_tr_b16 a[224:225], v132 offset:16512
v_mfma_f32_16x16x32_bf16 v[188:191], a[232:235], v[64:67], v[188:191]
ds_read_b128 v[76:79], v164 offset:20736
v_mfma_f32_16x16x32_bf16 v[192:195], a[232:235], v[68:71], v[192:195]
s_waitcnt lgkmcnt(11)
ds_read_b64_tr_b16 a[230:231], v133 offset:17024
v_mfma_f32_16x16x32_bf16 v[196:199], a[236:239], v[64:67], v[196:199]
ds_read_b64_tr_b16 a[228:229], v133 offset:16512
v_mfma_f32_16x16x32_bf16 v[200:203], a[236:239], v[68:71], v[200:203]
s_waitcnt lgkmcnt(11)
ds_read_b64_tr_b16 a[234:235], v134 offset:17024
v_mfma_f32_16x16x32_bf16 v[204:207], a[240:243], v[64:67], v[204:207]
ds_read_b64_tr_b16 a[232:233], v134 offset:16512
v_mfma_f32_16x16x32_bf16 v[208:211], a[240:243], v[68:71], v[208:211]
s_waitcnt lgkmcnt(11)
ds_read_b64_tr_b16 a[238:239], v135 offset:17024
v_mfma_f32_16x16x32_bf16 v[212:215], a[244:247], v[64:67], v[212:215]
ds_read_b64_tr_b16 a[236:237], v135 offset:16512
v_mfma_f32_16x16x32_bf16 v[216:219], a[244:247], v[68:71], v[216:219]
s_waitcnt lgkmcnt(11)
ds_read_b64_tr_b16 a[242:243], v136 offset:17024
v_mfma_f32_16x16x32_bf16 v[220:223], a[248:251], v[64:67], v[220:223]
ds_read_b64_tr_b16 a[240:241], v136 offset:16512
v_mfma_f32_16x16x32_bf16 v[224:227], a[248:251], v[68:71], v[224:227]
s_waitcnt lgkmcnt(11)
ds_read_b64_tr_b16 a[246:247], v137 offset:17024
v_mfma_f32_16x16x32_bf16 v[228:231], a[252:255], v[64:67], v[228:231]
ds_read_b64_tr_b16 a[244:245], v137 offset:16512
v_mfma_f32_16x16x32_bf16 v[232:235], a[252:255], v[68:71], v[232:235]
s_waitcnt lgkmcnt(11)
ds_read_b64_tr_b16 a[250:251], v138 offset:17024
v_mfma_f32_16x16x32_bf16 a[96:99], a[224:227], a[192:195], a[96:99]
ds_read_b64_tr_b16 a[248:249], v138 offset:16512
v_mfma_f32_16x16x32_bf16 a[100:103], a[224:227], a[208:211], a[100:103]
s_waitcnt lgkmcnt(12)
ds_read_b64_tr_b16 a[254:255], v139 offset:17024
v_mfma_f32_16x16x32_bf16 v[160:163], a[224:227], v[76:79], v[160:163]
s_waitcnt lgkmcnt(11)
ds_read_b128 v[76:79], v165 offset:20736
v_mfma_f32_16x16x32_bf16 a[104:107], a[228:231], a[192:195], a[104:107]
ds_read_b64_tr_b16 a[252:253], v139 offset:16512
v_mfma_f32_16x16x32_bf16 a[108:111], a[228:231], a[208:211], a[108:111]
s_waitcnt lgkmcnt(11)
ds_read_b64_tr_b16 a[230:231], v141 offset:17024
v_mfma_f32_16x16x32_bf16 a[112:115], a[232:235], a[192:195], a[112:115]
ds_read_b64_tr_b16 a[228:229], v141 offset:16512
v_mfma_f32_16x16x32_bf16 a[116:119], a[232:235], a[208:211], a[116:119]
s_waitcnt lgkmcnt(11)
ds_read_b64_tr_b16 a[226:227], v140 offset:17024
v_mfma_f32_16x16x32_bf16 a[120:123], a[236:239], a[192:195], a[120:123]
ds_read_b64_tr_b16 a[234:235], v142 offset:17024
v_mfma_f32_16x16x32_bf16 a[124:127], a[236:239], a[208:211], a[124:127]
s_waitcnt lgkmcnt(11)
ds_read_b64_tr_b16 a[224:225], v140 offset:16512
v_mfma_f32_16x16x32_bf16 a[96:99], a[240:243], a[196:199], a[96:99]
ds_read_b64_tr_b16 a[232:233], v142 offset:16512
v_mfma_f32_16x16x32_bf16 a[100:103], a[240:243], a[212:215], a[100:103]
s_waitcnt lgkmcnt(7)
ds_read_b64_tr_b16 a[238:239], v143 offset:17024
v_mfma_f32_16x16x32_bf16 v[160:163], a[240:243], v[76:79], v[160:163]
ds_read_b128 v[76:79], v166 offset:20736
v_mfma_f32_16x16x32_bf16 a[104:107], a[244:247], a[196:199], a[104:107]
ds_read_b64_tr_b16 a[236:237], v143 offset:16512
v_mfma_f32_16x16x32_bf16 a[108:111], a[244:247], a[212:215], a[108:111]
ds_read_b64_tr_b16 a[242:243], v144 offset:17024
v_mfma_f32_16x16x32_bf16 a[112:115], a[248:251], a[196:199], a[112:115]
ds_read_b64_tr_b16 a[240:241], v144 offset:16512
v_mfma_f32_16x16x32_bf16 a[116:119], a[248:251], a[212:215], a[116:119]
s_waitcnt lgkmcnt(11)
ds_read_b64_tr_b16 a[246:247], v145 offset:17024
v_mfma_f32_16x16x32_bf16 a[120:123], a[252:255], a[196:199], a[120:123]
ds_read_b64_tr_b16 a[244:245], v145 offset:16512
v_mfma_f32_16x16x32_bf16 a[124:127], a[252:255], a[212:215], a[124:127]
s_waitcnt lgkmcnt(8)
ds_read_b64_tr_b16 a[250:251], v146 offset:17024
v_mfma_f32_16x16x32_bf16 a[96:99], a[224:227], a[200:203], a[96:99]
ds_read_b64_tr_b16 a[248:249], v146 offset:16512
v_exp_f32 v63, v63
v_mfma_f32_16x16x32_bf16 a[100:103], a[224:227], a[216:219], a[100:103]
s_waitcnt lgkmcnt(7)
ds_read_b64_tr_b16 a[254:255], v147 offset:17024
v_exp_f32 v62, v62
v_mfma_f32_16x16x32_bf16 v[160:163], a[224:227], v[76:79], v[160:163]
ds_read_b64_tr_b16 a[252:253], v147 offset:16512
v_exp_f32 v61, v61
v_mfma_f32_16x16x32_bf16 a[104:107], a[228:231], a[200:203], a[104:107]
ds_read_b128 v[76:79], v167 offset:20736
v_exp_f32 v60, v60
v_mfma_f32_16x16x32_bf16 a[108:111], a[228:231], a[216:219], a[108:111]
v_cvt_pk_bf16_f32 v73, v62, v63
v_cvt_pk_bf16_f32 v72, v60, v61
ds_write_b64 v11, v[72:73] offset:37120
v_mfma_f32_16x16x32_bf16 a[112:115], a[232:235], a[200:203], a[112:115]
v_exp_f32 v47, v47
v_mfma_f32_16x16x32_bf16 a[116:119], a[232:235], a[216:219], a[116:119]
s_waitcnt lgkmcnt(10)
v_exp_f32 v46, v46
v_mfma_f32_16x16x32_bf16 a[120:123], a[236:239], a[200:203], a[120:123]
v_exp_f32 v45, v45
v_mfma_f32_16x16x32_bf16 a[124:127], a[236:239], a[216:219], a[124:127]
s_waitcnt lgkmcnt(8)
s_waitcnt lgkmcnt(0) vmcnt(9)
s_barrier
ds_read_b128 a[224:227], v0 offset:8192
v_cvt_pk_bf16_f32 v65, v46, v47
v_mfma_f32_16x16x32_bf16 a[96:99], a[240:243], a[204:207], a[96:99]
ds_read_b128 a[228:231], v1 offset:8192
v_mfma_f32_16x16x32_bf16 a[100:103], a[240:243], a[220:223], a[100:103]
v_exp_f32 v44, v44
v_mfma_f32_16x16x32_bf16 v[160:163], a[240:243], v[76:79], v[160:163]
v_exp_f32 v51, v51
v_mfma_f32_16x16x32_bf16 a[104:107], a[244:247], a[204:207], a[104:107]
ds_read_b128 a[232:235], v2 offset:8192
v_cvt_pk_bf16_f32 v64, v44, v45
v_mfma_f32_16x16x32_bf16 a[108:111], a[244:247], a[220:223], a[108:111]
v_exp_f32 v50, v50
v_mfma_f32_16x16x32_bf16 a[112:115], a[248:251], a[204:207], a[112:115]
v_exp_f32 v49, v49
v_mfma_f32_16x16x32_bf16 a[116:119], a[248:251], a[220:223], a[116:119]
ds_read_b128 a[236:239], v3 offset:8192
v_cvt_pk_bf16_f32 v69, v50, v51
v_mfma_f32_16x16x32_bf16 a[120:123], a[252:255], a[204:207], a[120:123]
v_exp_f32 v48, v48
v_mfma_f32_16x16x32_bf16 a[124:127], a[252:255], a[220:223], a[124:127]
s_waitcnt lgkmcnt(3)
ds_read_b128 a[240:243], v0 offset:8704
v_cvt_pk_bf16_f32 v68, v48, v49
v_mfma_f32_16x16x32_bf16 v[44:47], a[224:227], a[128:131], v[20:23]
v_exp_f32 v55, v55
v_mfma_f32_16x16x32_bf16 v[48:51], a[224:227], a[144:147], v[24:27]
s_waitcnt lgkmcnt(3)
ds_read_b128 a[244:247], v1 offset:8704
buffer_load_dwordx4 v13, s[12:15], 0 offen nt lds
v_exp_f32 v54, v54
v_mfma_f32_16x16x32_bf16 v[44:47], a[228:231], a[132:135], v[44:47]
s_add_u32 m0, s42, 28768
v_exp_f32 v53, v53
v_mfma_f32_16x16x32_bf16 v[48:51], a[228:231], a[148:151], v[48:51]
s_waitcnt lgkmcnt(3)
v_exp_f32 v52, v52
v_mfma_f32_16x16x32_bf16 v[44:47], a[232:235], a[136:139], v[44:47]
v_exp_f32 v59, v59
v_mfma_f32_16x16x32_bf16 v[48:51], a[232:235], a[152:155], v[48:51]
s_waitcnt lgkmcnt(2)
ds_read_b128 a[248:251], v2 offset:8704
buffer_load_dwordx4 v13, s[12:15], 0 offen offset:128 nt lds
v_exp_f32 v58, v58
v_mfma_f32_16x16x32_bf16 v[44:47], a[236:239], a[140:143], v[44:47]
s_add_u32 m0, s42, 49536
ds_read_b128 a[252:255], v3 offset:8704
v_cvt_pk_bf16_f32 v67, v54, v55
v_exp_f32 v57, v57
v_mfma_f32_16x16x32_bf16 v[48:51], a[236:239], a[156:159], v[48:51]
s_waitcnt lgkmcnt(3)
ds_read_b128 v[80:83], v10 offset:37120
v_cvt_pk_bf16_f32 v66, v52, v53
v_exp_f32 v56, v56
v_mfma_f32_16x16x32_bf16 v[52:55], a[240:243], a[128:131], v[20:23]
ds_read_b64_tr_b16 a[226:227], v6 offset:512
v_cvt_pk_bf16_f32 v71, v58, v59
v_cvt_pk_bf16_f32 v70, v56, v57
v_mfma_f32_16x16x32_bf16 v[56:59], a[240:243], a[144:147], v[24:27]
s_waitcnt lgkmcnt(4)
ds_read_b64_tr_b16 a[224:225], v6 offset:0
buffer_load_dwordx4 v255, s[36:39], 0 offen lds
v_mfma_f32_16x16x32_bf16 v[52:55], a[244:247], a[132:135], v[52:55]
s_add_u32 m0, s42, 53664
ds_read_b64_tr_b16 a[230:231], v6 offset:520
v_add_u32 v255, s46, v14
v_mfma_f32_16x16x32_bf16 v[56:59], a[244:247], a[148:151], v[56:59]
s_waitcnt lgkmcnt(5)
ds_read_b64_tr_b16 a[228:229], v6 offset:8
buffer_load_dwordx4 v255, s[36:39], 0 offen lds
v_mfma_f32_16x16x32_bf16 v[52:55], a[248:251], a[136:139], v[52:55]
s_add_u32 s46, s47, 327680
ds_read_b64_tr_b16 a[234:235], v7 offset:512
s_add_u32 m0, s42, 57792
v_mfma_f32_16x16x32_bf16 v[56:59], a[248:251], a[152:155], v[56:59]
s_waitcnt lgkmcnt(6)
ds_read_b64_tr_b16 a[232:233], v7 offset:0
v_add_u32 v255, s46, v14
v_mfma_f32_16x16x32_bf16 v[52:55], a[252:255], a[140:143], v[52:55]
s_add_u32 s46, s47, 360448
ds_read_b64_tr_b16 a[238:239], v7 offset:520
v_add_u32 v13, s6, v13
v_mfma_f32_16x16x32_bf16 v[56:59], a[252:255], a[156:159], v[56:59]
ds_read_b64_tr_b16 a[236:237], v7 offset:8
buffer_load_dwordx4 v255, s[36:39], 0 offen lds
v_mfma_f32_16x16x32_bf16 v[32:35], v[16:19], v[64:67], v[32:35]
s_add_u32 m0, s42, 61920
ds_read_b64_tr_b16 a[242:243], v8 offset:512
v_add_u32 v255, s46, v14
v_mfma_f32_16x16x32_bf16 v[36:39], v[16:19], v[68:71], v[36:39]
s_waitcnt lgkmcnt(9)
ds_read_b64_tr_b16 a[240:241], v8 offset:0
s_add_u32 s46, s71, 262144
v_mfma_f32_16x16x32_bf16 v[40:43], v[16:19], v[80:83], v[40:43]
s_waitcnt lgkmcnt(8)
ds_read_b64_tr_b16 a[246:247], v8 offset:520
v_mfma_f32_16x16x32_bf16 v[172:175], a[224:227], v[64:67], v[172:175]
ds_read_b64_tr_b16 a[244:245], v8 offset:8
buffer_load_dwordx4 v255, s[36:39], 0 offen lds
v_mfma_f32_16x16x32_bf16 v[176:179], a[224:227], v[68:71], v[176:179]
s_add_u32 m0, s42, 66048
ds_read_b64_tr_b16 a[250:251], v9 offset:512
v_add_u32 v255, s46, v14
v_mfma_f32_16x16x32_bf16 v[236:239], a[224:227], v[80:83], v[236:239]
s_waitcnt lgkmcnt(9)
ds_read_b64_tr_b16 a[248:249], v9 offset:0
s_add_u32 s46, s71, 294912
v_mfma_f32_16x16x32_bf16 v[180:183], a[228:231], v[64:67], v[180:183]
ds_read_b64_tr_b16 a[254:255], v9 offset:520
v_mfma_f32_16x16x32_bf16 v[184:187], a[228:231], v[68:71], v[184:187]
ds_read_b64_tr_b16 a[252:253], v9 offset:8
v_mfma_f32_16x16x32_bf16 v[240:243], a[228:231], v[80:83], v[240:243]
s_waitcnt lgkmcnt(10)
ds_read_b64_tr_b16 a[226:227], v132 offset:33536
v_mfma_f32_16x16x32_bf16 v[188:191], a[232:235], v[64:67], v[188:191]
ds_read_b64_tr_b16 a[224:225], v132 offset:33024
v_mfma_f32_16x16x32_bf16 v[192:195], a[232:235], v[68:71], v[192:195]
s_waitcnt lgkmcnt(10)
ds_read_b128 v[76:79], v164 offset:24832
v_mfma_f32_16x16x32_bf16 v[196:199], a[236:239], v[64:67], v[196:199]
ds_read_b64_tr_b16 a[230:231], v133 offset:33536
v_mfma_f32_16x16x32_bf16 v[200:203], a[236:239], v[68:71], v[200:203]
s_waitcnt lgkmcnt(10)
ds_read_b64_tr_b16 a[228:229], v133 offset:33024
v_mfma_f32_16x16x32_bf16 v[204:207], a[240:243], v[64:67], v[204:207]
ds_read_b64_tr_b16 a[234:235], v134 offset:33536
v_mfma_f32_16x16x32_bf16 v[208:211], a[240:243], v[68:71], v[208:211]
s_waitcnt lgkmcnt(10)
ds_read_b64_tr_b16 a[232:233], v134 offset:33024
v_mfma_f32_16x16x32_bf16 v[212:215], a[244:247], v[64:67], v[212:215]
ds_read_b64_tr_b16 a[238:239], v135 offset:33536
v_mfma_f32_16x16x32_bf16 v[216:219], a[244:247], v[68:71], v[216:219]
s_waitcnt lgkmcnt(10)
ds_read_b64_tr_b16 a[236:237], v135 offset:33024
v_mfma_f32_16x16x32_bf16 v[220:223], a[248:251], v[64:67], v[220:223]
ds_read_b64_tr_b16 a[242:243], v136 offset:33536
v_mfma_f32_16x16x32_bf16 v[224:227], a[248:251], v[68:71], v[224:227]
s_waitcnt lgkmcnt(10)
ds_read_b64_tr_b16 a[240:241], v136 offset:33024
v_mfma_f32_16x16x32_bf16 v[228:231], a[252:255], v[64:67], v[228:231]
ds_read_b64_tr_b16 a[246:247], v137 offset:33536
v_mfma_f32_16x16x32_bf16 v[232:235], a[252:255], v[68:71], v[232:235]
s_waitcnt lgkmcnt(10)
ds_read_b64_tr_b16 a[244:245], v137 offset:33024
v_mfma_f32_16x16x32_bf16 a[0:3], a[224:227], v[100:103], a[0:3]
ds_read_b64_tr_b16 a[250:251], v138 offset:33536
v_mfma_f32_16x16x32_bf16 a[4:7], a[224:227], v[116:119], a[4:7]
s_waitcnt lgkmcnt(11)
ds_read_b64_tr_b16 a[248:249], v138 offset:33024
v_mfma_f32_16x16x32_bf16 v[148:151], a[224:227], v[76:79], v[148:151]
s_waitcnt lgkmcnt(10)
ds_read_b128 v[76:79], v165 offset:24832
v_mfma_f32_16x16x32_bf16 a[8:11], a[228:231], v[100:103], a[8:11]
ds_read_b64_tr_b16 a[254:255], v139 offset:33536
v_mfma_f32_16x16x32_bf16 a[12:15], a[228:231], v[116:119], a[12:15]
s_waitcnt lgkmcnt(10)
ds_read_b64_tr_b16 a[230:231], v141 offset:33536
v_mfma_f32_16x16x32_bf16 a[16:19], a[232:235], v[100:103], a[16:19]
ds_read_b64_tr_b16 a[252:253], v139 offset:33024
v_mfma_f32_16x16x32_bf16 a[20:23], a[232:235], v[116:119], a[20:23]
s_waitcnt lgkmcnt(10)
ds_read_b64_tr_b16 a[228:229], v141 offset:33024
v_mfma_f32_16x16x32_bf16 a[24:27], a[236:239], v[100:103], a[24:27]
ds_read_b64_tr_b16 a[226:227], v140 offset:33536
v_mfma_f32_16x16x32_bf16 a[28:31], a[236:239], v[116:119], a[28:31]
s_waitcnt lgkmcnt(10)
ds_read_b64_tr_b16 a[234:235], v142 offset:33536
v_mfma_f32_16x16x32_bf16 a[0:3], a[240:243], v[104:107], a[0:3]
ds_read_b64_tr_b16 a[224:225], v140 offset:33024
v_mfma_f32_16x16x32_bf16 a[4:7], a[240:243], v[120:123], a[4:7]
s_waitcnt lgkmcnt(7)
ds_read_b64_tr_b16 a[232:233], v142 offset:33024
v_mfma_f32_16x16x32_bf16 v[148:151], a[240:243], v[76:79], v[148:151]
ds_read_b64_tr_b16 a[238:239], v143 offset:33536
ds_read_b128 v[76:79], v166 offset:24832
v_mfma_f32_16x16x32_bf16 a[8:11], a[244:247], v[104:107], a[8:11]
ds_read_b64_tr_b16 a[236:237], v143 offset:33024
v_mfma_f32_16x16x32_bf16 a[12:15], a[244:247], v[120:123], a[12:15]
ds_read_b64_tr_b16 a[242:243], v144 offset:33536
v_mfma_f32_16x16x32_bf16 a[16:19], a[248:251], v[104:107], a[16:19]
ds_read_b64_tr_b16 a[240:241], v144 offset:33024
v_mfma_f32_16x16x32_bf16 a[20:23], a[248:251], v[120:123], a[20:23]
s_waitcnt lgkmcnt(10)
ds_read_b64_tr_b16 a[246:247], v145 offset:33536
v_mfma_f32_16x16x32_bf16 a[24:27], a[252:255], v[104:107], a[24:27]
ds_read_b64_tr_b16 a[244:245], v145 offset:33024
v_mfma_f32_16x16x32_bf16 a[28:31], a[252:255], v[120:123], a[28:31]
s_waitcnt lgkmcnt(8)
ds_read_b64_tr_b16 a[250:251], v146 offset:33536
v_mfma_f32_16x16x32_bf16 a[0:3], a[224:227], v[108:111], a[0:3]
ds_read_b64_tr_b16 a[248:249], v146 offset:33024
v_mfma_f32_16x16x32_bf16 a[4:7], a[224:227], v[124:127], a[4:7]
s_waitcnt lgkmcnt(7)
ds_read_b64_tr_b16 a[254:255], v147 offset:33536
v_mfma_f32_16x16x32_bf16 v[148:151], a[224:227], v[76:79], v[148:151]
ds_read_b64_tr_b16 a[252:253], v147 offset:33024
v_mfma_f32_16x16x32_bf16 a[8:11], a[228:231], v[108:111], a[8:11]
ds_read_b128 v[76:79], v167 offset:24832
v_mfma_f32_16x16x32_bf16 a[12:15], a[228:231], v[124:127], a[12:15]
v_exp_f32 v47, v47
v_mfma_f32_16x16x32_bf16 a[16:19], a[232:235], v[108:111], a[16:19]
v_exp_f32 v46, v46
v_mfma_f32_16x16x32_bf16 a[20:23], a[232:235], v[124:127], a[20:23]
s_waitcnt lgkmcnt(9)
v_exp_f32 v45, v45
v_mfma_f32_16x16x32_bf16 a[24:27], a[236:239], v[108:111], a[24:27]
v_exp_f32 v44, v44
v_mfma_f32_16x16x32_bf16 a[28:31], a[236:239], v[124:127], a[28:31]
s_waitcnt lgkmcnt(7)
s_waitcnt lgkmcnt(0) vmcnt(7)
s_barrier
ds_read_b128 a[224:227], v0 offset:16384
v_cvt_pk_bf16_f32 v65, v46, v47
v_mfma_f32_16x16x32_bf16 a[0:3], a[240:243], v[112:115], a[0:3]
ds_read_b128 a[228:231], v1 offset:16384
buffer_load_dwordx4 v255, s[36:39], 0 offen lds
v_mfma_f32_16x16x32_bf16 a[4:7], a[240:243], v[128:131], a[4:7]
s_add_u32 m0, s42, 70176
v_exp_f32 v51, v51
v_mfma_f32_16x16x32_bf16 v[148:151], a[240:243], v[76:79], v[148:151]
ds_read_b128 a[232:235], v2 offset:16384
v_add_u32 v255, s46, v14
v_mfma_f32_16x16x32_bf16 a[8:11], a[244:247], v[112:115], a[8:11]
s_add_u32 s46, s71, 327680
v_exp_f32 v50, v50
v_mfma_f32_16x16x32_bf16 a[12:15], a[244:247], v[128:131], a[12:15]
ds_read_b128 a[236:239], v3 offset:16384
buffer_load_dwordx4 v255, s[36:39], 0 offen lds
v_mfma_f32_16x16x32_bf16 a[16:19], a[248:251], v[112:115], a[16:19]
s_add_u32 m0, s42, 74304
v_exp_f32 v49, v49
v_mfma_f32_16x16x32_bf16 a[20:23], a[248:251], v[128:131], a[20:23]
ds_read_b128 a[240:243], v0 offset:16896
v_cvt_pk_bf16_f32 v64, v44, v45
v_mfma_f32_16x16x32_bf16 a[24:27], a[252:255], v[112:115], a[24:27]
v_exp_f32 v48, v48
v_mfma_f32_16x16x32_bf16 a[28:31], a[252:255], v[128:131], a[28:31]
s_waitcnt lgkmcnt(4)
ds_read_b128 a[244:247], v1 offset:16896
v_cvt_pk_bf16_f32 v69, v50, v51
v_mfma_f32_16x16x32_bf16 v[44:47], a[224:227], a[128:131], v[20:23]
ds_read_b128 a[248:251], v2 offset:16896
v_cvt_pk_bf16_f32 v68, v48, v49
v_exp_f32 v55, v55
v_mfma_f32_16x16x32_bf16 v[48:51], a[224:227], a[144:147], v[24:27]
s_waitcnt lgkmcnt(5)
ds_read_b128 a[252:255], v3 offset:16896
v_add_u32 v255, s46, v14
buffer_load_dwordx4 v255, s[36:39], 0 offen lds
v_mfma_f32_16x16x32_bf16 v[44:47], a[228:231], a[132:135], v[44:47]
s_add_u32 s46, s71, 360448
v_exp_f32 v54, v54
v_exp_f32 v53, v53
v_mfma_f32_16x16x32_bf16 v[48:51], a[228:231], a[148:151], v[48:51]
s_waitcnt lgkmcnt(5)
v_exp_f32 v52, v52
v_mfma_f32_16x16x32_bf16 v[44:47], a[232:235], a[136:139], v[44:47]
s_add_u32 m0, s42, 78432
v_exp_f32 v59, v59
v_mfma_f32_16x16x32_bf16 v[48:51], a[232:235], a[152:155], v[48:51]
s_waitcnt lgkmcnt(4)
ds_read_b128 a[224:227], v4 offset:16384
v_add_u32 v255, s46, v14
buffer_load_dwordx4 v255, s[36:39], 0 offen lds
v_mfma_f32_16x16x32_bf16 v[44:47], a[236:239], a[140:143], v[44:47]
s_add_u32 s46, s44, 393216
v_exp_f32 v58, v58
v_cvt_pk_bf16_f32 v67, v54, v55
v_mfma_f32_16x16x32_bf16 v[48:51], a[236:239], a[156:159], v[48:51]
s_waitcnt lgkmcnt(4)
v_exp_f32 v57, v57
v_cvt_pk_bf16_f32 v66, v52, v53
v_mfma_f32_16x16x32_bf16 v[52:55], a[240:243], a[128:131], v[20:23]
s_add_u32 m0, s42, 33024
v_exp_f32 v56, v56
v_cvt_pk_bf16_f32 v71, v58, v59
v_cvt_pk_bf16_f32 v70, v56, v57
v_mfma_f32_16x16x32_bf16 v[56:59], a[240:243], a[144:147], v[24:27]
s_waitcnt lgkmcnt(3)
ds_read_b128 a[228:231], v5 offset:16384
v_add_u32 v255, s46, v14
v_mfma_f32_16x16x32_bf16 v[52:55], a[244:247], a[132:135], v[52:55]
s_add_u32 s46, s44, 425984
ds_read_b128 a[232:235], v4 offset:20480
v_mfma_f32_16x16x32_bf16 v[56:59], a[244:247], a[148:151], v[56:59]
s_waitcnt lgkmcnt(4)
ds_read_b128 a[236:239], v5 offset:20480
v_mfma_f32_16x16x32_bf16 v[52:55], a[248:251], a[136:139], v[52:55]
ds_read_b128 v[80:83], v10 offset:38144
v_mfma_f32_16x16x32_bf16 v[56:59], a[248:251], a[152:155], v[56:59]
s_waitcnt lgkmcnt(5)
ds_read_b64_tr_b16 a[242:243], v6 offset:8768
v_mfma_f32_16x16x32_bf16 v[52:55], a[252:255], a[140:143], v[52:55]
ds_read_b64_tr_b16 a[240:241], v6 offset:8256
v_mfma_f32_16x16x32_bf16 v[56:59], a[252:255], a[156:159], v[56:59]
s_waitcnt lgkmcnt(6)
ds_read_b64_tr_b16 a[246:247], v6 offset:8776
v_mfma_f32_16x16x32_bf16 v[60:63], a[224:227], v[84:87], v[28:31]
s_waitcnt lgkmcnt(6)
ds_read_b64_tr_b16 a[244:245], v6 offset:8264
v_mfma_f32_16x16x32_bf16 v[60:63], a[228:231], v[88:91], v[60:63]
s_waitcnt lgkmcnt(6)
ds_read_b64_tr_b16 a[250:251], v7 offset:8768
v_mfma_f32_16x16x32_bf16 v[60:63], a[232:235], v[92:95], v[60:63]
s_waitcnt lgkmcnt(6)
ds_read_b64_tr_b16 a[248:249], v7 offset:8256
v_mfma_f32_16x16x32_bf16 v[60:63], a[236:239], v[96:99], v[60:63]
ds_read_b64_tr_b16 a[254:255], v7 offset:8776
v_mfma_f32_16x16x32_bf16 v[32:35], v[16:19], v[64:67], v[32:35]
ds_read_b64_tr_b16 a[252:253], v7 offset:8264
v_mfma_f32_16x16x32_bf16 v[36:39], v[16:19], v[68:71], v[36:39]
s_waitcnt lgkmcnt(8)
ds_read_b64_tr_b16 a[226:227], v8 offset:8768
v_mfma_f32_16x16x32_bf16 v[40:43], v[16:19], v[80:83], v[40:43]
s_waitcnt lgkmcnt(7)
ds_read_b64_tr_b16 a[224:225], v8 offset:8256
v_mfma_f32_16x16x32_bf16 v[172:175], a[240:243], v[64:67], v[172:175]
ds_read_b64_tr_b16 a[230:231], v8 offset:8776
v_mfma_f32_16x16x32_bf16 v[176:179], a[240:243], v[68:71], v[176:179]
ds_read_b64_tr_b16 a[228:229], v8 offset:8264
v_mfma_f32_16x16x32_bf16 v[236:239], a[240:243], v[80:83], v[236:239]
s_waitcnt lgkmcnt(8)
ds_read_b64_tr_b16 a[234:235], v9 offset:8768
v_mfma_f32_16x16x32_bf16 v[180:183], a[244:247], v[64:67], v[180:183]
ds_read_b64_tr_b16 a[232:233], v9 offset:8256
v_mfma_f32_16x16x32_bf16 v[184:187], a[244:247], v[68:71], v[184:187]
ds_read_b64_tr_b16 a[238:239], v9 offset:8776
v_mfma_f32_16x16x32_bf16 v[240:243], a[244:247], v[80:83], v[240:243]
s_waitcnt lgkmcnt(9)
ds_read_b64_tr_b16 a[236:237], v9 offset:8264
v_mfma_f32_16x16x32_bf16 v[188:191], a[248:251], v[64:67], v[188:191]
ds_read_b64_tr_b16 a[242:243], v132 offset:512
v_mfma_f32_16x16x32_bf16 v[192:195], a[248:251], v[68:71], v[192:195]
s_waitcnt lgkmcnt(9)
ds_read_b64_tr_b16 a[240:241], v132 offset:0
v_mfma_f32_16x16x32_bf16 v[196:199], a[252:255], v[64:67], v[196:199]
ds_read_b128 v[76:79], v164 offset:24832
v_mfma_f32_16x16x32_bf16 v[200:203], a[252:255], v[68:71], v[200:203]
s_waitcnt lgkmcnt(9)
ds_read_b64_tr_b16 a[246:247], v133 offset:512
v_mfma_f32_16x16x32_bf16 v[204:207], a[224:227], v[64:67], v[204:207]
ds_read_b64_tr_b16 a[244:245], v133 offset:0
v_mfma_f32_16x16x32_bf16 v[208:211], a[224:227], v[68:71], v[208:211]
s_waitcnt lgkmcnt(9)
ds_read_b64_tr_b16 a[250:251], v134 offset:512
v_mfma_f32_16x16x32_bf16 v[212:215], a[228:231], v[64:67], v[212:215]
ds_read_b64_tr_b16 a[248:249], v134 offset:0
v_mfma_f32_16x16x32_bf16 v[216:219], a[228:231], v[68:71], v[216:219]
s_waitcnt lgkmcnt(9)
ds_read_b64_tr_b16 a[254:255], v135 offset:512
v_mfma_f32_16x16x32_bf16 v[220:223], a[232:235], v[64:67], v[220:223]
ds_read_b64_tr_b16 a[252:253], v135 offset:0
v_mfma_f32_16x16x32_bf16 v[224:227], a[232:235], v[68:71], v[224:227]
s_waitcnt lgkmcnt(9)
ds_read_b64_tr_b16 a[226:227], v136 offset:512
v_mfma_f32_16x16x32_bf16 v[228:231], a[236:239], v[64:67], v[228:231]
ds_read_b64_tr_b16 a[224:225], v136 offset:0
v_mfma_f32_16x16x32_bf16 v[232:235], a[236:239], v[68:71], v[232:235]
s_waitcnt lgkmcnt(9)
ds_read_b64_tr_b16 a[230:231], v137 offset:512
v_mfma_f32_16x16x32_bf16 a[32:35], a[240:243], v[100:103], a[32:35]
ds_read_b64_tr_b16 a[228:229], v137 offset:0
v_mfma_f32_16x16x32_bf16 a[36:39], a[240:243], v[116:119], a[36:39]
s_waitcnt lgkmcnt(10)
ds_read_b64_tr_b16 a[234:235], v138 offset:512
v_mfma_f32_16x16x32_bf16 v[152:155], a[240:243], v[76:79], v[152:155]
s_waitcnt lgkmcnt(9)
ds_read_b128 v[76:79], v165 offset:24832
v_mfma_f32_16x16x32_bf16 a[40:43], a[244:247], v[100:103], a[40:43]
ds_read_b64_tr_b16 a[232:233], v138 offset:0
v_mfma_f32_16x16x32_bf16 a[44:47], a[244:247], v[116:119], a[44:47]
s_waitcnt lgkmcnt(9)
ds_read_b64_tr_b16 a[238:239], v139 offset:512
v_mfma_f32_16x16x32_bf16 a[48:51], a[248:251], v[100:103], a[48:51]
ds_read_b64_tr_b16 a[246:247], v141 offset:512
v_mfma_f32_16x16x32_bf16 a[52:55], a[248:251], v[116:119], a[52:55]
s_waitcnt lgkmcnt(9)
ds_read_b64_tr_b16 a[236:237], v139 offset:0
v_mfma_f32_16x16x32_bf16 a[56:59], a[252:255], v[100:103], a[56:59]
ds_read_b64_tr_b16 a[244:245], v141 offset:0
v_mfma_f32_16x16x32_bf16 a[60:63], a[252:255], v[116:119], a[60:63]
s_waitcnt lgkmcnt(9)
ds_read_b64_tr_b16 a[242:243], v140 offset:512
v_mfma_f32_16x16x32_bf16 a[32:35], a[224:227], v[104:107], a[32:35]
ds_read_b64_tr_b16 a[250:251], v142 offset:512
v_mfma_f32_16x16x32_bf16 a[36:39], a[224:227], v[120:123], a[36:39]
s_waitcnt lgkmcnt(7)
ds_read_b64_tr_b16 a[240:241], v140 offset:0
ds_read_b64_tr_b16 a[248:249], v142 offset:0
v_mfma_f32_16x16x32_bf16 v[152:155], a[224:227], v[76:79], v[152:155]
ds_read_b64_tr_b16 a[254:255], v143 offset:512
ds_read_b128 v[76:79], v166 offset:24832
v_mfma_f32_16x16x32_bf16 a[40:43], a[228:231], v[104:107], a[40:43]
ds_read_b64_tr_b16 a[252:253], v143 offset:0
v_mfma_f32_16x16x32_bf16 a[44:47], a[228:231], v[120:123], a[44:47]
s_waitcnt lgkmcnt(11)
ds_read_b64_tr_b16 a[226:227], v144 offset:512
v_mfma_f32_16x16x32_bf16 a[48:51], a[232:235], v[104:107], a[48:51]
ds_read_b64_tr_b16 a[224:225], v144 offset:0
v_mfma_f32_16x16x32_bf16 a[52:55], a[232:235], v[120:123], a[52:55]
s_waitcnt lgkmcnt(10)
ds_read_b64_tr_b16 a[230:231], v145 offset:512
v_mfma_f32_16x16x32_bf16 a[56:59], a[236:239], v[104:107], a[56:59]
ds_read_b64_tr_b16 a[228:229], v145 offset:0
v_mfma_f32_16x16x32_bf16 a[60:63], a[236:239], v[120:123], a[60:63]
s_waitcnt lgkmcnt(8)
ds_read_b64_tr_b16 a[234:235], v146 offset:512
v_mfma_f32_16x16x32_bf16 a[32:35], a[240:243], v[108:111], a[32:35]
ds_read_b64_tr_b16 a[232:233], v146 offset:0
v_exp_f32 v63, v63
v_mfma_f32_16x16x32_bf16 a[36:39], a[240:243], v[124:127], a[36:39]
s_waitcnt lgkmcnt(7)
ds_read_b64_tr_b16 a[238:239], v147 offset:512
v_exp_f32 v62, v62
v_mfma_f32_16x16x32_bf16 v[152:155], a[240:243], v[76:79], v[152:155]
ds_read_b64_tr_b16 a[236:237], v147 offset:0
v_exp_f32 v61, v61
v_mfma_f32_16x16x32_bf16 a[40:43], a[244:247], v[108:111], a[40:43]
ds_read_b128 v[76:79], v167 offset:24832
v_exp_f32 v60, v60
v_mfma_f32_16x16x32_bf16 a[44:47], a[244:247], v[124:127], a[44:47]
v_cvt_pk_bf16_f32 v73, v62, v63
v_cvt_pk_bf16_f32 v72, v60, v61
ds_write_b64 v11, v[72:73] offset:39168
v_mfma_f32_16x16x32_bf16 a[48:51], a[248:251], v[108:111], a[48:51]
v_exp_f32 v47, v47
v_mfma_f32_16x16x32_bf16 a[52:55], a[248:251], v[124:127], a[52:55]
s_waitcnt lgkmcnt(10)
v_exp_f32 v46, v46
v_mfma_f32_16x16x32_bf16 a[56:59], a[252:255], v[108:111], a[56:59]
v_exp_f32 v45, v45
v_mfma_f32_16x16x32_bf16 a[60:63], a[252:255], v[124:127], a[60:63]
s_waitcnt lgkmcnt(8)
s_waitcnt lgkmcnt(0) vmcnt(4)
s_barrier
ds_read_b128 a[240:243], v0 offset:24576
v_cvt_pk_bf16_f32 v65, v46, v47
v_mfma_f32_16x16x32_bf16 a[32:35], a[224:227], v[112:115], a[32:35]
ds_read_b128 a[244:247], v1 offset:24576
buffer_load_dwordx4 v255, s[36:39], 0 offen lds
v_mfma_f32_16x16x32_bf16 a[36:39], a[224:227], v[128:131], a[36:39]
s_add_u32 m0, s42, 37152
v_exp_f32 v44, v44
v_mfma_f32_16x16x32_bf16 v[152:155], a[224:227], v[76:79], v[152:155]
v_exp_f32 v51, v51
v_mfma_f32_16x16x32_bf16 a[40:43], a[228:231], v[112:115], a[40:43]
ds_read_b128 a[248:251], v2 offset:24576
v_add_u32 v255, s46, v14
v_mfma_f32_16x16x32_bf16 a[44:47], a[228:231], v[128:131], a[44:47]
s_add_u32 s46, s44, 458752
ds_read_b128 a[252:255], v3 offset:24576
buffer_load_dwordx4 v255, s[36:39], 0 offen lds
v_mfma_f32_16x16x32_bf16 a[48:51], a[232:235], v[112:115], a[48:51]
s_add_u32 m0, s42, 41280
v_exp_f32 v50, v50
v_mfma_f32_16x16x32_bf16 a[52:55], a[232:235], v[128:131], a[52:55]
v_exp_f32 v49, v49
v_mfma_f32_16x16x32_bf16 a[56:59], a[236:239], v[112:115], a[56:59]
ds_read_b128 a[224:227], v0 offset:25088
v_cvt_pk_bf16_f32 v64, v44, v45
v_mfma_f32_16x16x32_bf16 a[60:63], a[236:239], v[128:131], a[60:63]
s_waitcnt lgkmcnt(4)
v_exp_f32 v48, v48
v_cvt_pk_bf16_f32 v69, v50, v51
v_mfma_f32_16x16x32_bf16 v[44:47], a[240:243], a[128:131], v[20:23]
ds_read_b128 a[228:231], v1 offset:25088
v_cvt_pk_bf16_f32 v68, v48, v49
v_exp_f32 v55, v55
v_mfma_f32_16x16x32_bf16 v[48:51], a[240:243], a[144:147], v[24:27]
s_waitcnt lgkmcnt(4)
ds_read_b128 a[232:235], v2 offset:25088
v_add_u32 v255, s46, v14
buffer_load_dwordx4 v255, s[36:39], 0 offen lds
v_mfma_f32_16x16x32_bf16 v[44:47], a[244:247], a[132:135], v[44:47]
s_add_u32 s46, s44, 491520
v_exp_f32 v54, v54
v_exp_f32 v53, v53
v_mfma_f32_16x16x32_bf16 v[48:51], a[244:247], a[148:151], v[48:51]
s_waitcnt lgkmcnt(4)
v_exp_f32 v52, v52
v_mfma_f32_16x16x32_bf16 v[44:47], a[248:251], a[136:139], v[44:47]
s_add_u32 m0, s42, 45408
v_exp_f32 v59, v59
v_mfma_f32_16x16x32_bf16 v[48:51], a[248:251], a[152:155], v[48:51]
s_waitcnt lgkmcnt(3)
ds_read_b128 a[236:239], v3 offset:25088
v_add_u32 v255, s46, v14
buffer_load_dwordx4 v255, s[36:39], 0 offen lds
v_mfma_f32_16x16x32_bf16 v[44:47], a[252:255], a[140:143], v[44:47]
s_mov_b32 m0, 148224
v_exp_f32 v58, v58
v_cvt_pk_bf16_f32 v67, v54, v55
v_mfma_f32_16x16x32_bf16 v[48:51], a[252:255], a[156:159], v[48:51]
s_waitcnt lgkmcnt(3)
v_exp_f32 v57, v57
v_cvt_pk_bf16_f32 v66, v52, v53
v_mfma_f32_16x16x32_bf16 v[52:55], a[224:227], a[128:131], v[20:23]
s_add_u32 s46, s45, 393216
v_exp_f32 v56, v56
v_cvt_pk_bf16_f32 v71, v58, v59
v_cvt_pk_bf16_f32 v70, v56, v57
v_mfma_f32_16x16x32_bf16 v[56:59], a[224:227], a[144:147], v[24:27]
s_waitcnt lgkmcnt(2)
ds_read_b128 v[80:83], v10 offset:39168
buffer_load_dwordx4 v253, s[92:95], s64 offen lds
v_mfma_f32_16x16x32_bf16 v[52:55], a[228:231], a[132:135], v[52:55]
s_add_u32 m0, s42, 49536
ds_read_b64_tr_b16 a[242:243], v6 offset:17024
v_add_u32 v255, s46, v14
v_mfma_f32_16x16x32_bf16 v[56:59], a[228:231], a[148:151], v[56:59]
s_waitcnt lgkmcnt(3)
ds_read_b64_tr_b16 a[240:241], v6 offset:16512
s_add_u32 s46, s45, 425984
v_mfma_f32_16x16x32_bf16 v[52:55], a[232:235], a[136:139], v[52:55]
ds_read_b64_tr_b16 a[246:247], v6 offset:17032
v_mfma_f32_16x16x32_bf16 v[56:59], a[232:235], a[152:155], v[56:59]
s_waitcnt lgkmcnt(4)
ds_read_b64_tr_b16 a[244:245], v6 offset:16520
v_mfma_f32_16x16x32_bf16 v[52:55], a[236:239], a[140:143], v[52:55]
ds_read_b64_tr_b16 a[250:251], v7 offset:17024
v_mfma_f32_16x16x32_bf16 v[56:59], a[236:239], a[156:159], v[56:59]
ds_read_b64_tr_b16 a[248:249], v7 offset:16512
v_mfma_f32_16x16x32_bf16 v[32:35], v[16:19], v[64:67], v[32:35]
ds_read_b64_tr_b16 a[254:255], v7 offset:17032
v_mfma_f32_16x16x32_bf16 v[36:39], v[16:19], v[68:71], v[36:39]
s_waitcnt lgkmcnt(7)
ds_read_b64_tr_b16 a[252:253], v7 offset:16520
v_mfma_f32_16x16x32_bf16 v[40:43], v[16:19], v[80:83], v[40:43]
s_waitcnt lgkmcnt(6)
ds_read_b64_tr_b16 a[226:227], v8 offset:17024
v_mfma_f32_16x16x32_bf16 v[172:175], a[240:243], v[64:67], v[172:175]
ds_read_b64_tr_b16 a[224:225], v8 offset:16512
v_mfma_f32_16x16x32_bf16 v[176:179], a[240:243], v[68:71], v[176:179]
ds_read_b64_tr_b16 a[230:231], v8 offset:17032
v_mfma_f32_16x16x32_bf16 v[236:239], a[240:243], v[80:83], v[236:239]
s_waitcnt lgkmcnt(7)
ds_read_b64_tr_b16 a[228:229], v8 offset:16520
v_mfma_f32_16x16x32_bf16 v[180:183], a[244:247], v[64:67], v[180:183]
ds_read_b64_tr_b16 a[234:235], v9 offset:17024
v_mfma_f32_16x16x32_bf16 v[184:187], a[244:247], v[68:71], v[184:187]
ds_read_b64_tr_b16 a[232:233], v9 offset:16512
v_mfma_f32_16x16x32_bf16 v[240:243], a[244:247], v[80:83], v[240:243]
s_waitcnt lgkmcnt(8)
ds_read_b64_tr_b16 a[238:239], v9 offset:17032
v_mfma_f32_16x16x32_bf16 v[188:191], a[248:251], v[64:67], v[188:191]
ds_read_b64_tr_b16 a[236:237], v9 offset:16520
v_mfma_f32_16x16x32_bf16 v[192:195], a[248:251], v[68:71], v[192:195]
s_waitcnt lgkmcnt(8)
ds_read_b64_tr_b16 a[242:243], v132 offset:17024
v_mfma_f32_16x16x32_bf16 v[196:199], a[252:255], v[64:67], v[196:199]
ds_read_b64_tr_b16 a[240:241], v132 offset:16512
v_mfma_f32_16x16x32_bf16 v[200:203], a[252:255], v[68:71], v[200:203]
s_waitcnt lgkmcnt(8)
ds_read_b128 v[76:79], v164 offset:24832
v_mfma_f32_16x16x32_bf16 v[204:207], a[224:227], v[64:67], v[204:207]
ds_read_b64_tr_b16 a[246:247], v133 offset:17024
v_mfma_f32_16x16x32_bf16 v[208:211], a[224:227], v[68:71], v[208:211]
s_waitcnt lgkmcnt(8)
ds_read_b64_tr_b16 a[244:245], v133 offset:16512
v_mfma_f32_16x16x32_bf16 v[212:215], a[228:231], v[64:67], v[212:215]
ds_read_b64_tr_b16 a[250:251], v134 offset:17024
v_mfma_f32_16x16x32_bf16 v[216:219], a[228:231], v[68:71], v[216:219]
s_waitcnt lgkmcnt(8)
ds_read_b64_tr_b16 a[248:249], v134 offset:16512
v_mfma_f32_16x16x32_bf16 v[220:223], a[232:235], v[64:67], v[220:223]
ds_read_b64_tr_b16 a[254:255], v135 offset:17024
v_mfma_f32_16x16x32_bf16 v[224:227], a[232:235], v[68:71], v[224:227]
s_waitcnt lgkmcnt(8)
ds_read_b64_tr_b16 a[252:253], v135 offset:16512
v_mfma_f32_16x16x32_bf16 v[228:231], a[236:239], v[64:67], v[228:231]
ds_read_b64_tr_b16 a[226:227], v136 offset:17024
v_mfma_f32_16x16x32_bf16 v[232:235], a[236:239], v[68:71], v[232:235]
s_waitcnt lgkmcnt(8)
ds_read_b64_tr_b16 a[224:225], v136 offset:16512
v_mfma_f32_16x16x32_bf16 a[64:67], a[240:243], v[100:103], a[64:67]
ds_read_b64_tr_b16 a[230:231], v137 offset:17024
v_mfma_f32_16x16x32_bf16 a[68:71], a[240:243], v[116:119], a[68:71]
s_waitcnt lgkmcnt(9)
ds_read_b64_tr_b16 a[228:229], v137 offset:16512
v_mfma_f32_16x16x32_bf16 v[156:159], a[240:243], v[76:79], v[156:159]
s_waitcnt lgkmcnt(8)
ds_read_b128 v[76:79], v165 offset:24832
v_mfma_f32_16x16x32_bf16 a[72:75], a[244:247], v[100:103], a[72:75]
ds_read_b64_tr_b16 a[234:235], v138 offset:17024
v_mfma_f32_16x16x32_bf16 a[76:79], a[244:247], v[116:119], a[76:79]
s_waitcnt lgkmcnt(8)
ds_read_b64_tr_b16 a[232:233], v138 offset:16512
v_mfma_f32_16x16x32_bf16 a[80:83], a[248:251], v[100:103], a[80:83]
ds_read_b64_tr_b16 a[238:239], v139 offset:17024
v_mfma_f32_16x16x32_bf16 a[84:87], a[248:251], v[116:119], a[84:87]
s_waitcnt lgkmcnt(8)
ds_read_b64_tr_b16 a[246:247], v141 offset:17024
v_mfma_f32_16x16x32_bf16 a[88:91], a[252:255], v[100:103], a[88:91]
ds_read_b64_tr_b16 a[236:237], v139 offset:16512
v_mfma_f32_16x16x32_bf16 a[92:95], a[252:255], v[116:119], a[92:95]
s_waitcnt lgkmcnt(8)
ds_read_b64_tr_b16 a[244:245], v141 offset:16512
v_mfma_f32_16x16x32_bf16 a[64:67], a[224:227], v[104:107], a[64:67]
ds_read_b64_tr_b16 a[242:243], v140 offset:17024
ds_read_b64_tr_b16 a[250:251], v142 offset:17024
v_mfma_f32_16x16x32_bf16 a[68:71], a[224:227], v[120:123], a[68:71]
s_waitcnt lgkmcnt(8)
ds_read_b64_tr_b16 a[240:241], v140 offset:16512
ds_read_b64_tr_b16 a[248:249], v142 offset:16512
v_mfma_f32_16x16x32_bf16 v[156:159], a[224:227], v[76:79], v[156:159]
ds_read_b64_tr_b16 a[254:255], v143 offset:17024
ds_read_b128 v[76:79], v166 offset:24832
v_mfma_f32_16x16x32_bf16 a[72:75], a[228:231], v[104:107], a[72:75]
ds_read_b64_tr_b16 a[252:253], v143 offset:16512
v_mfma_f32_16x16x32_bf16 a[76:79], a[228:231], v[120:123], a[76:79]
s_waitcnt lgkmcnt(11)
ds_read_b64_tr_b16 a[226:227], v144 offset:17024
v_mfma_f32_16x16x32_bf16 a[80:83], a[232:235], v[104:107], a[80:83]
ds_read_b64_tr_b16 a[224:225], v144 offset:16512
v_mfma_f32_16x16x32_bf16 a[84:87], a[232:235], v[120:123], a[84:87]
s_waitcnt lgkmcnt(10)
ds_read_b64_tr_b16 a[230:231], v145 offset:17024
v_mfma_f32_16x16x32_bf16 a[88:91], a[236:239], v[104:107], a[88:91]
ds_read_b64_tr_b16 a[228:229], v145 offset:16512
v_mfma_f32_16x16x32_bf16 a[92:95], a[236:239], v[120:123], a[92:95]
s_waitcnt lgkmcnt(8)
ds_read_b64_tr_b16 a[234:235], v146 offset:17024
v_mfma_f32_16x16x32_bf16 a[64:67], a[240:243], v[108:111], a[64:67]
ds_read_b64_tr_b16 a[232:233], v146 offset:16512
v_mfma_f32_16x16x32_bf16 a[68:71], a[240:243], v[124:127], a[68:71]
s_waitcnt lgkmcnt(7)
ds_read_b64_tr_b16 a[238:239], v147 offset:17024
v_mfma_f32_16x16x32_bf16 v[156:159], a[240:243], v[76:79], v[156:159]
ds_read_b64_tr_b16 a[236:237], v147 offset:16512
v_exp_f32 v55, v55
v_mfma_f32_16x16x32_bf16 a[72:75], a[244:247], v[108:111], a[72:75]
ds_read_b128 v[76:79], v167 offset:24832
v_exp_f32 v54, v54
v_mfma_f32_16x16x32_bf16 a[76:79], a[244:247], v[124:127], a[76:79]
v_exp_f32 v53, v53
v_mfma_f32_16x16x32_bf16 a[80:83], a[248:251], v[108:111], a[80:83]
v_exp_f32 v52, v52
v_mfma_f32_16x16x32_bf16 a[84:87], a[248:251], v[124:127], a[84:87]
s_waitcnt lgkmcnt(9)
v_exp_f32 v47, v47
v_mfma_f32_16x16x32_bf16 a[88:91], a[252:255], v[108:111], a[88:91]
v_exp_f32 v46, v46
v_mfma_f32_16x16x32_bf16 a[92:95], a[252:255], v[124:127], a[92:95]
s_waitcnt lgkmcnt(7)
s_waitcnt lgkmcnt(0) vmcnt(5)
s_barrier
v_exp_f32 v45, v45
v_mfma_f32_16x16x32_bf16 a[64:67], a[224:227], v[112:115], a[64:67]
v_exp_f32 v44, v44
v_mfma_f32_16x16x32_bf16 a[68:71], a[224:227], v[128:131], a[68:71]
v_exp_f32 v59, v59
v_mfma_f32_16x16x32_bf16 v[156:159], a[224:227], v[76:79], v[156:159]
ds_read_b128 v[80:83], v10 offset:40192
buffer_load_dwordx4 v255, s[36:39], 0 offen lds
v_exp_f32 v58, v58
v_mfma_f32_16x16x32_bf16 a[72:75], a[228:231], v[112:115], a[72:75]
s_add_u32 m0, s42, 53664
v_exp_f32 v57, v57
v_mfma_f32_16x16x32_bf16 a[76:79], a[228:231], v[128:131], a[76:79]
ds_read_b64_tr_b16 a[242:243], v6 offset:25280
v_add_u32 v255, s46, v14
v_exp_f32 v56, v56
v_mfma_f32_16x16x32_bf16 a[80:83], a[232:235], v[112:115], a[80:83]
s_add_u32 s46, s45, 458752
ds_read_b64_tr_b16 a[240:241], v6 offset:24768
v_cvt_pk_bf16_f32 v67, v54, v55
v_cvt_pk_bf16_f32 v66, v52, v53
v_mfma_f32_16x16x32_bf16 a[84:87], a[232:235], v[128:131], a[84:87]
ds_read_b64_tr_b16 a[246:247], v6 offset:25288
buffer_load_dwordx4 v255, s[36:39], 0 offen lds
v_exp_f32 v51, v51
v_mfma_f32_16x16x32_bf16 a[88:91], a[236:239], v[112:115], a[88:91]
s_add_u32 m0, s42, 57792
ds_read_b64_tr_b16 a[244:245], v6 offset:24776
v_cvt_pk_bf16_f32 v65, v46, v47
v_exp_f32 v50, v50
v_mfma_f32_16x16x32_bf16 a[92:95], a[236:239], v[128:131], a[92:95]
ds_read_b64_tr_b16 a[250:251], v7 offset:25280
v_cvt_pk_bf16_f32 v64, v44, v45
v_cvt_pk_bf16_f32 v71, v58, v59
s_nop 0
v_mfma_f32_16x16x32_bf16 v[32:35], v[16:19], v[64:67], v[32:35]
v_exp_f32 v49, v49
v_cvt_pk_bf16_f32 v70, v56, v57
v_cvt_pk_bf16_f32 v69, v50, v51
v_exp_f32 v48, v48
s_nop 0
v_cvt_pk_bf16_f32 v68, v48, v49
s_nop 1
v_mfma_f32_16x16x32_bf16 v[36:39], v[16:19], v[68:71], v[36:39]
s_waitcnt lgkmcnt(5)
ds_read_b64_tr_b16 a[248:249], v7 offset:24768
v_add_u32 v255, s46, v14
buffer_load_dwordx4 v255, s[36:39], 0 offen lds
v_mfma_f32_16x16x32_bf16 v[40:43], v[16:19], v[80:83], v[40:43]
s_waitcnt lgkmcnt(4)
ds_read_b64_tr_b16 a[254:255], v7 offset:25288
s_add_u32 s46, s45, 491520
v_mfma_f32_16x16x32_bf16 v[172:175], a[240:243], v[64:67], v[172:175]
s_add_u32 m0, s42, 61920
ds_read_b64_tr_b16 a[252:253], v7 offset:24776
v_add_u32 v255, s46, v14
v_mfma_f32_16x16x32_bf16 v[176:179], a[240:243], v[68:71], v[176:179]
ds_read_b64_tr_b16 a[226:227], v8 offset:25280
buffer_load_dwordx4 v255, s[36:39], 0 offen lds
v_mfma_f32_16x16x32_bf16 v[236:239], a[240:243], v[80:83], v[236:239]
s_waitcnt lgkmcnt(5)
ds_read_b64_tr_b16 a[224:225], v8 offset:24768
v_cmp_nge_f32 vcc, s49, v40
v_mfma_f32_16x16x32_bf16 v[180:183], a[244:247], v[64:67], v[180:183]
s_and_b64 vcc, vcc, s[52:53]
ds_read_b64_tr_b16 a[230:231], v8 offset:25288
s_or_b64 s[50:51], s[50:51], vcc
v_mfma_f32_16x16x32_bf16 v[184:187], a[244:247], v[68:71], v[184:187]
ds_read_b64_tr_b16 a[228:229], v8 offset:24776
v_cmp_nge_f32 vcc, s49, v32
v_mfma_f32_16x16x32_bf16 v[240:243], a[244:247], v[80:83], v[240:243]
s_waitcnt lgkmcnt(6)
ds_read_b64_tr_b16 a[234:235], v9 offset:25280
s_and_b64 vcc, vcc, s[52:53]
v_mfma_f32_16x16x32_bf16 v[188:191], a[248:251], v[64:67], v[188:191]
s_or_b64 s[50:51], s[50:51], vcc
ds_read_b64_tr_b16 a[232:233], v9 offset:24768
v_cmp_nge_f32 vcc, s49, v36
v_mfma_f32_16x16x32_bf16 v[192:195], a[248:251], v[68:71], v[192:195]
s_waitcnt lgkmcnt(6)
ds_read_b64_tr_b16 a[238:239], v9 offset:25288
s_and_b64 vcc, vcc, s[52:53]
v_mfma_f32_16x16x32_bf16 v[196:199], a[252:255], v[64:67], v[196:199]
s_or_b64 s[50:51], s[50:51], vcc
ds_read_b64_tr_b16 a[236:237], v9 offset:24776
s_or_b32 s61, s50, s51
v_mfma_f32_16x16x32_bf16 v[200:203], a[252:255], v[68:71], v[200:203]
s_waitcnt lgkmcnt(6)
ds_read_b64_tr_b16 a[242:243], v132 offset:33536
v_mov_b32 v74, s61
v_mfma_f32_16x16x32_bf16 v[204:207], a[224:227], v[64:67], v[204:207]
ds_read_b64_tr_b16 a[240:241], v132 offset:33024
v_rcp_f32 v250, v40
v_mfma_f32_16x16x32_bf16 v[208:211], a[224:227], v[68:71], v[208:211]
s_waitcnt lgkmcnt(6)
ds_read_b128 v[76:79], v164 offset:24832
v_rcp_f32 v248, v32
v_mfma_f32_16x16x32_bf16 v[212:215], a[228:231], v[64:67], v[212:215]
ds_read_b64_tr_b16 a[246:247], v133 offset:33536
v_rcp_f32 v249, v36
v_mfma_f32_16x16x32_bf16 v[216:219], a[228:231], v[68:71], v[216:219]
s_waitcnt lgkmcnt(6)
ds_read_b64_tr_b16 a[244:245], v133 offset:33024
v_mul_f32 v237, v250, v237
v_mul_f32 v204, v248, v204
v_mfma_f32_16x16x32_bf16 v[220:223], a[232:235], v[64:67], v[220:223]
ds_read_b64_tr_b16 a[250:251], v134 offset:33536
v_mul_f32 v205, v248, v205
v_mul_f32 v206, v248, v206
v_mfma_f32_16x16x32_bf16 v[224:227], a[232:235], v[68:71], v[224:227]
s_waitcnt lgkmcnt(6)
ds_read_b64_tr_b16 a[248:249], v134 offset:33024
v_mul_f32 v207, v248, v207
v_mul_f32 v203, v249, v203
v_mul_f32 v236, v250, v236
v_mul_f32 v202, v249, v202
v_mfma_f32_16x16x32_bf16 v[228:231], a[236:239], v[64:67], v[228:231]
ds_read_b64_tr_b16 a[254:255], v135 offset:33536
v_mul_f32 v209, v249, v209
v_mul_f32 v210, v249, v210
v_mul_f32 v211, v249, v211
v_mul_f32 v201, v249, v201
v_mul_f32 v208, v249, v208
v_cvt_pk_bf16_f32 v236, v236, v237
v_mfma_f32_16x16x32_bf16 v[232:235], a[236:239], v[68:71], v[232:235]
s_waitcnt lgkmcnt(6)
ds_read_b64_tr_b16 a[252:253], v135 offset:33024
v_mul_f32 v200, v249, v200
v_mul_f32 v212, v248, v212
v_mul_f32 v213, v248, v213
v_mul_f32 v214, v248, v214
v_mul_f32 v215, v248, v215
v_mul_f32 v239, v250, v239
v_mul_f32 v195, v249, v195
v_mul_f32 v238, v250, v238
v_mfma_f32_16x16x32_bf16 a[96:99], a[240:243], v[100:103], a[96:99]
ds_read_b64_tr_b16 a[226:227], v136 offset:33536
v_mul_f32 v216, v249, v216
v_mul_f32 v217, v249, v217
v_mul_f32 v218, v249, v218
v_mul_f32 v219, v249, v219
v_mul_f32 v194, v249, v194
v_mul_f32 v193, v249, v193
v_mfma_f32_16x16x32_bf16 a[100:103], a[240:243], v[116:119], a[100:103]
s_waitcnt lgkmcnt(7)
ds_read_b64_tr_b16 a[224:225], v136 offset:33024
v_mul_f32 v220, v248, v220
v_mul_f32 v221, v248, v221
v_mul_f32 v222, v248, v222
v_mul_f32 v223, v248, v223
v_cvt_pk_bf16_f32 v237, v238, v239
v_mul_f32 v192, v249, v192
v_mul_f32 v243, v250, v243
v_mfma_f32_16x16x32_bf16 v[160:163], a[240:243], v[76:79], v[160:163]
s_waitcnt lgkmcnt(6)
ds_read_b64_tr_b16 a[230:231], v137 offset:33536
v_mul_f32 v199, v248, v199
v_mul_f32 v225, v249, v225
v_mul_f32 v226, v249, v226
v_mul_f32 v227, v249, v227
v_mul_f32 v242, v250, v242
v_mul_f32 v224, v249, v224
v_mul_f32 v198, v248, v198
v_mul_f32 v241, v250, v241
v_mfma_f32_16x16x32_bf16 a[104:107], a[244:247], v[100:103], a[104:107]
ds_read_b128 v[76:79], v165 offset:24832
v_mul_f32 v228, v248, v228
v_mul_f32 v229, v248, v229
v_mul_f32 v230, v248, v230
v_mul_f32 v231, v248, v231
v_mul_f32 v197, v248, v197
v_mul_f32 v240, v250, v240
v_mul_f32 v196, v248, v196
v_mfma_f32_16x16x32_bf16 a[108:111], a[244:247], v[116:119], a[108:111]
s_waitcnt lgkmcnt(6)
ds_read_b64_tr_b16 a[228:229], v137 offset:33024
v_mul_f32 v232, v249, v232
v_mul_f32 v233, v249, v233
v_mul_f32 v234, v249, v234
v_mul_f32 v235, v249, v235
v_mfma_f32_16x16x32_bf16 a[112:115], a[248:251], v[100:103], a[112:115]
ds_read_b64_tr_b16 a[234:235], v138 offset:33536
v_mul_f32 v191, v248, v191
v_mul_f32 v190, v248, v190
v_mfma_f32_16x16x32_bf16 a[116:119], a[248:251], v[116:119], a[116:119]
s_waitcnt lgkmcnt(6)
ds_read_b64_tr_b16 a[232:233], v138 offset:33024
v_cvt_pk_bf16_f32 v239, v242, v243
v_cvt_pk_bf16_f32 v238, v240, v241
v_mfma_f32_16x16x32_bf16 a[120:123], a[252:255], v[100:103], a[120:123]
ds_read_b64_tr_b16 a[238:239], v139 offset:33536
v_mul_f32 v189, v248, v189
v_mul_f32 v188, v248, v188
v_mfma_f32_16x16x32_bf16 a[124:127], a[252:255], v[116:119], a[124:127]
s_waitcnt lgkmcnt(6)
ds_read_b64_tr_b16 a[236:237], v139 offset:33024
v_mul_f32 v187, v249, v187
ds_read_b64_tr_b16 a[252:253], v143 offset:33024
v_mfma_f32_16x16x32_bf16 a[96:99], a[224:227], v[104:107], a[96:99]
ds_read_b64_tr_b16 a[254:255], v143 offset:33536
v_mul_f32 v186, v249, v186
ds_read_b64_tr_b16 a[242:243], v140 offset:33536
v_mfma_f32_16x16x32_bf16 a[100:103], a[224:227], v[120:123], a[100:103]
s_waitcnt lgkmcnt(8)
ds_read_b64_tr_b16 a[250:251], v142 offset:33536
v_mul_f32 v185, v249, v185
ds_read_b64_tr_b16 a[240:241], v140 offset:33024
v_mfma_f32_16x16x32_bf16 v[160:163], a[224:227], v[76:79], v[160:163]
s_waitcnt lgkmcnt(9)
ds_read_b64_tr_b16 a[248:249], v142 offset:33024
v_mul_f32 v184, v249, v184
v_mul_f32 v179, v249, v179
v_mfma_f32_16x16x32_bf16 a[104:107], a[228:231], v[104:107], a[104:107]
ds_read_b64_tr_b16 a[246:247], v141 offset:33536
v_subrev_u32 v143, 33024, v143
v_mul_f32 v178, v249, v178
v_mfma_f32_16x16x32_bf16 a[108:111], a[228:231], v[120:123], a[108:111]
s_waitcnt lgkmcnt(9)
ds_read_b64_tr_b16 a[224:225], v144 offset:33024
v_subrev_u32 v142, 33024, v142
ds_read_b64_tr_b16 a[226:227], v144 offset:33536
v_subrev_u32 v144, 33024, v144
v_mul_f32 v177, v249, v177
ds_read_b64_tr_b16 a[244:245], v141 offset:33024
v_subrev_u32 v141, 33024, v141
v_mfma_f32_16x16x32_bf16 a[112:115], a[232:235], v[104:107], a[112:115]
ds_read_b64_tr_b16 a[228:229], v145 offset:33024
v_mul_f32 v176, v249, v176
v_subrev_u32 v140, 33024, v140
v_mul_f32 v183, v248, v183
v_subrev_u32 v139, 33024, v139
v_mfma_f32_16x16x32_bf16 a[116:119], a[232:235], v[120:123], a[116:119]
s_waitcnt lgkmcnt(11)
ds_read_b64_tr_b16 a[230:231], v145 offset:33536
v_mul_f32 v182, v248, v182
ds_read_b128 v[76:79], v166 offset:24832
v_subrev_u32 v145, 33024, v145
v_subrev_u32 v138, 33024, v138
v_mul_f32 v181, v248, v181
v_mfma_f32_16x16x32_bf16 a[120:123], a[236:239], v[104:107], a[120:123]
ds_read_b64_tr_b16 a[232:233], v146 offset:33024
v_subrev_u32 v137, 33024, v137
v_mul_f32 v180, v248, v180
v_subrev_u32 v136, 33024, v136
v_mfma_f32_16x16x32_bf16 a[124:127], a[236:239], v[120:123], a[124:127]
s_waitcnt lgkmcnt(9)
ds_read_b64_tr_b16 a[234:235], v146 offset:33536
v_mul_f32 v175, v248, v175
v_subrev_u32 v135, 33024, v135
v_subrev_u32 v146, 33024, v146
v_mul_f32 v174, v248, v174
v_subrev_u32 v134, 33024, v134
v_mfma_f32_16x16x32_bf16 a[96:99], a[240:243], v[108:111], a[96:99]
ds_read_b64_tr_b16 a[236:237], v147 offset:33024
v_mul_f32 v173, v248, v173
v_subrev_u32 v133, 33024, v133
v_mul_f32 v172, v248, v172
v_mfma_f32_16x16x32_bf16 a[100:103], a[240:243], v[124:127], a[100:103]
s_waitcnt lgkmcnt(3)
ds_read_b64_tr_b16 a[238:239], v147 offset:33536
v_subrev_u32 v132, 33024, v132
v_subrev_u32 v147, 33024, v147
v_cvt_pk_bf16_f32 v63, v234, v235
v_mfma_f32_16x16x32_bf16 v[160:163], a[240:243], v[76:79], v[160:163]
ds_read_b128 v[76:79], v167 offset:24832
v_cvt_pk_bf16_f32 v62, v232, v233
v_cvt_pk_bf16_f32 v61, v226, v227
v_mfma_f32_16x16x32_bf16 a[104:107], a[244:247], v[108:111], a[104:107]
v_cvt_pk_bf16_f32 v60, v224, v225
v_cvt_pk_bf16_f32 v59, v230, v231
v_cvt_pk_bf16_f32 v58, v228, v229
v_mfma_f32_16x16x32_bf16 a[108:111], a[244:247], v[124:127], a[108:111]
v_cvt_pk_bf16_f32 v57, v222, v223
v_cvt_pk_bf16_f32 v56, v220, v221
v_cvt_pk_bf16_f32 v171, v218, v219
v_mfma_f32_16x16x32_bf16 a[112:115], a[248:251], v[108:111], a[112:115]
v_cvt_pk_bf16_f32 v170, v216, v217
v_cvt_pk_bf16_f32 v169, v210, v211
v_mfma_f32_16x16x32_bf16 a[116:119], a[248:251], v[124:127], a[116:119]
v_cvt_pk_bf16_f32 v168, v208, v209
v_cvt_pk_bf16_f32 v55, v214, v215
v_mfma_f32_16x16x32_bf16 a[120:123], a[252:255], v[108:111], a[120:123]
v_cvt_pk_bf16_f32 v54, v212, v213
v_cvt_pk_bf16_f32 v53, v206, v207
v_mfma_f32_16x16x32_bf16 a[124:127], a[252:255], v[124:127], a[124:127]
v_cvt_pk_bf16_f32 v52, v204, v205
v_cvt_pk_bf16_f32 v71, v202, v203
v_mfma_f32_16x16x32_bf16 a[96:99], a[224:227], v[112:115], a[96:99]
v_cvt_pk_bf16_f32 v70, v200, v201
v_cvt_pk_bf16_f32 v69, v194, v195
v_mfma_f32_16x16x32_bf16 a[100:103], a[224:227], v[128:131], a[100:103]
s_waitcnt lgkmcnt(0)
v_cvt_pk_bf16_f32 v68, v192, v193
v_cvt_pk_bf16_f32 v51, v198, v199
v_mfma_f32_16x16x32_bf16 v[160:163], a[224:227], v[76:79], v[160:163]
v_cvt_pk_bf16_f32 v50, v196, v197
v_cvt_pk_bf16_f32 v49, v190, v191
v_mfma_f32_16x16x32_bf16 a[104:107], a[228:231], v[112:115], a[104:107]
ds_write_b32 v75, v74 offset:0
v_mfma_f32_16x16x32_bf16 a[108:111], a[228:231], v[128:131], a[108:111]
ds_write_b128 v15, v[236:239] offset:0
v_mfma_f32_16x16x32_bf16 a[112:115], a[232:235], v[112:115], a[112:115]
v_cvt_pk_bf16_f32 v48, v188, v189
v_cvt_pk_bf16_f32 v67, v186, v187
v_cvt_pk_bf16_f32 v66, v184, v185
v_mfma_f32_16x16x32_bf16 a[116:119], a[232:235], v[128:131], a[116:119]
v_cvt_pk_bf16_f32 v65, v178, v179
v_cvt_pk_bf16_f32 v64, v176, v177
v_mfma_f32_16x16x32_bf16 a[120:123], a[236:239], v[112:115], a[120:123]
v_cvt_pk_bf16_f32 v47, v182, v183
v_cvt_pk_bf16_f32 v46, v180, v181
v_mfma_f32_16x16x32_bf16 a[124:127], a[236:239], v[128:131], a[124:127]
s_waitcnt lgkmcnt(0)
s_barrier
v_cvt_pk_bf16_f32 v45, v174, v175
v_cvt_pk_bf16_f32 v44, v172, v173
s_add_u32 s46, s47, 393216
s_mov_b32 m0, s42
v_add_u32 v95, s46, v14
buffer_load_dwordx4 v95, s[36:39], 0 offen lds
s_add_u32 s46, s47, 425984
s_add_u32 m0, s42, 4128
v_add_u32 v96, s46, v14
buffer_load_dwordx4 v96, s[36:39], 0 offen lds
s_add_u32 s46, s47, 458752
s_add_u32 m0, s42, 8256
v_add_u32 v95, s46, v14
buffer_load_dwordx4 v95, s[36:39], 0 offen lds
s_add_u32 s46, s47, 491520
s_add_u32 m0, s42, 12384
v_add_u32 v96, s46, v14
buffer_load_dwordx4 v96, s[36:39], 0 offen lds
ds_read_b128 v[72:75], v164 offset:28928
ds_read_b128 v[76:79], v165 offset:28928
ds_read_b128 v[80:83], v166 offset:28928
ds_read_b128 v[84:87], v167 offset:28928
v_mov_b32 v34, 161536
ds_read_b128 v[36:39], v34
v_mov_b32 v88, v253
v_lshrrev_b32 v89, 1, v253
v_add_u32 v89, 0x1000, v89
v_cmp_eq_u32 vcc, 0, v253
v_mov_b32 v34, s75
s_nop 0
v_cndmask_b32 v90, v34, 0, vcc
v_mov_b32 v255, s57
s_mul_i32 s3, s58, 147456
s_mul_i32 s4, s40, 4608
s_add_u32 s72, s3, s4
s_mul_i32 s3, s58, 18432
s_add_u32 s70, s3, s4
s_lshl_b32 s3, s58, 7
s_lshl_b32 s4, s40, 2
s_add_u32 s73, s3, s4
s_lshl_b32 s3, s58, 4
s_add_u32 s74, s3, s4
s_mov_b32 s69, 0
s_waitcnt lgkmcnt(0) vmcnt(9)
s_barrier
ds_read_b64_tr_b16 a[128:129], v132 offset:33024
ds_read_b64_tr_b16 a[130:131], v132 offset:33536
s_waitcnt lgkmcnt(0)
v_mfma_f32_16x16x32_bf16 a[0:3], a[128:131], v[44:47], a[0:3]
s_add_u32 s46, s71, 393216
ds_read_b64_tr_b16 a[132:133], v133 offset:33024
ds_read_b64_tr_b16 a[134:135], v133 offset:33536
ds_read_b64_tr_b16 a[136:137], v134 offset:33024
ds_read_b64_tr_b16 a[138:139], v134 offset:33536
v_mfma_f32_16x16x32_bf16 a[4:7], a[128:131], v[64:67], a[4:7]
s_add_u32 m0, s42, 16512
ds_read_b64_tr_b16 a[142:143], v135 offset:33536
ds_read_b64_tr_b16 a[140:141], v135 offset:33024
v_mfma_f32_16x16x32_bf16 v[148:151], a[128:131], v[72:75], v[148:151]
s_waitcnt lgkmcnt(4)
v_or3_b32 v36, v36, v37, v38
v_mfma_f32_16x16x32_bf16 a[8:11], a[132:135], v[44:47], a[8:11]
s_add_u32 s69, s69, 1
ds_read_b64_tr_b16 a[146:147], v136 offset:33536
v_or_b32 v36, v36, v39
v_add_u32 v95, s46, v14
v_readfirstlane_b32 s3, v36
s_nop 0
s_cmp_lg_u32 s3, 0
s_cbranch_scc1 L_redo
L_noredo:
v_mfma_f32_16x16x32_bf16 a[12:15], a[132:135], v[64:67], a[12:15]
s_waitcnt lgkmcnt(3)
ds_read_b64_tr_b16 a[144:145], v136 offset:33024
buffer_load_dwordx4 v95, s[36:39], 0 offen lds
ds_read_b64_tr_b16 a[150:151], v137 offset:33536
v_mfma_f32_16x16x32_bf16 a[16:19], a[136:139], v[44:47], a[16:19]
s_add_u32 s46, s71, 425984
ds_read_b64_tr_b16 a[148:149], v137 offset:33024
s_add_u32 m0, s42, 20640
v_mfma_f32_16x16x32_bf16 a[20:23], a[136:139], v[64:67], a[20:23]
s_waitcnt lgkmcnt(4)
ds_read_b64_tr_b16 a[154:155], v138 offset:33536
v_add_u32 v96, s46, v14
buffer_load_dwordx4 v96, s[36:39], 0 offen lds
v_mfma_f32_16x16x32_bf16 a[24:27], a[140:143], v[44:47], a[24:27]
s_add_u32 s46, s71, 458752
ds_read_b64_tr_b16 a[152:153], v138 offset:33024
s_add_u32 m0, s42, 24768
v_mfma_f32_16x16x32_bf16 a[28:31], a[140:143], v[64:67], a[28:31]
s_waitcnt lgkmcnt(4)
ds_read_b64_tr_b16 a[158:159], v139 offset:33536
v_add_u32 v95, s46, v14
v_mfma_f32_16x16x32_bf16 a[0:3], a[144:147], v[48:51], a[0:3]
s_add_u32 s46, s71, 491520
ds_read_b64_tr_b16 a[156:157], v139 offset:33024
buffer_load_dwordx4 v95, s[36:39], 0 offen lds
v_mfma_f32_16x16x32_bf16 a[4:7], a[144:147], v[68:71], a[4:7]
s_add_u32 m0, s42, 28896
ds_read_b64_tr_b16 a[226:227], v140 offset:33536
v_add_u32 v96, s46, v14
v_mfma_f32_16x16x32_bf16 v[148:151], a[144:147], v[76:79], v[148:151]
s_waitcnt lgkmcnt(5)
ds_read_b64_tr_b16 a[224:225], v140 offset:33024
v_lshrrev_b32 v34, 4, v253
v_mfma_f32_16x16x32_bf16 a[8:11], a[148:151], v[48:51], a[8:11]
s_mov_b32 s46, s65
ds_read_b64_tr_b16 a[230:231], v141 offset:33536
buffer_load_dwordx4 v96, s[36:39], 0 offen lds
v_mfma_f32_16x16x32_bf16 a[12:15], a[148:151], v[68:71], a[12:15]
s_waitcnt lgkmcnt(5)
ds_read_b64_tr_b16 a[228:229], v141 offset:33024
ds_read_b64_tr_b16 a[234:235], v142 offset:33536
v_mfma_f32_16x16x32_bf16 a[16:19], a[152:155], v[48:51], a[16:19]
s_add_u32 m0, s42, 33024
ds_read_b64_tr_b16 a[232:233], v142 offset:33024
v_and_b32 v35, 15, v34
v_mfma_f32_16x16x32_bf16 a[20:23], a[152:155], v[68:71], a[20:23]
s_waitcnt lgkmcnt(6)
ds_read_b64_tr_b16 a[238:239], v143 offset:33536
ds_read_b64_tr_b16 a[236:237], v143 offset:33024
v_mfma_f32_16x16x32_bf16 a[24:27], a[156:159], v[48:51], a[24:27]
s_add_u32 s63, s58, s69
ds_read_b64_tr_b16 a[242:243], v144 offset:33536
v_and_b32 v38, 1, v35
v_mfma_f32_16x16x32_bf16 a[28:31], a[156:159], v[68:71], a[28:31]
s_waitcnt lgkmcnt(7)
ds_read_b64_tr_b16 a[240:241], v144 offset:33024
ds_read_b64_tr_b16 a[254:255], v147 offset:33536
v_mfma_f32_16x16x32_bf16 a[0:3], a[224:227], v[52:55], a[0:3]
s_and_b32 s63, s63, 7
ds_read_b64_tr_b16 a[252:253], v147 offset:33024
v_lshrrev_b32 v37, 2, v35
v_mfma_f32_16x16x32_bf16 a[4:7], a[224:227], v[168:171], a[4:7]
s_mul_i32 s67, s63, 147456
ds_read_b64_tr_b16 a[250:251], v146 offset:33536
v_lshrrev_b32 v36, 4, v34
v_mfma_f32_16x16x32_bf16 v[148:151], a[224:227], v[80:83], v[148:151]
s_waitcnt lgkmcnt(9)
ds_read_b64_tr_b16 a[248:249], v146 offset:33024
ds_read_b64_tr_b16 a[246:247], v145 offset:33536
v_mfma_f32_16x16x32_bf16 a[8:11], a[228:231], v[52:55], a[8:11]
s_add_u32 s67, s67, s70
ds_read_b64_tr_b16 a[244:245], v145 offset:33024
v_mov_b32 v39, 0x3f80
v_mfma_f32_16x16x32_bf16 a[12:15], a[228:231], v[168:171], a[12:15]
s_waitcnt lgkmcnt(10)
v_lshlrev_b32 v38, 4, v38
v_cmp_eq_u32 vcc, v36, v37
v_mfma_f32_16x16x32_bf16 a[16:19], a[232:235], v[52:55], a[16:19]
s_mov_b32 s7, s68
v_lshlrev_b32 v39, v38, v39
v_add_u32 v95, s46, v14
v_mfma_f32_16x16x32_bf16 a[20:23], a[232:235], v[168:171], a[20:23]
s_waitcnt lgkmcnt(8)
v_cndmask_b32 v39, 0, v39, vcc
v_and_b32 v38, 2, v35
v_mfma_f32_16x16x32_bf16 a[24:27], a[236:239], v[52:55], a[24:27]
s_add_u32 s46, s65, 32768
v_add_u32 v96, s46, v14
v_cmp_eq_u32 vcc, 0, v38
v_mfma_f32_16x16x32_bf16 a[28:31], a[236:239], v[168:171], a[28:31]
s_waitcnt lgkmcnt(6)
s_waitcnt lgkmcnt(0) vmcnt(8)
s_barrier
ds_read_b64_tr_b16 a[130:131], v132 offset:50048
v_cndmask_b32 v245, v39, 0, vcc
v_mfma_f32_16x16x32_bf16 a[0:3], a[240:243], v[56:59], a[0:3]
s_add_u32 s46, s65, 65536
ds_read_b64_tr_b16 a[128:129], v132 offset:49536
buffer_load_dwordx4 v95, s[36:39], 0 offen lds
v_mfma_f32_16x16x32_bf16 a[4:7], a[240:243], v[60:63], a[4:7]
s_add_u32 m0, s42, 37152
ds_read_b64_tr_b16 a[134:135], v133 offset:50048
v_cndmask_b32 v244, 0, v39, vcc
v_mfma_f32_16x16x32_bf16 v[148:151], a[240:243], v[84:87], v[148:151]
s_lshl_b32 s63, s63, 7
ds_read_b64_tr_b16 a[132:133], v133 offset:49536
v_accvgpr_read_b32 v34, a0
v_accvgpr_read_b32 v35, a1
v_mfma_f32_16x16x32_bf16 a[8:11], a[244:247], v[56:59], a[8:11]
s_add_u32 s69, s69, 1
ds_read_b64_tr_b16 a[138:139], v134 offset:50048
v_cvt_pk_bf16_f32 v16, v34, v35
v_add_u32 v95, s46, v14
v_mfma_f32_16x16x32_bf16 a[12:15], a[244:247], v[60:63], a[12:15]
s_add_u32 s46, s65, 98304
ds_read_b64_tr_b16 a[136:137], v134 offset:49536
v_accvgpr_read_b32 v40, a6
v_accvgpr_read_b32 v41, a7
v_mfma_f32_16x16x32_bf16 a[16:19], a[248:251], v[56:59], a[16:19]
s_add_u32 s68, s63, s74
ds_read_b64_tr_b16 a[142:143], v135 offset:50048
v_accvgpr_read_b32 v38, a4
v_accvgpr_read_b32 v39, a5
v_mfma_f32_16x16x32_bf16 a[20:23], a[248:251], v[60:63], a[20:23]
s_add_u32 s63, s58, s69
ds_read_b64_tr_b16 a[140:141], v135 offset:49536
buffer_load_dwordx4 v96, s[36:39], 0 offen lds
v_cvt_pk_bf16_f32 v25, v40, v41
v_accvgpr_read_b32 v37, a3
v_mfma_f32_16x16x32_bf16 a[24:27], a[252:255], v[56:59], a[24:27]
s_add_u32 m0, s42, 41280
ds_read_b64_tr_b16 a[146:147], v136 offset:50048
v_accvgpr_read_b32 v36, a2
v_cvt_pk_bf16_f32 v24, v38, v39
v_mfma_f32_16x16x32_bf16 a[28:31], a[252:255], v[60:63], a[28:31]
s_waitcnt lgkmcnt(7)
ds_read_b64_tr_b16 a[144:145], v136 offset:49536
v_accvgpr_read_b32 v35, a11
v_accvgpr_read_b32 v34, a10
v_mfma_f32_16x16x32_bf16 a[32:35], a[128:131], v[44:47], a[32:35]
s_and_b32 s63, s63, 7
ds_read_b64_tr_b16 a[150:151], v137 offset:50048
v_add_u32 v96, s46, v14
v_accvgpr_read_b32 v43, a9
v_mfma_f32_16x16x32_bf16 a[36:39], a[128:131], v[64:67], a[36:39]
s_add_u32 s46, s65, 131072
ds_read_b64_tr_b16 a[148:149], v137 offset:49536
buffer_load_dwordx4 v95, s[36:39], 0 offen lds
v_accvgpr_read_b32 v42, a8
v_mfma_f32_16x16x32_bf16 v[152:155], a[128:131], v[72:75], v[152:155]
s_waitcnt lgkmcnt(8)
ds_read_b64_tr_b16 a[154:155], v138 offset:50048
v_accvgpr_read_b32 v41, a17
v_accvgpr_read_b32 v40, a16
v_mfma_f32_16x16x32_bf16 a[40:43], a[132:135], v[44:47], a[40:43]
s_add_u32 m0, s42, 45408
ds_read_b64_tr_b16 a[152:153], v138 offset:49536
v_cvt_pk_bf16_f32 v17, v36, v37
v_accvgpr_read_b32 v39, a15
v_mfma_f32_16x16x32_bf16 a[44:47], a[132:135], v[64:67], a[44:47]
s_waitcnt lgkmcnt(8)
ds_read_b64_tr_b16 a[158:159], v139 offset:50048
v_accvgpr_read_b32 v38, a14
v_cvt_pk_bf16_f32 v19, v34, v35
v_mfma_f32_16x16x32_bf16 a[48:51], a[136:139], v[44:47], a[48:51]
s_mov_b32 s7, s68
ds_read_b64_tr_b16 a[156:157], v139 offset:49536
buffer_load_dwordx4 v96, s[36:39], 0 offen lds
v_cvt_pk_bf16_f32 v33, v150, v151
v_mfma_f32_16x16x32_bf16 a[52:55], a[136:139], v[64:67], a[52:55]
s_waitcnt lgkmcnt(8)
ds_read_b64_tr_b16 a[226:227], v140 offset:50048
v_cvt_pk_bf16_f32 v32, v148, v149
v_add_u32 v8, s67, v89
v_mfma_f32_16x16x32_bf16 a[56:59], a[140:143], v[44:47], a[56:59]
s_add_u32 m0, s42, 49536
ds_read_b64_tr_b16 a[224:225], v140 offset:49536
v_cvt_pk_bf16_f32 v18, v42, v43
v_cvt_pk_bf16_f32 v20, v40, v41
v_mfma_f32_16x16x32_bf16 a[60:63], a[140:143], v[64:67], a[60:63]
s_waitcnt lgkmcnt(8)
ds_read_b64_tr_b16 a[230:231], v141 offset:50048
v_accvgpr_read_b32 v37, a13
v_accvgpr_read_b32 v36, a12
v_mfma_f32_16x16x32_bf16 a[32:35], a[144:147], v[48:51], a[32:35]
s_add_u32 s69, s69, 1
ds_read_b64_tr_b16 a[228:229], v141 offset:49536
v_add_u32 v7, s67, v88
v_cvt_pk_bf16_f32 v27, v38, v39
v_mfma_f32_16x16x32_bf16 a[36:39], a[144:147], v[68:71], a[36:39]
s_mul_i32 s67, s63, 147456
ds_read_b64_tr_b16 a[234:235], v142 offset:50048
buffer_store_dwordx2 v[32:33], v8, s[24:27], 0 offen sc1
v_accvgpr_read_b32 v35, a21
v_mfma_f32_16x16x32_bf16 v[152:155], a[144:147], v[76:79], v[152:155]
s_waitcnt lgkmcnt(9)
ds_read_b64_tr_b16 a[232:233], v142 offset:49536
v_accvgpr_read_b32 v34, a20
v_accvgpr_read_b32 v43, a19
v_mfma_f32_16x16x32_bf16 a[40:43], a[148:151], v[48:51], a[40:43]
s_add_u32 s67, s67, s70
ds_read_b64_tr_b16 a[238:239], v143 offset:50048
v_accvgpr_read_b32 v42, a18
v_accvgpr_read_b32 v41, a27
v_mfma_f32_16x16x32_bf16 a[44:47], a[148:151], v[68:71], a[44:47]
s_waitcnt lgkmcnt(9)
ds_read_b64_tr_b16 a[236:237], v143 offset:49536
buffer_store_dwordx4 v[16:19], v7, s[24:27], 0 offen sc1
v_accvgpr_read_b32 v40, a26
v_mfma_f32_16x16x32_bf16 a[48:51], a[152:155], v[48:51], a[48:51]
s_lshl_b32 s63, s63, 7
ds_read_b64_tr_b16 a[242:243], v144 offset:50048
v_cvt_pk_bf16_f32 v26, v36, v37
v_accvgpr_read_b32 v39, a25
v_mfma_f32_16x16x32_bf16 a[52:55], a[152:155], v[68:71], a[52:55]
s_waitcnt lgkmcnt(9)
ds_read_b64_tr_b16 a[240:241], v144 offset:49536
v_accvgpr_read_b32 v38, a24
v_cvt_pk_bf16_f32 v28, v34, v35
v_mfma_f32_16x16x32_bf16 a[56:59], a[156:159], v[48:51], a[56:59]
s_add_u32 s68, s63, s74
ds_read_b64_tr_b16 a[254:255], v147 offset:50048
buffer_store_dwordx4 v[24:27], v7, s[24:27], 0 offen offset:2048 sc1
v_cvt_pk_bf16_f32 v21, v42, v43
v_mfma_f32_16x16x32_bf16 a[60:63], a[156:159], v[68:71], a[60:63]
s_waitcnt lgkmcnt(9)
ds_read_b64_tr_b16 a[252:253], v147 offset:49536
v_cvt_pk_bf16_f32 v23, v40, v41
v_cvt_pk_bf16_f32 v22, v38, v39
v_mfma_f32_16x16x32_bf16 a[32:35], a[224:227], v[52:55], a[32:35]
s_add_u32 s63, s58, s69
ds_read_b64_tr_b16 a[250:251], v146 offset:50048
v_accvgpr_read_b32 v35, a31
v_accvgpr_read_b32 v34, a30
v_mfma_f32_16x16x32_bf16 a[36:39], a[224:227], v[168:171], a[36:39]
s_and_b32 s63, s63, 7
ds_read_b64_tr_b16 a[248:249], v146 offset:49536
buffer_store_dwordx4 v[20:23], v7, s[24:27], 0 offen offset:1024 sc1
v_accvgpr_read_b32 v43, a29
v_mfma_f32_16x16x32_bf16 v[152:155], a[224:227], v[80:83], v[152:155]
s_waitcnt lgkmcnt(10)
ds_read_b64_tr_b16 a[246:247], v145 offset:50048
v_accvgpr_read_b32 v42, a28
v_accvgpr_read_b32 v37, a23
v_mfma_f32_16x16x32_bf16 a[40:43], a[228:231], v[52:55], a[40:43]
s_add_u32 s3, s58, 3
ds_read_b64_tr_b16 a[244:245], v145 offset:49536
v_accvgpr_read_b32 v36, a22
v_cvt_pk_bf16_f32 v31, v34, v35
v_mfma_f32_16x16x32_bf16 a[44:47], a[228:231], v[168:171], a[44:47]
s_waitcnt lgkmcnt(10)
v_cvt_pk_bf16_f32 v30, v42, v43
v_cvt_pk_bf16_f32 v29, v36, v37
buffer_store_dwordx4 v[28:31], v7, s[24:27], 0 offen offset:3072 sc1
v_mfma_f32_16x16x32_bf16 a[48:51], a[232:235], v[52:55], a[48:51]
s_and_b32 s3, s3, 7
v_add_u32 v95, s46, v14
s_add_u32 s46, s65, 163840
v_mfma_f32_16x16x32_bf16 a[52:55], a[232:235], v[168:171], a[52:55]
s_waitcnt lgkmcnt(8)
v_add_u32 v96, s46, v14
s_add_u32 s46, s65, 196608
v_mfma_f32_16x16x32_bf16 a[56:59], a[236:239], v[52:55], a[56:59]
s_mul_i32 s6, s3, 18432
v_add_u32 v8, s67, v89
v_add_u32 v7, s67, v88
v_mfma_f32_16x16x32_bf16 a[60:63], a[236:239], v[168:171], a[60:63]
s_waitcnt lgkmcnt(6)
s_waitcnt lgkmcnt(0) vmcnt(13)
s_barrier
ds_read_b64_tr_b16 a[130:131], v132 offset:512
v_mov_b32 v243, v163
v_mfma_f32_16x16x32_bf16 a[32:35], a[240:243], v[56:59], a[32:35]
s_mul_i32 s67, s63, 147456
ds_read_b64_tr_b16 a[128:129], v132 offset:0
buffer_load_dwordx4 v95, s[36:39], 0 offen lds
v_mfma_f32_16x16x32_bf16 a[36:39], a[240:243], v[60:63], a[36:39]
s_add_u32 m0, s42, 53664
ds_read_b64_tr_b16 a[134:135], v133 offset:512
v_add_u32 v95, s46, v14
v_mfma_f32_16x16x32_bf16 v[152:155], a[240:243], v[84:87], v[152:155]
s_add_u32 s46, s65, 229376
ds_read_b64_tr_b16 a[132:133], v133 offset:0
v_accvgpr_read_b32 v34, a32
v_accvgpr_read_b32 v35, a33
v_mfma_f32_16x16x32_bf16 a[40:43], a[244:247], v[56:59], a[40:43]
s_add_u32 s67, s67, s70
ds_read_b64_tr_b16 a[138:139], v134 offset:512
v_cvt_pk_bf16_f32 v16, v34, v35
v_accvgpr_read_b32 v40, a38
v_mfma_f32_16x16x32_bf16 a[44:47], a[244:247], v[60:63], a[44:47]
s_lshl_b32 s3, s3, 4
ds_read_b64_tr_b16 a[136:137], v134 offset:0
v_accvgpr_read_b32 v41, a39
v_accvgpr_read_b32 v38, a36
v_mfma_f32_16x16x32_bf16 a[48:51], a[248:251], v[56:59], a[48:51]
s_add_u32 s41, s3, s73
ds_read_b64_tr_b16 a[142:143], v135 offset:512
v_accvgpr_read_b32 v39, a37
v_cvt_pk_bf16_f32 v25, v40, v41
v_mfma_f32_16x16x32_bf16 a[52:55], a[248:251], v[60:63], a[52:55]
s_add_u32 s3, s58, 2
ds_read_b64_tr_b16 a[140:141], v135 offset:0
buffer_load_dwordx4 v96, s[36:39], 0 offen lds
v_accvgpr_read_b32 v37, a35
v_mfma_f32_16x16x32_bf16 a[56:59], a[252:255], v[56:59], a[56:59]
s_add_u32 m0, s42, 57792
ds_read_b64_tr_b16 a[146:147], v136 offset:512
v_accvgpr_read_b32 v36, a34
v_cvt_pk_bf16_f32 v24, v38, v39
v_mfma_f32_16x16x32_bf16 a[60:63], a[252:255], v[60:63], a[60:63]
s_waitcnt lgkmcnt(7)
ds_read_b64_tr_b16 a[144:145], v136 offset:0
v_accvgpr_read_b32 v35, a43
v_accvgpr_read_b32 v34, a42
v_mfma_f32_16x16x32_bf16 a[64:67], a[128:131], v[44:47], a[64:67]
s_and_b32 s3, s3, 7
ds_read_b64_tr_b16 a[150:151], v137 offset:512
v_add_u32 v96, s46, v14
v_accvgpr_read_b32 v43, a41
v_mfma_f32_16x16x32_bf16 a[68:71], a[128:131], v[64:67], a[68:71]
s_add_u32 s46, s65, 262144
ds_read_b64_tr_b16 a[148:149], v137 offset:0
buffer_load_dwordx4 v95, s[36:39], 0 offen lds
v_accvgpr_read_b32 v42, a40
v_mfma_f32_16x16x32_bf16 v[156:159], a[128:131], v[72:75], v[156:159]
s_waitcnt lgkmcnt(8)
ds_read_b64_tr_b16 a[154:155], v138 offset:512
v_accvgpr_read_b32 v41, a49
v_accvgpr_read_b32 v40, a48
v_mfma_f32_16x16x32_bf16 a[72:75], a[132:135], v[44:47], a[72:75]
s_add_u32 m0, s42, 61920
ds_read_b64_tr_b16 a[152:153], v138 offset:0
v_cvt_pk_bf16_f32 v17, v36, v37
v_accvgpr_read_b32 v39, a47
v_mfma_f32_16x16x32_bf16 a[76:79], a[132:135], v[64:67], a[76:79]
s_waitcnt lgkmcnt(8)
ds_read_b64_tr_b16 a[158:159], v139 offset:512
v_accvgpr_read_b32 v38, a46
v_cvt_pk_bf16_f32 v19, v34, v35
v_mfma_f32_16x16x32_bf16 a[80:83], a[136:139], v[44:47], a[80:83]
s_mul_i32 s43, s3, 18432
ds_read_b64_tr_b16 a[156:157], v139 offset:0
buffer_load_dwordx4 v96, s[36:39], 0 offen lds
v_cvt_pk_bf16_f32 v33, v154, v155
v_mfma_f32_16x16x32_bf16 a[84:87], a[136:139], v[64:67], a[84:87]
s_waitcnt lgkmcnt(8)
ds_read_b64_tr_b16 a[226:227], v140 offset:512
v_cvt_pk_bf16_f32 v32, v152, v153
v_cvt_pk_bf16_f32 v18, v42, v43
v_mfma_f32_16x16x32_bf16 a[88:91], a[140:143], v[44:47], a[88:91]
s_mov_b32 m0, s42
ds_read_b64_tr_b16 a[224:225], v140 offset:0
v_cvt_pk_bf16_f32 v20, v40, v41
v_accvgpr_read_b32 v37, a45
v_mfma_f32_16x16x32_bf16 a[92:95], a[140:143], v[64:67], a[92:95]
s_waitcnt lgkmcnt(8)
ds_read_b64_tr_b16 a[230:231], v141 offset:512
v_accvgpr_read_b32 v36, a44
v_mfma_f32_16x16x32_bf16 a[64:67], a[144:147], v[48:51], a[64:67]
s_lshl_b32 s3, s3, 4
ds_read_b64_tr_b16 a[228:229], v141 offset:0
v_cvt_pk_bf16_f32 v27, v38, v39
v_accvgpr_read_b32 v35, a53
v_mfma_f32_16x16x32_bf16 a[68:71], a[144:147], v[68:71], a[68:71]
s_add_u32 s48, s3, s73
ds_read_b64_tr_b16 a[234:235], v142 offset:512
buffer_store_dwordx2 v[32:33], v8, s[24:27], 0 offen sc1
v_accvgpr_read_b32 v34, a52
v_mfma_f32_16x16x32_bf16 v[156:159], a[144:147], v[76:79], v[156:159]
s_waitcnt lgkmcnt(9)
ds_read_b64_tr_b16 a[232:233], v142 offset:0
v_accvgpr_read_b32 v43, a51
v_accvgpr_read_b32 v42, a50
v_mfma_f32_16x16x32_bf16 a[72:75], a[148:151], v[48:51], a[72:75]
s_add_u32 s3, s58, 1
ds_read_b64_tr_b16 a[238:239], v143 offset:512
v_accvgpr_read_b32 v41, a59
v_accvgpr_read_b32 v40, a58
v_mfma_f32_16x16x32_bf16 a[76:79], a[148:151], v[68:71], a[76:79]
s_waitcnt lgkmcnt(9)
ds_read_b64_tr_b16 a[236:237], v143 offset:0
buffer_store_dwordx4 v[16:19], v7, s[24:27], 0 offen sc1
v_cvt_pk_bf16_f32 v26, v36, v37
v_mfma_f32_16x16x32_bf16 a[80:83], a[152:155], v[48:51], a[80:83]
s_and_b32 s3, s3, 7
ds_read_b64_tr_b16 a[242:243], v144 offset:512
v_accvgpr_read_b32 v39, a57
v_accvgpr_read_b32 v38, a56
v_mfma_f32_16x16x32_bf16 a[84:87], a[152:155], v[68:71], a[84:87]
s_waitcnt lgkmcnt(9)
ds_read_b64_tr_b16 a[240:241], v144 offset:0
v_cvt_pk_bf16_f32 v28, v34, v35
v_cvt_pk_bf16_f32 v21, v42, v43
v_mfma_f32_16x16x32_bf16 a[88:91], a[156:159], v[48:51], a[88:91]
s_mul_i32 s54, s3, 18432
ds_read_b64_tr_b16 a[254:255], v147 offset:512
buffer_store_dwordx4 v[24:27], v7, s[24:27], 0 offen offset:2048 sc1
v_cvt_pk_bf16_f32 v23, v40, v41
v_mfma_f32_16x16x32_bf16 a[92:95], a[156:159], v[68:71], a[92:95]
s_waitcnt lgkmcnt(9)
ds_read_b64_tr_b16 a[252:253], v147 offset:0
v_cvt_pk_bf16_f32 v22, v38, v39
v_accvgpr_read_b32 v35, a63
v_mfma_f32_16x16x32_bf16 a[64:67], a[224:227], v[52:55], a[64:67]
s_lshl_b32 s63, s63, 7
ds_read_b64_tr_b16 a[250:251], v146 offset:512
v_accvgpr_read_b32 v34, a62
v_accvgpr_read_b32 v43, a61
v_mfma_f32_16x16x32_bf16 a[68:71], a[224:227], v[168:171], a[68:71]
s_lshl_b32 s3, s3, 4
ds_read_b64_tr_b16 a[248:249], v146 offset:0
buffer_store_dwordx4 v[20:23], v7, s[24:27], 0 offen offset:1024 sc1
v_accvgpr_read_b32 v42, a60
v_mfma_f32_16x16x32_bf16 v[156:159], a[224:227], v[80:83], v[156:159]
s_waitcnt lgkmcnt(10)
ds_read_b64_tr_b16 a[246:247], v145 offset:512
v_accvgpr_read_b32 v37, a55
v_accvgpr_read_b32 v36, a54
v_mfma_f32_16x16x32_bf16 a[72:75], a[228:231], v[52:55], a[72:75]
s_add_u32 s69, s69, 1
ds_read_b64_tr_b16 a[244:245], v145 offset:0
v_cvt_pk_bf16_f32 v31, v34, v35
v_cvt_pk_bf16_f32 v30, v42, v43
v_mfma_f32_16x16x32_bf16 a[76:79], a[228:231], v[168:171], a[76:79]
s_waitcnt lgkmcnt(10)
v_cvt_pk_bf16_f32 v29, v36, v37
buffer_store_dwordx4 v[28:31], v7, s[24:27], 0 offen offset:3072 sc1
v_mfma_f32_16x16x32_bf16 a[80:83], a[232:235], v[52:55], a[80:83]
s_add_u32 s55, s3, s73
v_mov_b32 v242, v162
v_mov_b32 v241, v161
v_mfma_f32_16x16x32_bf16 a[84:87], a[232:235], v[168:171], a[84:87]
s_waitcnt lgkmcnt(8)
v_mov_b32 v240, v160
v_accvgpr_read_b32 v219, a107
v_mfma_f32_16x16x32_bf16 a[88:91], a[236:239], v[52:55], a[88:91]
s_add_u32 s3, s58, 7
v_accvgpr_read_b32 v218, a106
v_accvgpr_read_b32 v217, a105
v_mfma_f32_16x16x32_bf16 a[92:95], a[236:239], v[168:171], a[92:95]
s_waitcnt lgkmcnt(6)
s_waitcnt lgkmcnt(0) vmcnt(9)
s_barrier
ds_read_b64_tr_b16 a[130:131], v132 offset:17024
v_accvgpr_read_b32 v216, a104
v_mfma_f32_16x16x32_bf16 a[64:67], a[240:243], v[56:59], a[64:67]
s_and_b32 s3, s3, 7
ds_read_b64_tr_b16 a[128:129], v132 offset:16512
v_add_u32 v97, s7, v90
buffer_store_dword v255, v97, s[28:31], 0 offen sc1
v_mfma_f32_16x16x32_bf16 a[68:71], a[240:243], v[60:63], a[68:71]
s_mov_b32 s7, s68
ds_read_b64_tr_b16 a[134:135], v133 offset:17024
v_accvgpr_read_b32 v223, a111
v_accvgpr_read_b32 v222, a110
v_mfma_f32_16x16x32_bf16 v[156:159], a[240:243], v[84:87], v[156:159]
s_add_u32 s68, s63, s74
ds_read_b64_tr_b16 a[132:133], v133 offset:16512
v_accvgpr_read_b32 v221, a109
v_accvgpr_read_b32 v220, a108
v_mfma_f32_16x16x32_bf16 a[72:75], a[244:247], v[56:59], a[72:75]
s_add_u32 s63, s58, s69
ds_read_b64_tr_b16 a[138:139], v134 offset:17024
v_accvgpr_read_b32 v36, a66
v_accvgpr_read_b32 v37, a67
v_mfma_f32_16x16x32_bf16 a[76:79], a[244:247], v[60:63], a[76:79]
s_and_b32 s63, s63, 7
ds_read_b64_tr_b16 a[136:137], v134 offset:16512
v_accvgpr_read_b32 v35, a65
v_cvt_pk_bf16_f32 v17, v36, v37
v_mfma_f32_16x16x32_bf16 a[80:83], a[248:251], v[56:59], a[80:83]
s_mul_i32 s4, s3, 18432
ds_read_b64_tr_b16 a[142:143], v135 offset:17024
v_accvgpr_read_b32 v34, a64
v_accvgpr_read_b32 v215, a103
v_accvgpr_read_b32 v227, a115
v_mfma_f32_16x16x32_bf16 a[84:87], a[248:251], v[60:63], a[84:87]
s_lshl_b32 s3, s3, 4
ds_read_b64_tr_b16 a[140:141], v135 offset:16512
v_add_u32 v97, s7, v90
v_accvgpr_read_b32 v39, a69
v_accvgpr_read_b32 v214, a102
v_accvgpr_read_b32 v226, a114
v_accvgpr_read_b32 v235, a123
v_accvgpr_read_b32 v38, a68
v_accvgpr_read_b32 v211, a99
v_accvgpr_read_b32 v213, a101
v_accvgpr_read_b32 v225, a113
v_mfma_f32_16x16x32_bf16 a[88:91], a[252:255], v[56:59], a[88:91]
s_mov_b32 s7, s68
ds_read_b64_tr_b16 a[146:147], v136 offset:17024
v_accvgpr_read_b32 v234, a122
v_cvt_pk_bf16_f32 v16, v34, v35
v_accvgpr_read_b32 v210, a98
v_cvt_pk_bf16_f32 v24, v38, v39
v_accvgpr_read_b32 v212, a100
v_accvgpr_read_b32 v224, a112
v_accvgpr_read_b32 v231, a119
v_accvgpr_read_b32 v233, a121
v_accvgpr_read_b32 v42, a72
v_accvgpr_read_b32 v43, a73
v_accvgpr_read_b32 v34, a74
v_accvgpr_read_b32 v35, a75
v_accvgpr_read_b32 v209, a97
v_mfma_f32_16x16x32_bf16 a[92:95], a[252:255], v[60:63], a[92:95]
s_waitcnt lgkmcnt(7)
ds_read_b64_tr_b16 a[144:145], v136 offset:16512
v_accvgpr_read_b32 v41, a71
v_cvt_pk_bf16_f32 v18, v42, v43
v_cvt_pk_bf16_f32 v19, v34, v35
v_accvgpr_read_b32 v230, a118
v_accvgpr_read_b32 v232, a120
v_accvgpr_read_b32 v208, a96
v_accvgpr_read_b32 v40, a70
ds_read_b64_tr_b16 a[150:151], v137 offset:17024
v_accvgpr_read_b32 v229, a117
v_mfma_f32_16x16x32_bf16 v[208:211], a[128:131], v[44:47], v[208:211]
s_add_u32 s6, s6, s72
ds_read_b64_tr_b16 a[148:149], v137 offset:16512
v_accvgpr_read_b32 v239, a127
v_accvgpr_read_b32 v38, a78
v_accvgpr_read_b32 v39, a79
v_cvt_pk_bf16_f32 v25, v40, v41
v_accvgpr_read_b32 v228, a116
v_accvgpr_read_b32 v238, a126
v_accvgpr_read_b32 v40, a80
v_accvgpr_read_b32 v41, a81
v_mfma_f32_16x16x32_bf16 v[212:215], a[128:131], v[64:67], v[212:215]
s_add_u32 s43, s43, s72
ds_read_b64_tr_b16 a[154:155], v138 offset:17024
v_cvt_pk_bf16_f32 v20, v40, v41
v_accvgpr_read_b32 v237, a125
v_accvgpr_read_b32 v236, a124
v_mfma_f32_16x16x32_bf16 v[240:243], a[128:131], v[72:75], v[240:243]
s_waitcnt lgkmcnt(9)
ds_read_b64_tr_b16 a[152:153], v138 offset:16512
v_cvt_pk_bf16_f32 v27, v38, v39
ds_read_b64_tr_b16 a[158:159], v139 offset:17024
v_mfma_f32_16x16x32_bf16 v[216:219], a[132:135], v[44:47], v[216:219]
s_add_u32 s54, s54, s72
ds_read_b64_tr_b16 a[156:157], v139 offset:16512
v_accvgpr_read_b32 v35, a85
v_accvgpr_read_b32 v34, a84
v_mfma_f32_16x16x32_bf16 v[220:223], a[132:135], v[64:67], v[220:223]
s_waitcnt lgkmcnt(10)
ds_read_b64_tr_b16 a[226:227], v140 offset:17024
v_cvt_pk_bf16_f32 v33, v158, v159
v_cvt_pk_bf16_f32 v32, v156, v157
ds_read_b64_tr_b16 a[224:225], v140 offset:16512
v_mfma_f32_16x16x32_bf16 v[224:227], a[136:139], v[44:47], v[224:227]
s_add_u32 s4, s4, s72
ds_read_b64_tr_b16 a[230:231], v141 offset:17024
v_add_u32 v8, s67, v89
v_accvgpr_read_b32 v37, a77
v_mfma_f32_16x16x32_bf16 v[228:231], a[136:139], v[64:67], v[228:231]
s_waitcnt lgkmcnt(11)
ds_read_b64_tr_b16 a[228:229], v141 offset:16512
v_accvgpr_read_b32 v36, a76
ds_read_b64_tr_b16 a[234:235], v142 offset:17024
v_mfma_f32_16x16x32_bf16 v[232:235], a[140:143], v[44:47], v[232:235]
s_add_u32 s5, s3, s73
ds_read_b64_tr_b16 a[232:233], v142 offset:16512
v_accvgpr_read_b32 v43, a83
v_accvgpr_read_b32 v42, a82
v_mfma_f32_16x16x32_bf16 v[236:239], a[140:143], v[64:67], v[236:239]
s_waitcnt lgkmcnt(12)
ds_read_b64_tr_b16 a[238:239], v143 offset:17024
s_waitcnt vmcnt(1)
buffer_store_dword v255, v97, s[28:31], 0 offen sc1
v_accvgpr_read_b32 v41, a91
v_mfma_f32_16x16x32_bf16 v[208:211], a[144:147], v[48:51], v[208:211]
ds_read_b64_tr_b16 a[236:237], v143 offset:16512
buffer_store_dwordx2 v[32:33], v8, s[24:27], 0 offen sc1
v_accvgpr_read_b32 v40, a90
v_add_u32 v7, s67, v88
ds_read_b64_tr_b16 a[254:255], v147 offset:17024
v_mfma_f32_16x16x32_bf16 v[212:215], a[144:147], v[68:71], v[212:215]
s_mul_i32 s67, s63, 147456
ds_read_b64_tr_b16 a[252:253], v147 offset:16512
v_accvgpr_read_b32 v39, a89
v_accvgpr_read_b32 v38, a88
v_mfma_f32_16x16x32_bf16 v[240:243], a[144:147], v[76:79], v[240:243]
s_waitcnt lgkmcnt(14)
ds_read_b64_tr_b16 a[250:251], v146 offset:17024
buffer_store_dwordx4 v[16:19], v7, s[24:27], 0 offen sc1
v_cvt_pk_bf16_f32 v28, v34, v35
v_mfma_f32_16x16x32_bf16 v[216:219], a[148:151], v[48:51], v[216:219]
s_lshl_b32 s63, s63, 7
ds_read_b64_tr_b16 a[248:249], v146 offset:16512
v_cvt_pk_bf16_f32 v26, v36, v37
v_cvt_pk_bf16_f32 v21, v42, v43
ds_read_b64_tr_b16 a[246:247], v145 offset:17024
v_mfma_f32_16x16x32_bf16 v[220:223], a[148:151], v[68:71], v[220:223]
s_waitcnt lgkmcnt(15)
ds_read_b64_tr_b16 a[244:245], v145 offset:16512
buffer_store_dwordx4 v[24:27], v7, s[24:27], 0 offen offset:2048 sc1
v_cvt_pk_bf16_f32 v23, v40, v41
v_cvt_pk_bf16_f32 v22, v38, v39
v_mfma_f32_16x16x32_bf16 v[224:227], a[152:155], v[48:51], v[224:227]
s_add_u32 s67, s67, s70
ds_read_b64_tr_b16 a[242:243], v144 offset:17024
v_accvgpr_read_b32 v35, a95
ds_read_b64_tr_b16 a[240:241], v144 offset:16512
v_mfma_f32_16x16x32_bf16 v[228:231], a[152:155], v[68:71], v[228:231]
s_waitcnt lgkmcnt(15)
ds_read_b128 a[44:47], v167 offset:24832
buffer_store_dwordx4 v[20:23], v7, s[24:27], 0 offen offset:1024 sc1
v_accvgpr_read_b32 v34, a94
v_accvgpr_read_b32 v43, a93
v_mfma_f32_16x16x32_bf16 v[232:235], a[156:159], v[48:51], v[232:235]
s_add_u32 s68, s63, s74
ds_read_b128 a[40:43], v166 offset:24832
v_accvgpr_read_b32 v42, a92
v_accvgpr_read_b32 v37, a87
v_mfma_f32_16x16x32_bf16 v[236:239], a[156:159], v[68:71], v[236:239]
s_waitcnt lgkmcnt(15)
ds_read_b128 a[36:39], v165 offset:24832
v_accvgpr_read_b32 v36, a86
ds_read_b128 a[32:35], v164 offset:24832
v_mfma_f32_16x16x32_bf16 v[208:211], a[224:227], v[52:55], v[208:211]
ds_read_b128 a[28:31], v167 offset:20736
v_cvt_pk_bf16_f32 v31, v34, v35
v_cvt_pk_bf16_f32 v30, v42, v43
v_mfma_f32_16x16x32_bf16 v[212:215], a[224:227], v[168:171], v[212:215]
ds_read_b128 a[24:27], v166 offset:20736
v_cvt_pk_bf16_f32 v29, v36, v37
buffer_store_dwordx4 v[28:31], v7, s[24:27], 0 offen offset:3072 sc1
ds_read_b128 a[20:23], v165 offset:20736
v_mfma_f32_16x16x32_bf16 v[240:243], a[224:227], v[80:83], v[240:243]
s_waitcnt lgkmcnt(15)
ds_read_b128 a[16:19], v164 offset:20736
ds_read_b128 a[12:15], v167 offset:16640
v_mfma_f32_16x16x32_bf16 v[216:219], a[228:231], v[52:55], v[216:219]
ds_read_b128 a[8:11], v166 offset:16640
v_add_u32 v95, s46, v14
s_add_u32 s46, s65, 294912
v_mfma_f32_16x16x32_bf16 v[220:223], a[228:231], v[168:171], v[220:223]
ds_read_b128 a[4:7], v165 offset:16640
buffer_load_dwordx4 v95, s[36:39], 0 offen lds
v_add_u32 v96, s46, v14
s_add_u32 s46, s65, 327680
s_add_u32 m0, s42, 4128
v_add_u32 v95, s46, v14
v_mfma_f32_16x16x32_bf16 v[224:227], a[232:235], v[52:55], v[224:227]
s_add_u32 s46, s65, 360448
ds_read_b128 a[0:3], v164 offset:16640
buffer_load_dwordx4 v96, s[36:39], 0 offen lds
v_add_u32 v96, s46, v14
v_accvgpr_write_b32 a123, 0
v_mfma_f32_16x16x32_bf16 v[228:231], a[232:235], v[168:171], v[228:231]
s_add_u32 m0, s42, 8256
v_accvgpr_write_b32 a122, 0
v_accvgpr_write_b32 a103, 0
v_accvgpr_write_b32 a102, 0
v_mfma_f32_16x16x32_bf16 v[232:235], a[236:239], v[52:55], v[232:235]
buffer_load_dwordx4 v95, s[36:39], 0 offen lds
v_accvgpr_write_b32 a83, 0
v_accvgpr_write_b32 a82, 0
v_mfma_f32_16x16x32_bf16 v[236:239], a[236:239], v[168:171], v[236:239]
s_add_u32 m0, s42, 12384
v_mov_b32 v251, v245
v_mov_b32 v250, v244
v_mov_b32 v249, 0
v_mov_b32 v248, 0
v_mov_b32 v247, 0
v_mov_b32 v246, 0
buffer_load_dwordx4 v96, s[36:39], 0 offen lds
L_trip:
s_waitcnt lgkmcnt(0) vmcnt(13)
s_barrier
v_mfma_f32_16x16x32_bf16 v[208:211], a[240:243], v[56:59], v[208:211]
s_add_u32 s46, s65, 393216
ds_read_b64_tr_b16 a[130:131], v132 offset:33536
ds_read_b64_tr_b16 a[128:129], v132 offset:33024
v_mfma_f32_16x16x32_bf16 v[212:215], a[240:243], v[60:63], v[212:215]
s_add_u32 m0, s42, 16512
ds_read_b64_tr_b16 a[134:135], v133 offset:33536
v_add_u32 v98, s5, v90
buffer_load_dword v91, v98, s[28:31], 0 offen sc1
v_mfma_f32_16x16x32_bf16 v[240:243], a[240:243], v[84:87], v[240:243]
ds_read_b64_tr_b16 a[132:133], v133 offset:33024
v_add_u32 v95, s46, v14
v_mfma_f32_16x16x32_bf16 v[216:219], a[244:247], v[56:59], v[216:219]
s_add_u32 s46, s65, 425984
ds_read_b64_tr_b16 a[138:139], v134 offset:33536
v_cvt_pk_bf16_f32 v17, v210, v211
v_mfma_f32_16x16x32_bf16 v[220:223], a[244:247], v[60:63], v[220:223]
ds_read_b64_tr_b16 a[136:137], v134 offset:33024
v_cvt_pk_bf16_f32 v16, v208, v209
v_mfma_f32_16x16x32_bf16 v[224:227], a[248:251], v[56:59], v[224:227]
ds_read_b64_tr_b16 a[142:143], v135 offset:33536
v_cvt_pk_bf16_f32 v25, v214, v215
v_mfma_f32_16x16x32_bf16 v[228:231], a[248:251], v[60:63], v[228:231]
ds_read_b64_tr_b16 a[140:141], v135 offset:33024
buffer_load_dwordx4 v95, s[36:39], 0 offen lds
v_cvt_pk_bf16_f32 v24, v212, v213
v_mfma_f32_16x16x32_bf16 v[232:235], a[252:255], v[56:59], v[232:235]
s_add_u32 m0, s42, 20640
ds_read_b64_tr_b16 a[146:147], v136 offset:33536
v_add_u32 v96, s46, v14
v_cvt_pk_bf16_f32 v33, v242, v243
v_mfma_f32_16x16x32_bf16 v[236:239], a[252:255], v[60:63], v[236:239]
s_waitcnt lgkmcnt(7)
ds_read_b64_tr_b16 a[144:145], v136 offset:33024
v_cvt_pk_bf16_f32 v32, v240, v241
v_mfma_f32_16x16x32_bf16 v[208:211], a[128:131], a[160:163], 0
s_add_u32 s46, s65, 458752
ds_read_b64_tr_b16 a[150:151], v137 offset:33536
v_cvt_pk_bf16_f32 v19, v218, v219
v_cvt_pk_bf16_f32 v18, v216, v217
v_mfma_f32_16x16x32_bf16 v[212:215], a[128:131], a[176:179], 0
ds_read_b64_tr_b16 a[148:149], v137 offset:33024
buffer_load_dwordx4 v96, s[36:39], 0 offen lds
v_cvt_pk_bf16_f32 v27, v222, v223
v_mfma_f32_16x16x32_bf16 v[240:243], a[128:131], a[0:3], 0
s_waitcnt lgkmcnt(8)
ds_read_b64_tr_b16 a[154:155], v138 offset:33536
v_cvt_pk_bf16_f32 v26, v220, v221
v_cvt_pk_bf16_f32 v21, v226, v227
v_mfma_f32_16x16x32_bf16 v[216:219], a[132:135], a[160:163], 0
s_add_u32 m0, s42, 24768
ds_read_b64_tr_b16 a[152:153], v138 offset:33024
v_cvt_pk_bf16_f32 v20, v224, v225
v_add_u32 v95, s46, v14
v_mfma_f32_16x16x32_bf16 v[220:223], a[132:135], a[176:179], 0
s_waitcnt lgkmcnt(8)
ds_read_b64_tr_b16 a[158:159], v139 offset:33536
v_cvt_pk_bf16_f32 v29, v230, v231
v_cvt_pk_bf16_f32 v28, v228, v229
v_mfma_f32_16x16x32_bf16 v[224:227], a[136:139], a[160:163], 0
s_add_u32 s46, s65, 491520
ds_read_b64_tr_b16 a[156:157], v139 offset:33024
buffer_load_dwordx4 v95, s[36:39], 0 offen lds
v_cvt_pk_bf16_f32 v23, v234, v235
v_mfma_f32_16x16x32_bf16 v[228:231], a[136:139], a[176:179], 0
s_waitcnt lgkmcnt(8)
ds_read_b64_tr_b16 a[226:227], v140 offset:33536
v_cvt_pk_bf16_f32 v22, v232, v233
v_cvt_pk_bf16_f32 v31, v238, v239
v_mfma_f32_16x16x32_bf16 v[232:235], a[140:143], a[160:163], 0
s_add_u32 m0, s42, 28896
ds_read_b64_tr_b16 a[224:225], v140 offset:33024
v_cvt_pk_bf16_f32 v30, v236, v237
v_mfma_f32_16x16x32_bf16 v[236:239], a[140:143], a[176:179], 0
s_waitcnt lgkmcnt(8)
ds_read_b64_tr_b16 a[230:231], v141 offset:33536
v_add_u32 v96, s46, v14
v_mfma_f32_16x16x32_bf16 v[208:211], a[144:147], a[164:167], v[208:211]
s_mov_b32 s46, s66
ds_read_b64_tr_b16 a[228:229], v141 offset:33024
buffer_load_dwordx4 v96, s[36:39], 0 offen lds
v_mfma_f32_16x16x32_bf16 v[212:215], a[144:147], a[180:183], v[212:215]
s_add_u32 m0, s42, 33024
ds_read_b64_tr_b16 a[234:235], v142 offset:33536
v_add_u32 v8, s67, v89
v_mfma_f32_16x16x32_bf16 v[240:243], a[144:147], a[4:7], v[240:243]
s_waitcnt lgkmcnt(9)
ds_read_b64_tr_b16 a[232:233], v142 offset:33024
buffer_store_dwordx2 v[32:33], v8, s[24:27], 0 offen sc1
v_mfma_f32_16x16x32_bf16 v[216:219], a[148:151], a[164:167], v[216:219]
s_mov_b32 s65, s66
ds_read_b64_tr_b16 a[238:239], v143 offset:33536
v_add_u32 v7, s67, v88
v_mfma_f32_16x16x32_bf16 v[220:223], a[148:151], a[180:183], v[220:223]
s_waitcnt lgkmcnt(9)
ds_read_b64_tr_b16 a[236:237], v143 offset:33024
v_add_u32 v95, s46, v14
v_mfma_f32_16x16x32_bf16 v[224:227], a[152:155], a[164:167], v[224:227]
s_add_u32 s46, s66, 32768
ds_read_b64_tr_b16 a[242:243], v144 offset:33536
v_add_u32 v96, s46, v14
v_mfma_f32_16x16x32_bf16 v[228:231], a[152:155], a[180:183], v[228:231]
s_waitcnt lgkmcnt(9)
ds_read_b64_tr_b16 a[240:241], v144 offset:33024
s_add_u32 s46, s66, 65536
v_mfma_f32_16x16x32_bf16 v[232:235], a[156:159], a[164:167], v[232:235]
ds_read_b64_tr_b16 a[254:255], v147 offset:33536
buffer_store_dwordx4 v[16:19], v7, s[24:27], 0 offen sc1
v_mfma_f32_16x16x32_bf16 v[236:239], a[156:159], a[180:183], v[236:239]
s_waitcnt lgkmcnt(9)
ds_read_b64_tr_b16 a[252:253], v147 offset:33024
v_add_u32 v97, s7, v90
v_mfma_f32_16x16x32_bf16 v[208:211], a[224:227], a[168:171], v[208:211]
s_mov_b32 s7, s68
ds_read_b64_tr_b16 a[250:251], v146 offset:33536
v_add_u32 v9, s4, v88
v_mfma_f32_16x16x32_bf16 v[212:215], a[224:227], a[184:187], v[212:215]
ds_read_b64_tr_b16 a[248:249], v146 offset:33024
v_add_u32 v11, s4, v89
v_mfma_f32_16x16x32_bf16 v[240:243], a[224:227], a[8:11], v[240:243]
s_waitcnt lgkmcnt(10)
ds_read_b64_tr_b16 a[246:247], v145 offset:33536
v_mfma_f32_16x16x32_bf16 v[216:219], a[228:231], a[168:171], v[216:219]
ds_read_b64_tr_b16 a[244:245], v145 offset:33024
buffer_store_dwordx4 v[24:27], v7, s[24:27], 0 offen offset:2048 sc1
v_mfma_f32_16x16x32_bf16 v[220:223], a[228:231], a[184:187], v[220:223]
s_waitcnt lgkmcnt(10)
v_mfma_f32_16x16x32_bf16 v[224:227], a[232:235], a[168:171], v[224:227]
v_mfma_f32_16x16x32_bf16 v[228:231], a[232:235], a[184:187], v[228:231]
s_waitcnt lgkmcnt(8)
v_mfma_f32_16x16x32_bf16 v[232:235], a[236:239], a[168:171], v[232:235]
v_mfma_f32_16x16x32_bf16 v[236:239], a[236:239], a[184:187], v[236:239]
s_waitcnt lgkmcnt(6)
s_waitcnt lgkmcnt(0) vmcnt(17)
s_barrier
ds_read_b64_tr_b16 a[130:131], v132 offset:50048
v_mfma_f32_16x16x32_bf16 v[208:211], a[240:243], a[172:175], v[208:211]
ds_read_b64_tr_b16 a[128:129], v132 offset:49536
v_mfma_f32_16x16x32_bf16 v[212:215], a[240:243], a[188:191], v[212:215]
ds_read_b64_tr_b16 a[134:135], v133 offset:50048
v_mfma_f32_16x16x32_bf16 v[240:243], a[240:243], a[12:15], v[240:243]
ds_read_b64_tr_b16 a[132:133], v133 offset:49536
buffer_store_dwordx4 v[20:23], v7, s[24:27], 0 offen offset:1024 sc1
v_mfma_f32_16x16x32_bf16 v[216:219], a[244:247], a[172:175], v[216:219]
ds_read_b64_tr_b16 a[138:139], v134 offset:50048
v_mfma_f32_16x16x32_bf16 v[220:223], a[244:247], a[188:191], v[220:223]
ds_read_b64_tr_b16 a[136:137], v134 offset:49536
v_mfma_f32_16x16x32_bf16 v[224:227], a[248:251], a[172:175], v[224:227]
ds_read_b64_tr_b16 a[142:143], v135 offset:50048
v_mfma_f32_16x16x32_bf16 v[228:231], a[248:251], a[188:191], v[228:231]
ds_read_b64_tr_b16 a[140:141], v135 offset:49536
v_mfma_f32_16x16x32_bf16 v[232:235], a[252:255], a[172:175], v[232:235]
ds_read_b64_tr_b16 a[146:147], v136 offset:50048
buffer_store_dwordx4 v[28:31], v7, s[24:27], 0 offen offset:3072 sc1
v_mfma_f32_16x16x32_bf16 v[236:239], a[252:255], a[188:191], v[236:239]
s_waitcnt lgkmcnt(7)
ds_read_b64_tr_b16 a[144:145], v136 offset:49536
v_mfma_f32_16x16x32_bf16 v[208:211], a[128:131], a[192:195], v[208:211]
ds_read_b64_tr_b16 a[150:151], v137 offset:50048
v_mfma_f32_16x16x32_bf16 v[212:215], a[128:131], a[208:211], v[212:215]
ds_read_b64_tr_b16 a[148:149], v137 offset:49536
v_mfma_f32_16x16x32_bf16 v[240:243], a[128:131], a[16:19], v[240:243]
s_waitcnt lgkmcnt(8)
ds_read_b64_tr_b16 a[154:155], v138 offset:50048
v_mfma_f32_16x16x32_bf16 v[216:219], a[132:135], a[192:195], v[216:219]
ds_read_b64_tr_b16 a[152:153], v138 offset:49536
buffer_load_dwordx4 v95, s[36:39], 0 offen lds
v_mfma_f32_16x16x32_bf16 v[220:223], a[132:135], a[208:211], v[220:223]
s_waitcnt lgkmcnt(8)
ds_read_b64_tr_b16 a[158:159], v139 offset:50048
s_add_u32 m0, s42, 37152
v_mfma_f32_16x16x32_bf16 v[224:227], a[136:139], a[192:195], v[224:227]
ds_read_b64_tr_b16 a[156:157], v139 offset:49536
v_add_u32 v95, s46, v14
v_mfma_f32_16x16x32_bf16 v[228:231], a[136:139], a[208:211], v[228:231]
s_waitcnt lgkmcnt(8)
ds_read_b64_tr_b16 a[226:227], v140 offset:50048
s_add_u32 s46, s66, 98304
v_mfma_f32_16x16x32_bf16 v[232:235], a[140:143], a[192:195], v[232:235]
ds_read_b64_tr_b16 a[224:225], v140 offset:49536
buffer_load_dwordx4 v96, s[36:39], 0 offen lds
v_mfma_f32_16x16x32_bf16 v[236:239], a[140:143], a[208:211], v[236:239]
s_waitcnt lgkmcnt(8)
ds_read_b64_tr_b16 a[230:231], v141 offset:50048
s_add_u32 m0, s42, 41280
v_mfma_f32_16x16x32_bf16 v[208:211], a[144:147], a[196:199], v[208:211]
ds_read_b64_tr_b16 a[228:229], v141 offset:49536
v_add_u32 v96, s46, v14
v_mfma_f32_16x16x32_bf16 v[212:215], a[144:147], a[212:215], v[212:215]
s_add_u32 s46, s66, 131072
ds_read_b64_tr_b16 a[234:235], v142 offset:50048
v_mfma_f32_16x16x32_bf16 v[240:243], a[144:147], a[20:23], v[240:243]
s_waitcnt lgkmcnt(9)
ds_read_b64_tr_b16 a[232:233], v142 offset:49536
buffer_load_dwordx4 v95, s[36:39], 0 offen lds
v_mfma_f32_16x16x32_bf16 v[216:219], a[148:151], a[196:199], v[216:219]
s_add_u32 m0, s42, 45408
ds_read_b64_tr_b16 a[238:239], v143 offset:50048
v_add_u32 v95, s46, v14
v_mfma_f32_16x16x32_bf16 v[220:223], a[148:151], a[212:215], v[220:223]
s_waitcnt lgkmcnt(9)
ds_read_b64_tr_b16 a[236:237], v143 offset:49536
s_add_u32 s46, s66, 163840
v_mfma_f32_16x16x32_bf16 v[224:227], a[152:155], a[196:199], v[224:227]
ds_read_b64_tr_b16 a[242:243], v144 offset:50048
v_mfma_f32_16x16x32_bf16 v[228:231], a[152:155], a[212:215], v[228:231]
s_waitcnt lgkmcnt(9)
ds_read_b64_tr_b16 a[240:241], v144 offset:49536
buffer_load_dwordx4 v96, s[36:39], 0 offen lds
v_mfma_f32_16x16x32_bf16 v[232:235], a[156:159], a[196:199], v[232:235]
s_add_u32 m0, s42, 49536
ds_read_b64_tr_b16 a[254:255], v147 offset:50048
v_add_u32 v96, s46, v14
v_mfma_f32_16x16x32_bf16 v[236:239], a[156:159], a[212:215], v[236:239]
s_waitcnt lgkmcnt(9)
ds_read_b64_tr_b16 a[252:253], v147 offset:49536
s_add_u32 s46, s66, 196608
v_mfma_f32_16x16x32_bf16 v[208:211], a[224:227], a[200:203], v[208:211]
ds_read_b64_tr_b16 a[250:251], v146 offset:50048
v_mfma_f32_16x16x32_bf16 v[212:215], a[224:227], a[216:219], v[212:215]
ds_read_b64_tr_b16 a[248:249], v146 offset:49536
v_mfma_f32_16x16x32_bf16 v[240:243], a[224:227], a[24:27], v[240:243]
s_waitcnt lgkmcnt(10)
ds_read_b64_tr_b16 a[246:247], v145 offset:50048
v_mfma_f32_16x16x32_bf16 v[216:219], a[228:231], a[200:203], v[216:219]
ds_read_b64_tr_b16 a[244:245], v145 offset:49536
v_mfma_f32_16x16x32_bf16 v[220:223], a[228:231], a[216:219], v[220:223]
s_waitcnt lgkmcnt(10)
v_mfma_f32_16x16x32_bf16 v[224:227], a[232:235], a[200:203], v[224:227]
v_mfma_f32_16x16x32_bf16 v[228:231], a[232:235], a[216:219], v[228:231]
s_waitcnt lgkmcnt(8)
v_mfma_f32_16x16x32_bf16 v[232:235], a[236:239], a[200:203], v[232:235]
v_mfma_f32_16x16x32_bf16 v[236:239], a[236:239], a[216:219], v[236:239]
s_waitcnt lgkmcnt(6)
s_waitcnt lgkmcnt(0) vmcnt(14)
s_barrier
ds_read_b64_tr_b16 a[130:131], v132 offset:512
buffer_store_dword v255, v97, s[28:31], 0 offen sc1
v_mfma_f32_16x16x32_bf16 v[208:211], a[240:243], a[204:207], v[208:211]
ds_read_b64_tr_b16 a[128:129], v132 offset:0
v_mfma_f32_16x16x32_bf16 v[212:215], a[240:243], a[220:223], v[212:215]
ds_read_b64_tr_b16 a[134:135], v133 offset:512
v_mfma_f32_16x16x32_bf16 v[240:243], a[240:243], a[28:31], v[240:243]
ds_read_b64_tr_b16 a[132:133], v133 offset:0
buffer_load_dwordx4 v95, s[36:39], 0 offen lds
v_mfma_f32_16x16x32_bf16 v[216:219], a[244:247], a[204:207], v[216:219]
s_add_u32 m0, s42, 53664
ds_read_b64_tr_b16 a[138:139], v134 offset:512
v_add_u32 v95, s46, v14
v_mfma_f32_16x16x32_bf16 v[220:223], a[244:247], a[220:223], v[220:223]
s_add_u32 s46, s66, 229376
ds_read_b64_tr_b16 a[136:137], v134 offset:0
v_mfma_f32_16x16x32_bf16 v[224:227], a[248:251], a[204:207], v[224:227]
ds_read_b64_tr_b16 a[142:143], v135 offset:512
v_mfma_f32_16x16x32_bf16 v[228:231], a[248:251], a[220:223], v[228:231]
ds_read_b64_tr_b16 a[140:141], v135 offset:0
buffer_load_dwordx4 v96, s[36:39], 0 offen lds
v_mfma_f32_16x16x32_bf16 v[232:235], a[252:255], a[204:207], v[232:235]
s_add_u32 m0, s42, 57792
ds_read_b64_tr_b16 a[146:147], v136 offset:512
v_add_u32 v96, s46, v14
v_mfma_f32_16x16x32_bf16 v[236:239], a[252:255], a[220:223], v[236:239]
s_waitcnt lgkmcnt(7)
ds_read_b64_tr_b16 a[144:145], v136 offset:0
s_add_u32 s46, s66, 262144
v_mfma_f32_16x16x32_bf16 v[208:211], a[128:131], v[100:103], v[208:211]
ds_read_b64_tr_b16 a[150:151], v137 offset:512
v_mfma_f32_16x16x32_bf16 v[212:215], a[128:131], v[116:119], v[212:215]
ds_read_b64_tr_b16 a[148:149], v137 offset:0
buffer_load_dwordx4 v95, s[36:39], 0 offen lds
v_mfma_f32_16x16x32_bf16 v[240:243], a[128:131], a[32:35], v[240:243]
s_waitcnt lgkmcnt(8)
ds_read_b64_tr_b16 a[154:155], v138 offset:512
s_add_u32 m0, s42, 61920
v_mfma_f32_16x16x32_bf16 v[216:219], a[132:135], v[100:103], v[216:219]
ds_read_b64_tr_b16 a[152:153], v138 offset:0
s_cmp_lt_u32 s69, 5
s_cbranch_scc1 L_ni8
s_cmp_eq_u32 s69, 5
s_cbranch_scc1 L_iz8
v_mfma_f32_16x16x32_bf16 v[172:175], v[244:247], a[64:67], v[172:175]
v_mfma_f32_16x16x32_bf16 v[176:179], v[244:247], a[72:75], v[176:179]
v_mfma_f32_16x16x32_bf16 v[180:183], v[248:251], a[64:67], v[180:183]
v_mfma_f32_16x16x32_bf16 v[184:187], v[248:251], a[72:75], v[184:187]
v_mfma_f32_16x16x32_bf16 v[188:191], v[244:247], a[68:71], v[188:191]
v_mfma_f32_16x16x32_bf16 v[192:195], v[244:247], a[76:79], v[192:195]
v_mfma_f32_16x16x32_bf16 v[196:199], v[248:251], a[68:71], v[196:199]
v_mfma_f32_16x16x32_bf16 v[200:203], v[248:251], a[76:79], v[200:203]
v_mfma_f32_16x16x32_bf16 v[204:207], v[244:247], a[80:83], v[204:207]
s_branch L_ni8
L_iz8:
v_mfma_f32_16x16x32_bf16 v[172:175], v[244:247], a[64:67], 0
v_mfma_f32_16x16x32_bf16 v[176:179], v[244:247], a[72:75], 0
v_mfma_f32_16x16x32_bf16 v[180:183], v[248:251], a[64:67], 0
v_mfma_f32_16x16x32_bf16 v[184:187], v[248:251], a[72:75], 0
v_mfma_f32_16x16x32_bf16 v[188:191], v[244:247], a[68:71], 0
v_mfma_f32_16x16x32_bf16 v[192:195], v[244:247], a[76:79], 0
v_mfma_f32_16x16x32_bf16 v[196:199], v[248:251], a[68:71], 0
v_mfma_f32_16x16x32_bf16 v[200:203], v[248:251], a[76:79], 0
v_mfma_f32_16x16x32_bf16 v[204:207], v[244:247], a[80:83], 0
L_ni8:
v_mfma_f32_16x16x32_bf16 v[220:223], a[132:135], v[116:119], v[220:223]
s_waitcnt lgkmcnt(8)
ds_read_b64_tr_b16 a[158:159], v139 offset:512
v_add_u32 v95, s46, v14
v_mfma_f32_16x16x32_bf16 v[224:227], a[136:139], v[100:103], v[224:227]
s_add_u32 s46, s66, 294912
ds_read_b64_tr_b16 a[156:157], v139 offset:0
buffer_load_dwordx4 v96, s[36:39], 0 offen lds
v_mfma_f32_16x16x32_bf16 v[228:231], a[136:139], v[116:119], v[228:231]
s_waitcnt lgkmcnt(8)
ds_read_b64_tr_b16 a[226:227], v140 offset:512
s_mov_b32 m0, s42
v_mfma_f32_16x16x32_bf16 v[232:235], a[140:143], v[100:103], v[232:235]
s_add_u32 s69, s69, 1
ds_read_b64_tr_b16 a[224:225], v140 offset:0
v_add_u32 v96, s46, v14
v_mfma_f32_16x16x32_bf16 v[236:239], a[140:143], v[116:119], v[236:239]
s_waitcnt lgkmcnt(8)
ds_read_b64_tr_b16 a[230:231], v141 offset:512
s_add_u32 s46, s66, 327680
v_mfma_f32_16x16x32_bf16 v[208:211], a[144:147], v[104:107], v[208:211]
s_add_u32 s63, s58, s69
ds_read_b64_tr_b16 a[228:229], v141 offset:0
s_and_b32 s63, s63, 7
v_mfma_f32_16x16x32_bf16 v[212:215], a[144:147], v[120:123], v[212:215]
s_mul_i32 s67, s63, 147456
ds_read_b64_tr_b16 a[234:235], v142 offset:512
s_lshl_b32 s63, s63, 7
v_mfma_f32_16x16x32_bf16 v[240:243], a[144:147], a[36:39], v[240:243]
s_waitcnt lgkmcnt(9)
ds_read_b64_tr_b16 a[232:233], v142 offset:0
s_add_u32 s67, s67, s70
v_mfma_f32_16x16x32_bf16 v[216:219], a[148:151], v[104:107], v[216:219]
s_add_u32 s68, s63, s74
ds_read_b64_tr_b16 a[238:239], v143 offset:512
v_mfma_f32_16x16x32_bf16 v[220:223], a[148:151], v[120:123], v[220:223]
s_waitcnt lgkmcnt(9)
ds_read_b64_tr_b16 a[236:237], v143 offset:0
v_mfma_f32_16x16x32_bf16 v[224:227], a[152:155], v[104:107], v[224:227]
ds_read_b64_tr_b16 a[242:243], v144 offset:512
v_mfma_f32_16x16x32_bf16 v[228:231], a[152:155], v[120:123], v[228:231]
s_waitcnt lgkmcnt(9)
ds_read_b64_tr_b16 a[240:241], v144 offset:0
v_mfma_f32_16x16x32_bf16 v[232:235], a[156:159], v[104:107], v[232:235]
ds_read_b64_tr_b16 a[254:255], v147 offset:512
v_mfma_f32_16x16x32_bf16 v[236:239], a[156:159], v[120:123], v[236:239]
s_waitcnt lgkmcnt(9)
ds_read_b64_tr_b16 a[252:253], v147 offset:0
v_mfma_f32_16x16x32_bf16 v[208:211], a[224:227], v[108:111], v[208:211]
ds_read_b64_tr_b16 a[250:251], v146 offset:512
v_mfma_f32_16x16x32_bf16 v[212:215], a[224:227], v[124:127], v[212:215]
ds_read_b64_tr_b16 a[248:249], v146 offset:0
v_mfma_f32_16x16x32_bf16 v[240:243], a[224:227], a[40:43], v[240:243]
s_waitcnt lgkmcnt(10)
ds_read_b64_tr_b16 a[246:247], v145 offset:512
v_mfma_f32_16x16x32_bf16 v[216:219], a[228:231], v[108:111], v[216:219]
ds_read_b64_tr_b16 a[244:245], v145 offset:0
v_mfma_f32_16x16x32_bf16 v[220:223], a[228:231], v[124:127], v[220:223]
s_waitcnt lgkmcnt(10)
v_mfma_f32_16x16x32_bf16 v[224:227], a[232:235], v[108:111], v[224:227]
v_mfma_f32_16x16x32_bf16 v[228:231], a[232:235], v[124:127], v[228:231]
s_waitcnt lgkmcnt(8)
v_mfma_f32_16x16x32_bf16 v[232:235], a[236:239], v[108:111], v[232:235]
v_mfma_f32_16x16x32_bf16 v[236:239], a[236:239], v[124:127], v[236:239]
s_waitcnt lgkmcnt(6)
s_waitcnt lgkmcnt(0) vmcnt(14)
s_barrier
ds_read_b64_tr_b16 a[130:131], v132 offset:17024
v_readfirstlane_b32 s3, v91
s_nop 0
s_cmp_eq_u32 s3, s57
s_cbranch_scc1 L_ok9
s_mov_b32 s62, 0x40000
L_sp9:
buffer_load_dword v91, v90, s[28:31], s5 offen sc1
s_waitcnt vmcnt(0)
v_readfirstlane_b32 s3, v91
s_sub_u32 s62, s62, 1
s_cmp_eq_u32 s62, 0
s_cbranch_scc1 L_ok9
s_cmp_eq_u32 s3, s57
s_cbranch_scc0 L_sp9
L_ok9:
v_mfma_f32_16x16x32_bf16 v[208:211], a[240:243], v[112:115], v[208:211]
ds_read_b64_tr_b16 a[128:129], v132 offset:16512
v_mfma_f32_16x16x32_bf16 v[212:215], a[240:243], v[128:131], v[212:215]
ds_read_b64_tr_b16 a[134:135], v133 offset:17024
buffer_load_dwordx4 a[64:67], v9, s[24:27], 0 offen sc1
v_mfma_f32_16x16x32_bf16 v[240:243], a[240:243], a[44:47], v[240:243]
ds_read_b64_tr_b16 a[132:133], v133 offset:16512
v_mfma_f32_16x16x32_bf16 v[216:219], a[244:247], v[112:115], v[216:219]
ds_read_b64_tr_b16 a[138:139], v134 offset:17024
v_mfma_f32_16x16x32_bf16 v[220:223], a[244:247], v[128:131], v[220:223]
ds_read_b64_tr_b16 a[136:137], v134 offset:16512
buffer_load_dwordx4 a[68:71], v9, s[24:27], 0 offen offset:1024 sc1
v_mfma_f32_16x16x32_bf16 v[224:227], a[248:251], v[112:115], v[224:227]
ds_read_b64_tr_b16 a[142:143], v135 offset:17024
v_mfma_f32_16x16x32_bf16 v[228:231], a[248:251], v[128:131], v[228:231]
ds_read_b64_tr_b16 a[140:141], v135 offset:16512
v_mfma_f32_16x16x32_bf16 v[232:235], a[252:255], v[112:115], v[232:235]
ds_read_b64_tr_b16 a[146:147], v136 offset:17024
buffer_load_dwordx4 a[72:75], v9, s[24:27], 0 offen offset:2048 sc1
v_mfma_f32_16x16x32_bf16 v[236:239], a[252:255], v[128:131], v[236:239]
s_waitcnt lgkmcnt(7)
ds_read_b64_tr_b16 a[144:145], v136 offset:16512
v_mfma_f32_16x16x32_bf16 v[208:211], a[128:131], v[44:47], v[208:211]
ds_read_b64_tr_b16 a[150:151], v137 offset:17024
v_mfma_f32_16x16x32_bf16 v[212:215], a[128:131], v[64:67], v[212:215]
ds_read_b64_tr_b16 a[148:149], v137 offset:16512
buffer_load_dwordx4 a[76:79], v9, s[24:27], 0 offen offset:3072 sc1
v_mfma_f32_16x16x32_bf16 v[240:243], a[128:131], v[72:75], v[240:243]
s_waitcnt lgkmcnt(8)
ds_read_b64_tr_b16 a[154:155], v138 offset:17024
v_mfma_f32_16x16x32_bf16 v[216:219], a[132:135], v[44:47], v[216:219]
ds_read_b64_tr_b16 a[152:153], v138 offset:16512
v_mfma_f32_16x16x32_bf16 v[220:223], a[132:135], v[64:67], v[220:223]
s_waitcnt lgkmcnt(8)
ds_read_b64_tr_b16 a[158:159], v139 offset:17024
buffer_load_dwordx2 a[80:81], v11, s[24:27], 0 offen sc1
v_mfma_f32_16x16x32_bf16 v[224:227], a[136:139], v[44:47], v[224:227]
ds_read_b64_tr_b16 a[156:157], v139 offset:16512
v_mfma_f32_16x16x32_bf16 v[228:231], a[136:139], v[64:67], v[228:231]
s_waitcnt lgkmcnt(8)
ds_read_b64_tr_b16 a[226:227], v140 offset:17024
v_mfma_f32_16x16x32_bf16 v[232:235], a[140:143], v[44:47], v[232:235]
ds_read_b64_tr_b16 a[224:225], v140 offset:16512
buffer_load_dwordx4 v95, s[36:39], 0 offen lds
v_mfma_f32_16x16x32_bf16 v[236:239], a[140:143], v[64:67], v[236:239]
s_waitcnt lgkmcnt(8)
ds_read_b64_tr_b16 a[230:231], v141 offset:17024
s_add_u32 m0, s42, 4128
v_mfma_f32_16x16x32_bf16 v[208:211], a[144:147], v[48:51], v[208:211]
ds_read_b64_tr_b16 a[228:229], v141 offset:16512
v_add_u32 v95, s46, v14
v_mfma_f32_16x16x32_bf16 v[212:215], a[144:147], v[68:71], v[212:215]
s_add_u32 s46, s66, 360448
ds_read_b64_tr_b16 a[234:235], v142 offset:17024
s_add_u32 s66, s66, 128
v_mfma_f32_16x16x32_bf16 v[240:243], a[144:147], v[76:79], v[240:243]
s_waitcnt lgkmcnt(9)
ds_read_b64_tr_b16 a[232:233], v142 offset:16512
buffer_load_dwordx4 v96, s[36:39], 0 offen lds
v_mfma_f32_16x16x32_bf16 v[216:219], a[148:151], v[48:51], v[216:219]
s_add_u32 m0, s42, 8256
ds_read_b64_tr_b16 a[238:239], v143 offset:17024
v_add_u32 v96, s46, v14
v_mfma_f32_16x16x32_bf16 v[220:223], a[148:151], v[68:71], v[220:223]
s_waitcnt lgkmcnt(9)
ds_read_b64_tr_b16 a[236:237], v143 offset:16512
s_and_b32 s66, s66, 0x3ff
v_mfma_f32_16x16x32_bf16 v[224:227], a[152:155], v[48:51], v[224:227]
ds_read_b64_tr_b16 a[254:255], v147 offset:17024
v_mfma_f32_16x16x32_bf16 v[228:231], a[152:155], v[68:71], v[228:231]
s_waitcnt lgkmcnt(9)
ds_read_b64_tr_b16 a[252:253], v147 offset:16512
buffer_load_dwordx4 v95, s[36:39], 0 offen lds
v_mfma_f32_16x16x32_bf16 v[232:235], a[156:159], v[48:51], v[232:235]
s_add_u32 m0, s42, 12384
ds_read_b64_tr_b16 a[250:251], v146 offset:17024
v_mfma_f32_16x16x32_bf16 v[236:239], a[156:159], v[68:71], v[236:239]
s_waitcnt lgkmcnt(9)
ds_read_b64_tr_b16 a[248:249], v146 offset:16512
v_mfma_f32_16x16x32_bf16 v[208:211], a[224:227], v[52:55], v[208:211]
ds_read_b64_tr_b16 a[246:247], v145 offset:17024
v_mfma_f32_16x16x32_bf16 v[212:215], a[224:227], v[168:171], v[212:215]
ds_read_b64_tr_b16 a[244:245], v145 offset:16512
buffer_load_dwordx4 v96, s[36:39], 0 offen lds
v_mfma_f32_16x16x32_bf16 v[240:243], a[224:227], v[80:83], v[240:243]
s_waitcnt lgkmcnt(10)
ds_read_b64_tr_b16 a[242:243], v144 offset:17024
v_mfma_f32_16x16x32_bf16 v[216:219], a[228:231], v[52:55], v[216:219]
ds_read_b64_tr_b16 a[240:241], v144 offset:16512
v_mfma_f32_16x16x32_bf16 v[220:223], a[228:231], v[168:171], v[220:223]
s_waitcnt lgkmcnt(10)
v_mfma_f32_16x16x32_bf16 v[224:227], a[232:235], v[52:55], v[224:227]
v_mfma_f32_16x16x32_bf16 v[228:231], a[232:235], v[168:171], v[228:231]
s_waitcnt lgkmcnt(8)
v_mfma_f32_16x16x32_bf16 v[232:235], a[236:239], v[52:55], v[232:235]
v_mfma_f32_16x16x32_bf16 v[236:239], a[236:239], v[168:171], v[236:239]
s_sub_u32 s3, s58, s69
s_add_u32 s3, s3, 3
s_and_b32 s3, s3, 7
s_mul_i32 s4, s3, 18432
s_add_u32 s4, s4, s72
s_lshl_b32 s3, s3, 4
s_add_u32 s5, s3, s73
s_cmp_lt_u32 s69, 7
s_cbranch_scc1 L_trip
s_waitcnt lgkmcnt(0) vmcnt(14)
s_barrier
v_mfma_f32_16x16x32_bf16 v[208:211], a[240:243], v[56:59], v[208:211]
s_add_u32 s46, s65, 393216
ds_read_b64_tr_b16 a[130:131], v132 offset:33536
v_add_u32 v97, s7, v90
buffer_store_dword v255, v97, s[28:31], 0 offen sc1
v_mfma_f32_16x16x32_bf16 v[212:215], a[240:243], v[60:63], v[212:215]
s_add_u32 m0, s42, 16512
ds_read_b64_tr_b16 a[128:129], v132 offset:33024
v_add_u32 v98, s5, v90
buffer_load_dword v91, v98, s[28:31], 0 offen sc1
v_mfma_f32_16x16x32_bf16 v[240:243], a[240:243], v[84:87], v[240:243]
s_lshl_b32 s63, s40, 5
ds_read_b64_tr_b16 a[134:135], v133 offset:33536
v_add_u32 v98, s41, v90
buffer_load_dword v92, v98, s[28:31], 0 offen sc1
v_mfma_f32_16x16x32_bf16 v[216:219], a[244:247], v[56:59], v[216:219]
s_and_b32 s62, s40, 1
ds_read_b64_tr_b16 a[132:133], v133 offset:33024
ds_read_b64_tr_b16 a[138:139], v134 offset:33536
v_mfma_f32_16x16x32_bf16 v[220:223], a[244:247], v[60:63], v[220:223]
s_lshl_b32 s62, s62, 3
ds_read_b64_tr_b16 a[136:137], v134 offset:33024
v_cvt_pk_bf16_f32 v33, v242, v243
v_mfma_f32_16x16x32_bf16 v[224:227], a[248:251], v[56:59], v[224:227]
ds_read_b64_tr_b16 a[142:143], v135 offset:33536
v_cvt_pk_bf16_f32 v32, v240, v241
v_mfma_f32_16x16x32_bf16 v[228:231], a[248:251], v[60:63], v[228:231]
ds_read_b64_tr_b16 a[140:141], v135 offset:33024
v_add_u32 v8, s67, v89
v_mfma_f32_16x16x32_bf16 v[232:235], a[252:255], v[56:59], v[232:235]
ds_read_b64_tr_b16 a[146:147], v136 offset:33536
v_cvt_pk_bf16_f32 v19, v218, v219
v_mfma_f32_16x16x32_bf16 v[236:239], a[252:255], v[60:63], v[236:239]
s_waitcnt lgkmcnt(7)
ds_read_b64_tr_b16 a[144:145], v136 offset:33024
v_cvt_pk_bf16_f32 v18, v216, v217
v_mfma_f32_16x16x32_bf16 v[172:175], a[128:131], a[160:163], v[172:175]
ds_read_b64_tr_b16 a[150:151], v137 offset:33536
v_cvt_pk_bf16_f32 v17, v210, v211
v_mfma_f32_16x16x32_bf16 v[176:179], a[128:131], a[176:179], v[176:179]
ds_read_b64_tr_b16 a[148:149], v137 offset:33024
v_cvt_pk_bf16_f32 v16, v208, v209
v_mfma_f32_16x16x32_bf16 v[204:207], a[128:131], a[0:3], v[204:207]
s_waitcnt lgkmcnt(8)
ds_read_b64_tr_b16 a[154:155], v138 offset:33536
buffer_store_dwordx2 v[32:33], v8, s[24:27], 0 offen sc1
v_mfma_f32_16x16x32_bf16 v[180:183], a[132:135], a[160:163], v[180:183]
ds_read_b64_tr_b16 a[152:153], v138 offset:33024
v_add_u32 v7, s67, v88
v_mfma_f32_16x16x32_bf16 v[184:187], a[132:135], a[176:179], v[184:187]
s_waitcnt lgkmcnt(8)
ds_read_b64_tr_b16 a[158:159], v139 offset:33536
v_cvt_pk_bf16_f32 v27, v222, v223
v_mfma_f32_16x16x32_bf16 v[188:191], a[136:139], a[160:163], v[188:191]
ds_read_b64_tr_b16 a[156:157], v139 offset:33024
v_cvt_pk_bf16_f32 v26, v220, v221
v_mfma_f32_16x16x32_bf16 v[192:195], a[136:139], a[176:179], v[192:195]
s_waitcnt lgkmcnt(8)
ds_read_b64_tr_b16 a[226:227], v140 offset:33536
buffer_store_dwordx4 v[16:19], v7, s[24:27], 0 offen sc1
v_cvt_pk_bf16_f32 v25, v214, v215
v_mfma_f32_16x16x32_bf16 v[196:199], a[140:143], a[160:163], v[196:199]
ds_read_b64_tr_b16 a[224:225], v140 offset:33024
v_cvt_pk_bf16_f32 v24, v212, v213
v_cvt_pk_bf16_f32 v23, v234, v235
v_mfma_f32_16x16x32_bf16 v[200:203], a[140:143], a[176:179], v[200:203]
s_waitcnt lgkmcnt(8)
ds_read_b64_tr_b16 a[230:231], v141 offset:33536
buffer_store_dwordx4 v[24:27], v7, s[24:27], 0 offen offset:2048 sc1
v_cvt_pk_bf16_f32 v22, v232, v233
v_mfma_f32_16x16x32_bf16 v[172:175], a[144:147], a[164:167], v[172:175]
ds_read_b64_tr_b16 a[228:229], v141 offset:33024
v_cvt_pk_bf16_f32 v21, v226, v227
v_cvt_pk_bf16_f32 v20, v224, v225
v_mfma_f32_16x16x32_bf16 v[176:179], a[144:147], a[180:183], v[176:179]
ds_read_b64_tr_b16 a[234:235], v142 offset:33536
buffer_store_dwordx4 v[20:23], v7, s[24:27], 0 offen offset:1024 sc1
v_cvt_pk_bf16_f32 v31, v238, v239
v_mfma_f32_16x16x32_bf16 v[204:207], a[144:147], a[4:7], v[204:207]
s_waitcnt lgkmcnt(9)
ds_read_b64_tr_b16 a[232:233], v142 offset:33024
v_cvt_pk_bf16_f32 v30, v236, v237
v_cvt_pk_bf16_f32 v29, v230, v231
v_mfma_f32_16x16x32_bf16 v[180:183], a[148:151], a[164:167], v[180:183]
ds_read_b64_tr_b16 a[238:239], v143 offset:33536
v_cvt_pk_bf16_f32 v28, v228, v229
buffer_store_dwordx4 v[28:31], v7, s[24:27], 0 offen offset:3072 sc1
v_mfma_f32_16x16x32_bf16 v[184:187], a[148:151], a[180:183], v[184:187]
s_waitcnt lgkmcnt(9)
ds_read_b64_tr_b16 a[236:237], v143 offset:33024
v_add_u32 v95, s46, v14
v_mfma_f32_16x16x32_bf16 v[188:191], a[152:155], a[164:167], v[188:191]
s_add_u32 s46, s65, 425984
ds_read_b64_tr_b16 a[242:243], v144 offset:33536
buffer_load_dwordx4 v95, s[36:39], 0 offen lds
v_mfma_f32_16x16x32_bf16 v[192:195], a[152:155], a[180:183], v[192:195]
s_waitcnt lgkmcnt(9)
ds_read_b64_tr_b16 a[240:241], v144 offset:33024
v_add_u32 v96, s46, v14
v_mfma_f32_16x16x32_bf16 v[196:199], a[156:159], a[164:167], v[196:199]
s_add_u32 m0, s42, 20640
ds_read_b64_tr_b16 a[246:247], v145 offset:33536
buffer_load_dwordx4 v96, s[36:39], 0 offen lds
v_mfma_f32_16x16x32_bf16 v[200:203], a[156:159], a[180:183], v[200:203]
s_waitcnt lgkmcnt(9)
ds_read_b64_tr_b16 a[244:245], v145 offset:33024
v_lshrrev_b32 v34, 4, v253
v_mfma_f32_16x16x32_bf16 v[172:175], a[224:227], a[168:171], v[172:175]
s_add_u32 s46, s65, 458752
ds_read_b64_tr_b16 a[250:251], v146 offset:33536
v_add_u32 v95, s46, v14
v_mfma_f32_16x16x32_bf16 v[176:179], a[224:227], a[184:187], v[176:179]
s_add_u32 m0, s42, 24768
ds_read_b64_tr_b16 a[248:249], v146 offset:33024
v_and_b32 v35, 15, v34
v_mfma_f32_16x16x32_bf16 v[204:207], a[224:227], a[8:11], v[204:207]
s_waitcnt lgkmcnt(10)
ds_read_b64_tr_b16 a[254:255], v147 offset:33536
buffer_load_dwordx4 v95, s[36:39], 0 offen lds
v_mfma_f32_16x16x32_bf16 v[180:183], a[228:231], a[168:171], v[180:183]
s_add_u32 s46, s65, 491520
ds_read_b64_tr_b16 a[252:253], v147 offset:33024
v_add_u32 v4, s63, v35
v_mfma_f32_16x16x32_bf16 v[184:187], a[228:231], a[184:187], v[184:187]
s_waitcnt lgkmcnt(10)
v_lshlrev_b32 v4, 11, v4
v_lshrrev_b32 v36, 4, v34
v_mfma_f32_16x16x32_bf16 v[188:191], a[232:235], a[168:171], v[188:191]
s_lshr_b32 s63, s40, 1
v_lshl_add_u32 v4, v36, 4, v4
s_lshl_b32 s63, s63, 6
v_mfma_f32_16x16x32_bf16 v[192:195], a[232:235], a[184:187], v[192:195]
s_waitcnt lgkmcnt(8)
v_add_u32 v4, s63, v4
s_add_u32 m0, s42, 28896
v_mfma_f32_16x16x32_bf16 v[196:199], a[236:239], a[168:171], v[196:199]
s_add_u32 s63, s63, s62
v_add_u32 v96, s46, v14
v_add_u32 v9, s4, v88
v_mfma_f32_16x16x32_bf16 v[200:203], a[236:239], a[184:187], v[200:203]
s_waitcnt lgkmcnt(6)
buffer_load_dwordx4 v96, s[36:39], 0 offen lds
s_waitcnt lgkmcnt(0) vmcnt(9)
s_barrier
v_readfirstlane_b32 s3, v91
s_nop 0
s_cmp_eq_u32 s3, s57
s_cbranch_scc1 L_ok10
s_mov_b32 s62, 0x40000
L_sp10:
buffer_load_dword v91, v90, s[28:31], s5 offen sc1
s_waitcnt vmcnt(0)
v_readfirstlane_b32 s3, v91
s_sub_u32 s62, s62, 1
s_cmp_eq_u32 s62, 0
s_cbranch_scc1 L_ok10
s_cmp_eq_u32 s3, s57
s_cbranch_scc0 L_sp10
L_ok10:
v_mfma_f32_16x16x32_bf16 v[172:175], a[240:243], a[172:175], v[172:175]
v_readfirstlane_b32 s3, v92
s_nop 0
s_cmp_eq_u32 s3, s57
s_cbranch_scc1 L_ok11
s_mov_b32 s62, 0x40000
L_sp11:
buffer_load_dword v92, v90, s[28:31], s41 offen sc1
s_waitcnt vmcnt(0)
v_readfirstlane_b32 s3, v92
s_sub_u32 s62, s62, 1
s_cmp_eq_u32 s62, 0
s_cbranch_scc1 L_ok11
s_cmp_eq_u32 s3, s57
s_cbranch_scc0 L_sp11
L_ok11:
v_mfma_f32_16x16x32_bf16 v[176:179], a[240:243], a[188:191], v[176:179]
ds_read_b64_tr_b16 a[130:131], v132 offset:50048
v_add_u32 v11, s4, v89
v_mfma_f32_16x16x32_bf16 v[204:207], a[240:243], a[12:15], v[204:207]
ds_read_b64_tr_b16 a[128:129], v132 offset:49536
buffer_load_dwordx4 a[84:87], v9, s[24:27], 0 offen sc1
v_mfma_f32_16x16x32_bf16 v[180:183], a[244:247], a[172:175], v[180:183]
ds_read_b64_tr_b16 a[134:135], v133 offset:50048
v_add_u32 v97, s68, v90
v_mfma_f32_16x16x32_bf16 v[184:187], a[244:247], a[188:191], v[184:187]
ds_read_b64_tr_b16 a[132:133], v133 offset:49536
v_add_u32 v98, s48, v90
v_mfma_f32_16x16x32_bf16 v[188:191], a[248:251], a[172:175], v[188:191]
ds_read_b64_tr_b16 a[138:139], v134 offset:50048
buffer_load_dwordx4 a[88:91], v9, s[24:27], 0 offen offset:1024 sc1
v_mfma_f32_16x16x32_bf16 v[192:195], a[248:251], a[188:191], v[192:195]
ds_read_b64_tr_b16 a[136:137], v134 offset:49536
v_add_u32 v6, 0x80, v35
v_mfma_f32_16x16x32_bf16 v[196:199], a[252:255], a[172:175], v[196:199]
ds_read_b64_tr_b16 a[142:143], v135 offset:50048
v_lshlrev_b32 v6, 11, v6
v_mfma_f32_16x16x32_bf16 v[200:203], a[252:255], a[188:191], v[200:203]
ds_read_b64_tr_b16 a[140:141], v135 offset:49536
buffer_load_dwordx4 a[92:95], v9, s[24:27], 0 offen offset:2048 sc1
v_mfma_f32_16x16x32_bf16 v[172:175], v[244:247], a[64:67], v[172:175]
ds_read_b64_tr_b16 a[146:147], v136 offset:50048
v_lshl_add_u32 v6, v36, 4, v6
v_mfma_f32_16x16x32_bf16 v[176:179], v[244:247], a[72:75], v[176:179]
ds_read_b64_tr_b16 a[144:145], v136 offset:49536
v_mov_b32 v43, 0
v_mfma_f32_16x16x32_bf16 v[180:183], v[248:251], a[64:67], v[180:183]
ds_read_b64_tr_b16 a[150:151], v137 offset:50048
buffer_load_dwordx4 a[96:99], v9, s[24:27], 0 offen offset:3072 sc1
v_mfma_f32_16x16x32_bf16 v[184:187], v[248:251], a[72:75], v[184:187]
ds_read_b64_tr_b16 a[148:149], v137 offset:49536
v_add_u32 v9, s6, v88
v_mfma_f32_16x16x32_bf16 v[188:191], v[244:247], a[68:71], v[188:191]
ds_read_b64_tr_b16 a[154:155], v138 offset:50048
v_mov_b32 v42, 0
v_mfma_f32_16x16x32_bf16 v[192:195], v[244:247], a[76:79], v[192:195]
ds_read_b64_tr_b16 a[152:153], v138 offset:49536
buffer_load_dwordx2 a[100:101], v11, s[24:27], 0 offen sc1
v_mfma_f32_16x16x32_bf16 v[196:199], v[248:251], a[68:71], v[196:199]
ds_read_b64_tr_b16 a[158:159], v139 offset:50048
v_add_u32 v11, s6, v89
v_mfma_f32_16x16x32_bf16 v[200:203], v[248:251], a[76:79], v[200:203]
ds_read_b64_tr_b16 a[156:157], v139 offset:49536
v_add_u32 v6, s63, v6
v_mfma_f32_16x16x32_bf16 v[204:207], v[244:247], a[80:83], v[204:207]
s_waitcnt lgkmcnt(14)
ds_read_b64_tr_b16 a[226:227], v140 offset:50048
buffer_load_dwordx4 a[104:107], v9, s[24:27], 0 offen sc1
v_mfma_f32_16x16x32_bf16 v[172:175], a[128:131], a[192:195], v[172:175]
ds_read_b64_tr_b16 a[224:225], v140 offset:49536
v_xor_b32 v5, 64, v4
v_mfma_f32_16x16x32_bf16 v[176:179], a[128:131], a[208:211], v[176:179]
ds_read_b64_tr_b16 a[230:231], v141 offset:50048
v_mfma_f32_16x16x32_bf16 v[204:207], a[128:131], a[16:19], v[204:207]
s_waitcnt lgkmcnt(15)
ds_read_b64_tr_b16 a[228:229], v141 offset:49536
buffer_load_dwordx4 a[108:111], v9, s[24:27], 0 offen offset:1024 sc1
v_mfma_f32_16x16x32_bf16 v[180:183], a[132:135], a[192:195], v[180:183]
ds_read_b64_tr_b16 a[234:235], v142 offset:50048
v_mfma_f32_16x16x32_bf16 v[184:187], a[132:135], a[208:211], v[184:187]
s_waitcnt lgkmcnt(15)
ds_read_b64_tr_b16 a[232:233], v142 offset:49536
v_mfma_f32_16x16x32_bf16 v[188:191], a[136:139], a[192:195], v[188:191]
ds_read_b64_tr_b16 a[238:239], v143 offset:50048
buffer_load_dwordx4 a[112:115], v9, s[24:27], 0 offen offset:2048 sc1
v_mfma_f32_16x16x32_bf16 v[192:195], a[136:139], a[208:211], v[192:195]
s_waitcnt lgkmcnt(15)
ds_read_b64_tr_b16 a[236:237], v143 offset:49536
v_mfma_f32_16x16x32_bf16 v[196:199], a[140:143], a[192:195], v[196:199]
ds_read_b64_tr_b16 a[242:243], v144 offset:50048
v_mfma_f32_16x16x32_bf16 v[200:203], a[140:143], a[208:211], v[200:203]
s_waitcnt lgkmcnt(15)
ds_read_b64_tr_b16 a[240:241], v144 offset:49536
buffer_load_dwordx4 a[116:119], v9, s[24:27], 0 offen offset:3072 sc1
v_mfma_f32_16x16x32_bf16 v[172:175], a[144:147], a[196:199], v[172:175]
ds_read_b64_tr_b16 a[246:247], v145 offset:50048
v_add_u32 v9, s43, v88
v_mfma_f32_16x16x32_bf16 v[176:179], a[144:147], a[212:215], v[176:179]
ds_read_b64_tr_b16 a[244:245], v145 offset:49536
v_mfma_f32_16x16x32_bf16 v[204:207], a[144:147], a[20:23], v[204:207]
s_waitcnt lgkmcnt(15)
ds_read_b64_tr_b16 a[250:251], v146 offset:50048
buffer_load_dwordx2 a[120:121], v11, s[24:27], 0 offen sc1
v_mfma_f32_16x16x32_bf16 v[180:183], a[148:151], a[196:199], v[180:183]
s_waitcnt vmcnt(14)
buffer_store_dword v255, v97, s[28:31], 0 offen sc1
v_mfma_f32_16x16x32_bf16 v[184:187], a[148:151], a[212:215], v[184:187]
s_waitcnt lgkmcnt(15)
ds_read_b64_tr_b16 a[248:249], v146 offset:49536
v_add_u32 v11, s43, v89
v_mfma_f32_16x16x32_bf16 v[188:191], a[152:155], a[196:199], v[188:191]
ds_read_b64_tr_b16 a[254:255], v147 offset:50048
v_mfma_f32_16x16x32_bf16 v[192:195], a[152:155], a[212:215], v[192:195]
s_waitcnt lgkmcnt(15)
ds_read_b64_tr_b16 a[252:253], v147 offset:49536
v_mfma_f32_16x16x32_bf16 v[196:199], a[156:159], a[196:199], v[196:199]
v_mfma_f32_16x16x32_bf16 v[200:203], a[156:159], a[212:215], v[200:203]
s_waitcnt lgkmcnt(14)
v_mfma_f32_16x16x32_bf16 v[172:175], a[224:227], a[200:203], v[172:175]
v_mfma_f32_16x16x32_bf16 v[176:179], a[224:227], a[216:219], v[176:179]
buffer_load_dword v93, v98, s[28:31], 0 offen sc1
v_add_u32 v98, s55, v90
v_mfma_f32_16x16x32_bf16 v[204:207], a[224:227], a[24:27], v[204:207]
s_waitcnt lgkmcnt(12)
v_mfma_f32_16x16x32_bf16 v[180:183], a[228:231], a[200:203], v[180:183]
v_mfma_f32_16x16x32_bf16 v[184:187], a[228:231], a[216:219], v[184:187]
s_waitcnt lgkmcnt(10)
v_mfma_f32_16x16x32_bf16 v[188:191], a[232:235], a[200:203], v[188:191]
v_mfma_f32_16x16x32_bf16 v[192:195], a[232:235], a[216:219], v[192:195]
s_waitcnt lgkmcnt(8)
v_mfma_f32_16x16x32_bf16 v[196:199], a[236:239], a[200:203], v[196:199]
v_mfma_f32_16x16x32_bf16 v[200:203], a[236:239], a[216:219], v[200:203]
s_waitcnt lgkmcnt(6)
s_waitcnt lgkmcnt(0)
s_barrier
ds_read_b64_tr_b16 a[130:131], v132 offset:512
v_mfma_f32_16x16x32_bf16 v[172:175], a[240:243], a[204:207], v[172:175]
ds_read_b64_tr_b16 a[128:129], v132 offset:0
v_mfma_f32_16x16x32_bf16 v[176:179], a[240:243], a[220:223], v[176:179]
ds_read_b64_tr_b16 a[134:135], v133 offset:512
v_mfma_f32_16x16x32_bf16 v[204:207], a[240:243], a[28:31], v[204:207]
ds_read_b64_tr_b16 a[132:133], v133 offset:0
v_mfma_f32_16x16x32_bf16 v[180:183], a[244:247], a[204:207], v[180:183]
ds_read_b64_tr_b16 a[138:139], v134 offset:512
v_mfma_f32_16x16x32_bf16 v[184:187], a[244:247], a[220:223], v[184:187]
ds_read_b64_tr_b16 a[136:137], v134 offset:0
v_mfma_f32_16x16x32_bf16 v[188:191], a[248:251], a[204:207], v[188:191]
ds_read_b64_tr_b16 a[142:143], v135 offset:512
v_mfma_f32_16x16x32_bf16 v[192:195], a[248:251], a[220:223], v[192:195]
ds_read_b64_tr_b16 a[140:141], v135 offset:0
v_mfma_f32_16x16x32_bf16 v[196:199], a[252:255], a[204:207], v[196:199]
ds_read_b64_tr_b16 a[146:147], v136 offset:512
v_mfma_f32_16x16x32_bf16 v[200:203], a[252:255], a[220:223], v[200:203]
s_waitcnt lgkmcnt(7)
ds_read_b64_tr_b16 a[144:145], v136 offset:0
v_mfma_f32_16x16x32_bf16 v[172:175], a[128:131], v[100:103], v[172:175]
ds_read_b64_tr_b16 a[150:151], v137 offset:512
v_mfma_f32_16x16x32_bf16 v[176:179], a[128:131], v[116:119], v[176:179]
ds_read_b64_tr_b16 a[148:149], v137 offset:0
v_mfma_f32_16x16x32_bf16 v[204:207], a[128:131], a[32:35], v[204:207]
s_waitcnt lgkmcnt(8)
ds_read_b64_tr_b16 a[154:155], v138 offset:512
v_mfma_f32_16x16x32_bf16 v[180:183], a[132:135], v[100:103], v[180:183]
ds_read_b64_tr_b16 a[152:153], v138 offset:0
v_mfma_f32_16x16x32_bf16 v[184:187], a[132:135], v[116:119], v[184:187]
s_waitcnt lgkmcnt(8)
ds_read_b64_tr_b16 a[158:159], v139 offset:512
v_mfma_f32_16x16x32_bf16 v[188:191], a[136:139], v[100:103], v[188:191]
ds_read_b64_tr_b16 a[156:157], v139 offset:0
v_mfma_f32_16x16x32_bf16 v[192:195], a[136:139], v[116:119], v[192:195]
s_waitcnt lgkmcnt(8)
ds_read_b64_tr_b16 a[226:227], v140 offset:512
v_mfma_f32_16x16x32_bf16 v[196:199], a[140:143], v[100:103], v[196:199]
ds_read_b64_tr_b16 a[224:225], v140 offset:0
v_mfma_f32_16x16x32_bf16 v[200:203], a[140:143], v[116:119], v[200:203]
s_waitcnt lgkmcnt(8)
ds_read_b64_tr_b16 a[230:231], v141 offset:512
v_mfma_f32_16x16x32_bf16 v[172:175], a[144:147], v[104:107], v[172:175]
ds_read_b64_tr_b16 a[228:229], v141 offset:0
v_mfma_f32_16x16x32_bf16 v[176:179], a[144:147], v[120:123], v[176:179]
ds_read_b64_tr_b16 a[234:235], v142 offset:512
v_mfma_f32_16x16x32_bf16 v[204:207], a[144:147], a[36:39], v[204:207]
s_waitcnt lgkmcnt(9)
ds_read_b64_tr_b16 a[232:233], v142 offset:0
v_mfma_f32_16x16x32_bf16 v[180:183], a[148:151], v[104:107], v[180:183]
ds_read_b64_tr_b16 a[238:239], v143 offset:512
s_waitcnt vmcnt(0)
v_mfma_f32_16x16x32_bf16 v[184:187], a[148:151], v[120:123], v[184:187]
s_waitcnt lgkmcnt(9)
ds_read_b64_tr_b16 a[236:237], v143 offset:0
v_readfirstlane_b32 s3, v93
s_nop 0
s_cmp_eq_u32 s3, s57
s_cbranch_scc1 L_ok12
s_mov_b32 s62, 0x40000
L_sp12:
buffer_load_dword v93, v90, s[28:31], s48 offen sc1
s_waitcnt vmcnt(0)
v_readfirstlane_b32 s3, v93
s_sub_u32 s62, s62, 1
s_cmp_eq_u32 s62, 0
s_cbranch_scc1 L_ok12
s_cmp_eq_u32 s3, s57
s_cbranch_scc0 L_sp12
L_ok12:
v_mfma_f32_16x16x32_bf16 v[188:191], a[152:155], v[104:107], v[188:191]
ds_read_b64_tr_b16 a[242:243], v144 offset:512
v_mfma_f32_16x16x32_bf16 v[192:195], a[152:155], v[120:123], v[192:195]
s_waitcnt lgkmcnt(9)
ds_read_b64_tr_b16 a[240:241], v144 offset:0
v_mfma_f32_16x16x32_bf16 v[196:199], a[156:159], v[104:107], v[196:199]
ds_read_b64_tr_b16 a[246:247], v145 offset:512
buffer_load_dword v94, v98, s[28:31], 0 offen sc1
v_mfma_f32_16x16x32_bf16 v[200:203], a[156:159], v[120:123], v[200:203]
s_waitcnt lgkmcnt(9)
ds_read_b64_tr_b16 a[244:245], v145 offset:0
buffer_load_dwordx4 a[64:67], v9, s[24:27], 0 offen sc1
v_mfma_f32_16x16x32_bf16 v[172:175], a[224:227], v[108:111], v[172:175]
ds_read_b64_tr_b16 a[250:251], v146 offset:512
v_mfma_f32_16x16x32_bf16 v[176:179], a[224:227], v[124:127], v[176:179]
ds_read_b64_tr_b16 a[248:249], v146 offset:0
buffer_load_dwordx4 a[68:71], v9, s[24:27], 0 offen offset:1024 sc1
v_mfma_f32_16x16x32_bf16 v[204:207], a[224:227], a[40:43], v[204:207]
s_waitcnt lgkmcnt(10)
ds_read_b64_tr_b16 a[254:255], v147 offset:512
v_mfma_f32_16x16x32_bf16 v[180:183], a[228:231], v[108:111], v[180:183]
ds_read_b64_tr_b16 a[252:253], v147 offset:0
buffer_load_dwordx4 a[72:75], v9, s[24:27], 0 offen offset:2048 sc1
v_mfma_f32_16x16x32_bf16 v[184:187], a[228:231], v[124:127], v[184:187]
s_waitcnt lgkmcnt(10)
v_mfma_f32_16x16x32_bf16 v[188:191], a[232:235], v[108:111], v[188:191]
buffer_load_dwordx4 a[76:79], v9, s[24:27], 0 offen offset:3072 sc1
v_add_u32 v9, s54, v88
v_mfma_f32_16x16x32_bf16 v[192:195], a[232:235], v[124:127], v[192:195]
s_waitcnt lgkmcnt(8)
v_mfma_f32_16x16x32_bf16 v[196:199], a[236:239], v[108:111], v[196:199]
buffer_load_dwordx2 a[80:81], v11, s[24:27], 0 offen sc1
v_add_u32 v11, s54, v89
v_mfma_f32_16x16x32_bf16 v[200:203], a[236:239], v[124:127], v[200:203]
s_waitcnt lgkmcnt(6)
s_waitcnt lgkmcnt(0)
s_barrier
ds_read_b64_tr_b16 a[130:131], v132 offset:17024
v_mfma_f32_16x16x32_bf16 v[172:175], a[240:243], v[112:115], v[172:175]
ds_read_b64_tr_b16 a[128:129], v132 offset:16512
v_mfma_f32_16x16x32_bf16 v[176:179], a[240:243], v[128:131], v[176:179]
ds_read_b64_tr_b16 a[134:135], v133 offset:17024
v_mfma_f32_16x16x32_bf16 v[204:207], a[240:243], a[44:47], v[204:207]
ds_read_b64_tr_b16 a[132:133], v133 offset:16512
v_mfma_f32_16x16x32_bf16 v[180:183], a[244:247], v[112:115], v[180:183]
ds_read_b64_tr_b16 a[138:139], v134 offset:17024
v_mfma_f32_16x16x32_bf16 v[184:187], a[244:247], v[128:131], v[184:187]
ds_read_b64_tr_b16 a[136:137], v134 offset:16512
v_mfma_f32_16x16x32_bf16 v[188:191], a[248:251], v[112:115], v[188:191]
ds_read_b64_tr_b16 a[142:143], v135 offset:17024
v_mfma_f32_16x16x32_bf16 v[192:195], a[248:251], v[128:131], v[192:195]
ds_read_b64_tr_b16 a[140:141], v135 offset:16512
v_mfma_f32_16x16x32_bf16 v[196:199], a[252:255], v[112:115], v[196:199]
ds_read_b64_tr_b16 a[146:147], v136 offset:17024
v_mfma_f32_16x16x32_bf16 v[200:203], a[252:255], v[128:131], v[200:203]
s_waitcnt lgkmcnt(7)
ds_read_b64_tr_b16 a[144:145], v136 offset:16512
v_mfma_f32_16x16x32_bf16 v[172:175], a[128:131], v[44:47], v[172:175]
ds_read_b64_tr_b16 a[150:151], v137 offset:17024
v_mfma_f32_16x16x32_bf16 v[176:179], a[128:131], v[64:67], v[176:179]
ds_read_b64_tr_b16 a[148:149], v137 offset:16512
v_mfma_f32_16x16x32_bf16 v[204:207], a[128:131], v[72:75], v[204:207]
s_waitcnt lgkmcnt(8)
ds_read_b64_tr_b16 a[154:155], v138 offset:17024
v_mfma_f32_16x16x32_bf16 v[180:183], a[132:135], v[44:47], v[180:183]
ds_read_b64_tr_b16 a[152:153], v138 offset:16512
v_mfma_f32_16x16x32_bf16 v[184:187], a[132:135], v[64:67], v[184:187]
s_waitcnt lgkmcnt(8)
ds_read_b64_tr_b16 a[158:159], v139 offset:17024
v_mfma_f32_16x16x32_bf16 v[188:191], a[136:139], v[44:47], v[188:191]
ds_read_b64_tr_b16 a[156:157], v139 offset:16512
v_mfma_f32_16x16x32_bf16 v[192:195], a[136:139], v[64:67], v[192:195]
s_waitcnt lgkmcnt(8)
s_waitcnt vmcnt(5)
ds_read_b64_tr_b16 a[226:227], v140 offset:17024
v_mfma_f32_16x16x32_bf16 v[196:199], a[140:143], v[44:47], v[196:199]
v_readfirstlane_b32 s3, v94
s_nop 0
s_cmp_eq_u32 s3, s57
s_cbranch_scc1 L_ok13
s_mov_b32 s62, 0x40000
L_sp13:
buffer_load_dword v94, v90, s[28:31], s55 offen sc1
s_waitcnt vmcnt(0)
v_readfirstlane_b32 s3, v94
s_sub_u32 s62, s62, 1
s_cmp_eq_u32 s62, 0
s_cbranch_scc1 L_ok13
s_cmp_eq_u32 s3, s57
s_cbranch_scc0 L_sp13
L_ok13:
v_mfma_f32_16x16x32_bf16 v[200:203], a[140:143], v[64:67], v[200:203]
s_waitcnt lgkmcnt(7)
ds_read_b64_tr_b16 a[224:225], v140 offset:16512
buffer_load_dwordx4 v[148:151], v9, s[24:27], 0 offen sc1
v_mfma_f32_16x16x32_bf16 v[172:175], a[144:147], v[48:51], v[172:175]
ds_read_b64_tr_b16 a[230:231], v141 offset:17024
buffer_load_dwordx4 v[152:155], v9, s[24:27], 0 offen offset:1024 sc1
v_mfma_f32_16x16x32_bf16 v[176:179], a[144:147], v[68:71], v[176:179]
ds_read_b64_tr_b16 a[228:229], v141 offset:16512
v_mfma_f32_16x16x32_bf16 v[204:207], a[144:147], v[76:79], v[204:207]
s_waitcnt lgkmcnt(8)
ds_read_b64_tr_b16 a[234:235], v142 offset:17024
buffer_load_dwordx4 v[156:159], v9, s[24:27], 0 offen offset:2048 sc1
v_mfma_f32_16x16x32_bf16 v[180:183], a[148:151], v[48:51], v[180:183]
ds_read_b64_tr_b16 a[232:233], v142 offset:16512
v_mfma_f32_16x16x32_bf16 v[184:187], a[148:151], v[68:71], v[184:187]
s_waitcnt lgkmcnt(8)
ds_read_b64_tr_b16 a[238:239], v143 offset:17024
buffer_load_dwordx4 v[160:163], v9, s[24:27], 0 offen offset:3072 sc1
v_mfma_f32_16x16x32_bf16 v[188:191], a[152:155], v[48:51], v[188:191]
ds_read_b64_tr_b16 a[236:237], v143 offset:16512
v_mfma_f32_16x16x32_bf16 v[192:195], a[152:155], v[68:71], v[192:195]
s_waitcnt lgkmcnt(8)
ds_read_b64_tr_b16 a[242:243], v144 offset:17024
buffer_load_dwordx2 v[40:41], v11, s[24:27], 0 offen sc1
v_mfma_f32_16x16x32_bf16 v[196:199], a[156:159], v[48:51], v[196:199]
ds_read_b64_tr_b16 a[240:241], v144 offset:16512
v_mfma_f32_16x16x32_bf16 v[200:203], a[156:159], v[68:71], v[200:203]
s_waitcnt lgkmcnt(8)
ds_read_b64_tr_b16 a[246:247], v145 offset:17024
v_mfma_f32_16x16x32_bf16 v[172:175], a[224:227], v[52:55], v[172:175]
ds_read_b64_tr_b16 a[244:245], v145 offset:16512
v_mfma_f32_16x16x32_bf16 v[176:179], a[224:227], v[168:171], v[176:179]
ds_read_b64_tr_b16 a[250:251], v146 offset:17024
v_mfma_f32_16x16x32_bf16 v[204:207], a[224:227], v[80:83], v[204:207]
s_waitcnt lgkmcnt(9)
ds_read_b64_tr_b16 a[248:249], v146 offset:16512
v_mfma_f32_16x16x32_bf16 v[180:183], a[228:231], v[52:55], v[180:183]
ds_read_b64_tr_b16 a[254:255], v147 offset:17024
v_mfma_f32_16x16x32_bf16 v[184:187], a[228:231], v[168:171], v[184:187]
s_waitcnt lgkmcnt(9)
ds_read_b64_tr_b16 a[252:253], v147 offset:16512
v_mfma_f32_16x16x32_bf16 v[188:191], a[232:235], v[52:55], v[188:191]
v_mfma_f32_16x16x32_bf16 v[192:195], a[232:235], v[168:171], v[192:195]
s_waitcnt lgkmcnt(8)
v_mfma_f32_16x16x32_bf16 v[196:199], a[236:239], v[52:55], v[196:199]
v_mfma_f32_16x16x32_bf16 v[200:203], a[236:239], v[168:171], v[200:203]
s_waitcnt lgkmcnt(6)
v_mfma_f32_16x16x32_bf16 v[172:175], a[240:243], v[56:59], v[172:175]
v_mfma_f32_16x16x32_bf16 v[176:179], a[240:243], v[60:63], v[176:179]
v_mfma_f32_16x16x32_bf16 v[204:207], a[240:243], v[84:87], v[204:207]
s_waitcnt lgkmcnt(4)
v_mfma_f32_16x16x32_bf16 v[180:183], a[244:247], v[56:59], v[180:183]
v_mfma_f32_16x16x32_bf16 v[184:187], a[244:247], v[60:63], v[184:187]
s_waitcnt lgkmcnt(2)
v_mfma_f32_16x16x32_bf16 v[188:191], a[248:251], v[56:59], v[188:191]
v_mfma_f32_16x16x32_bf16 v[192:195], a[248:251], v[60:63], v[192:195]
s_waitcnt lgkmcnt(0)
v_mfma_f32_16x16x32_bf16 v[196:199], a[252:255], v[56:59], v[196:199]
v_mfma_f32_16x16x32_bf16 v[200:203], a[252:255], v[60:63], v[200:203]
s_waitcnt vmcnt(5)
v_mfma_f32_16x16x32_bf16 v[172:175], v[244:247], a[84:87], v[172:175]
v_mfma_f32_16x16x32_bf16 v[176:179], v[244:247], a[92:95], v[176:179]
v_mfma_f32_16x16x32_bf16 v[180:183], v[248:251], a[84:87], v[180:183]
v_mfma_f32_16x16x32_bf16 v[184:187], v[248:251], a[92:95], v[184:187]
v_mfma_f32_16x16x32_bf16 v[188:191], v[244:247], a[88:91], v[188:191]
v_mfma_f32_16x16x32_bf16 v[192:195], v[244:247], a[96:99], v[192:195]
v_mfma_f32_16x16x32_bf16 v[196:199], v[248:251], a[88:91], v[196:199]
v_mfma_f32_16x16x32_bf16 v[200:203], v[248:251], a[96:99], v[200:203]
v_mfma_f32_16x16x32_bf16 v[204:207], v[244:247], a[100:103], v[204:207]
v_mfma_f32_16x16x32_bf16 v[172:175], v[244:247], a[104:107], v[172:175]
v_mfma_f32_16x16x32_bf16 v[176:179], v[244:247], a[112:115], v[176:179]
v_mfma_f32_16x16x32_bf16 v[180:183], v[248:251], a[104:107], v[180:183]
v_mfma_f32_16x16x32_bf16 v[184:187], v[248:251], a[112:115], v[184:187]
v_mfma_f32_16x16x32_bf16 v[188:191], v[244:247], a[108:111], v[188:191]
v_mfma_f32_16x16x32_bf16 v[192:195], v[244:247], a[116:119], v[192:195]
v_mfma_f32_16x16x32_bf16 v[196:199], v[248:251], a[108:111], v[196:199]
v_mfma_f32_16x16x32_bf16 v[200:203], v[248:251], a[116:119], v[200:203]
v_mfma_f32_16x16x32_bf16 v[204:207], v[244:247], a[120:123], v[204:207]
v_mfma_f32_16x16x32_bf16 v[172:175], v[244:247], a[64:67], v[172:175]
v_mfma_f32_16x16x32_bf16 v[176:179], v[244:247], a[72:75], v[176:179]
v_mfma_f32_16x16x32_bf16 v[180:183], v[248:251], a[64:67], v[180:183]
v_mfma_f32_16x16x32_bf16 v[184:187], v[248:251], a[72:75], v[184:187]
v_mfma_f32_16x16x32_bf16 v[188:191], v[244:247], a[68:71], v[188:191]
v_mfma_f32_16x16x32_bf16 v[192:195], v[244:247], a[76:79], v[192:195]
v_mfma_f32_16x16x32_bf16 v[196:199], v[248:251], a[68:71], v[196:199]
v_mfma_f32_16x16x32_bf16 v[200:203], v[248:251], a[76:79], v[200:203]
v_mfma_f32_16x16x32_bf16 v[204:207], v[244:247], a[80:83], v[204:207]
s_lshl_b32 s3, s60, 10
s_add_u32 s3, s3, s65
s_add_u32 s4, s3, 32768
s_waitcnt vmcnt(0)
v_mfma_f32_16x16x32_bf16 v[172:175], v[244:247], v[148:151], v[172:175]
v_mfma_f32_16x16x32_bf16 v[176:179], v[244:247], v[156:159], v[176:179]
v_mfma_f32_16x16x32_bf16 v[180:183], v[248:251], v[148:151], v[180:183]
v_mfma_f32_16x16x32_bf16 v[184:187], v[248:251], v[156:159], v[184:187]
v_mfma_f32_16x16x32_bf16 v[188:191], v[244:247], v[152:155], v[188:191]
v_mfma_f32_16x16x32_bf16 v[192:195], v[244:247], v[160:163], v[192:195]
v_mfma_f32_16x16x32_bf16 v[196:199], v[248:251], v[152:155], v[196:199]
v_mfma_f32_16x16x32_bf16 v[200:203], v[248:251], v[160:163], v[200:203]
v_mfma_f32_16x16x32_bf16 v[204:207], v[244:247], v[40:43], v[204:207]
v_cvt_pk_bf16_f32 v16, v172, v173
v_cvt_pk_bf16_f32 v17, v174, v175
v_cvt_pk_bf16_f32 v24, v176, v177
v_cvt_pk_bf16_f32 v25, v178, v179
s_nop 3
v_cvt_pk_bf16_f32 v32, v204, v205
v_cvt_pk_bf16_f32 v33, v206, v207
v_cvt_pk_bf16_f32 v18, v180, v181
v_cvt_pk_bf16_f32 v19, v182, v183
v_cvt_pk_bf16_f32 v26, v184, v185
v_cvt_pk_bf16_f32 v27, v186, v187
v_cvt_pk_bf16_f32 v20, v188, v189
v_cvt_pk_bf16_f32 v21, v190, v191
v_cvt_pk_bf16_f32 v28, v192, v193
v_cvt_pk_bf16_f32 v29, v194, v195
v_cvt_pk_bf16_f32 v22, v196, v197
v_cvt_pk_bf16_f32 v23, v198, v199
v_cvt_pk_bf16_f32 v30, v200, v201
v_cvt_pk_bf16_f32 v31, v202, v203
s_and_b32 s5, s40, 1
s_cbranch_scc0 L_nsw
v_swap_b32 v16, v18
v_swap_b32 v17, v19
v_swap_b32 v20, v22
v_swap_b32 v21, v23
v_swap_b32 v24, v26
v_swap_b32 v25, v27
v_swap_b32 v28, v30
v_swap_b32 v29, v31
L_nsw:
buffer_store_dwordx4 v[16:19], v4, s[32:35], s3 offen nt
buffer_store_dwordx4 v[20:23], v5, s[32:35], s3 offen nt
buffer_store_dwordx4 v[24:27], v4, s[32:35], s4 offen nt
buffer_store_dwordx4 v[28:31], v5, s[32:35], s4 offen nt
buffer_store_dwordx2 v[32:33], v6, s[32:35], s3 offen nt
s_or_b32 s5, s58, s40
s_cmp_eq_u32 s5, 0
s_cselect_b32 s5, 1024, s75
buffer_store_dword v255, v90, s[28:31], s5 offen
L_end:
s_endpgm
L_tm1:
s_mul_i32 s3, s47, 3072
s_add_u32 s3, s3, 151296
v_lshrrev_b32 v75, 2, v253
v_add_u32 v75, s3, v75
ds_read_b32 v74, v75
ds_read_b32 v15, v75 offset:256
s_waitcnt lgkmcnt(0)
v_max_f32 v74, v74, v15
ds_read_b32 v15, v75 offset:512
s_waitcnt lgkmcnt(0)
v_max_f32 v74, v74, v15
ds_read_b32 v15, v75 offset:768
s_waitcnt lgkmcnt(0)
v_max_f32 v74, v74, v15
s_branch L_tr1
L_tm2:
s_mul_i32 s3, s47, 3072
s_add_u32 s3, s3, 149248
v_lshrrev_b32 v245, 2, v253
v_add_u32 v245, s3, v245
s_lshl_b32 s3, s40, 8
v_add_u32 v245, s3, v245
ds_read_b32 v244, v245
s_waitcnt lgkmcnt(0)
s_branch L_tr2
L_tm3:
s_mul_i32 s3, s47, 3072
s_add_u32 s3, s3, 150272
v_lshrrev_b32 v247, 2, v253
v_add_u32 v247, s3, v247
s_lshl_b32 s3, s40, 8
v_add_u32 v247, s3, v247
ds_read_b32 v246, v247
s_waitcnt lgkmcnt(0)
s_branch L_tr3
L_tm5:
s_mov_b32 s3, 9216
s_add_u32 s3, s3, 151296
v_lshrrev_b32 v75, 2, v253
v_add_u32 v75, s3, v75
ds_read_b32 v74, v75
ds_read_b32 v15, v75 offset:256
s_waitcnt lgkmcnt(0)
v_max_f32 v74, v74, v15
ds_read_b32 v15, v75 offset:512
s_waitcnt lgkmcnt(0)
v_max_f32 v74, v74, v15
ds_read_b32 v15, v75 offset:768
s_waitcnt lgkmcnt(0)
v_max_f32 v74, v74, v15
s_branch L_tr5
L_tm6:
s_mov_b32 s3, 9216
s_add_u32 s3, s3, 149248
v_lshrrev_b32 v245, 2, v253
v_add_u32 v245, s3, v245
s_lshl_b32 s3, s40, 8
v_add_u32 v245, s3, v245
ds_read_b32 v244, v245
s_waitcnt lgkmcnt(0)
s_branch L_tr6
L_tm7:
s_mov_b32 s3, 9216
s_add_u32 s3, s3, 150272
v_lshrrev_b32 v247, 2, v253
v_add_u32 v247, s3, v247
s_lshl_b32 s3, s40, 8
v_add_u32 v247, s3, v247
ds_read_b32 v246, v247
s_waitcnt lgkmcnt(0)
s_branch L_tr7
L_redo:
s_cmp_lg_u32 s97, 0
s_cbranch_scc1 L_noredo
s_waitcnt vmcnt(0) lgkmcnt(0)
s_barrier
s_mov_b32 s97, 1
v_lshrrev_b32 v0, 4, v253
s_lshl_b32 s3, s40, 6
v_add_u32 v0, s3, v0
s_branch L_restart
L_collect:
s_waitcnt vmcnt(0)
L_cround:
s_waitcnt lgkmcnt(0) vmcnt(6)
s_barrier
ds_read_b128 a[224:227], v0 offset:0
v_mul_f32 v100, s48, v100
v_mul_f32 v101, s48, v101
v_cvt_pk_bf16_f32 v100, v100, v101
v_accvgpr_write_b32 a128, v100
v_mul_f32 v102, s48, v102
v_mul_f32 v103, s48, v103
v_cvt_pk_bf16_f32 v101, v102, v103
v_accvgpr_write_b32 a129, v101
v_mul_f32 v108, s48, v108
v_mul_f32 v109, s48, v109
v_cvt_pk_bf16_f32 v108, v108, v109
v_accvgpr_write_b32 a130, v108
v_mul_f32 v110, s48, v110
v_mul_f32 v111, s48, v111
v_cvt_pk_bf16_f32 v109, v110, v111
v_accvgpr_write_b32 a131, v109
s_waitcnt lgkmcnt(0)
s_nop 0
v_mfma_f32_16x16x32_bf16 v[44:47], a[224:227], a[128:131], 0
s_add_u32 m0, s41, 24576
ds_read_b128 a[228:231], v1 offset:0
ds_read_b128 a[232:235], v2 offset:0
v_mul_f32 v104, s48, v104
v_mul_f32 v105, s48, v105
v_mul_f32 v112, s48, v112
v_mul_f32 v113, s48, v113
v_mul_f32 v116, s48, v116
v_mul_f32 v117, s48, v117
v_mul_f32 v124, s48, v124
v_mul_f32 v125, s48, v125
v_mul_f32 v120, s48, v120
v_mul_f32 v121, s48, v121
v_mul_f32 v128, s48, v128
v_mul_f32 v129, s48, v129
v_mul_f32 v132, s48, v132
v_mul_f32 v133, s48, v133
v_mul_f32 v140, s48, v140
v_mul_f32 v141, s48, v141
v_mul_f32 v144, s48, v144
v_mul_f32 v145, s48, v145
v_mul_f32 v106, s48, v106
v_mul_f32 v107, s48, v107
v_mul_f32 v114, s48, v114
v_mul_f32 v115, s48, v115
v_mul_f32 v118, s48, v118
v_mul_f32 v119, s48, v119
v_mul_f32 v126, s48, v126
v_mul_f32 v127, s48, v127
v_mul_f32 v122, s48, v122
v_mul_f32 v123, s48, v123
v_mul_f32 v130, s48, v130
v_mul_f32 v131, s48, v131
v_mul_f32 v134, s48, v134
v_mul_f32 v135, s48, v135
v_mul_f32 v142, s48, v142
v_mul_f32 v143, s48, v143
v_mul_f32 v136, s48, v136
v_mul_f32 v137, s48, v137
v_mul_f32 v146, s48, v146
v_mul_f32 v147, s48, v147
v_mul_f32 v148, s48, v148
v_mul_f32 v149, s48, v149
v_mul_f32 v156, s48, v156
v_mul_f32 v157, s48, v157
v_mul_f32 v160, s48, v160
v_mul_f32 v161, s48, v161
v_cvt_pk_bf16_f32 v104, v104, v105
v_cvt_pk_bf16_f32 v112, v112, v113
v_cvt_pk_bf16_f32 v116, v116, v117
v_cvt_pk_bf16_f32 v124, v124, v125
v_cvt_pk_bf16_f32 v120, v120, v121
v_cvt_pk_bf16_f32 v128, v128, v129
v_cvt_pk_bf16_f32 v132, v132, v133
v_cvt_pk_bf16_f32 v140, v140, v141
v_cvt_pk_bf16_f32 v144, v144, v145
v_accvgpr_write_b32 a144, v104
v_cvt_pk_bf16_f32 v105, v106, v107
v_accvgpr_write_b32 a145, v105
v_accvgpr_write_b32 a146, v112
v_cvt_pk_bf16_f32 v113, v114, v115
v_accvgpr_write_b32 a147, v113
s_nop 1
v_mfma_f32_16x16x32_bf16 v[48:51], a[224:227], a[144:147], 0
s_waitcnt lgkmcnt(1)
ds_read_b128 a[236:239], v3 offset:0
v_mul_f32 v138, s48, v138
v_mul_f32 v139, s48, v139
v_mul_f32 v150, s48, v150
v_mul_f32 v151, s48, v151
v_mul_f32 v158, s48, v158
v_mul_f32 v159, s48, v159
v_mul_f32 v152, s48, v152
v_mul_f32 v153, s48, v153
v_mul_f32 v162, s48, v162
v_mul_f32 v163, s48, v163
v_cvt_pk_bf16_f32 v136, v136, v137
v_cvt_pk_bf16_f32 v148, v148, v149
v_cvt_pk_bf16_f32 v156, v156, v157
v_cvt_pk_bf16_f32 v160, v160, v161
v_cvt_pk_bf16_f32 v117, v118, v119
v_cvt_pk_bf16_f32 v125, v126, v127
v_cvt_pk_bf16_f32 v121, v122, v123
v_cvt_pk_bf16_f32 v129, v130, v131
v_cvt_pk_bf16_f32 v133, v134, v135
v_cvt_pk_bf16_f32 v141, v142, v143
v_cvt_pk_bf16_f32 v145, v146, v147
v_mul_f32 v154, s48, v154
v_mul_f32 v155, s48, v155
v_accvgpr_write_b32 a132, v116
v_accvgpr_write_b32 a134, v124
v_accvgpr_write_b32 a148, v120
v_accvgpr_write_b32 a150, v128
v_accvgpr_write_b32 a136, v132
v_accvgpr_write_b32 a138, v140
v_cvt_pk_bf16_f32 v152, v152, v153
v_cvt_pk_bf16_f32 v137, v138, v139
v_cvt_pk_bf16_f32 v149, v150, v151
v_cvt_pk_bf16_f32 v157, v158, v159
v_cvt_pk_bf16_f32 v161, v162, v163
v_accvgpr_write_b32 a133, v117
v_accvgpr_write_b32 a135, v125
v_accvgpr_write_b32 a149, v121
v_accvgpr_write_b32 a151, v129
v_accvgpr_write_b32 a137, v133
v_accvgpr_write_b32 a139, v141
v_accvgpr_write_b32 a155, v145
v_accvgpr_write_b32 a154, v144
v_mfma_f32_16x16x32_bf16 v[44:47], a[228:231], a[132:135], v[44:47]
s_add_u32 s43, s43, 8192
ds_read_b128 a[240:243], v0 offset:512
buffer_load_dwordx4 v12, s[8:11], 0 offen nt lds
v_accvgpr_write_b32 a153, v137
v_accvgpr_write_b32 a152, v136
v_mfma_f32_16x16x32_bf16 v[48:51], a[228:231], a[148:151], v[48:51]
s_waitcnt lgkmcnt(2)
ds_read_b128 a[244:247], v1 offset:512
v_accvgpr_write_b32 a143, v157
v_accvgpr_write_b32 a142, v156
v_mfma_f32_16x16x32_bf16 v[44:47], a[232:235], a[136:139], v[44:47]
s_add_u32 m0, s41, 28544
ds_read_b128 a[248:251], v2 offset:512
v_accvgpr_write_b32 a141, v149
v_accvgpr_write_b32 a140, v148
v_mfma_f32_16x16x32_bf16 v[48:51], a[232:235], a[152:155], v[48:51]
s_waitcnt lgkmcnt(3)
ds_read_b128 a[252:255], v3 offset:512
v_cvt_pk_bf16_f32 v153, v154, v155
v_accvgpr_write_b32 a159, v161
v_mfma_f32_16x16x32_bf16 v[44:47], a[236:239], a[140:143], v[44:47]
s_and_b32 s43, s43, 0x1ffff
s_cselect_b32 s6, s4, s5
ds_read_b128 a[224:227], v4 offset:0
buffer_load_dwordx4 v12, s[8:11], 0 offen offset:128 nt lds
v_accvgpr_write_b32 a158, v160
v_accvgpr_write_b32 a157, v153
v_accvgpr_write_b32 a156, v152
s_nop 1
v_mfma_f32_16x16x32_bf16 v[48:51], a[236:239], a[156:159], v[48:51]
s_waitcnt lgkmcnt(4)
ds_read_b128 v[84:87], v10 offset:33024
ds_read_b128 a[228:231], v5 offset:0
v_mfma_f32_16x16x32_bf16 v[52:55], a[240:243], a[128:131], 0
s_add_u32 m0, s42, 57792
ds_read_b128 v[88:91], v10 offset:34048
v_add_u32 v12, s6, v12
v_mfma_f32_16x16x32_bf16 v[56:59], a[240:243], a[144:147], 0
s_waitcnt lgkmcnt(6)
ds_read_b128 a[232:235], v4 offset:4096
ds_read_b128 v[92:95], v10 offset:35072
v_mfma_f32_16x16x32_bf16 v[52:55], a[244:247], a[132:135], v[52:55]
s_add_u32 s62, s62, 0x80000
ds_read_b128 a[236:239], v5 offset:4096
v_mov_b32 v32, 0xff800000
v_mfma_f32_16x16x32_bf16 v[56:59], a[244:247], a[148:151], v[56:59]
s_waitcnt lgkmcnt(8)
ds_read_b128 v[96:99], v10 offset:36096
v_max3_f32 v32, v32, v44, v45
v_mfma_f32_16x16x32_bf16 v[52:55], a[248:251], a[136:139], v[52:55]
s_and_b32 s62, s62, 0x3fffff
s_cselect_b32 s67, 0x40000, s61
ds_read_b64_tr_b16 a[242:243], v6 offset:33536
ds_read_b64_tr_b16 a[240:241], v6 offset:33024
v_mfma_f32_16x16x32_bf16 v[56:59], a[248:251], a[152:155], v[56:59]
s_waitcnt lgkmcnt(10)
ds_read_b128 v[76:79], v251 offset:0
v_max3_f32 v32, v32, v46, v47
v_mfma_f32_16x16x32_bf16 v[52:55], a[252:255], a[140:143], v[52:55]
s_add_u32 s43, s43, 8192
ds_read_b64_tr_b16 a[246:247], v6 offset:33544
v_mov_b32 v36, 0xff800000
v_mfma_f32_16x16x32_bf16 v[56:59], a[252:255], a[156:159], v[56:59]
s_waitcnt lgkmcnt(10)
ds_read_b64_tr_b16 a[244:245], v6 offset:33032
ds_read_b64_tr_b16 a[250:251], v7 offset:33536
v_mfma_f32_16x16x32_bf16 v[60:63], a[224:227], v[84:87], 0
s_waitcnt lgkmcnt(10)
ds_read_b64_tr_b16 a[248:249], v7 offset:33024
buffer_load_dwordx4 v14, s[16:19], 0 offen lds
v_mfma_f32_16x16x32_bf16 v[60:63], a[228:231], v[88:91], v[60:63]
s_waitcnt lgkmcnt(9)
ds_read_b64_tr_b16 a[254:255], v7 offset:33544
s_add_u32 m0, s42, 61792
v_mfma_f32_16x16x32_bf16 v[60:63], a[232:235], v[92:95], v[60:63]
s_waitcnt lgkmcnt(8)
ds_read_b64_tr_b16 a[252:253], v7 offset:33032
v_max3_f32 v36, v36, v48, v49
v_mfma_f32_16x16x32_bf16 v[60:63], a[236:239], v[96:99], v[60:63]
s_waitcnt lgkmcnt(7)
ds_read_b64_tr_b16 a[226:227], v8 offset:33536
ds_read_b64_tr_b16 a[224:225], v8 offset:33024
v_mfma_f32_16x16x32_bf16 v[100:103], a[240:243], a[0:3], 0
s_and_b32 s43, s43, 0x1ffff
s_cselect_b32 s7, s4, s5
ds_read_b64_tr_b16 a[230:231], v8 offset:33544
buffer_load_dwordx4 v14, s[16:19], 0 offen offset:128 lds
v_mfma_f32_16x16x32_bf16 v[104:107], a[240:243], a[64:67], 0
s_waitcnt lgkmcnt(9)
ds_read_b64_tr_b16 a[228:229], v8 offset:33032
s_mov_b32 m0, s41
v_mfma_f32_16x16x32_bf16 v[164:167], a[240:243], v[76:79], 0
s_waitcnt lgkmcnt(8)
ds_read_b64_tr_b16 a[234:235], v9 offset:33536
ds_read_b64_tr_b16 a[232:233], v9 offset:33024
v_mfma_f32_16x16x32_bf16 v[108:111], a[244:247], a[0:3], 0
s_add_u32 s43, s43, 8192
ds_read_b64_tr_b16 a[238:239], v9 offset:33544
v_max3_f32 v36, v36, v50, v51
v_mfma_f32_16x16x32_bf16 v[112:115], a[244:247], a[64:67], 0
s_and_b32 s43, s43, 0x1ffff
s_cselect_b32 s6, s4, s5
ds_read_b64_tr_b16 a[236:237], v9 offset:33032
v_max3_f32 v32, v32, v52, v53
v_mfma_f32_16x16x32_bf16 v[168:171], a[244:247], v[76:79], 0
s_waitcnt lgkmcnt(10)
v_max3_f32 v32, v32, v54, v55
v_max3_f32 v36, v36, v56, v57
v_mfma_f32_16x16x32_bf16 v[116:119], a[248:251], a[0:3], 0
s_add_u32 s62, s62, 0x80000
v_max3_f32 v36, v36, v58, v59
v_add_u32 v14, s67, v14
v_mfma_f32_16x16x32_bf16 v[120:123], a[248:251], a[64:67], 0
s_waitcnt lgkmcnt(8)
v_mov_b32 v40, 0xff800000
v_max3_f32 v40, v40, v60, v61
v_mfma_f32_16x16x32_bf16 v[124:127], a[252:255], a[0:3], 0
s_and_b32 s62, s62, 0x3fffff
s_cselect_b32 s67, 0x40000, s61
v_max3_f32 v40, v40, v62, v63
s_add_u32 s43, s43, 8192
v_mfma_f32_16x16x32_bf16 v[128:131], a[252:255], a[64:67], 0
s_waitcnt lgkmcnt(6)
s_waitcnt lgkmcnt(0) vmcnt(8)
s_barrier
ds_read_b128 a[240:243], v0 offset:8192
s_add_u32 s62, s62, 0x80000
v_mfma_f32_16x16x32_bf16 v[132:135], a[224:227], a[0:3], 0
s_mul_i32 s63, s47, 3072
ds_read_b128 a[244:247], v1 offset:8192
buffer_load_dwordx4 v12, s[8:11], 0 offen nt lds
v_mfma_f32_16x16x32_bf16 v[136:139], a[224:227], a[64:67], 0
s_add_u32 m0, s41, 3968
ds_read_b128 a[248:251], v2 offset:8192
v_lshrrev_b32 v75, 2, v253
v_mfma_f32_16x16x32_bf16 v[140:143], a[228:231], a[0:3], 0
s_lshl_b32 s3, s40, 8
ds_read_b128 a[252:255], v3 offset:8192
s_add_u32 s63, s63, s3
v_mfma_f32_16x16x32_bf16 v[144:147], a[228:231], a[64:67], 0
s_add_u32 s63, s63, 149248
ds_read_b128 a[224:227], v0 offset:8704
v_add_u32 v75, s63, v75
v_mfma_f32_16x16x32_bf16 v[148:151], a[232:235], a[0:3], 0
ds_read_b128 a[228:231], v1 offset:8704
buffer_load_dwordx4 v12, s[8:11], 0 offen offset:128 nt lds
v_mfma_f32_16x16x32_bf16 v[152:155], a[232:235], a[64:67], 0
s_add_u32 m0, s42, 33024
ds_read_b128 a[232:235], v2 offset:8704
v_add_u32 v12, s7, v12
v_mfma_f32_16x16x32_bf16 v[156:159], a[236:239], a[0:3], 0
s_and_b32 s43, s43, 0x1ffff
s_cselect_b32 s7, s4, s5
ds_read_b128 v[76:79], v252 offset:0
s_add_u32 s43, s43, 8192
v_mfma_f32_16x16x32_bf16 v[160:163], a[236:239], a[64:67], 0
s_waitcnt lgkmcnt(7)
ds_read_b128 a[236:239], v3 offset:8704
v_add_u32 v15, s56, v10
v_mfma_f32_16x16x32_bf16 v[44:47], a[240:243], a[128:131], 0
v_mfma_f32_16x16x32_bf16 v[48:51], a[240:243], a[144:147], 0
s_waitcnt lgkmcnt(7)
ds_read_b64_tr_b16 a[242:243], v6 offset:41792
v_mfma_f32_16x16x32_bf16 v[44:47], a[244:247], a[132:135], v[44:47]
ds_read_b64_tr_b16 a[240:241], v6 offset:41280
v_mfma_f32_16x16x32_bf16 v[48:51], a[244:247], a[148:151], v[48:51]
s_waitcnt lgkmcnt(8)
ds_read_b64_tr_b16 a[246:247], v6 offset:41800
v_mfma_f32_16x16x32_bf16 v[44:47], a[248:251], a[136:139], v[44:47]
ds_read_b64_tr_b16 a[244:245], v6 offset:41288
v_mfma_f32_16x16x32_bf16 v[48:51], a[248:251], a[152:155], v[48:51]
s_waitcnt lgkmcnt(9)
ds_read_b64_tr_b16 a[250:251], v7 offset:41792
v_mfma_f32_16x16x32_bf16 v[44:47], a[252:255], a[140:143], v[44:47]
ds_read_b64_tr_b16 a[248:249], v7 offset:41280
v_mfma_f32_16x16x32_bf16 v[48:51], a[252:255], a[156:159], v[48:51]
s_waitcnt lgkmcnt(10)
ds_read_b64_tr_b16 a[254:255], v7 offset:41800
v_mfma_f32_16x16x32_bf16 v[52:55], a[224:227], a[128:131], 0
ds_read_b64_tr_b16 a[252:253], v7 offset:41288
buffer_load_dwordx4 v14, s[16:19], 0 offen lds
v_mfma_f32_16x16x32_bf16 v[56:59], a[224:227], a[144:147], 0
s_waitcnt lgkmcnt(11)
ds_read_b64_tr_b16 a[226:227], v8 offset:41792
s_add_u32 m0, s42, 37024
v_mfma_f32_16x16x32_bf16 v[52:55], a[228:231], a[132:135], v[52:55]
ds_read_b64_tr_b16 a[224:225], v8 offset:41280
v_max3_f32 v32, v32, v44, v45
v_mfma_f32_16x16x32_bf16 v[56:59], a[228:231], a[148:151], v[56:59]
s_waitcnt lgkmcnt(12)
ds_read_b64_tr_b16 a[230:231], v8 offset:41800
v_max3_f32 v32, v32, v46, v47
v_mfma_f32_16x16x32_bf16 v[52:55], a[232:235], a[136:139], v[52:55]
ds_read_b64_tr_b16 a[228:229], v8 offset:41288
buffer_load_dwordx4 v14, s[16:19], 0 offen offset:128 lds
v_mfma_f32_16x16x32_bf16 v[56:59], a[232:235], a[152:155], v[56:59]
s_waitcnt lgkmcnt(12)
ds_read_b64_tr_b16 a[234:235], v9 offset:41792
s_add_u32 m0, s41, 8192
v_mfma_f32_16x16x32_bf16 v[52:55], a[236:239], a[140:143], v[52:55]
ds_read_b64_tr_b16 a[232:233], v9 offset:41280
v_max3_f32 v36, v36, v48, v49
v_mfma_f32_16x16x32_bf16 v[56:59], a[236:239], a[156:159], v[56:59]
s_waitcnt lgkmcnt(12)
ds_read_b64_tr_b16 a[238:239], v9 offset:41800
v_max3_f32 v36, v36, v50, v51
v_mfma_f32_16x16x32_bf16 v[100:103], a[240:243], a[4:7], v[100:103]
ds_read_b64_tr_b16 a[236:237], v9 offset:41288
v_max3_f32 v32, v32, v52, v53
v_mfma_f32_16x16x32_bf16 v[104:107], a[240:243], a[68:71], v[104:107]
v_max3_f32 v32, v32, v54, v55
v_max3_f32 v36, v36, v56, v57
v_mfma_f32_16x16x32_bf16 v[164:167], a[240:243], v[76:79], v[164:167]
s_waitcnt lgkmcnt(12)
v_max3_f32 v36, v36, v58, v59
v_add_u32 v14, 0x40000, v14
v_mfma_f32_16x16x32_bf16 v[108:111], a[244:247], a[4:7], v[108:111]
v_mfma_f32_16x16x32_bf16 v[112:115], a[244:247], a[68:71], v[112:115]
v_mfma_f32_16x16x32_bf16 v[168:171], a[244:247], v[76:79], v[168:171]
s_waitcnt lgkmcnt(10)
v_mfma_f32_16x16x32_bf16 v[116:119], a[248:251], a[4:7], v[116:119]
v_mfma_f32_16x16x32_bf16 v[120:123], a[248:251], a[68:71], v[120:123]
s_waitcnt lgkmcnt(8)
v_mfma_f32_16x16x32_bf16 v[124:127], a[252:255], a[4:7], v[124:127]
v_mfma_f32_16x16x32_bf16 v[128:131], a[252:255], a[68:71], v[128:131]
s_waitcnt lgkmcnt(6)
s_waitcnt lgkmcnt(0) vmcnt(6)
s_barrier
ds_read_b128 a[240:243], v0 offset:16384
v_mfma_f32_16x16x32_bf16 v[132:135], a[224:227], a[4:7], v[132:135]
ds_read_b128 a[244:247], v1 offset:16384
buffer_load_dwordx4 v12, s[8:11], 0 offen nt lds
v_mfma_f32_16x16x32_bf16 v[136:139], a[224:227], a[68:71], v[136:139]
s_add_u32 m0, s41, 12160
ds_read_b128 a[248:251], v2 offset:16384
v_mfma_f32_16x16x32_bf16 v[140:143], a[228:231], a[4:7], v[140:143]
ds_read_b128 a[252:255], v3 offset:16384
v_mfma_f32_16x16x32_bf16 v[144:147], a[228:231], a[68:71], v[144:147]
ds_read_b128 a[224:227], v0 offset:16896
v_mfma_f32_16x16x32_bf16 v[148:151], a[232:235], a[4:7], v[148:151]
ds_read_b128 a[228:231], v1 offset:16896
buffer_load_dwordx4 v12, s[8:11], 0 offen offset:128 nt lds
v_mfma_f32_16x16x32_bf16 v[152:155], a[232:235], a[68:71], v[152:155]
s_add_u32 m0, s42, 41280
ds_read_b128 a[232:235], v2 offset:16896
v_add_u32 v12, s6, v12
v_mfma_f32_16x16x32_bf16 v[156:159], a[236:239], a[4:7], v[156:159]
s_and_b32 s43, s43, 0x1ffff
s_cselect_b32 s6, s4, s5
ds_read_b128 v[76:79], v251 offset:2048
s_add_u32 s43, s43, 8192
v_mfma_f32_16x16x32_bf16 v[160:163], a[236:239], a[68:71], v[160:163]
s_waitcnt lgkmcnt(7)
ds_read_b128 a[236:239], v3 offset:16896
v_mfma_f32_16x16x32_bf16 v[44:47], a[240:243], a[128:131], 0
v_mfma_f32_16x16x32_bf16 v[48:51], a[240:243], a[144:147], 0
s_waitcnt lgkmcnt(7)
ds_read_b128 a[240:243], v4 offset:16384
v_mfma_f32_16x16x32_bf16 v[44:47], a[244:247], a[132:135], v[44:47]
v_mfma_f32_16x16x32_bf16 v[48:51], a[244:247], a[148:151], v[48:51]
s_waitcnt lgkmcnt(7)
ds_read_b128 a[244:247], v5 offset:16384
v_mfma_f32_16x16x32_bf16 v[44:47], a[248:251], a[136:139], v[44:47]
v_mfma_f32_16x16x32_bf16 v[48:51], a[248:251], a[152:155], v[48:51]
s_waitcnt lgkmcnt(7)
ds_read_b128 a[248:251], v4 offset:20480
v_mfma_f32_16x16x32_bf16 v[44:47], a[252:255], a[140:143], v[44:47]
v_mfma_f32_16x16x32_bf16 v[48:51], a[252:255], a[156:159], v[48:51]
s_waitcnt lgkmcnt(7)
ds_read_b128 a[252:255], v5 offset:20480
v_mfma_f32_16x16x32_bf16 v[52:55], a[224:227], a[128:131], 0
buffer_load_dwordx4 v14, s[16:19], 0 offen lds
s_add_u32 m0, s42, 45280
v_mfma_f32_16x16x32_bf16 v[56:59], a[224:227], a[144:147], 0
s_waitcnt lgkmcnt(7)
ds_read_b64_tr_b16 a[224:225], v6 offset:49536
ds_read_b64_tr_b16 a[226:227], v6 offset:50048
v_mfma_f32_16x16x32_bf16 v[52:55], a[228:231], a[132:135], v[52:55]
v_max3_f32 v32, v32, v44, v45
v_max3_f32 v32, v32, v46, v47
v_mfma_f32_16x16x32_bf16 v[56:59], a[228:231], a[148:151], v[56:59]
s_waitcnt lgkmcnt(8)
ds_read_b64_tr_b16 a[230:231], v6 offset:50056
v_max3_f32 v36, v36, v48, v49
v_mfma_f32_16x16x32_bf16 v[52:55], a[232:235], a[136:139], v[52:55]
ds_read_b64_tr_b16 a[228:229], v6 offset:49544
buffer_load_dwordx4 v14, s[16:19], 0 offen offset:128 lds
v_mfma_f32_16x16x32_bf16 v[56:59], a[232:235], a[152:155], v[56:59]
s_waitcnt lgkmcnt(8)
ds_read_b64_tr_b16 a[234:235], v7 offset:50048
s_add_u32 m0, s41, 16384
v_mfma_f32_16x16x32_bf16 v[52:55], a[236:239], a[140:143], v[52:55]
ds_read_b64_tr_b16 a[232:233], v7 offset:49536
v_max3_f32 v36, v36, v50, v51
v_mfma_f32_16x16x32_bf16 v[56:59], a[236:239], a[156:159], v[56:59]
s_waitcnt lgkmcnt(9)
ds_read_b64_tr_b16 a[238:239], v7 offset:50056
v_add_u32 v14, s67, v14
v_mfma_f32_16x16x32_bf16 v[60:63], a[240:243], v[84:87], 0
s_waitcnt lgkmcnt(9)
ds_read_b64_tr_b16 a[236:237], v7 offset:49544
v_max3_f32 v32, v32, v52, v53
v_mfma_f32_16x16x32_bf16 v[60:63], a[244:247], v[88:91], v[60:63]
s_waitcnt lgkmcnt(9)
ds_read_b64_tr_b16 a[242:243], v8 offset:50048
v_max3_f32 v32, v32, v54, v55
v_mfma_f32_16x16x32_bf16 v[60:63], a[248:251], v[92:95], v[60:63]
s_waitcnt lgkmcnt(9)
ds_read_b64_tr_b16 a[240:241], v8 offset:49536
v_max3_f32 v36, v36, v56, v57
v_mfma_f32_16x16x32_bf16 v[60:63], a[252:255], v[96:99], v[60:63]
s_waitcnt lgkmcnt(8)
ds_read_b64_tr_b16 a[246:247], v8 offset:50056
v_max3_f32 v36, v36, v58, v59
v_mfma_f32_16x16x32_bf16 v[100:103], a[224:227], a[8:11], v[100:103]
s_and_b32 s62, s62, 0x3fffff
s_cselect_b32 s67, 0x40000, s61
ds_read_b64_tr_b16 a[244:245], v8 offset:49544
s_add_u32 s62, s62, 0x80000
v_mfma_f32_16x16x32_bf16 v[104:107], a[224:227], a[72:75], v[104:107]
ds_read_b64_tr_b16 a[250:251], v9 offset:50048
v_max3_f32 v40, v40, v60, v61
v_mfma_f32_16x16x32_bf16 v[164:167], a[224:227], v[76:79], v[164:167]
s_waitcnt lgkmcnt(9)
ds_read_b64_tr_b16 a[248:249], v9 offset:49536
v_max3_f32 v40, v40, v62, v63
v_mfma_f32_16x16x32_bf16 v[108:111], a[228:231], a[8:11], v[108:111]
ds_read_b64_tr_b16 a[254:255], v9 offset:50056
v_mfma_f32_16x16x32_bf16 v[112:115], a[228:231], a[72:75], v[112:115]
ds_read_b64_tr_b16 a[252:253], v9 offset:49544
v_mfma_f32_16x16x32_bf16 v[168:171], a[228:231], v[76:79], v[168:171]
s_waitcnt lgkmcnt(10)
v_mfma_f32_16x16x32_bf16 v[116:119], a[232:235], a[8:11], v[116:119]
v_mfma_f32_16x16x32_bf16 v[120:123], a[232:235], a[72:75], v[120:123]
s_waitcnt lgkmcnt(8)
v_mfma_f32_16x16x32_bf16 v[124:127], a[236:239], a[8:11], v[124:127]
v_mfma_f32_16x16x32_bf16 v[128:131], a[236:239], a[72:75], v[128:131]
s_waitcnt lgkmcnt(6)
s_waitcnt lgkmcnt(0) vmcnt(8)
s_barrier
ds_read_b128 a[224:227], v0 offset:24576
v_mfma_f32_16x16x32_bf16 v[132:135], a[240:243], a[8:11], v[132:135]
ds_read_b128 a[228:231], v1 offset:24576
buffer_load_dwordx4 v12, s[8:11], 0 offen nt lds
v_mfma_f32_16x16x32_bf16 v[136:139], a[240:243], a[72:75], v[136:139]
s_add_u32 m0, s41, 20352
ds_read_b128 a[232:235], v2 offset:24576
v_mfma_f32_16x16x32_bf16 v[140:143], a[244:247], a[8:11], v[140:143]
ds_read_b128 a[236:239], v3 offset:24576
v_mfma_f32_16x16x32_bf16 v[144:147], a[244:247], a[72:75], v[144:147]
ds_read_b128 a[240:243], v0 offset:25088
v_mfma_f32_16x16x32_bf16 v[148:151], a[248:251], a[8:11], v[148:151]
ds_read_b128 a[244:247], v1 offset:25088
buffer_load_dwordx4 v12, s[8:11], 0 offen offset:128 nt lds
v_mfma_f32_16x16x32_bf16 v[152:155], a[248:251], a[72:75], v[152:155]
s_add_u32 m0, s42, 49536
ds_read_b128 a[248:251], v2 offset:25088
v_add_u32 v12, s7, v12
v_mfma_f32_16x16x32_bf16 v[156:159], a[252:255], a[8:11], v[156:159]
s_and_b32 s43, s43, 0x1ffff
s_cselect_b32 s7, s4, s5
ds_read_b128 v[76:79], v252 offset:2048
s_add_u32 s43, s43, 8192
v_mfma_f32_16x16x32_bf16 v[160:163], a[252:255], a[72:75], v[160:163]
s_waitcnt lgkmcnt(7)
ds_read_b128 a[252:255], v3 offset:25088
v_mfma_f32_16x16x32_bf16 v[44:47], a[224:227], a[128:131], 0
v_mfma_f32_16x16x32_bf16 v[48:51], a[224:227], a[144:147], 0
s_waitcnt lgkmcnt(7)
ds_read_b64_tr_b16 a[226:227], v6 offset:58304
v_mfma_f32_16x16x32_bf16 v[44:47], a[228:231], a[132:135], v[44:47]
ds_read_b64_tr_b16 a[224:225], v6 offset:57792
v_mfma_f32_16x16x32_bf16 v[48:51], a[228:231], a[148:151], v[48:51]
s_waitcnt lgkmcnt(8)
ds_read_b64_tr_b16 a[230:231], v6 offset:58312
v_mfma_f32_16x16x32_bf16 v[44:47], a[232:235], a[136:139], v[44:47]
ds_read_b64_tr_b16 a[228:229], v6 offset:57800
v_mfma_f32_16x16x32_bf16 v[48:51], a[232:235], a[152:155], v[48:51]
s_waitcnt lgkmcnt(9)
ds_read_b64_tr_b16 a[234:235], v7 offset:58304
v_mfma_f32_16x16x32_bf16 v[44:47], a[236:239], a[140:143], v[44:47]
ds_read_b64_tr_b16 a[232:233], v7 offset:57792
v_mfma_f32_16x16x32_bf16 v[48:51], a[236:239], a[156:159], v[48:51]
s_waitcnt lgkmcnt(10)
ds_read_b64_tr_b16 a[238:239], v7 offset:58312
v_mfma_f32_16x16x32_bf16 v[52:55], a[240:243], a[128:131], 0
ds_read_b64_tr_b16 a[236:237], v7 offset:57800
buffer_load_dwordx4 v14, s[16:19], 0 offen lds
v_mfma_f32_16x16x32_bf16 v[56:59], a[240:243], a[144:147], 0
s_waitcnt lgkmcnt(11)
ds_read_b64_tr_b16 a[242:243], v8 offset:58304
s_add_u32 m0, s42, 53536
v_mfma_f32_16x16x32_bf16 v[52:55], a[244:247], a[132:135], v[52:55]
ds_read_b64_tr_b16 a[240:241], v8 offset:57792
v_max3_f32 v32, v32, v44, v45
v_mfma_f32_16x16x32_bf16 v[56:59], a[244:247], a[148:151], v[56:59]
s_waitcnt lgkmcnt(12)
ds_read_b64_tr_b16 a[246:247], v8 offset:58312
v_max3_f32 v32, v32, v46, v47
v_mfma_f32_16x16x32_bf16 v[52:55], a[248:251], a[136:139], v[52:55]
ds_read_b64_tr_b16 a[244:245], v8 offset:57800
buffer_load_dwordx4 v14, s[16:19], 0 offen offset:128 lds
v_mfma_f32_16x16x32_bf16 v[56:59], a[248:251], a[152:155], v[56:59]
s_waitcnt lgkmcnt(12)
ds_read_b64_tr_b16 a[250:251], v9 offset:58304
s_add_u32 m0, s41, 24576
v_mfma_f32_16x16x32_bf16 v[52:55], a[252:255], a[140:143], v[52:55]
ds_read_b64_tr_b16 a[248:249], v9 offset:57792
v_max3_f32 v36, v36, v48, v49
v_mfma_f32_16x16x32_bf16 v[56:59], a[252:255], a[156:159], v[56:59]
s_waitcnt lgkmcnt(12)
ds_read_b64_tr_b16 a[254:255], v9 offset:58312
v_max3_f32 v36, v36, v50, v51
v_mfma_f32_16x16x32_bf16 v[100:103], a[224:227], a[12:15], v[100:103]
ds_read_b64_tr_b16 a[252:253], v9 offset:57800
v_max3_f32 v32, v32, v52, v53
v_mfma_f32_16x16x32_bf16 v[104:107], a[224:227], a[76:79], v[104:107]
v_max3_f32 v32, v32, v54, v55
v_max3_f32 v36, v36, v56, v57
v_mfma_f32_16x16x32_bf16 v[164:167], a[224:227], v[76:79], v[164:167]
s_waitcnt lgkmcnt(12)
v_max3_f32 v36, v36, v58, v59
v_add_u32 v14, 0x40000, v14
v_mfma_f32_16x16x32_bf16 v[108:111], a[228:231], a[12:15], v[108:111]
v_mfma_f32_16x16x32_bf16 v[112:115], a[228:231], a[76:79], v[112:115]
v_mfma_f32_16x16x32_bf16 v[168:171], a[228:231], v[76:79], v[168:171]
s_waitcnt lgkmcnt(10)
v_mfma_f32_16x16x32_bf16 v[116:119], a[232:235], a[12:15], v[116:119]
v_mfma_f32_16x16x32_bf16 v[120:123], a[232:235], a[76:79], v[120:123]
s_waitcnt lgkmcnt(8)
v_mfma_f32_16x16x32_bf16 v[124:127], a[236:239], a[12:15], v[124:127]
v_mfma_f32_16x16x32_bf16 v[128:131], a[236:239], a[76:79], v[128:131]
s_waitcnt lgkmcnt(6)
s_waitcnt lgkmcnt(0) vmcnt(6)
s_barrier
ds_read_b128 a[224:227], v0 offset:0
v_mfma_f32_16x16x32_bf16 v[132:135], a[240:243], a[12:15], v[132:135]
ds_read_b128 a[228:231], v1 offset:0
buffer_load_dwordx4 v12, s[8:11], 0 offen nt lds
v_mfma_f32_16x16x32_bf16 v[136:139], a[240:243], a[76:79], v[136:139]
s_add_u32 m0, s41, 28544
ds_read_b128 a[232:235], v2 offset:0
v_mfma_f32_16x16x32_bf16 v[140:143], a[244:247], a[12:15], v[140:143]
ds_read_b128 a[236:239], v3 offset:0
v_mfma_f32_16x16x32_bf16 v[144:147], a[244:247], a[76:79], v[144:147]
ds_read_b128 a[240:243], v0 offset:512
v_mfma_f32_16x16x32_bf16 v[148:151], a[248:251], a[12:15], v[148:151]
ds_read_b128 a[244:247], v1 offset:512
buffer_load_dwordx4 v12, s[8:11], 0 offen offset:128 nt lds
v_mfma_f32_16x16x32_bf16 v[152:155], a[248:251], a[76:79], v[152:155]
s_add_u32 m0, s42, 57792
ds_read_b128 a[248:251], v2 offset:512
v_add_u32 v12, s6, v12
v_mfma_f32_16x16x32_bf16 v[156:159], a[252:255], a[12:15], v[156:159]
s_and_b32 s43, s43, 0x1ffff
s_cselect_b32 s6, s4, s5
ds_read_b128 v[76:79], v251 offset:4096
s_add_u32 s43, s43, 8192
v_mfma_f32_16x16x32_bf16 v[160:163], a[252:255], a[76:79], v[160:163]
s_waitcnt lgkmcnt(7)
ds_read_b128 a[252:255], v3 offset:512
v_mfma_f32_16x16x32_bf16 v[44:47], a[224:227], a[128:131], 0
v_mfma_f32_16x16x32_bf16 v[48:51], a[224:227], a[144:147], 0
s_waitcnt lgkmcnt(7)
ds_read_b128 a[224:227], v4 offset:0
v_mfma_f32_16x16x32_bf16 v[44:47], a[228:231], a[132:135], v[44:47]
v_mfma_f32_16x16x32_bf16 v[48:51], a[228:231], a[148:151], v[48:51]
s_waitcnt lgkmcnt(7)
ds_read_b128 a[228:231], v5 offset:0
v_mfma_f32_16x16x32_bf16 v[44:47], a[232:235], a[136:139], v[44:47]
v_mfma_f32_16x16x32_bf16 v[48:51], a[232:235], a[152:155], v[48:51]
s_waitcnt lgkmcnt(7)
ds_read_b128 a[232:235], v4 offset:4096
v_mfma_f32_16x16x32_bf16 v[44:47], a[236:239], a[140:143], v[44:47]
v_mfma_f32_16x16x32_bf16 v[48:51], a[236:239], a[156:159], v[48:51]
s_waitcnt lgkmcnt(7)
ds_read_b128 a[236:239], v5 offset:4096
v_mfma_f32_16x16x32_bf16 v[52:55], a[240:243], a[128:131], 0
buffer_load_dwordx4 v14, s[16:19], 0 offen lds
s_add_u32 m0, s42, 61792
v_mfma_f32_16x16x32_bf16 v[56:59], a[240:243], a[144:147], 0
s_waitcnt lgkmcnt(7)
ds_read_b64_tr_b16 a[240:241], v6 offset:33024
ds_read_b64_tr_b16 a[242:243], v6 offset:33536
v_mfma_f32_16x16x32_bf16 v[52:55], a[244:247], a[132:135], v[52:55]
v_max3_f32 v32, v32, v44, v45
v_max3_f32 v32, v32, v46, v47
v_mfma_f32_16x16x32_bf16 v[56:59], a[244:247], a[148:151], v[56:59]
s_waitcnt lgkmcnt(8)
ds_read_b64_tr_b16 a[246:247], v6 offset:33544
v_max3_f32 v36, v36, v48, v49
v_mfma_f32_16x16x32_bf16 v[52:55], a[248:251], a[136:139], v[52:55]
ds_read_b64_tr_b16 a[244:245], v6 offset:33032
buffer_load_dwordx4 v14, s[16:19], 0 offen offset:128 lds
v_mfma_f32_16x16x32_bf16 v[56:59], a[248:251], a[152:155], v[56:59]
s_waitcnt lgkmcnt(8)
ds_read_b64_tr_b16 a[250:251], v7 offset:33536
s_mov_b32 m0, s41
v_mfma_f32_16x16x32_bf16 v[52:55], a[252:255], a[140:143], v[52:55]
ds_read_b64_tr_b16 a[248:249], v7 offset:33024
v_max3_f32 v36, v36, v50, v51
v_mfma_f32_16x16x32_bf16 v[56:59], a[252:255], a[156:159], v[56:59]
s_waitcnt lgkmcnt(9)
ds_read_b64_tr_b16 a[254:255], v7 offset:33544
v_add_u32 v14, s67, v14
v_mfma_f32_16x16x32_bf16 v[60:63], a[224:227], v[84:87], 0
s_waitcnt lgkmcnt(9)
ds_read_b64_tr_b16 a[252:253], v7 offset:33032
v_max3_f32 v32, v32, v52, v53
v_mfma_f32_16x16x32_bf16 v[60:63], a[228:231], v[88:91], v[60:63]
s_waitcnt lgkmcnt(9)
ds_read_b64_tr_b16 a[226:227], v8 offset:33536
v_max3_f32 v32, v32, v54, v55
v_mfma_f32_16x16x32_bf16 v[60:63], a[232:235], v[92:95], v[60:63]
s_waitcnt lgkmcnt(9)
ds_read_b64_tr_b16 a[224:225], v8 offset:33024
v_max3_f32 v36, v36, v56, v57
v_mfma_f32_16x16x32_bf16 v[60:63], a[236:239], v[96:99], v[60:63]
s_waitcnt lgkmcnt(8)
ds_read_b64_tr_b16 a[230:231], v8 offset:33544
v_max3_f32 v36, v36, v58, v59
v_mfma_f32_16x16x32_bf16 v[100:103], a[240:243], a[16:19], v[100:103]
s_and_b32 s62, s62, 0x3fffff
s_cselect_b32 s67, 0x40000, s61
ds_read_b64_tr_b16 a[228:229], v8 offset:33032
s_add_u32 s62, s62, 0x80000
v_mfma_f32_16x16x32_bf16 v[104:107], a[240:243], a[80:83], v[104:107]
ds_read_b64_tr_b16 a[234:235], v9 offset:33536
v_max3_f32 v40, v40, v60, v61
v_mfma_f32_16x16x32_bf16 v[164:167], a[240:243], v[76:79], v[164:167]
s_waitcnt lgkmcnt(9)
ds_read_b64_tr_b16 a[232:233], v9 offset:33024
v_max3_f32 v40, v40, v62, v63
v_mfma_f32_16x16x32_bf16 v[108:111], a[244:247], a[16:19], v[108:111]
ds_read_b64_tr_b16 a[238:239], v9 offset:33544
v_mfma_f32_16x16x32_bf16 v[112:115], a[244:247], a[80:83], v[112:115]
ds_read_b64_tr_b16 a[236:237], v9 offset:33032
v_mfma_f32_16x16x32_bf16 v[168:171], a[244:247], v[76:79], v[168:171]
s_waitcnt lgkmcnt(10)
v_mfma_f32_16x16x32_bf16 v[116:119], a[248:251], a[16:19], v[116:119]
v_mfma_f32_16x16x32_bf16 v[120:123], a[248:251], a[80:83], v[120:123]
s_waitcnt lgkmcnt(8)
v_mfma_f32_16x16x32_bf16 v[124:127], a[252:255], a[16:19], v[124:127]
v_mfma_f32_16x16x32_bf16 v[128:131], a[252:255], a[80:83], v[128:131]
s_waitcnt lgkmcnt(6)
s_waitcnt lgkmcnt(0) vmcnt(8)
s_barrier
ds_read_b128 a[240:243], v0 offset:8192
v_mfma_f32_16x16x32_bf16 v[132:135], a[224:227], a[16:19], v[132:135]
ds_read_b128 a[244:247], v1 offset:8192
buffer_load_dwordx4 v12, s[8:11], 0 offen nt lds
v_mfma_f32_16x16x32_bf16 v[136:139], a[224:227], a[80:83], v[136:139]
s_add_u32 m0, s41, 3968
ds_read_b128 a[248:251], v2 offset:8192
v_mfma_f32_16x16x32_bf16 v[140:143], a[228:231], a[16:19], v[140:143]
ds_read_b128 a[252:255], v3 offset:8192
v_mfma_f32_16x16x32_bf16 v[144:147], a[228:231], a[80:83], v[144:147]
ds_read_b128 a[224:227], v0 offset:8704
v_mfma_f32_16x16x32_bf16 v[148:151], a[232:235], a[16:19], v[148:151]
ds_read_b128 a[228:231], v1 offset:8704
buffer_load_dwordx4 v12, s[8:11], 0 offen offset:128 nt lds
v_mfma_f32_16x16x32_bf16 v[152:155], a[232:235], a[80:83], v[152:155]
s_add_u32 m0, s42, 33024
ds_read_b128 a[232:235], v2 offset:8704
v_add_u32 v12, s7, v12
v_mfma_f32_16x16x32_bf16 v[156:159], a[236:239], a[16:19], v[156:159]
s_and_b32 s43, s43, 0x1ffff
s_cselect_b32 s7, s4, s5
ds_read_b128 v[76:79], v252 offset:4096
s_add_u32 s43, s43, 8192
v_mfma_f32_16x16x32_bf16 v[160:163], a[236:239], a[80:83], v[160:163]
s_waitcnt lgkmcnt(7)
ds_read_b128 a[236:239], v3 offset:8704
v_mfma_f32_16x16x32_bf16 v[44:47], a[240:243], a[128:131], 0
v_mfma_f32_16x16x32_bf16 v[48:51], a[240:243], a[144:147], 0
s_waitcnt lgkmcnt(7)
ds_read_b64_tr_b16 a[242:243], v6 offset:41792
v_mfma_f32_16x16x32_bf16 v[44:47], a[244:247], a[132:135], v[44:47]
ds_read_b64_tr_b16 a[240:241], v6 offset:41280
v_mfma_f32_16x16x32_bf16 v[48:51], a[244:247], a[148:151], v[48:51]
s_waitcnt lgkmcnt(8)
ds_read_b64_tr_b16 a[246:247], v6 offset:41800
v_mfma_f32_16x16x32_bf16 v[44:47], a[248:251], a[136:139], v[44:47]
ds_read_b64_tr_b16 a[244:245], v6 offset:41288
v_mfma_f32_16x16x32_bf16 v[48:51], a[248:251], a[152:155], v[48:51]
s_waitcnt lgkmcnt(9)
ds_read_b64_tr_b16 a[250:251], v7 offset:41792
v_mfma_f32_16x16x32_bf16 v[44:47], a[252:255], a[140:143], v[44:47]
ds_read_b64_tr_b16 a[248:249], v7 offset:41280
v_mfma_f32_16x16x32_bf16 v[48:51], a[252:255], a[156:159], v[48:51]
s_waitcnt lgkmcnt(10)
ds_read_b64_tr_b16 a[254:255], v7 offset:41800
v_mfma_f32_16x16x32_bf16 v[52:55], a[224:227], a[128:131], 0
ds_read_b64_tr_b16 a[252:253], v7 offset:41288
buffer_load_dwordx4 v14, s[16:19], 0 offen lds
v_mfma_f32_16x16x32_bf16 v[56:59], a[224:227], a[144:147], 0
s_waitcnt lgkmcnt(11)
ds_read_b64_tr_b16 a[226:227], v8 offset:41792
s_add_u32 m0, s42, 37024
v_mfma_f32_16x16x32_bf16 v[52:55], a[228:231], a[132:135], v[52:55]
ds_read_b64_tr_b16 a[224:225], v8 offset:41280
v_max3_f32 v32, v32, v44, v45
v_mfma_f32_16x16x32_bf16 v[56:59], a[228:231], a[148:151], v[56:59]
s_waitcnt lgkmcnt(12)
ds_read_b64_tr_b16 a[230:231], v8 offset:41800
v_max3_f32 v32, v32, v46, v47
v_mfma_f32_16x16x32_bf16 v[52:55], a[232:235], a[136:139], v[52:55]
ds_read_b64_tr_b16 a[228:229], v8 offset:41288
buffer_load_dwordx4 v14, s[16:19], 0 offen offset:128 lds
v_mfma_f32_16x16x32_bf16 v[56:59], a[232:235], a[152:155], v[56:59]
s_waitcnt lgkmcnt(12)
ds_read_b64_tr_b16 a[234:235], v9 offset:41792
s_add_u32 m0, s41, 8192
v_mfma_f32_16x16x32_bf16 v[52:55], a[236:239], a[140:143], v[52:55]
ds_read_b64_tr_b16 a[232:233], v9 offset:41280
v_max3_f32 v36, v36, v48, v49
v_mfma_f32_16x16x32_bf16 v[56:59], a[236:239], a[156:159], v[56:59]
s_waitcnt lgkmcnt(12)
ds_read_b64_tr_b16 a[238:239], v9 offset:41800
v_max3_f32 v36, v36, v50, v51
v_mfma_f32_16x16x32_bf16 v[100:103], a[240:243], a[20:23], v[100:103]
ds_read_b64_tr_b16 a[236:237], v9 offset:41288
v_max3_f32 v32, v32, v52, v53
v_mfma_f32_16x16x32_bf16 v[104:107], a[240:243], a[84:87], v[104:107]
v_max3_f32 v32, v32, v54, v55
v_max3_f32 v36, v36, v56, v57
v_mfma_f32_16x16x32_bf16 v[164:167], a[240:243], v[76:79], v[164:167]
s_waitcnt lgkmcnt(12)
v_max3_f32 v36, v36, v58, v59
v_add_u32 v14, 0x40000, v14
v_mfma_f32_16x16x32_bf16 v[108:111], a[244:247], a[20:23], v[108:111]
v_mfma_f32_16x16x32_bf16 v[112:115], a[244:247], a[84:87], v[112:115]
v_mfma_f32_16x16x32_bf16 v[168:171], a[244:247], v[76:79], v[168:171]
s_waitcnt lgkmcnt(10)
v_mfma_f32_16x16x32_bf16 v[116:119], a[248:251], a[20:23], v[116:119]
v_mfma_f32_16x16x32_bf16 v[120:123], a[248:251], a[84:87], v[120:123]
s_waitcnt lgkmcnt(8)
v_mfma_f32_16x16x32_bf16 v[124:127], a[252:255], a[20:23], v[124:127]
v_mfma_f32_16x16x32_bf16 v[128:131], a[252:255], a[84:87], v[128:131]
s_waitcnt lgkmcnt(6)
s_waitcnt lgkmcnt(0) vmcnt(6)
s_barrier
ds_read_b128 a[240:243], v0 offset:16384
v_mfma_f32_16x16x32_bf16 v[132:135], a[224:227], a[20:23], v[132:135]
ds_read_b128 a[244:247], v1 offset:16384
buffer_load_dwordx4 v12, s[8:11], 0 offen nt lds
v_mfma_f32_16x16x32_bf16 v[136:139], a[224:227], a[84:87], v[136:139]
s_add_u32 m0, s41, 12160
ds_read_b128 a[248:251], v2 offset:16384
v_mfma_f32_16x16x32_bf16 v[140:143], a[228:231], a[20:23], v[140:143]
ds_read_b128 a[252:255], v3 offset:16384
v_mfma_f32_16x16x32_bf16 v[144:147], a[228:231], a[84:87], v[144:147]
ds_read_b128 a[224:227], v0 offset:16896
v_mfma_f32_16x16x32_bf16 v[148:151], a[232:235], a[20:23], v[148:151]
ds_read_b128 a[228:231], v1 offset:16896
buffer_load_dwordx4 v12, s[8:11], 0 offen offset:128 nt lds
v_mfma_f32_16x16x32_bf16 v[152:155], a[232:235], a[84:87], v[152:155]
s_add_u32 m0, s42, 41280
ds_read_b128 a[232:235], v2 offset:16896
v_add_u32 v12, s6, v12
v_mfma_f32_16x16x32_bf16 v[156:159], a[236:239], a[20:23], v[156:159]
s_and_b32 s43, s43, 0x1ffff
s_cselect_b32 s6, s4, s5
ds_read_b128 v[76:79], v251 offset:6144
s_add_u32 s43, s43, 8192
v_mfma_f32_16x16x32_bf16 v[160:163], a[236:239], a[84:87], v[160:163]
s_waitcnt lgkmcnt(7)
ds_read_b128 a[236:239], v3 offset:16896
v_mfma_f32_16x16x32_bf16 v[44:47], a[240:243], a[128:131], 0
v_mfma_f32_16x16x32_bf16 v[48:51], a[240:243], a[144:147], 0
s_waitcnt lgkmcnt(7)
ds_read_b128 a[240:243], v4 offset:16384
v_mfma_f32_16x16x32_bf16 v[44:47], a[244:247], a[132:135], v[44:47]
v_mfma_f32_16x16x32_bf16 v[48:51], a[244:247], a[148:151], v[48:51]
s_waitcnt lgkmcnt(7)
ds_read_b128 a[244:247], v5 offset:16384
v_mfma_f32_16x16x32_bf16 v[44:47], a[248:251], a[136:139], v[44:47]
v_mfma_f32_16x16x32_bf16 v[48:51], a[248:251], a[152:155], v[48:51]
s_waitcnt lgkmcnt(7)
ds_read_b128 a[248:251], v4 offset:20480
v_mfma_f32_16x16x32_bf16 v[44:47], a[252:255], a[140:143], v[44:47]
v_mfma_f32_16x16x32_bf16 v[48:51], a[252:255], a[156:159], v[48:51]
s_waitcnt lgkmcnt(7)
ds_read_b128 a[252:255], v5 offset:20480
v_mfma_f32_16x16x32_bf16 v[52:55], a[224:227], a[128:131], 0
buffer_load_dwordx4 v14, s[16:19], 0 offen lds
s_add_u32 m0, s42, 45280
v_mfma_f32_16x16x32_bf16 v[56:59], a[224:227], a[144:147], 0
s_waitcnt lgkmcnt(7)
ds_read_b64_tr_b16 a[224:225], v6 offset:49536
ds_read_b64_tr_b16 a[226:227], v6 offset:50048
v_mfma_f32_16x16x32_bf16 v[52:55], a[228:231], a[132:135], v[52:55]
v_max3_f32 v32, v32, v44, v45
v_max3_f32 v32, v32, v46, v47
v_mfma_f32_16x16x32_bf16 v[56:59], a[228:231], a[148:151], v[56:59]
s_waitcnt lgkmcnt(8)
ds_read_b64_tr_b16 a[230:231], v6 offset:50056
v_max3_f32 v36, v36, v48, v49
v_mfma_f32_16x16x32_bf16 v[52:55], a[232:235], a[136:139], v[52:55]
ds_read_b64_tr_b16 a[228:229], v6 offset:49544
buffer_load_dwordx4 v14, s[16:19], 0 offen offset:128 lds
v_mfma_f32_16x16x32_bf16 v[56:59], a[232:235], a[152:155], v[56:59]
s_waitcnt lgkmcnt(8)
ds_read_b64_tr_b16 a[234:235], v7 offset:50048
s_add_u32 m0, s41, 16384
v_mfma_f32_16x16x32_bf16 v[52:55], a[236:239], a[140:143], v[52:55]
ds_read_b64_tr_b16 a[232:233], v7 offset:49536
v_max3_f32 v36, v36, v50, v51
v_mfma_f32_16x16x32_bf16 v[56:59], a[236:239], a[156:159], v[56:59]
s_waitcnt lgkmcnt(9)
ds_read_b64_tr_b16 a[238:239], v7 offset:50056
v_add_u32 v14, s67, v14
v_mfma_f32_16x16x32_bf16 v[60:63], a[240:243], v[84:87], 0
s_waitcnt lgkmcnt(9)
ds_read_b64_tr_b16 a[236:237], v7 offset:49544
v_max3_f32 v32, v32, v52, v53
v_mfma_f32_16x16x32_bf16 v[60:63], a[244:247], v[88:91], v[60:63]
s_waitcnt lgkmcnt(9)
ds_read_b64_tr_b16 a[242:243], v8 offset:50048
v_max3_f32 v32, v32, v54, v55
v_mfma_f32_16x16x32_bf16 v[60:63], a[248:251], v[92:95], v[60:63]
s_waitcnt lgkmcnt(9)
ds_read_b64_tr_b16 a[240:241], v8 offset:49536
v_max3_f32 v36, v36, v56, v57
v_mfma_f32_16x16x32_bf16 v[60:63], a[252:255], v[96:99], v[60:63]
s_waitcnt lgkmcnt(8)
ds_read_b64_tr_b16 a[246:247], v8 offset:50056
v_max3_f32 v36, v36, v58, v59
v_mfma_f32_16x16x32_bf16 v[100:103], a[224:227], a[24:27], v[100:103]
s_and_b32 s62, s62, 0x3fffff
s_cselect_b32 s67, 0x40000, s61
ds_read_b64_tr_b16 a[244:245], v8 offset:49544
s_add_u32 s62, s62, 0x80000
v_mfma_f32_16x16x32_bf16 v[104:107], a[224:227], a[88:91], v[104:107]
ds_read_b64_tr_b16 a[250:251], v9 offset:50048
v_max3_f32 v40, v40, v60, v61
v_mfma_f32_16x16x32_bf16 v[164:167], a[224:227], v[76:79], v[164:167]
s_waitcnt lgkmcnt(9)
ds_read_b64_tr_b16 a[248:249], v9 offset:49536
v_max3_f32 v40, v40, v62, v63
v_mfma_f32_16x16x32_bf16 v[108:111], a[228:231], a[24:27], v[108:111]
ds_read_b64_tr_b16 a[254:255], v9 offset:50056
v_mfma_f32_16x16x32_bf16 v[112:115], a[228:231], a[88:91], v[112:115]
ds_read_b64_tr_b16 a[252:253], v9 offset:49544
v_mfma_f32_16x16x32_bf16 v[168:171], a[228:231], v[76:79], v[168:171]
s_waitcnt lgkmcnt(10)
v_mfma_f32_16x16x32_bf16 v[116:119], a[232:235], a[24:27], v[116:119]
v_mfma_f32_16x16x32_bf16 v[120:123], a[232:235], a[88:91], v[120:123]
s_waitcnt lgkmcnt(8)
v_mfma_f32_16x16x32_bf16 v[124:127], a[236:239], a[24:27], v[124:127]
v_mfma_f32_16x16x32_bf16 v[128:131], a[236:239], a[88:91], v[128:131]
s_waitcnt lgkmcnt(6)
s_waitcnt lgkmcnt(0) vmcnt(8)
s_barrier
ds_read_b128 a[224:227], v0 offset:24576
v_mfma_f32_16x16x32_bf16 v[132:135], a[240:243], a[24:27], v[132:135]
ds_read_b128 a[228:231], v1 offset:24576
buffer_load_dwordx4 v12, s[8:11], 0 offen nt lds
v_mfma_f32_16x16x32_bf16 v[136:139], a[240:243], a[88:91], v[136:139]
s_add_u32 m0, s41, 20352
ds_read_b128 a[232:235], v2 offset:24576
v_mfma_f32_16x16x32_bf16 v[140:143], a[244:247], a[24:27], v[140:143]
ds_read_b128 a[236:239], v3 offset:24576
v_mfma_f32_16x16x32_bf16 v[144:147], a[244:247], a[88:91], v[144:147]
ds_read_b128 a[240:243], v0 offset:25088
v_mfma_f32_16x16x32_bf16 v[148:151], a[248:251], a[24:27], v[148:151]
ds_read_b128 a[244:247], v1 offset:25088
buffer_load_dwordx4 v12, s[8:11], 0 offen offset:128 nt lds
v_mfma_f32_16x16x32_bf16 v[152:155], a[248:251], a[88:91], v[152:155]
s_add_u32 m0, s42, 49536
ds_read_b128 a[248:251], v2 offset:25088
v_add_u32 v12, s7, v12
v_mfma_f32_16x16x32_bf16 v[156:159], a[252:255], a[24:27], v[156:159]
s_and_b32 s43, s43, 0x1ffff
s_cselect_b32 s7, s4, s5
ds_read_b128 v[76:79], v252 offset:6144
s_add_u32 s43, s43, 8192
v_mfma_f32_16x16x32_bf16 v[160:163], a[252:255], a[88:91], v[160:163]
s_waitcnt lgkmcnt(7)
ds_read_b128 a[252:255], v3 offset:25088
v_mfma_f32_16x16x32_bf16 v[44:47], a[224:227], a[128:131], 0
v_mfma_f32_16x16x32_bf16 v[48:51], a[224:227], a[144:147], 0
s_waitcnt lgkmcnt(7)
ds_read_b64_tr_b16 a[226:227], v6 offset:58304
v_mfma_f32_16x16x32_bf16 v[44:47], a[228:231], a[132:135], v[44:47]
ds_read_b64_tr_b16 a[224:225], v6 offset:57792
v_mfma_f32_16x16x32_bf16 v[48:51], a[228:231], a[148:151], v[48:51]
s_waitcnt lgkmcnt(8)
ds_read_b64_tr_b16 a[230:231], v6 offset:58312
v_mfma_f32_16x16x32_bf16 v[44:47], a[232:235], a[136:139], v[44:47]
ds_read_b64_tr_b16 a[228:229], v6 offset:57800
v_mfma_f32_16x16x32_bf16 v[48:51], a[232:235], a[152:155], v[48:51]
s_waitcnt lgkmcnt(9)
ds_read_b64_tr_b16 a[234:235], v7 offset:58304
v_mfma_f32_16x16x32_bf16 v[44:47], a[236:239], a[140:143], v[44:47]
ds_read_b64_tr_b16 a[232:233], v7 offset:57792
v_mfma_f32_16x16x32_bf16 v[48:51], a[236:239], a[156:159], v[48:51]
s_waitcnt lgkmcnt(10)
ds_read_b64_tr_b16 a[238:239], v7 offset:58312
v_mfma_f32_16x16x32_bf16 v[52:55], a[240:243], a[128:131], 0
ds_read_b64_tr_b16 a[236:237], v7 offset:57800
buffer_load_dwordx4 v14, s[16:19], 0 offen lds
v_mfma_f32_16x16x32_bf16 v[56:59], a[240:243], a[144:147], 0
s_waitcnt lgkmcnt(11)
ds_read_b64_tr_b16 a[242:243], v8 offset:58304
s_add_u32 m0, s42, 53536
v_mfma_f32_16x16x32_bf16 v[52:55], a[244:247], a[132:135], v[52:55]
ds_read_b64_tr_b16 a[240:241], v8 offset:57792
v_max3_f32 v32, v32, v44, v45
v_mfma_f32_16x16x32_bf16 v[56:59], a[244:247], a[148:151], v[56:59]
s_waitcnt lgkmcnt(12)
ds_read_b64_tr_b16 a[246:247], v8 offset:58312
v_max3_f32 v32, v32, v46, v47
v_mfma_f32_16x16x32_bf16 v[52:55], a[248:251], a[136:139], v[52:55]
ds_read_b64_tr_b16 a[244:245], v8 offset:57800
buffer_load_dwordx4 v14, s[16:19], 0 offen offset:128 lds
v_mfma_f32_16x16x32_bf16 v[56:59], a[248:251], a[152:155], v[56:59]
s_waitcnt lgkmcnt(12)
ds_read_b64_tr_b16 a[250:251], v9 offset:58304
s_add_u32 m0, s41, 24576
v_mfma_f32_16x16x32_bf16 v[52:55], a[252:255], a[140:143], v[52:55]
ds_read_b64_tr_b16 a[248:249], v9 offset:57792
v_max3_f32 v36, v36, v48, v49
v_mfma_f32_16x16x32_bf16 v[56:59], a[252:255], a[156:159], v[56:59]
s_waitcnt lgkmcnt(12)
ds_read_b64_tr_b16 a[254:255], v9 offset:58312
v_max3_f32 v36, v36, v50, v51
v_mfma_f32_16x16x32_bf16 v[100:103], a[224:227], a[28:31], v[100:103]
ds_read_b64_tr_b16 a[252:253], v9 offset:57800
v_max3_f32 v32, v32, v52, v53
v_mfma_f32_16x16x32_bf16 v[104:107], a[224:227], a[92:95], v[104:107]
v_max3_f32 v32, v32, v54, v55
v_max3_f32 v36, v36, v56, v57
v_mfma_f32_16x16x32_bf16 v[164:167], a[224:227], v[76:79], v[164:167]
s_waitcnt lgkmcnt(12)
v_max3_f32 v36, v36, v58, v59
v_add_u32 v14, 0x40000, v14
v_mfma_f32_16x16x32_bf16 v[108:111], a[228:231], a[28:31], v[108:111]
v_mfma_f32_16x16x32_bf16 v[112:115], a[228:231], a[92:95], v[112:115]
v_mfma_f32_16x16x32_bf16 v[168:171], a[228:231], v[76:79], v[168:171]
s_waitcnt lgkmcnt(10)
v_mfma_f32_16x16x32_bf16 v[116:119], a[232:235], a[28:31], v[116:119]
v_mfma_f32_16x16x32_bf16 v[120:123], a[232:235], a[92:95], v[120:123]
s_waitcnt lgkmcnt(8)
v_mfma_f32_16x16x32_bf16 v[124:127], a[236:239], a[28:31], v[124:127]
v_mfma_f32_16x16x32_bf16 v[128:131], a[236:239], a[92:95], v[128:131]
s_waitcnt lgkmcnt(6)
s_waitcnt lgkmcnt(0) vmcnt(6)
s_barrier
ds_read_b128 a[224:227], v0 offset:0
v_mfma_f32_16x16x32_bf16 v[132:135], a[240:243], a[28:31], v[132:135]
ds_read_b128 a[228:231], v1 offset:0
buffer_load_dwordx4 v12, s[8:11], 0 offen nt lds
v_mfma_f32_16x16x32_bf16 v[136:139], a[240:243], a[92:95], v[136:139]
s_add_u32 m0, s41, 28544
ds_read_b128 a[232:235], v2 offset:0
v_mfma_f32_16x16x32_bf16 v[140:143], a[244:247], a[28:31], v[140:143]
ds_read_b128 a[236:239], v3 offset:0
v_mfma_f32_16x16x32_bf16 v[144:147], a[244:247], a[92:95], v[144:147]
ds_read_b128 a[240:243], v0 offset:512
v_mfma_f32_16x16x32_bf16 v[148:151], a[248:251], a[28:31], v[148:151]
ds_read_b128 a[244:247], v1 offset:512
buffer_load_dwordx4 v12, s[8:11], 0 offen offset:128 nt lds
v_mfma_f32_16x16x32_bf16 v[152:155], a[248:251], a[92:95], v[152:155]
s_add_u32 m0, s42, 57792
ds_read_b128 a[248:251], v2 offset:512
v_add_u32 v12, s6, v12
v_mfma_f32_16x16x32_bf16 v[156:159], a[252:255], a[28:31], v[156:159]
s_and_b32 s43, s43, 0x1ffff
s_cselect_b32 s6, s4, s5
ds_read_b128 v[76:79], v251 offset:8192
s_add_u32 s43, s43, 8192
v_mfma_f32_16x16x32_bf16 v[160:163], a[252:255], a[92:95], v[160:163]
s_waitcnt lgkmcnt(7)
ds_read_b128 a[252:255], v3 offset:512
v_mfma_f32_16x16x32_bf16 v[44:47], a[224:227], a[128:131], 0
v_mfma_f32_16x16x32_bf16 v[48:51], a[224:227], a[144:147], 0
s_waitcnt lgkmcnt(7)
ds_read_b128 a[224:227], v4 offset:0
v_mfma_f32_16x16x32_bf16 v[44:47], a[228:231], a[132:135], v[44:47]
v_mfma_f32_16x16x32_bf16 v[48:51], a[228:231], a[148:151], v[48:51]
s_waitcnt lgkmcnt(7)
ds_read_b128 a[228:231], v5 offset:0
v_mfma_f32_16x16x32_bf16 v[44:47], a[232:235], a[136:139], v[44:47]
v_mfma_f32_16x16x32_bf16 v[48:51], a[232:235], a[152:155], v[48:51]
s_waitcnt lgkmcnt(7)
ds_read_b128 a[232:235], v4 offset:4096
v_mfma_f32_16x16x32_bf16 v[44:47], a[236:239], a[140:143], v[44:47]
v_mfma_f32_16x16x32_bf16 v[48:51], a[236:239], a[156:159], v[48:51]
s_waitcnt lgkmcnt(7)
ds_read_b128 a[236:239], v5 offset:4096
v_mfma_f32_16x16x32_bf16 v[52:55], a[240:243], a[128:131], 0
buffer_load_dwordx4 v14, s[16:19], 0 offen lds
s_add_u32 m0, s42, 61792
v_mfma_f32_16x16x32_bf16 v[56:59], a[240:243], a[144:147], 0
s_waitcnt lgkmcnt(7)
ds_read_b64_tr_b16 a[240:241], v6 offset:33024
ds_read_b64_tr_b16 a[242:243], v6 offset:33536
v_mfma_f32_16x16x32_bf16 v[52:55], a[244:247], a[132:135], v[52:55]
v_max3_f32 v32, v32, v44, v45
v_max3_f32 v32, v32, v46, v47
v_mfma_f32_16x16x32_bf16 v[56:59], a[244:247], a[148:151], v[56:59]
s_waitcnt lgkmcnt(8)
ds_read_b64_tr_b16 a[246:247], v6 offset:33544
v_max3_f32 v36, v36, v48, v49
v_mfma_f32_16x16x32_bf16 v[52:55], a[248:251], a[136:139], v[52:55]
ds_read_b64_tr_b16 a[244:245], v6 offset:33032
buffer_load_dwordx4 v14, s[16:19], 0 offen offset:128 lds
v_mfma_f32_16x16x32_bf16 v[56:59], a[248:251], a[152:155], v[56:59]
s_waitcnt lgkmcnt(8)
ds_read_b64_tr_b16 a[250:251], v7 offset:33536
s_mov_b32 m0, s41
v_mfma_f32_16x16x32_bf16 v[52:55], a[252:255], a[140:143], v[52:55]
ds_read_b64_tr_b16 a[248:249], v7 offset:33024
v_max3_f32 v36, v36, v50, v51
v_mfma_f32_16x16x32_bf16 v[56:59], a[252:255], a[156:159], v[56:59]
s_waitcnt lgkmcnt(9)
ds_read_b64_tr_b16 a[254:255], v7 offset:33544
v_add_u32 v14, s67, v14
v_mfma_f32_16x16x32_bf16 v[60:63], a[224:227], v[84:87], 0
s_waitcnt lgkmcnt(9)
ds_read_b64_tr_b16 a[252:253], v7 offset:33032
v_max3_f32 v32, v32, v52, v53
v_mfma_f32_16x16x32_bf16 v[60:63], a[228:231], v[88:91], v[60:63]
s_waitcnt lgkmcnt(9)
ds_read_b64_tr_b16 a[226:227], v8 offset:33536
v_max3_f32 v32, v32, v54, v55
v_mfma_f32_16x16x32_bf16 v[60:63], a[232:235], v[92:95], v[60:63]
s_waitcnt lgkmcnt(9)
ds_read_b64_tr_b16 a[224:225], v8 offset:33024
v_max3_f32 v36, v36, v56, v57
v_mfma_f32_16x16x32_bf16 v[60:63], a[236:239], v[96:99], v[60:63]
s_waitcnt lgkmcnt(8)
ds_read_b64_tr_b16 a[230:231], v8 offset:33544
v_max3_f32 v36, v36, v58, v59
v_mfma_f32_16x16x32_bf16 v[100:103], a[240:243], a[32:35], v[100:103]
s_and_b32 s62, s62, 0x3fffff
s_cselect_b32 s67, 0x40000, s61
ds_read_b64_tr_b16 a[228:229], v8 offset:33032
s_add_u32 s62, s62, 0x80000
v_mfma_f32_16x16x32_bf16 v[104:107], a[240:243], a[96:99], v[104:107]
ds_read_b64_tr_b16 a[234:235], v9 offset:33536
v_max3_f32 v40, v40, v60, v61
v_mfma_f32_16x16x32_bf16 v[164:167], a[240:243], v[76:79], v[164:167]
s_waitcnt lgkmcnt(9)
ds_read_b64_tr_b16 a[232:233], v9 offset:33024
v_max3_f32 v40, v40, v62, v63
v_mfma_f32_16x16x32_bf16 v[108:111], a[244:247], a[32:35], v[108:111]
ds_read_b64_tr_b16 a[238:239], v9 offset:33544
v_mfma_f32_16x16x32_bf16 v[112:115], a[244:247], a[96:99], v[112:115]
ds_read_b64_tr_b16 a[236:237], v9 offset:33032
v_mfma_f32_16x16x32_bf16 v[168:171], a[244:247], v[76:79], v[168:171]
s_waitcnt lgkmcnt(10)
v_mfma_f32_16x16x32_bf16 v[116:119], a[248:251], a[32:35], v[116:119]
v_mfma_f32_16x16x32_bf16 v[120:123], a[248:251], a[96:99], v[120:123]
s_waitcnt lgkmcnt(8)
v_mfma_f32_16x16x32_bf16 v[124:127], a[252:255], a[32:35], v[124:127]
v_mfma_f32_16x16x32_bf16 v[128:131], a[252:255], a[96:99], v[128:131]
s_waitcnt lgkmcnt(6)
s_waitcnt lgkmcnt(0) vmcnt(8)
s_barrier
ds_read_b128 a[240:243], v0 offset:8192
v_mfma_f32_16x16x32_bf16 v[132:135], a[224:227], a[32:35], v[132:135]
ds_read_b128 a[244:247], v1 offset:8192
buffer_load_dwordx4 v12, s[8:11], 0 offen nt lds
v_mfma_f32_16x16x32_bf16 v[136:139], a[224:227], a[96:99], v[136:139]
s_add_u32 m0, s41, 3968
ds_read_b128 a[248:251], v2 offset:8192
v_mfma_f32_16x16x32_bf16 v[140:143], a[228:231], a[32:35], v[140:143]
ds_read_b128 a[252:255], v3 offset:8192
v_mfma_f32_16x16x32_bf16 v[144:147], a[228:231], a[96:99], v[144:147]
ds_read_b128 a[224:227], v0 offset:8704
v_mfma_f32_16x16x32_bf16 v[148:151], a[232:235], a[32:35], v[148:151]
ds_read_b128 a[228:231], v1 offset:8704
buffer_load_dwordx4 v12, s[8:11], 0 offen offset:128 nt lds
v_mfma_f32_16x16x32_bf16 v[152:155], a[232:235], a[96:99], v[152:155]
s_add_u32 m0, s42, 33024
ds_read_b128 a[232:235], v2 offset:8704
v_add_u32 v12, s7, v12
v_mfma_f32_16x16x32_bf16 v[156:159], a[236:239], a[32:35], v[156:159]
s_and_b32 s43, s43, 0x1ffff
s_cselect_b32 s7, s4, s5
ds_read_b128 v[76:79], v252 offset:8192
s_add_u32 s43, s43, 8192
v_mfma_f32_16x16x32_bf16 v[160:163], a[236:239], a[96:99], v[160:163]
s_waitcnt lgkmcnt(7)
ds_read_b128 a[236:239], v3 offset:8704
v_mfma_f32_16x16x32_bf16 v[44:47], a[240:243], a[128:131], 0
v_mfma_f32_16x16x32_bf16 v[48:51], a[240:243], a[144:147], 0
s_waitcnt lgkmcnt(7)
ds_read_b64_tr_b16 a[242:243], v6 offset:41792
v_mfma_f32_16x16x32_bf16 v[44:47], a[244:247], a[132:135], v[44:47]
ds_read_b64_tr_b16 a[240:241], v6 offset:41280
v_mfma_f32_16x16x32_bf16 v[48:51], a[244:247], a[148:151], v[48:51]
s_waitcnt lgkmcnt(8)
ds_read_b64_tr_b16 a[246:247], v6 offset:41800
v_mfma_f32_16x16x32_bf16 v[44:47], a[248:251], a[136:139], v[44:47]
ds_read_b64_tr_b16 a[244:245], v6 offset:41288
v_mfma_f32_16x16x32_bf16 v[48:51], a[248:251], a[152:155], v[48:51]
s_waitcnt lgkmcnt(9)
ds_read_b64_tr_b16 a[250:251], v7 offset:41792
v_mfma_f32_16x16x32_bf16 v[44:47], a[252:255], a[140:143], v[44:47]
ds_read_b64_tr_b16 a[248:249], v7 offset:41280
v_mfma_f32_16x16x32_bf16 v[48:51], a[252:255], a[156:159], v[48:51]
s_waitcnt lgkmcnt(10)
ds_read_b64_tr_b16 a[254:255], v7 offset:41800
v_mfma_f32_16x16x32_bf16 v[52:55], a[224:227], a[128:131], 0
ds_read_b64_tr_b16 a[252:253], v7 offset:41288
buffer_load_dwordx4 v14, s[16:19], 0 offen lds
v_mfma_f32_16x16x32_bf16 v[56:59], a[224:227], a[144:147], 0
s_waitcnt lgkmcnt(11)
ds_read_b64_tr_b16 a[226:227], v8 offset:41792
s_add_u32 m0, s42, 37024
v_mfma_f32_16x16x32_bf16 v[52:55], a[228:231], a[132:135], v[52:55]
ds_read_b64_tr_b16 a[224:225], v8 offset:41280
v_max3_f32 v32, v32, v44, v45
v_mfma_f32_16x16x32_bf16 v[56:59], a[228:231], a[148:151], v[56:59]
s_waitcnt lgkmcnt(12)
ds_read_b64_tr_b16 a[230:231], v8 offset:41800
v_max3_f32 v32, v32, v46, v47
v_mfma_f32_16x16x32_bf16 v[52:55], a[232:235], a[136:139], v[52:55]
ds_read_b64_tr_b16 a[228:229], v8 offset:41288
buffer_load_dwordx4 v14, s[16:19], 0 offen offset:128 lds
v_mfma_f32_16x16x32_bf16 v[56:59], a[232:235], a[152:155], v[56:59]
s_waitcnt lgkmcnt(12)
ds_read_b64_tr_b16 a[234:235], v9 offset:41792
s_add_u32 m0, s41, 8192
v_mfma_f32_16x16x32_bf16 v[52:55], a[236:239], a[140:143], v[52:55]
ds_read_b64_tr_b16 a[232:233], v9 offset:41280
v_max3_f32 v36, v36, v48, v49
v_mfma_f32_16x16x32_bf16 v[56:59], a[236:239], a[156:159], v[56:59]
s_waitcnt lgkmcnt(12)
ds_read_b64_tr_b16 a[238:239], v9 offset:41800
v_max3_f32 v36, v36, v50, v51
v_mfma_f32_16x16x32_bf16 v[100:103], a[240:243], a[36:39], v[100:103]
ds_read_b64_tr_b16 a[236:237], v9 offset:41288
v_max3_f32 v32, v32, v52, v53
v_mfma_f32_16x16x32_bf16 v[104:107], a[240:243], a[100:103], v[104:107]
v_max3_f32 v32, v32, v54, v55
v_max3_f32 v36, v36, v56, v57
v_mfma_f32_16x16x32_bf16 v[164:167], a[240:243], v[76:79], v[164:167]
s_waitcnt lgkmcnt(12)
v_max3_f32 v36, v36, v58, v59
v_add_u32 v14, 0x40000, v14
v_mfma_f32_16x16x32_bf16 v[108:111], a[244:247], a[36:39], v[108:111]
v_mfma_f32_16x16x32_bf16 v[112:115], a[244:247], a[100:103], v[112:115]
v_mfma_f32_16x16x32_bf16 v[168:171], a[244:247], v[76:79], v[168:171]
s_waitcnt lgkmcnt(10)
v_mfma_f32_16x16x32_bf16 v[116:119], a[248:251], a[36:39], v[116:119]
v_mfma_f32_16x16x32_bf16 v[120:123], a[248:251], a[100:103], v[120:123]
s_waitcnt lgkmcnt(8)
v_mfma_f32_16x16x32_bf16 v[124:127], a[252:255], a[36:39], v[124:127]
v_mfma_f32_16x16x32_bf16 v[128:131], a[252:255], a[100:103], v[128:131]
s_waitcnt lgkmcnt(6)
s_waitcnt lgkmcnt(0) vmcnt(6)
s_barrier
ds_read_b128 a[240:243], v0 offset:16384
v_mfma_f32_16x16x32_bf16 v[132:135], a[224:227], a[36:39], v[132:135]
ds_read_b128 a[244:247], v1 offset:16384
buffer_load_dwordx4 v12, s[8:11], 0 offen nt lds
v_mfma_f32_16x16x32_bf16 v[136:139], a[224:227], a[100:103], v[136:139]
s_add_u32 m0, s41, 12160
ds_read_b128 a[248:251], v2 offset:16384
v_mfma_f32_16x16x32_bf16 v[140:143], a[228:231], a[36:39], v[140:143]
ds_read_b128 a[252:255], v3 offset:16384
v_mfma_f32_16x16x32_bf16 v[144:147], a[228:231], a[100:103], v[144:147]
ds_read_b128 a[224:227], v0 offset:16896
v_mfma_f32_16x16x32_bf16 v[148:151], a[232:235], a[36:39], v[148:151]
ds_read_b128 a[228:231], v1 offset:16896
buffer_load_dwordx4 v12, s[8:11], 0 offen offset:128 nt lds
v_mfma_f32_16x16x32_bf16 v[152:155], a[232:235], a[100:103], v[152:155]
s_add_u32 m0, s42, 41280
ds_read_b128 a[232:235], v2 offset:16896
v_add_u32 v12, s6, v12
v_mfma_f32_16x16x32_bf16 v[156:159], a[236:239], a[36:39], v[156:159]
s_and_b32 s43, s43, 0x1ffff
s_cselect_b32 s6, 0x22000, s4
ds_read_b128 v[76:79], v251 offset:10240
s_add_u32 s43, s43, 8192
v_mfma_f32_16x16x32_bf16 v[160:163], a[236:239], a[100:103], v[160:163]
s_waitcnt lgkmcnt(7)
ds_read_b128 a[236:239], v3 offset:16896
v_mfma_f32_16x16x32_bf16 v[44:47], a[240:243], a[128:131], 0
v_mfma_f32_16x16x32_bf16 v[48:51], a[240:243], a[144:147], 0
s_waitcnt lgkmcnt(7)
ds_read_b128 a[240:243], v4 offset:16384
v_mfma_f32_16x16x32_bf16 v[44:47], a[244:247], a[132:135], v[44:47]
v_mfma_f32_16x16x32_bf16 v[48:51], a[244:247], a[148:151], v[48:51]
s_waitcnt lgkmcnt(7)
ds_read_b128 a[244:247], v5 offset:16384
v_mfma_f32_16x16x32_bf16 v[44:47], a[248:251], a[136:139], v[44:47]
v_mfma_f32_16x16x32_bf16 v[48:51], a[248:251], a[152:155], v[48:51]
s_waitcnt lgkmcnt(7)
ds_read_b128 a[248:251], v4 offset:20480
v_mfma_f32_16x16x32_bf16 v[44:47], a[252:255], a[140:143], v[44:47]
v_mfma_f32_16x16x32_bf16 v[48:51], a[252:255], a[156:159], v[48:51]
s_waitcnt lgkmcnt(7)
ds_read_b128 a[252:255], v5 offset:20480
v_mfma_f32_16x16x32_bf16 v[52:55], a[224:227], a[128:131], 0
buffer_load_dwordx4 v14, s[16:19], 0 offen lds
s_add_u32 m0, s42, 45280
v_mfma_f32_16x16x32_bf16 v[56:59], a[224:227], a[144:147], 0
s_waitcnt lgkmcnt(7)
ds_read_b64_tr_b16 a[224:225], v6 offset:49536
ds_read_b64_tr_b16 a[226:227], v6 offset:50048
v_mfma_f32_16x16x32_bf16 v[52:55], a[228:231], a[132:135], v[52:55]
v_max3_f32 v32, v32, v44, v45
v_max3_f32 v32, v32, v46, v47
v_mfma_f32_16x16x32_bf16 v[56:59], a[228:231], a[148:151], v[56:59]
s_waitcnt lgkmcnt(8)
ds_read_b64_tr_b16 a[230:231], v6 offset:50056
v_max3_f32 v36, v36, v48, v49
v_mfma_f32_16x16x32_bf16 v[52:55], a[232:235], a[136:139], v[52:55]
ds_read_b64_tr_b16 a[228:229], v6 offset:49544
buffer_load_dwordx4 v14, s[16:19], 0 offen offset:128 lds
v_mfma_f32_16x16x32_bf16 v[56:59], a[232:235], a[152:155], v[56:59]
s_waitcnt lgkmcnt(8)
ds_read_b64_tr_b16 a[234:235], v7 offset:50048
s_add_u32 m0, s41, 16384
v_mfma_f32_16x16x32_bf16 v[52:55], a[236:239], a[140:143], v[52:55]
ds_read_b64_tr_b16 a[232:233], v7 offset:49536
v_max3_f32 v36, v36, v50, v51
v_mfma_f32_16x16x32_bf16 v[56:59], a[236:239], a[156:159], v[56:59]
s_waitcnt lgkmcnt(9)
ds_read_b64_tr_b16 a[238:239], v7 offset:50056
v_add_u32 v14, s67, v14
v_mfma_f32_16x16x32_bf16 v[60:63], a[240:243], v[84:87], 0
s_waitcnt lgkmcnt(9)
ds_read_b64_tr_b16 a[236:237], v7 offset:49544
v_max3_f32 v32, v32, v52, v53
v_mfma_f32_16x16x32_bf16 v[60:63], a[244:247], v[88:91], v[60:63]
s_waitcnt lgkmcnt(9)
ds_read_b64_tr_b16 a[242:243], v8 offset:50048
v_max3_f32 v32, v32, v54, v55
v_mfma_f32_16x16x32_bf16 v[60:63], a[248:251], v[92:95], v[60:63]
s_waitcnt lgkmcnt(9)
ds_read_b64_tr_b16 a[240:241], v8 offset:49536
v_max3_f32 v36, v36, v56, v57
v_mfma_f32_16x16x32_bf16 v[60:63], a[252:255], v[96:99], v[60:63]
s_waitcnt lgkmcnt(8)
ds_read_b64_tr_b16 a[246:247], v8 offset:50056
v_max3_f32 v36, v36, v58, v59
v_mfma_f32_16x16x32_bf16 v[100:103], a[224:227], a[40:43], v[100:103]
s_and_b32 s62, s62, 0x3fffff
s_cselect_b32 s67, s45, s44
ds_read_b64_tr_b16 a[244:245], v8 offset:49544
s_add_u32 s62, s62, 0x80000
v_mfma_f32_16x16x32_bf16 v[104:107], a[224:227], a[104:107], v[104:107]
ds_read_b64_tr_b16 a[250:251], v9 offset:50048
v_max3_f32 v40, v40, v60, v61
v_mfma_f32_16x16x32_bf16 v[164:167], a[224:227], v[76:79], v[164:167]
s_waitcnt lgkmcnt(9)
ds_read_b64_tr_b16 a[248:249], v9 offset:49536
v_max3_f32 v40, v40, v62, v63
v_mfma_f32_16x16x32_bf16 v[108:111], a[228:231], a[40:43], v[108:111]
ds_read_b64_tr_b16 a[254:255], v9 offset:50056
v_mfma_f32_16x16x32_bf16 v[112:115], a[228:231], a[104:107], v[112:115]
ds_read_b64_tr_b16 a[252:253], v9 offset:49544
v_mfma_f32_16x16x32_bf16 v[168:171], a[228:231], v[76:79], v[168:171]
s_waitcnt lgkmcnt(10)
v_mfma_f32_16x16x32_bf16 v[116:119], a[232:235], a[40:43], v[116:119]
v_mfma_f32_16x16x32_bf16 v[120:123], a[232:235], a[104:107], v[120:123]
s_waitcnt lgkmcnt(8)
v_mfma_f32_16x16x32_bf16 v[124:127], a[236:239], a[40:43], v[124:127]
v_mfma_f32_16x16x32_bf16 v[128:131], a[236:239], a[104:107], v[128:131]
s_waitcnt lgkmcnt(6)
s_waitcnt lgkmcnt(0) vmcnt(8)
s_barrier
ds_read_b128 a[224:227], v0 offset:24576
v_mfma_f32_16x16x32_bf16 v[132:135], a[240:243], a[40:43], v[132:135]
ds_read_b128 a[228:231], v1 offset:24576
buffer_load_dwordx4 v12, s[8:11], 0 offen nt lds
v_mfma_f32_16x16x32_bf16 v[136:139], a[240:243], a[104:107], v[136:139]
s_add_u32 m0, s41, 20352
ds_read_b128 a[232:235], v2 offset:24576
v_mfma_f32_16x16x32_bf16 v[140:143], a[244:247], a[40:43], v[140:143]
ds_read_b128 a[236:239], v3 offset:24576
v_mfma_f32_16x16x32_bf16 v[144:147], a[244:247], a[104:107], v[144:147]
ds_read_b128 a[240:243], v0 offset:25088
v_mfma_f32_16x16x32_bf16 v[148:151], a[248:251], a[40:43], v[148:151]
ds_read_b128 a[244:247], v1 offset:25088
buffer_load_dwordx4 v12, s[8:11], 0 offen offset:128 nt lds
v_mfma_f32_16x16x32_bf16 v[152:155], a[248:251], a[104:107], v[152:155]
s_add_u32 m0, s42, 49536
ds_read_b128 a[248:251], v2 offset:25088
v_add_u32 v12, s7, v12
v_mfma_f32_16x16x32_bf16 v[156:159], a[252:255], a[40:43], v[156:159]
s_and_b32 s43, s43, 0x1ffff
s_cselect_b32 s7, s4, s5
ds_read_b128 v[76:79], v252 offset:10240
s_add_u32 s43, s43, 8192
v_mfma_f32_16x16x32_bf16 v[160:163], a[252:255], a[104:107], v[160:163]
s_waitcnt lgkmcnt(7)
ds_read_b128 a[252:255], v3 offset:25088
v_mfma_f32_16x16x32_bf16 v[44:47], a[224:227], a[128:131], 0
v_mfma_f32_16x16x32_bf16 v[48:51], a[224:227], a[144:147], 0
s_waitcnt lgkmcnt(7)
ds_read_b64_tr_b16 a[226:227], v6 offset:58304
v_mfma_f32_16x16x32_bf16 v[44:47], a[228:231], a[132:135], v[44:47]
ds_read_b64_tr_b16 a[224:225], v6 offset:57792
v_mfma_f32_16x16x32_bf16 v[48:51], a[228:231], a[148:151], v[48:51]
s_waitcnt lgkmcnt(8)
ds_read_b64_tr_b16 a[230:231], v6 offset:58312
v_mfma_f32_16x16x32_bf16 v[44:47], a[232:235], a[136:139], v[44:47]
ds_read_b64_tr_b16 a[228:229], v6 offset:57800
v_mfma_f32_16x16x32_bf16 v[48:51], a[232:235], a[152:155], v[48:51]
s_waitcnt lgkmcnt(9)
ds_read_b64_tr_b16 a[234:235], v7 offset:58304
v_mfma_f32_16x16x32_bf16 v[44:47], a[236:239], a[140:143], v[44:47]
ds_read_b64_tr_b16 a[232:233], v7 offset:57792
v_mfma_f32_16x16x32_bf16 v[48:51], a[236:239], a[156:159], v[48:51]
s_waitcnt lgkmcnt(10)
ds_read_b64_tr_b16 a[238:239], v7 offset:58312
v_mfma_f32_16x16x32_bf16 v[52:55], a[240:243], a[128:131], 0
ds_read_b64_tr_b16 a[236:237], v7 offset:57800
buffer_load_dwordx4 v14, s[16:19], 0 offen lds
v_mfma_f32_16x16x32_bf16 v[56:59], a[240:243], a[144:147], 0
s_waitcnt lgkmcnt(11)
ds_read_b64_tr_b16 a[242:243], v8 offset:58304
s_add_u32 m0, s42, 53536
v_mfma_f32_16x16x32_bf16 v[52:55], a[244:247], a[132:135], v[52:55]
ds_read_b64_tr_b16 a[240:241], v8 offset:57792
v_max3_f32 v32, v32, v44, v45
v_mfma_f32_16x16x32_bf16 v[56:59], a[244:247], a[148:151], v[56:59]
s_waitcnt lgkmcnt(12)
ds_read_b64_tr_b16 a[246:247], v8 offset:58312
v_max3_f32 v32, v32, v46, v47
v_mfma_f32_16x16x32_bf16 v[52:55], a[248:251], a[136:139], v[52:55]
ds_read_b64_tr_b16 a[244:245], v8 offset:57800
buffer_load_dwordx4 v14, s[16:19], 0 offen offset:128 lds
v_mfma_f32_16x16x32_bf16 v[56:59], a[248:251], a[152:155], v[56:59]
s_waitcnt lgkmcnt(12)
ds_read_b64_tr_b16 a[250:251], v9 offset:58304
s_add_u32 m0, s41, 24576
v_mfma_f32_16x16x32_bf16 v[52:55], a[252:255], a[140:143], v[52:55]
ds_read_b64_tr_b16 a[248:249], v9 offset:57792
v_max3_f32 v36, v36, v48, v49
v_mfma_f32_16x16x32_bf16 v[56:59], a[252:255], a[156:159], v[56:59]
s_waitcnt lgkmcnt(12)
ds_read_b64_tr_b16 a[254:255], v9 offset:58312
v_max3_f32 v36, v36, v50, v51
v_mfma_f32_16x16x32_bf16 v[100:103], a[224:227], a[44:47], v[100:103]
ds_read_b64_tr_b16 a[252:253], v9 offset:57800
v_max3_f32 v32, v32, v52, v53
v_mfma_f32_16x16x32_bf16 v[104:107], a[224:227], a[108:111], v[104:107]
v_max3_f32 v32, v32, v54, v55
v_max3_f32 v36, v36, v56, v57
v_mfma_f32_16x16x32_bf16 v[164:167], a[224:227], v[76:79], v[164:167]
s_waitcnt lgkmcnt(12)
v_max3_f32 v36, v36, v58, v59
v_add_u32 v14, 0x40000, v14
v_mfma_f32_16x16x32_bf16 v[108:111], a[228:231], a[44:47], v[108:111]
v_mfma_f32_16x16x32_bf16 v[112:115], a[228:231], a[108:111], v[112:115]
v_mfma_f32_16x16x32_bf16 v[168:171], a[228:231], v[76:79], v[168:171]
s_waitcnt lgkmcnt(10)
v_mfma_f32_16x16x32_bf16 v[116:119], a[232:235], a[44:47], v[116:119]
v_mfma_f32_16x16x32_bf16 v[120:123], a[232:235], a[108:111], v[120:123]
s_waitcnt lgkmcnt(8)
v_mfma_f32_16x16x32_bf16 v[124:127], a[236:239], a[44:47], v[124:127]
v_mfma_f32_16x16x32_bf16 v[128:131], a[236:239], a[108:111], v[128:131]
s_waitcnt lgkmcnt(6)
s_waitcnt lgkmcnt(0) vmcnt(6)
s_barrier
ds_read_b128 a[224:227], v0 offset:0
v_mfma_f32_16x16x32_bf16 v[132:135], a[240:243], a[44:47], v[132:135]
ds_read_b128 a[228:231], v1 offset:0
buffer_load_dwordx4 v12, s[8:11], 0 offen nt lds
v_mfma_f32_16x16x32_bf16 v[136:139], a[240:243], a[108:111], v[136:139]
s_add_u32 m0, s41, 28544
ds_read_b128 a[232:235], v2 offset:0
v_mfma_f32_16x16x32_bf16 v[140:143], a[244:247], a[44:47], v[140:143]
ds_read_b128 a[236:239], v3 offset:0
v_mfma_f32_16x16x32_bf16 v[144:147], a[244:247], a[108:111], v[144:147]
ds_read_b128 a[240:243], v0 offset:512
v_mfma_f32_16x16x32_bf16 v[148:151], a[248:251], a[44:47], v[148:151]
ds_read_b128 a[244:247], v1 offset:512
buffer_load_dwordx4 v12, s[8:11], 0 offen offset:128 nt lds
v_mfma_f32_16x16x32_bf16 v[152:155], a[248:251], a[108:111], v[152:155]
s_add_u32 m0, s42, 57792
ds_read_b128 a[248:251], v2 offset:512
v_add_u32 v12, s6, v12
v_mfma_f32_16x16x32_bf16 v[156:159], a[252:255], a[44:47], v[156:159]
s_and_b32 s43, s43, 0x1ffff
s_cselect_b32 s6, s4, s5
ds_read_b128 v[76:79], v251 offset:12288
s_add_u32 s43, s43, 8192
v_mfma_f32_16x16x32_bf16 v[160:163], a[252:255], a[108:111], v[160:163]
s_waitcnt lgkmcnt(7)
ds_read_b128 a[252:255], v3 offset:512
v_mfma_f32_16x16x32_bf16 v[44:47], a[224:227], a[128:131], 0
v_mfma_f32_16x16x32_bf16 v[48:51], a[224:227], a[144:147], 0
s_waitcnt lgkmcnt(7)
ds_read_b128 a[224:227], v4 offset:0
v_mfma_f32_16x16x32_bf16 v[44:47], a[228:231], a[132:135], v[44:47]
v_mfma_f32_16x16x32_bf16 v[48:51], a[228:231], a[148:151], v[48:51]
s_waitcnt lgkmcnt(7)
ds_read_b128 a[228:231], v5 offset:0
v_mfma_f32_16x16x32_bf16 v[44:47], a[232:235], a[136:139], v[44:47]
v_mfma_f32_16x16x32_bf16 v[48:51], a[232:235], a[152:155], v[48:51]
s_waitcnt lgkmcnt(7)
ds_read_b128 a[232:235], v4 offset:4096
v_mfma_f32_16x16x32_bf16 v[44:47], a[236:239], a[140:143], v[44:47]
v_mfma_f32_16x16x32_bf16 v[48:51], a[236:239], a[156:159], v[48:51]
s_waitcnt lgkmcnt(7)
ds_read_b128 a[236:239], v5 offset:4096
v_mfma_f32_16x16x32_bf16 v[52:55], a[240:243], a[128:131], 0
buffer_load_dwordx4 v14, s[16:19], 0 offen lds
s_add_u32 m0, s42, 61792
v_mfma_f32_16x16x32_bf16 v[56:59], a[240:243], a[144:147], 0
s_waitcnt lgkmcnt(7)
ds_read_b64_tr_b16 a[240:241], v6 offset:33024
ds_read_b64_tr_b16 a[242:243], v6 offset:33536
v_mfma_f32_16x16x32_bf16 v[52:55], a[244:247], a[132:135], v[52:55]
v_max3_f32 v32, v32, v44, v45
v_max3_f32 v32, v32, v46, v47
v_mfma_f32_16x16x32_bf16 v[56:59], a[244:247], a[148:151], v[56:59]
s_waitcnt lgkmcnt(8)
ds_read_b64_tr_b16 a[246:247], v6 offset:33544
v_max3_f32 v36, v36, v48, v49
v_mfma_f32_16x16x32_bf16 v[52:55], a[248:251], a[136:139], v[52:55]
ds_read_b64_tr_b16 a[244:245], v6 offset:33032
buffer_load_dwordx4 v14, s[16:19], 0 offen offset:128 lds
v_mfma_f32_16x16x32_bf16 v[56:59], a[248:251], a[152:155], v[56:59]
s_waitcnt lgkmcnt(8)
ds_read_b64_tr_b16 a[250:251], v7 offset:33536
s_mov_b32 m0, s41
v_mfma_f32_16x16x32_bf16 v[52:55], a[252:255], a[140:143], v[52:55]
ds_read_b64_tr_b16 a[248:249], v7 offset:33024
v_max3_f32 v36, v36, v50, v51
v_mfma_f32_16x16x32_bf16 v[56:59], a[252:255], a[156:159], v[56:59]
s_waitcnt lgkmcnt(9)
ds_read_b64_tr_b16 a[254:255], v7 offset:33544
v_add_u32 v14, s67, v14
v_mfma_f32_16x16x32_bf16 v[60:63], a[224:227], v[84:87], 0
s_waitcnt lgkmcnt(9)
ds_read_b64_tr_b16 a[252:253], v7 offset:33032
v_max3_f32 v32, v32, v52, v53
v_mfma_f32_16x16x32_bf16 v[60:63], a[228:231], v[88:91], v[60:63]
s_waitcnt lgkmcnt(9)
ds_read_b64_tr_b16 a[226:227], v8 offset:33536
v_max3_f32 v32, v32, v54, v55
v_mfma_f32_16x16x32_bf16 v[60:63], a[232:235], v[92:95], v[60:63]
s_waitcnt lgkmcnt(9)
ds_read_b64_tr_b16 a[224:225], v8 offset:33024
v_max3_f32 v36, v36, v56, v57
v_mfma_f32_16x16x32_bf16 v[60:63], a[236:239], v[96:99], v[60:63]
s_waitcnt lgkmcnt(8)
ds_read_b64_tr_b16 a[230:231], v8 offset:33544
v_max3_f32 v36, v36, v58, v59
v_mfma_f32_16x16x32_bf16 v[100:103], a[240:243], a[48:51], v[100:103]
s_and_b32 s62, s62, 0x3fffff
s_cselect_b32 s67, 0x40000, s61
ds_read_b64_tr_b16 a[228:229], v8 offset:33032
v_mfma_f32_16x16x32_bf16 v[104:107], a[240:243], a[112:115], v[104:107]
ds_read_b64_tr_b16 a[234:235], v9 offset:33536
v_max3_f32 v40, v40, v60, v61
v_mfma_f32_16x16x32_bf16 v[164:167], a[240:243], v[76:79], v[164:167]
s_waitcnt lgkmcnt(9)
ds_read_b64_tr_b16 a[232:233], v9 offset:33024
v_max3_f32 v40, v40, v62, v63
v_mfma_f32_16x16x32_bf16 v[108:111], a[244:247], a[48:51], v[108:111]
ds_read_b64_tr_b16 a[238:239], v9 offset:33544
v_mfma_f32_16x16x32_bf16 v[112:115], a[244:247], a[112:115], v[112:115]
ds_read_b64_tr_b16 a[236:237], v9 offset:33032
v_mfma_f32_16x16x32_bf16 v[168:171], a[244:247], v[76:79], v[168:171]
s_waitcnt lgkmcnt(10)
v_mfma_f32_16x16x32_bf16 v[116:119], a[248:251], a[48:51], v[116:119]
v_mfma_f32_16x16x32_bf16 v[120:123], a[248:251], a[112:115], v[120:123]
s_waitcnt lgkmcnt(8)
v_mfma_f32_16x16x32_bf16 v[124:127], a[252:255], a[48:51], v[124:127]
v_mfma_f32_16x16x32_bf16 v[128:131], a[252:255], a[112:115], v[128:131]
s_waitcnt lgkmcnt(6)
s_waitcnt lgkmcnt(0) vmcnt(8)
s_barrier
ds_read_b128 a[240:243], v0 offset:8192
v_mfma_f32_16x16x32_bf16 v[132:135], a[224:227], a[48:51], v[132:135]
ds_read_b128 a[244:247], v1 offset:8192
buffer_load_dwordx4 v12, s[8:11], 0 offen nt lds
v_mfma_f32_16x16x32_bf16 v[136:139], a[224:227], a[112:115], v[136:139]
s_add_u32 m0, s41, 3968
ds_read_b128 a[248:251], v2 offset:8192
v_mfma_f32_16x16x32_bf16 v[140:143], a[228:231], a[48:51], v[140:143]
ds_read_b128 a[252:255], v3 offset:8192
v_mfma_f32_16x16x32_bf16 v[144:147], a[228:231], a[112:115], v[144:147]
ds_read_b128 a[224:227], v0 offset:8704
v_mfma_f32_16x16x32_bf16 v[148:151], a[232:235], a[48:51], v[148:151]
ds_read_b128 a[228:231], v1 offset:8704
buffer_load_dwordx4 v12, s[8:11], 0 offen offset:128 nt lds
v_mfma_f32_16x16x32_bf16 v[152:155], a[232:235], a[112:115], v[152:155]
s_add_u32 m0, s42, 33024
ds_read_b128 a[232:235], v2 offset:8704
v_add_u32 v12, s7, v12
v_mfma_f32_16x16x32_bf16 v[156:159], a[236:239], a[48:51], v[156:159]
s_and_b32 s43, s43, 0x1ffff
s_cselect_b32 s7, s4, s5
ds_read_b128 v[76:79], v252 offset:12288
v_mfma_f32_16x16x32_bf16 v[160:163], a[236:239], a[112:115], v[160:163]
s_waitcnt lgkmcnt(7)
ds_read_b128 a[236:239], v3 offset:8704
v_mfma_f32_16x16x32_bf16 v[44:47], a[240:243], a[128:131], 0
v_mfma_f32_16x16x32_bf16 v[48:51], a[240:243], a[144:147], 0
s_waitcnt lgkmcnt(7)
ds_read_b64_tr_b16 a[242:243], v6 offset:41792
v_mfma_f32_16x16x32_bf16 v[44:47], a[244:247], a[132:135], v[44:47]
ds_read_b64_tr_b16 a[240:241], v6 offset:41280
v_mfma_f32_16x16x32_bf16 v[48:51], a[244:247], a[148:151], v[48:51]
s_waitcnt lgkmcnt(8)
ds_read_b64_tr_b16 a[246:247], v6 offset:41800
v_mfma_f32_16x16x32_bf16 v[44:47], a[248:251], a[136:139], v[44:47]
ds_read_b64_tr_b16 a[244:245], v6 offset:41288
v_mfma_f32_16x16x32_bf16 v[48:51], a[248:251], a[152:155], v[48:51]
s_waitcnt lgkmcnt(9)
ds_read_b64_tr_b16 a[250:251], v7 offset:41792
v_mfma_f32_16x16x32_bf16 v[44:47], a[252:255], a[140:143], v[44:47]
ds_read_b64_tr_b16 a[248:249], v7 offset:41280
v_mfma_f32_16x16x32_bf16 v[48:51], a[252:255], a[156:159], v[48:51]
s_waitcnt lgkmcnt(10)
ds_read_b64_tr_b16 a[254:255], v7 offset:41800
v_mfma_f32_16x16x32_bf16 v[52:55], a[224:227], a[128:131], 0
ds_read_b64_tr_b16 a[252:253], v7 offset:41288
buffer_load_dwordx4 v14, s[16:19], 0 offen lds
v_mfma_f32_16x16x32_bf16 v[56:59], a[224:227], a[144:147], 0
s_waitcnt lgkmcnt(11)
ds_read_b64_tr_b16 a[226:227], v8 offset:41792
s_add_u32 m0, s42, 37024
v_mfma_f32_16x16x32_bf16 v[52:55], a[228:231], a[132:135], v[52:55]
ds_read_b64_tr_b16 a[224:225], v8 offset:41280
v_max3_f32 v32, v32, v44, v45
v_mfma_f32_16x16x32_bf16 v[56:59], a[228:231], a[148:151], v[56:59]
s_waitcnt lgkmcnt(12)
ds_read_b64_tr_b16 a[230:231], v8 offset:41800
v_max3_f32 v32, v32, v46, v47
v_mfma_f32_16x16x32_bf16 v[52:55], a[232:235], a[136:139], v[52:55]
ds_read_b64_tr_b16 a[228:229], v8 offset:41288
buffer_load_dwordx4 v14, s[16:19], 0 offen offset:128 lds
v_mfma_f32_16x16x32_bf16 v[56:59], a[232:235], a[152:155], v[56:59]
s_waitcnt lgkmcnt(12)
ds_read_b64_tr_b16 a[234:235], v9 offset:41792
s_add_u32 m0, s41, 8192
v_mfma_f32_16x16x32_bf16 v[52:55], a[236:239], a[140:143], v[52:55]
ds_read_b64_tr_b16 a[232:233], v9 offset:41280
v_max3_f32 v36, v36, v48, v49
v_mfma_f32_16x16x32_bf16 v[56:59], a[236:239], a[156:159], v[56:59]
s_waitcnt lgkmcnt(12)
ds_read_b64_tr_b16 a[238:239], v9 offset:41800
v_max3_f32 v36, v36, v50, v51
v_mfma_f32_16x16x32_bf16 v[100:103], a[240:243], a[52:55], v[100:103]
ds_read_b64_tr_b16 a[236:237], v9 offset:41288
v_max3_f32 v32, v32, v52, v53
v_mfma_f32_16x16x32_bf16 v[104:107], a[240:243], a[116:119], v[104:107]
v_max3_f32 v32, v32, v54, v55
v_max3_f32 v36, v36, v56, v57
v_mfma_f32_16x16x32_bf16 v[164:167], a[240:243], v[76:79], v[164:167]
s_waitcnt lgkmcnt(12)
v_max3_f32 v36, v36, v58, v59
v_add_u32 v14, 0x40000, v14
v_mfma_f32_16x16x32_bf16 v[108:111], a[244:247], a[52:55], v[108:111]
v_mfma_f32_16x16x32_bf16 v[112:115], a[244:247], a[116:119], v[112:115]
v_mfma_f32_16x16x32_bf16 v[168:171], a[244:247], v[76:79], v[168:171]
s_waitcnt lgkmcnt(10)
v_mfma_f32_16x16x32_bf16 v[116:119], a[248:251], a[52:55], v[116:119]
v_mfma_f32_16x16x32_bf16 v[120:123], a[248:251], a[116:119], v[120:123]
s_waitcnt lgkmcnt(8)
v_mfma_f32_16x16x32_bf16 v[124:127], a[252:255], a[52:55], v[124:127]
v_mfma_f32_16x16x32_bf16 v[128:131], a[252:255], a[116:119], v[128:131]
s_waitcnt lgkmcnt(6)
s_waitcnt lgkmcnt(0) vmcnt(6)
s_barrier
ds_read_b128 a[240:243], v0 offset:16384
v_mfma_f32_16x16x32_bf16 v[132:135], a[224:227], a[52:55], v[132:135]
ds_read_b128 a[244:247], v1 offset:16384
buffer_load_dwordx4 v12, s[8:11], 0 offen nt lds
v_mfma_f32_16x16x32_bf16 v[136:139], a[224:227], a[116:119], v[136:139]
s_add_u32 m0, s41, 12160
ds_read_b128 a[248:251], v2 offset:16384
v_mfma_f32_16x16x32_bf16 v[140:143], a[228:231], a[52:55], v[140:143]
ds_read_b128 a[252:255], v3 offset:16384
v_mfma_f32_16x16x32_bf16 v[144:147], a[228:231], a[116:119], v[144:147]
ds_read_b128 a[224:227], v0 offset:16896
v_mfma_f32_16x16x32_bf16 v[148:151], a[232:235], a[52:55], v[148:151]
ds_read_b128 a[228:231], v1 offset:16896
buffer_load_dwordx4 v12, s[8:11], 0 offen offset:128 nt lds
v_mfma_f32_16x16x32_bf16 v[152:155], a[232:235], a[116:119], v[152:155]
s_add_u32 m0, s42, 41280
ds_read_b128 a[232:235], v2 offset:16896
v_add_u32 v12, s6, v12
v_mfma_f32_16x16x32_bf16 v[156:159], a[236:239], a[52:55], v[156:159]
ds_read_b128 v[76:79], v251 offset:14336
v_mfma_f32_16x16x32_bf16 v[160:163], a[236:239], a[116:119], v[160:163]
s_waitcnt lgkmcnt(7)
ds_read_b128 a[236:239], v3 offset:16896
v_mfma_f32_16x16x32_bf16 v[44:47], a[240:243], a[128:131], 0
v_mfma_f32_16x16x32_bf16 v[48:51], a[240:243], a[144:147], 0
s_waitcnt lgkmcnt(7)
ds_read_b128 a[240:243], v4 offset:16384
v_mfma_f32_16x16x32_bf16 v[44:47], a[244:247], a[132:135], v[44:47]
v_mfma_f32_16x16x32_bf16 v[48:51], a[244:247], a[148:151], v[48:51]
s_waitcnt lgkmcnt(7)
ds_read_b128 a[244:247], v5 offset:16384
v_mfma_f32_16x16x32_bf16 v[44:47], a[248:251], a[136:139], v[44:47]
v_mfma_f32_16x16x32_bf16 v[48:51], a[248:251], a[152:155], v[48:51]
s_waitcnt lgkmcnt(7)
ds_read_b128 a[248:251], v4 offset:20480
v_mfma_f32_16x16x32_bf16 v[44:47], a[252:255], a[140:143], v[44:47]
v_mfma_f32_16x16x32_bf16 v[48:51], a[252:255], a[156:159], v[48:51]
s_waitcnt lgkmcnt(7)
ds_read_b128 a[252:255], v5 offset:20480
v_mfma_f32_16x16x32_bf16 v[52:55], a[224:227], a[128:131], 0
buffer_load_dwordx4 v14, s[16:19], 0 offen lds
s_add_u32 m0, s42, 45280
v_mfma_f32_16x16x32_bf16 v[56:59], a[224:227], a[144:147], 0
s_waitcnt lgkmcnt(7)
ds_read_b64_tr_b16 a[224:225], v6 offset:49536
ds_read_b64_tr_b16 a[226:227], v6 offset:50048
v_mfma_f32_16x16x32_bf16 v[52:55], a[228:231], a[132:135], v[52:55]
v_max3_f32 v32, v32, v44, v45
v_max3_f32 v32, v32, v46, v47
v_mfma_f32_16x16x32_bf16 v[56:59], a[228:231], a[148:151], v[56:59]
s_waitcnt lgkmcnt(8)
ds_read_b64_tr_b16 a[230:231], v6 offset:50056
v_max3_f32 v36, v36, v48, v49
v_mfma_f32_16x16x32_bf16 v[52:55], a[232:235], a[136:139], v[52:55]
ds_read_b64_tr_b16 a[228:229], v6 offset:49544
buffer_load_dwordx4 v14, s[16:19], 0 offen offset:128 lds
v_mfma_f32_16x16x32_bf16 v[56:59], a[232:235], a[152:155], v[56:59]
s_waitcnt lgkmcnt(8)
ds_read_b64_tr_b16 a[234:235], v7 offset:50048
s_add_u32 m0, s41, 16384
v_mfma_f32_16x16x32_bf16 v[52:55], a[236:239], a[140:143], v[52:55]
ds_read_b64_tr_b16 a[232:233], v7 offset:49536
v_max3_f32 v36, v36, v50, v51
v_mfma_f32_16x16x32_bf16 v[56:59], a[236:239], a[156:159], v[56:59]
s_waitcnt lgkmcnt(9)
ds_read_b64_tr_b16 a[238:239], v7 offset:50056
v_add_u32 v14, s67, v14
v_mfma_f32_16x16x32_bf16 v[60:63], a[240:243], v[84:87], 0
s_waitcnt lgkmcnt(9)
ds_read_b64_tr_b16 a[236:237], v7 offset:49544
v_max3_f32 v32, v32, v52, v53
v_mfma_f32_16x16x32_bf16 v[60:63], a[244:247], v[88:91], v[60:63]
s_waitcnt lgkmcnt(9)
ds_read_b64_tr_b16 a[242:243], v8 offset:50048
v_max3_f32 v32, v32, v54, v55
v_mfma_f32_16x16x32_bf16 v[60:63], a[248:251], v[92:95], v[60:63]
s_waitcnt lgkmcnt(9)
ds_read_b64_tr_b16 a[240:241], v8 offset:49536
v_max3_f32 v36, v36, v56, v57
v_mfma_f32_16x16x32_bf16 v[60:63], a[252:255], v[96:99], v[60:63]
s_waitcnt lgkmcnt(8)
ds_read_b64_tr_b16 a[246:247], v8 offset:50056
v_max3_f32 v36, v36, v58, v59
v_mfma_f32_16x16x32_bf16 v[100:103], a[224:227], a[56:59], v[100:103]
ds_read_b64_tr_b16 a[244:245], v8 offset:49544
v_mfma_f32_16x16x32_bf16 v[104:107], a[224:227], a[120:123], v[104:107]
ds_read_b64_tr_b16 a[250:251], v9 offset:50048
v_mfma_f32_16x16x32_bf16 v[164:167], a[224:227], v[76:79], v[164:167]
s_waitcnt lgkmcnt(9)
ds_read_b64_tr_b16 a[248:249], v9 offset:49536
v_max3_f32 v40, v40, v60, v61
v_mfma_f32_16x16x32_bf16 v[108:111], a[228:231], a[56:59], v[108:111]
ds_read_b64_tr_b16 a[254:255], v9 offset:50056
v_max3_f32 v40, v40, v62, v63
v_mfma_f32_16x16x32_bf16 v[112:115], a[228:231], a[120:123], v[112:115]
ds_read_b64_tr_b16 a[252:253], v9 offset:49544
v_mfma_f32_16x16x32_bf16 v[168:171], a[228:231], v[76:79], v[168:171]
s_waitcnt lgkmcnt(10)
v_mfma_f32_16x16x32_bf16 v[116:119], a[232:235], a[56:59], v[116:119]
v_mfma_f32_16x16x32_bf16 v[120:123], a[232:235], a[120:123], v[120:123]
s_waitcnt lgkmcnt(8)
v_mfma_f32_16x16x32_bf16 v[124:127], a[236:239], a[56:59], v[124:127]
v_mfma_f32_16x16x32_bf16 v[128:131], a[236:239], a[120:123], v[128:131]
s_waitcnt lgkmcnt(6)
s_waitcnt lgkmcnt(0) vmcnt(8)
s_barrier
ds_read_b128 a[224:227], v0 offset:24576
v_mfma_f32_16x16x32_bf16 v[132:135], a[240:243], a[56:59], v[132:135]
ds_read_b128 a[228:231], v1 offset:24576
buffer_load_dwordx4 v12, s[8:11], 0 offen nt lds
v_mfma_f32_16x16x32_bf16 v[136:139], a[240:243], a[120:123], v[136:139]
s_add_u32 m0, s41, 20352
ds_read_b128 a[232:235], v2 offset:24576
v_mfma_f32_16x16x32_bf16 v[140:143], a[244:247], a[56:59], v[140:143]
ds_read_b128 a[236:239], v3 offset:24576
v_mfma_f32_16x16x32_bf16 v[144:147], a[244:247], a[120:123], v[144:147]
ds_read_b128 a[240:243], v0 offset:25088
v_mfma_f32_16x16x32_bf16 v[148:151], a[248:251], a[56:59], v[148:151]
ds_read_b128 a[244:247], v1 offset:25088
buffer_load_dwordx4 v12, s[8:11], 0 offen offset:128 nt lds
v_mfma_f32_16x16x32_bf16 v[152:155], a[248:251], a[120:123], v[152:155]
s_add_u32 m0, s42, 49536
ds_read_b128 a[248:251], v2 offset:25088
v_add_u32 v12, s7, v12
v_mfma_f32_16x16x32_bf16 v[156:159], a[252:255], a[56:59], v[156:159]
ds_read_b128 v[76:79], v252 offset:14336
v_mfma_f32_16x16x32_bf16 v[160:163], a[252:255], a[120:123], v[160:163]
s_waitcnt lgkmcnt(7)
ds_read_b128 a[252:255], v3 offset:25088
v_mfma_f32_16x16x32_bf16 v[44:47], a[224:227], a[128:131], 0
v_mfma_f32_16x16x32_bf16 v[48:51], a[224:227], a[144:147], 0
s_waitcnt lgkmcnt(7)
ds_read_b64_tr_b16 a[226:227], v6 offset:58304
v_mfma_f32_16x16x32_bf16 v[44:47], a[228:231], a[132:135], v[44:47]
ds_read_b64_tr_b16 a[224:225], v6 offset:57792
v_mfma_f32_16x16x32_bf16 v[48:51], a[228:231], a[148:151], v[48:51]
s_waitcnt lgkmcnt(8)
ds_read_b64_tr_b16 a[230:231], v6 offset:58312
v_mfma_f32_16x16x32_bf16 v[44:47], a[232:235], a[136:139], v[44:47]
ds_read_b64_tr_b16 a[228:229], v6 offset:57800
v_mfma_f32_16x16x32_bf16 v[48:51], a[232:235], a[152:155], v[48:51]
s_waitcnt lgkmcnt(9)
ds_read_b64_tr_b16 a[234:235], v7 offset:58304
v_mfma_f32_16x16x32_bf16 v[44:47], a[236:239], a[140:143], v[44:47]
ds_read_b64_tr_b16 a[232:233], v7 offset:57792
v_mfma_f32_16x16x32_bf16 v[48:51], a[236:239], a[156:159], v[48:51]
s_waitcnt lgkmcnt(10)
ds_read_b64_tr_b16 a[238:239], v7 offset:58312
v_mfma_f32_16x16x32_bf16 v[52:55], a[240:243], a[128:131], 0
ds_read_b64_tr_b16 a[236:237], v7 offset:57800
buffer_load_dwordx4 v14, s[16:19], 0 offen lds
v_mfma_f32_16x16x32_bf16 v[56:59], a[240:243], a[144:147], 0
s_waitcnt lgkmcnt(11)
ds_read_b64_tr_b16 a[242:243], v8 offset:58304
v_max3_f32 v32, v32, v44, v45
v_mfma_f32_16x16x32_bf16 v[52:55], a[244:247], a[132:135], v[52:55]
s_add_u32 m0, s42, 53536
ds_read_b64_tr_b16 a[240:241], v8 offset:57792
v_max3_f32 v32, v32, v46, v47
v_mfma_f32_16x16x32_bf16 v[56:59], a[244:247], a[148:151], v[56:59]
s_waitcnt lgkmcnt(12)
ds_read_b64_tr_b16 a[246:247], v8 offset:58312
v_max3_f32 v36, v36, v48, v49
v_mfma_f32_16x16x32_bf16 v[52:55], a[248:251], a[136:139], v[52:55]
ds_read_b64_tr_b16 a[244:245], v8 offset:57800
buffer_load_dwordx4 v14, s[16:19], 0 offen offset:128 lds
v_mfma_f32_16x16x32_bf16 v[56:59], a[248:251], a[152:155], v[56:59]
s_waitcnt lgkmcnt(12)
ds_read_b64_tr_b16 a[250:251], v9 offset:58304
v_max3_f32 v36, v36, v50, v51
v_mfma_f32_16x16x32_bf16 v[52:55], a[252:255], a[140:143], v[52:55]
ds_read_b64_tr_b16 a[248:249], v9 offset:57792
v_add_u32 v14, 0x40000, v14
v_mfma_f32_16x16x32_bf16 v[56:59], a[252:255], a[156:159], v[56:59]
s_waitcnt lgkmcnt(12)
ds_read_b64_tr_b16 a[254:255], v9 offset:58312
v_mfma_f32_16x16x32_bf16 v[100:103], a[224:227], a[60:63], v[100:103]
ds_read_b64_tr_b16 a[252:253], v9 offset:57800
v_mfma_f32_16x16x32_bf16 v[104:107], a[224:227], a[124:127], v[104:107]
v_max3_f32 v32, v32, v52, v53
v_max3_f32 v32, v32, v54, v55
v_mov_b32 v74, v32
v_mfma_f32_16x16x32_bf16 v[164:167], a[224:227], v[76:79], v[164:167]
s_waitcnt lgkmcnt(12)
v_permlane32_swap_b32 v32, v74
v_max_f32 v32, v32, v74
v_mov_b32 v74, v32
v_mfma_f32_16x16x32_bf16 v[108:111], a[228:231], a[60:63], v[108:111]
v_max3_f32 v36, v36, v56, v57
v_permlane16_swap_b32 v32, v74
v_max_f32 v32, v32, v74
v_max3_f32 v36, v36, v58, v59
v_mov_b32 v74, v36
v_mfma_f32_16x16x32_bf16 v[112:115], a[228:231], a[124:127], v[112:115]
v_mul_f32 v165, s48, v165
v_permlane32_swap_b32 v36, v74
v_max_f32 v36, v36, v74
v_mfma_f32_16x16x32_bf16 v[168:171], a[228:231], v[76:79], v[168:171]
s_waitcnt lgkmcnt(10)
v_mov_b32 v74, v36
v_mul_f32 v164, s48, v164
v_mfma_f32_16x16x32_bf16 v[116:119], a[232:235], a[60:63], v[116:119]
v_permlane16_swap_b32 v36, v74
v_max_f32 v36, v36, v74
v_mov_b32 v74, v40
v_mfma_f32_16x16x32_bf16 v[120:123], a[232:235], a[124:127], v[120:123]
s_waitcnt lgkmcnt(8)
v_permlane32_swap_b32 v40, v74
v_max_f32 v40, v40, v74
v_mfma_f32_16x16x32_bf16 v[124:127], a[236:239], a[60:63], v[124:127]
v_mov_b32 v74, v40
v_cvt_pk_bf16_f32 v164, v164, v165
v_mfma_f32_16x16x32_bf16 v[128:131], a[236:239], a[124:127], v[128:131]
s_waitcnt lgkmcnt(6)
v_permlane16_swap_b32 v40, v74
v_mul_f32 v167, s48, v167
v_mfma_f32_16x16x32_bf16 v[132:135], a[240:243], a[60:63], v[132:135]
v_mul_f32 v166, s48, v166
v_max_f32 v40, v40, v74
v_mfma_f32_16x16x32_bf16 v[136:139], a[240:243], a[124:127], v[136:139]
s_waitcnt lgkmcnt(4)
v_cvt_pk_bf16_f32 v165, v166, v167
v_mul_f32 v171, s48, v171
v_mfma_f32_16x16x32_bf16 v[140:143], a[244:247], a[60:63], v[140:143]
v_mul_f32 v170, s48, v170
v_mul_f32 v169, s48, v169
v_mfma_f32_16x16x32_bf16 v[144:147], a[244:247], a[124:127], v[144:147]
s_waitcnt lgkmcnt(2)
v_mul_f32 v168, s48, v168
v_cvt_pk_bf16_f32 v167, v170, v171
v_mfma_f32_16x16x32_bf16 v[148:151], a[248:251], a[60:63], v[148:151]
v_cvt_pk_bf16_f32 v166, v168, v169
v_mfma_f32_16x16x32_bf16 v[152:155], a[248:251], a[124:127], v[152:155]
s_waitcnt lgkmcnt(0)
v_mfma_f32_16x16x32_bf16 v[156:159], a[252:255], a[60:63], v[156:159]
ds_write_b32 v75, v40 offset:2048
v_mfma_f32_16x16x32_bf16 v[160:163], a[252:255], a[124:127], v[160:163]
ds_write_b32 v75, v36 offset:1024
ds_write_b32 v75, v32 offset:0
ds_write_b128 v15, v[164:167] offset:33024
s_cmp_ge_u32 s47, 1
s_cselect_b32 s45, s75, s45
s_cselect_b32 s44, s75, s44
s_add_u32 s47, s47, 1
s_cmp_lt_u32 s47, 4
s_cbranch_scc1 L_cround
s_waitcnt vmcnt(0) lgkmcnt(0)
s_barrier
s_mov_b32 s97, 2
v_lshrrev_b32 v0, 4, v253
s_lshl_b32 s3, s40, 6
v_add_u32 v0, s3, v0
s_branch L_restart
.section .rodata,"a"
.p2align 6
.amdhsa_kernel concat_heads__mha_block_cached__mha_block_cached__near_ridge_kernel
  .amdhsa_next_free_vgpr 512
  .amdhsa_next_free_sgpr 102
  .amdhsa_accum_offset 256
  .amdhsa_group_segment_fixed_size 0
  .amdhsa_kernarg_size 104
  .amdhsa_user_sgpr_count 2
  .amdhsa_user_sgpr_kernarg_segment_ptr 1
  .amdhsa_system_sgpr_workgroup_id_x 1
.end_amdhsa_kernel
```
